```python
import torch

def _softmax(x, axis=-1):
    return torch.softmax(x, dim=axis)
def _gelu(x):
    return torch.nn.functional.gelu(x, approximate="tanh")
def _silu(x):
    return torch.nn.functional.silu(x)
def _sigmoid(x):
    return torch.sigmoid(x)
def _layernorm(x, axis=-1, eps=1e-5):
    m = x.mean(dim=axis, keepdim=True)
    v = x.var(dim=axis, keepdim=True, unbiased=False)
    return (x - m) / torch.sqrt(v + eps)
def _scatter_add(tgt, idx, src, axis=0):
    return tgt.clone().index_add_(axis, idx, src)
def _segment_sum(src, seg, n):
    out = torch.zeros((n,) + src.shape[1:], dtype=src.dtype)
    return out.index_add_(0, seg, src)
def _pad(x, pw):
    flat = tuple(v for pair in reversed(pw) for v in pair)
    return torch.nn.functional.pad(x, flat)

kernel_name = 'gated_mix__compressed_kv_cla__dense_activation_mish__prompt'

def setup_inputs():

    _w = (lambda a: (lambda t: t.to(torch.bfloat16) if t.is_floating_point() else t)(torch.as_tensor(a)))
    def _A_setup():
        B, H, Sq, Sk, D, M = 1, 32, 2048, 2048, 128, 512
        Dc = 4 * D
        return {
            "x": _w((lambda *s: torch.randn(*s, dtype=torch.bfloat16) * 0.05)(B, Sq, M)),
            "c_kv": _w((lambda *s: torch.randn(*s, dtype=torch.bfloat16) * 0.2)(B, Sk, Dc)),
            "w_q": _w((lambda *s: torch.randn(*s, dtype=torch.bfloat16) * 12.8)(M, H, D) * (M ** -0.5)),
            "w_uk": _w((lambda *s: torch.randn(*s, dtype=torch.bfloat16) * 12.8)(Dc, H, D) * (Dc ** -0.5)),
            "w_uv": _w((lambda *s: torch.randn(*s, dtype=torch.bfloat16) * 0.2)(Dc, H, D) * (Dc ** -0.5)),
            "w_o": _w((lambda *s: torch.randn(*s, dtype=torch.bfloat16) * 0.2)(H, D, M) * ((H * D) ** -0.5)),
        }
    _A_in = _A_setup()

    def _B_setup():
        B, S, D, F = 1, 2048, 512, 1792
        return {
            "x": _w((lambda *s: torch.randn(*s, dtype=torch.bfloat16) * 0.05)(B, S, D)),
            "w1": _w((lambda *s: torch.randn(*s, dtype=torch.bfloat16) * 6.4)(D, F) * (D ** -0.5)),
            "b1": _w((lambda *s: torch.randn(*s, dtype=torch.bfloat16) * 0.05)(F)),
            "w2": _w((lambda *s: torch.randn(*s, dtype=torch.bfloat16) * 0.05)(F, D) * (F ** -0.5)),
        }
    _B_in = _B_setup()

    return {
        "A_x": _A_in["x"],
        "A_c_kv": _A_in["c_kv"],
        "A_w_q": _A_in["w_q"],
        "A_w_uk": _A_in["w_uk"],
        "A_w_uv": _A_in["w_uv"],
        "A_w_o": _A_in["w_o"],
        "B_x": _B_in["x"],
        "B_w1": _B_in["w1"],
        "B_b1": _B_in["b1"],
        "B_w2": _B_in["w2"],
        "gate_w": _w((lambda *s: torch.randn(*s, dtype=torch.bfloat16) * 0.05)(512) * 16.0),
    }

def reference(A_x, A_c_kv, A_w_q, A_w_uk, A_w_uv, A_w_o, B_x, B_w1, B_b1, B_w2, gate_w):
    def _A_ref(x, c_kv, w_q, w_uk, w_uv, w_o):
        B, Sq, M = x.shape[0], x.shape[1], x.shape[2]
        Sk = c_kv.shape[1]
        H, D = w_q.shape[1], w_q.shape[2]
        q = torch.einsum("bqm,mhd->bhqd", x, w_q)
        k = torch.einsum("bkc,chd->bhkd", c_kv, w_uk)
        v = torch.einsum("bkc,chd->bhkd", c_kv, w_uv)
        scores = torch.einsum("bhqd,bhkd->bhqk", q, k) * (D ** -0.5)
        off = Sk - Sq
        qi = torch.arange(Sq)[:, None]
        kj = torch.arange(Sk)[None, :]
        cmask = kj <= (qi + off)
        scores = torch.where(cmask[None, None], scores, -1e9)
        p = _softmax(scores, axis=-1)
        ctx = torch.einsum("bhqk,bhkd->bhqd", p, v)
        return torch.einsum("bhqd,hdm->bqm", ctx, w_o)

    def _B_ref(x, w1, b1, w2):
        h = torch.einsum("bsd,df->bsf", x, w1) + b1
        sp = torch.log1p(torch.exp(-torch.abs(h))) + torch.where(h > 0, h, torch.zeros_like(h))
        act = h * torch.tanh(sp)
        return torch.einsum("bsf,fd->bsd", act, w2)

    x = A_x
    g = _sigmoid((x * gate_w).sum(-1, keepdims=True))
    a = _A_ref(x, A_c_kv, A_w_q, A_w_uk, A_w_uv, A_w_o)
    b = _B_ref(x, B_w1, B_b1, B_w2)
    return g * a + (1 - g) * b
```

```asm
; @launch grid=(256,1,1) block=(256,1,1) lds=163840
.amdgcn_target "amdgcn-amd-amdhsa--gfx950"
.text
.globl gated_mix__compressed_kv_cla__dense_activation_mish__prompt_kernel
.p2align 8
.type gated_mix__compressed_kv_cla__dense_activation_mish__prompt_kernel,@function
gated_mix__compressed_kv_cla__dense_activation_mish__prompt_kernel:
    s_load_dwordx2 s[12:13], s[0:1], 8
    s_load_dwordx2 s[20:21], s[0:1], 24
    s_load_dwordx2 s[56:57], s[0:1], 32
    s_cmp_ge_u32 s2, 256
    s_cbranch_scc0 L_go
    s_endpgm
L_go:
    s_getpc_b64 s[90:91]
L_pc:
    v_lshrrev_b32 v3, 6, v0
    v_and_b32 v1, 63, v0
    v_readfirstlane_b32 s60, v3
    v_min_u32 v30, 5, v1
    v_lshlrev_b32 v30, 7, v30
    s_lshr_b32 s70, s2, 3
    s_lshl_b32 s70, s70, 2
    s_add_u32 s70, s70, s60
    s_mul_i32 s70, s70, 768
    v_add_u32 v30, s70, v30
    v_min_u32 v30, L_codeend - L_pc - 4, v30
    global_load_dword v55, v30, s[90:91]
    s_mov_b32 s14, 2097152
    s_mov_b32 s15, 0x20000
    s_mov_b32 s22, 4194304
    s_mov_b32 s23, 0x20000
    s_mov_b32 s58, 4194304
    s_mov_b32 s59, 0x20000
    s_and_b32 s69, s2, 7
    s_lshr_b32 s70, s2, 3
    s_and_b32 s61, s70, 3
    s_lshl_b32 s69, s69, 2
    s_add_u32 s61, s61, s69
    s_lshr_b32 s62, s70, 2
    s_lshl_b32 s63, s60, 13
    v_lshrrev_b32 v30, 4, v1
    v_and_b32 v31, 15, v1
    v_lshlrev_b32 v32, 1, v30
    v_xor_b32 v31, v31, v32
    v_lshlrev_b32 v31, 4, v31
    v_lshl_add_u32 v31, v30, 13, v31
    v_add_u32 v4, 0, v31
    v_add_u32 v5, 31744, v31
    v_xor_b32 v6, 128, v31
    v_add_u32 v6, 63488, v6
    v_xor_b32 v7, 128, v31
    v_add_u32 v7, 95232, v7
    v_and_b32 v31, 7, v1
    v_xor_b32 v32, v31, v30
    v_lshlrev_b32 v32, 4, v32
    v_lshrrev_b32 v33, 3, v1
    v_lshl_add_u32 v32, v33, 10, v32
    v_add_u32 v8, 0, v32
    v_xor_b32 v9, 64, v32
    v_add_u32 v9, 7168, v9
    v_add_u32 v10, 14336, v32
    v_xor_b32 v11, 64, v32
    v_add_u32 v11, 21504, v11
    s_lshl_b32 s64, s60, 17
    s_lshl_b32 s70, s61, 8
    s_add_u32 s64, s64, s70
    s_lshl_b32 s65, s62, 18
    s_lshl_b32 s70, s60, 16
    s_add_u32 s65, s65, s70
    s_lshl_b32 s80, s60, 12
    s_waitcnt lgkmcnt(0)
    s_add_u32 m0, s63, 98304
    s_nop 0
    buffer_load_dwordx4 v8, s[12:15], s65 offen offset:0 lds
    buffer_load_dwordx4 v9, s[12:15], s65 offen offset:1024 lds
    buffer_load_dwordx4 v10, s[12:15], s65 offen offset:2048 lds
    buffer_load_dwordx4 v11, s[12:15], s65 offen offset:3072 lds
    s_add_u32 s70, s65, 32768
    s_add_u32 m0, s63, 102400
    s_nop 0
    buffer_load_dwordx4 v8, s[12:15], s70 offen offset:0 lds
    buffer_load_dwordx4 v9, s[12:15], s70 offen offset:1024 lds
    buffer_load_dwordx4 v10, s[12:15], s70 offen offset:2048 lds
    buffer_load_dwordx4 v11, s[12:15], s70 offen offset:3072 lds
    s_add_u32 s65, s65, 128
    s_add_u32 m0, s80, 0
    s_nop 0
    buffer_load_dwordx4 v4, s[20:23], s64 offen offset:0 nt lds
    buffer_load_dwordx4 v5, s[20:23], s64 offen offset:1024 nt lds
    buffer_load_dwordx4 v6, s[20:23], s64 offen offset:2048 nt lds
    buffer_load_dwordx4 v7, s[20:23], s64 offen offset:3072 nt lds
    s_add_u32 m0, s80, 16384
    s_nop 0
    buffer_load_dwordx4 v4, s[56:59], s64 offen offset:0 nt lds
    buffer_load_dwordx4 v5, s[56:59], s64 offen offset:1024 nt lds
    buffer_load_dwordx4 v6, s[56:59], s64 offen offset:2048 nt lds
    buffer_load_dwordx4 v7, s[56:59], s64 offen offset:3072 nt lds
    s_add_u32 s64, s64, 524288
    s_load_dwordx2 s[8:9], s[0:1], 0
    s_load_dwordx2 s[16:17], s[0:1], 16
    s_load_dwordx2 s[24:25], s[0:1], 40
    s_load_dwordx2 s[28:29], s[0:1], 56
    s_load_dwordx2 s[32:33], s[0:1], 64
    s_load_dwordx2 s[36:37], s[0:1], 72
    s_load_dwordx2 s[40:41], s[0:1], 80
    s_load_dwordx2 s[44:45], s[0:1], 88
    s_load_dwordx2 s[52:53], s[0:1], 96
    s_load_dwordx2 s[48:49], s[0:1], 104
    s_mov_b32 s10, 2097152
    s_mov_b32 s11, 0x20000
    s_mov_b32 s18, 4194304
    s_mov_b32 s19, 0x20000
    s_mov_b32 s26, 4194304
    s_mov_b32 s27, 0x20000
    s_mov_b32 s30, 1835008
    s_mov_b32 s31, 0x20000
    s_mov_b32 s34, 3584
    s_mov_b32 s35, 0x20000
    s_mov_b32 s38, 1835008
    s_mov_b32 s39, 0x20000
    s_mov_b32 s46, 2097152
    s_mov_b32 s47, 0x20000
    s_mov_b32 s50, 100663296
    s_mov_b32 s51, 0x20000
    s_mov_b32 s54, 256
    s_mov_b32 s55, 0x20000
    s_lshr_b32 s69, s61, 2
    s_and_b32 s70, s62, 1
    s_add_u32 s71, s69, 1
    s_sub_u32 s71, s71, s70
    s_lshr_b32 s71, s71, 1
    s_sub_u32 s42, s61, s71
    s_lshl_b32 s70, s70, 2
    s_add_u32 s70, s70, 3
    s_and_b32 s71, s61, 7
    s_lshr_b32 s69, s69, 1
    s_add_u32 s69, s69, 28
    s_cmp_eq_u32 s70, s71
    s_cselect_b32 s42, s69, s42
    v_lshlrev_b32 v2, 4, v1
    s_waitcnt lgkmcnt(0)
    s_mul_i32 s69, s60, 24
    v_min_u32 v31, 23, v1
    v_add_u32 v31, s69, v31
    s_and_b32 s69, s61, 3
    s_lshl_b32 s70, s62, 2
    s_add_u32 s70, s70, s69
    s_lshl_b32 s70, s70, 16
    v_lshlrev_b32 v32, 10, v31
    v_add_u32 v32, s70, v32
    v_mov_b32 v40, s12
    v_mov_b32 v41, s13
    v_mov_b32 v42, 128
    s_lshl_b32 s70, s62, 16
    s_lshl_b32 s71, s61, 8
    s_add_u32 s70, s70, s71
    v_and_b32 v33, 14, v31
    v_lshlrev_b32 v33, 12, v33
    v_and_b32 v34, 1, v31
    v_lshl_add_u32 v33, v34, 7, v33
    v_add_u32 v33, s70, v33
    v_cmp_le_u32 vcc, 64, v31
    v_mov_b32 v34, s20
    v_mov_b32 v35, s21
    v_mov_b32 v30, 524288
    v_cndmask_b32 v32, v32, v33, vcc
    v_cndmask_b32 v40, v40, v34, vcc
    v_cndmask_b32 v41, v41, v35, vcc
    v_cndmask_b32 v42, v42, v30, vcc
    v_cmp_le_u32 vcc, 80, v31
    v_mov_b32 v34, s56
    v_mov_b32 v35, s57
    v_cndmask_b32 v40, v40, v34, vcc
    v_cndmask_b32 v41, v41, v35, vcc
    v_add_co_u32 v40, vcc, v40, v32
    s_nop 1
    v_addc_co_u32 v41, vcc, 0, v41, vcc
    v_add_co_u32 v40, vcc, v40, v42
    s_nop 1
    v_addc_co_u32 v41, vcc, 0, v41, vcc
    v_add_co_u32 v40, vcc, v40, v42
    s_nop 1
    v_addc_co_u32 v41, vcc, 0, v41, vcc
    v_add_co_u32 v40, vcc, v40, v42
    s_nop 1
    v_addc_co_u32 v41, vcc, 0, v41, vcc
    s_mul_i32 s69, s60, 24
    v_min_u32 v31, 23, v1
    v_add_u32 v31, s69, v31
    s_and_b32 s69, s61, 3
    s_lshl_b32 s70, s62, 1
    s_sub_u32 s71, 28, s70
    s_cmp_ge_u32 s69, 2
    s_cselect_b32 s70, s71, s70
    s_add_u32 s70, s70, s69
    s_lshl_b32 s70, s70, 16
    v_lshlrev_b32 v32, 10, v31
    v_add_u32 v32, s70, v32
    v_mov_b32 v43, s8
    v_mov_b32 v44, s9
    v_mov_b32 v45, 128
    s_lshl_b32 s70, s62, 16
    s_lshl_b32 s71, s61, 8
    s_add_u32 s70, s70, s71
    v_and_b32 v33, 14, v31
    v_lshlrev_b32 v33, 12, v33
    v_and_b32 v34, 1, v31
    v_lshl_add_u32 v33, v34, 7, v33
    v_add_u32 v33, s70, v33
    v_cmp_le_u32 vcc, 64, v31
    v_mov_b32 v34, s16
    v_mov_b32 v35, s17
    v_mov_b32 v30, 524288
    v_cndmask_b32 v32, v32, v33, vcc
    v_cndmask_b32 v43, v43, v34, vcc
    v_cndmask_b32 v44, v44, v35, vcc
    v_cndmask_b32 v45, v45, v30, vcc
    v_cmp_le_u32 vcc, 80, v31
    v_mov_b32 v34, s28
    v_mov_b32 v35, s29
    s_mul_i32 s70, s62, 28672
    s_min_u32 s71, s42, 27
    s_lshl_b32 s71, s71, 7
    s_add_u32 s70, s70, s71
    v_and_b32 v33, 7, v31
    v_mul_u32_u24 v33, 3584, v33
    v_add_u32 v33, s70, v33
    v_mov_b32 v30, 229376
    v_cndmask_b32 v32, v32, v33, vcc
    v_cndmask_b32 v45, v45, v30, vcc
    v_cndmask_b32 v43, v43, v34, vcc
    v_cndmask_b32 v44, v44, v35, vcc
    v_add_co_u32 v43, vcc, v43, v32
    s_nop 1
    v_addc_co_u32 v44, vcc, 0, v44, vcc
    v_lshrrev_b32 v30, 4, v1
    v_lshlrev_b32 v30, 3, v30
    s_lshl_b32 s69, s42, 7
    buffer_load_dwordx2 v[56:57], v30, s[32:35], s69 offen offset:0
    buffer_load_dwordx2 v[58:59], v30, s[32:35], s69 offen offset:32
    buffer_load_dwordx2 v[60:61], v30, s[32:35], s69 offen offset:64
    buffer_load_dwordx2 v[62:63], v30, s[32:35], s69 offen offset:96
    s_lshl_b32 s69, s2, 7
    s_add_u32 s69, s69, 58785792
    v_mov_b32 v30, 1073741824
    v_mov_b32 v31, s69
    v_cmp_eq_u32 vcc, 0, v0
    s_nop 1
    v_cndmask_b32 v14, v30, v31, vcc
    v_mov_b32 v15, 0
    s_cmp_lt_u32 s2, 128
    s_cselect_b32 s69, 32768, 1073741824
    buffer_store_dword v15, v14, s[48:51], s69 offen sc1
    s_lshl_b32 s69, s61, 7
    s_add_u32 s69, s69, 58785792
    v_mov_b32 v30, 1073741824
    v_mov_b32 v31, s69
    v_cmp_eq_u32 vcc, 0, v0
    s_nop 1
    v_cndmask_b32 v52, v30, v31, vcc
    v_mov_b32 v53, s69
    s_cmp_eq_u32 s62, 0
    s_cselect_b32 s3, 0, 1073741824
    buffer_store_dword v15, v52, s[48:51], s3 offen sc1
    s_add_u32 m0, s80, 32768
    s_nop 0
    buffer_load_dwordx4 v4, s[20:23], s64 offen offset:0 nt lds
    buffer_load_dwordx4 v5, s[20:23], s64 offen offset:1024 nt lds
    buffer_load_dwordx4 v6, s[20:23], s64 offen offset:2048 nt lds
    buffer_load_dwordx4 v7, s[20:23], s64 offen offset:3072 nt lds
    s_add_u32 m0, s80, 49152
    s_nop 0
    buffer_load_dwordx4 v4, s[56:59], s64 offen offset:0 nt lds
    buffer_load_dwordx4 v5, s[56:59], s64 offen offset:1024 nt lds
    buffer_load_dwordx4 v6, s[56:59], s64 offen offset:2048 nt lds
    buffer_load_dwordx4 v7, s[56:59], s64 offen offset:3072 nt lds
    s_add_u32 s64, s64, 524288
    s_add_u32 m0, s63, 131072
    s_nop 0
    buffer_load_dwordx4 v8, s[12:15], s65 offen offset:0 lds
    buffer_load_dwordx4 v9, s[12:15], s65 offen offset:1024 lds
    buffer_load_dwordx4 v10, s[12:15], s65 offen offset:2048 lds
    buffer_load_dwordx4 v11, s[12:15], s65 offen offset:3072 lds
    s_add_u32 s70, s65, 32768
    s_add_u32 m0, s63, 135168
    s_nop 0
    buffer_load_dwordx4 v8, s[12:15], s70 offen offset:0 lds
    buffer_load_dwordx4 v9, s[12:15], s70 offen offset:1024 lds
    buffer_load_dwordx4 v10, s[12:15], s70 offen offset:2048 lds
    buffer_load_dwordx4 v11, s[12:15], s70 offen offset:3072 lds
    s_add_u32 s65, s65, 128
    v_lshrrev_b32 v30, 4, v1
    v_and_b32 v31, 7, v1
    v_lshrrev_b32 v33, 3, v1
    v_and_b32 v32, 1, v30
    v_lshlrev_b32 v32, 1, v32
    v_xor_b32 v32, v31, v32
    s_mov_b32 s74, 229376
    s_cmp_eq_u32 s42, 28
    s_cbranch_scc1 L_w1gate
    v_lshlrev_b32 v32, 4, v32
    v_mul_u32_u24 v33, 3584, v33
    v_add_u32 v12, v32, v33
    v_xor_b32 v32, 64, v32
    v_add_u32 v13, v32, v33
    v_add_u32 v13, 27648, v13
    s_branch L_w1done
L_w1gate:
    s_mov_b32 s74, 128
    s_sub_u32 s28, s40, 1024
    s_subb_u32 s29, s41, 0
    s_mov_b32 s30, 2048
    v_and_b32 v34, 1, v33
    v_and_b32 v33, 6, v33
    v_lshlrev_b32 v33, 1, v33
    v_mov_b32 v35, 1073741824
    v_cmp_eq_u32 vcc, v32, v34
    v_add_u32 v30, 1024, v33
    v_xor_b32 v32, 4, v32
    v_cndmask_b32 v12, v35, v30, vcc
    v_cmp_eq_u32 vcc, v32, v34
    v_add_u32 v30, 16, v33
    s_nop 0
    v_cndmask_b32 v13, v35, v30, vcc
L_w1done:
    s_mov_b32 s95, s64
    s_and_b32 s84, s2, 3
    s_lshr_b32 s69, s2, 3
    s_and_b32 s86, s69, 3
    s_lshr_b32 s85, s69, 2
    s_and_b32 s70, s2, 4
    s_lshl_b32 s70, s70, 1
    s_add_u32 s85, s85, s70
    s_lshl_b32 s87, s85, 2
    s_add_u32 s87, s87, s86
    s_lshl_b32 s67, s87, 18
    s_lshl_b32 s69, s60, 12
    s_add_u32 s67, s67, s69
    s_add_u32 s67, s67, 67108864
    s_lshl_b32 s69, s84, 14
    s_add_u32 s64, s67, s69
    s_lshl_b32 s69, s84, 16
    s_add_u32 s67, s67, s69
    s_add_u32 s69, s84, 1
    s_and_b32 s69, s69, 3
    s_lshl_b32 s69, s69, 14
    s_add_u32 s70, s67, s69
    s_add_u32 s69, s84, 2
    s_and_b32 s69, s69, 3
    s_lshl_b32 s69, s69, 14
    s_add_u32 s71, s67, s69
    s_add_u32 s69, s84, 3
    s_and_b32 s69, s69, 3
    s_lshl_b32 s69, s69, 14
    s_add_u32 s72, s67, s69
    s_mov_b32 s64, s95
    s_mov_b32 s92, s70
    s_mov_b32 s93, s71
    s_mov_b32 s94, s72
    v_mov_b32 v48, -1
    v_mov_b32 v49, -1
    v_mov_b32 v50, -1
    v_mov_b32 v51, -1
    s_lshl_b32 s66, s61, 20
    s_lshl_b32 s70, s62, 17
    s_add_u32 s66, s66, s70
    s_lshl_b32 s70, s60, 15
    s_add_u32 s66, s66, s70
    s_add_u32 s72, s63, 98304
    v_lshrrev_b32 v30, 4, v1
    v_and_b32 v31, 15, v1
    v_lshrrev_b32 v32, 1, v31
    v_xor_b32 v32, v32, v30
    v_lshlrev_b32 v32, 4, v32
    v_lshl_add_u32 v32, v31, 7, v32
    v_add_u32 v24, s72, v32
    v_xor_b32 v25, 64, v24
    v_lshrrev_b32 v32, 2, v31
    v_lshl_add_u32 v33, v30, 3, v32
    v_and_b32 v34, 1, v30
    v_lshl_add_u32 v32, v34, 2, v32
    v_lshlrev_b32 v32, 5, v32
    v_lshl_add_u32 v32, v33, 8, v32
    v_and_b32 v34, 3, v31
    v_lshl_add_u32 v32, v34, 3, v32
    v_add_u32 v32, 0, v32
    v_xor_b32 v16, 0, v32
    v_xor_b32 v17, 32, v32
    v_xor_b32 v18, 64, v32
    v_xor_b32 v19, 96, v32
    v_xor_b32 v20, 128, v32
    v_xor_b32 v21, 160, v32
    v_xor_b32 v22, 192, v32
    v_xor_b32 v23, 224, v32
    v_lshrrev_b32 v32, 3, v31
    v_and_b32 v30, 1, v30
    v_lshl_add_u32 v32, v30, 1, v32
    v_lshlrev_b32 v32, 5, v32
    v_lshl_add_u32 v32, v33, 7, v32
    v_lshl_add_u32 v32, v34, 3, v32
    v_add_u32 v32, 16384, v32
    v_xor_b32 v26, 0, v32
    v_xor_b32 v27, 32, v32
    v_xor_b32 v28, 64, v32
    v_xor_b32 v29, 96, v32
    v_add_u32 v26, 65536, v26
    v_add_u32 v27, 65536, v27
    v_add_u32 v28, 65536, v28
    v_add_u32 v29, 65536, v29
    s_lshl_b32 s69, s62, 1
    s_sub_u32 s70, 28, s69
    s_cmp_ge_u32 s60, 2
    s_cselect_b32 s73, s70, s69
    s_add_u32 s73, s73, s60
    s_lshl_b32 s95, s73, 16
    s_mul_i32 s67, s60, 57344
    s_lshl_b32 s69, s42, 7
    s_add_u32 s67, s67, s69
    s_cmp_ge_u32 s42, 28
    s_cselect_b32 s67, 1073741824, s67
    s_lshl_b32 s69, s60, 5
    s_cmp_eq_u32 s42, 28
    s_cselect_b32 s67, s69, s67
    s_and_b32 s69, s61, 15
    s_lshl_b32 s69, s69, 2
    s_lshr_b32 s70, s61, 4
    s_lshl_b32 s70, s70, 7
    s_add_u32 s69, s69, s70
    v_mov_b32 v30, 1073741824
    v_mov_b32 v31, s69
    v_cmp_eq_u32 vcc, 0, v0
    s_nop 1
    v_cndmask_b32 v14, v30, v31, vcc
    v_mov_b32 v15, s69
    s_waitcnt vmcnt(26)
    s_barrier
    ds_read_b128 a[192:195], v24 offset:0
    ds_read_b128 a[196:199], v25 offset:0
    ds_read_b128 a[200:203], v24 offset:2048
    ds_read_b128 a[204:207], v25 offset:2048
    ds_read_b128 a[208:211], v24 offset:4096
    ds_read_b128 a[212:215], v25 offset:4096
    ds_read_b128 a[216:219], v24 offset:6144
    ds_read_b128 a[220:223], v25 offset:6144
    ds_read_b64_tr_b16 a[160:161], v16 offset:0
    ds_read_b64_tr_b16 a[162:163], v16 offset:1024
    ds_read_b64_tr_b16 a[164:165], v16 offset:8192
    ds_read_b64_tr_b16 a[166:167], v16 offset:9216
    ds_read_b64_tr_b16 a[168:169], v17 offset:0
    ds_read_b64_tr_b16 a[170:171], v17 offset:1024
    ds_read_b64_tr_b16 a[172:173], v17 offset:8192
    ds_read_b64_tr_b16 a[174:175], v17 offset:9216
    ds_read_b64_tr_b16 a[176:177], v18 offset:0
    ds_read_b64_tr_b16 a[178:179], v18 offset:1024
    ds_read_b64_tr_b16 a[180:181], v18 offset:8192
    ds_read_b64_tr_b16 a[182:183], v18 offset:9216
    s_waitcnt lgkmcnt(8)
    v_mfma_f32_16x16x32_bf16 v[88:91], a[160:163], a[192:195], 0
    ds_read_b64_tr_b16 a[184:185], v19 offset:0
    v_mov_b32 v30, 1
    v_mfma_f32_16x16x32_bf16 v[88:91], a[164:167], a[196:199], v[88:91]
    s_mov_b32 s72, 1040356334
    v_mfma_f32_16x16x32_bf16 v[80:83], a[164:167], a[204:207], 0
    s_add_u32 m0, s80, 65536
    ds_read_b64_tr_b16 a[186:187], v19 offset:1024
    v_mfma_f32_16x16x32_bf16 v[80:83], a[160:163], a[200:203], v[80:83]
    buffer_load_dwordx4 v4, s[20:23], s64 offen offset:0 nt lds
    v_mfma_f32_16x16x32_bf16 v[72:75], a[160:163], a[208:211], 0
    ds_read_b64_tr_b16 a[188:189], v19 offset:8192
    v_mfma_f32_16x16x32_bf16 v[72:75], a[164:167], a[212:215], v[72:75]
    v_mfma_f32_16x16x32_bf16 v[64:67], a[164:167], a[220:223], 0
    ds_read_b64_tr_b16 a[190:191], v19 offset:9216
    v_mfma_f32_16x16x32_bf16 v[64:67], a[160:163], a[216:219], v[64:67]
    s_waitcnt lgkmcnt(8)
    buffer_load_dwordx4 v5, s[20:23], s64 offen offset:1024 nt lds
    v_mfma_f32_16x16x32_bf16 v[68:71], a[168:171], a[216:219], 0
    ds_read_b64_tr_b16 a[160:161], v20 offset:0
    v_mfma_f32_16x16x32_bf16 v[68:71], a[172:175], a[220:223], v[68:71]
    v_mfma_f32_16x16x32_bf16 v[76:79], a[172:175], a[212:215], 0
    ds_read_b64_tr_b16 a[162:163], v20 offset:1024
    v_mfma_f32_16x16x32_bf16 v[76:79], a[168:171], a[208:211], v[76:79]
    buffer_load_dwordx4 v6, s[20:23], s64 offen offset:2048 nt lds
    v_mfma_f32_16x16x32_bf16 v[84:87], a[168:171], a[200:203], 0
    ds_read_b64_tr_b16 a[164:165], v20 offset:8192
    v_mfma_f32_16x16x32_bf16 v[84:87], a[172:175], a[204:207], v[84:87]
    v_mfma_f32_16x16x32_bf16 v[92:95], a[172:175], a[196:199], 0
    ds_read_b64_tr_b16 a[166:167], v20 offset:9216
    v_mfma_f32_16x16x32_bf16 v[92:95], a[168:171], a[192:195], v[92:95]
    s_waitcnt lgkmcnt(8)
    buffer_load_dwordx4 v7, s[20:23], s64 offen offset:3072 nt lds
    v_mfma_f32_16x16x32_bf16 v[120:123], a[176:179], a[192:195], 0
    ds_read_b64_tr_b16 a[168:169], v21 offset:0
    v_mfma_f32_16x16x32_bf16 v[120:123], a[180:183], a[196:199], v[120:123]
    v_mfma_f32_16x16x32_bf16 v[112:115], a[180:183], a[204:207], 0
    s_add_u32 m0, s80, 81920
    ds_read_b64_tr_b16 a[170:171], v21 offset:1024
    v_mfma_f32_16x16x32_bf16 v[112:115], a[176:179], a[200:203], v[112:115]
    buffer_load_dwordx4 v4, s[56:59], s64 offen offset:0 nt lds
    v_mfma_f32_16x16x32_bf16 v[104:107], a[176:179], a[208:211], 0
    ds_read_b64_tr_b16 a[172:173], v21 offset:8192
    v_mfma_f32_16x16x32_bf16 v[104:107], a[180:183], a[212:215], v[104:107]
    v_mfma_f32_16x16x32_bf16 v[96:99], a[180:183], a[220:223], 0
    ds_read_b64_tr_b16 a[174:175], v21 offset:9216
    v_mfma_f32_16x16x32_bf16 v[96:99], a[176:179], a[216:219], v[96:99]
    s_waitcnt lgkmcnt(8)
    buffer_load_dwordx4 v5, s[56:59], s64 offen offset:1024 nt lds
    v_mfma_f32_16x16x32_bf16 v[100:103], a[184:187], a[216:219], 0
    ds_read_b64_tr_b16 a[176:177], v22 offset:0
    v_mfma_f32_16x16x32_bf16 v[100:103], a[188:191], a[220:223], v[100:103]
    v_mfma_f32_16x16x32_bf16 v[108:111], a[188:191], a[212:215], 0
    ds_read_b64_tr_b16 a[178:179], v22 offset:1024
    v_mfma_f32_16x16x32_bf16 v[108:111], a[184:187], a[208:211], v[108:111]
    buffer_load_dwordx4 v6, s[56:59], s64 offen offset:2048 nt lds
    v_mfma_f32_16x16x32_bf16 v[116:119], a[184:187], a[200:203], 0
    ds_read_b64_tr_b16 a[180:181], v22 offset:8192
    v_mfma_f32_16x16x32_bf16 v[116:119], a[188:191], a[204:207], v[116:119]
    v_mfma_f32_16x16x32_bf16 v[124:127], a[188:191], a[196:199], 0
    ds_read_b64_tr_b16 a[182:183], v22 offset:9216
    v_mfma_f32_16x16x32_bf16 v[124:127], a[184:187], a[192:195], v[124:127]
    s_waitcnt lgkmcnt(8)
    buffer_load_dwordx4 v7, s[56:59], s64 offen offset:3072 nt lds
    v_mfma_f32_16x16x32_bf16 v[152:155], a[160:163], a[192:195], 0
    s_add_u32 s64, s64, 524288
    ds_read_b64_tr_b16 a[184:185], v23 offset:0
    v_mfma_f32_16x16x32_bf16 v[152:155], a[164:167], a[196:199], v[152:155]
    v_mfma_f32_16x16x32_bf16 v[144:147], a[164:167], a[204:207], 0
    s_add_u32 m0, s63, 98304
    ds_read_b64_tr_b16 a[186:187], v23 offset:1024
    v_mfma_f32_16x16x32_bf16 v[144:147], a[160:163], a[200:203], v[144:147]
    buffer_load_dwordx4 v8, s[12:15], s65 offen offset:0 lds
    v_mfma_f32_16x16x32_bf16 v[136:139], a[160:163], a[208:211], 0
    ds_read_b64_tr_b16 a[188:189], v23 offset:8192
    v_mfma_f32_16x16x32_bf16 v[136:139], a[164:167], a[212:215], v[136:139]
    v_mfma_f32_16x16x32_bf16 v[128:131], a[164:167], a[220:223], 0
    s_waitcnt vmcnt(31)
    ds_read_b64_tr_b16 a[190:191], v23 offset:9216
    v_mfma_f32_16x16x32_bf16 v[128:131], a[160:163], a[216:219], v[128:131]
    s_waitcnt lgkmcnt(8)
    buffer_load_dwordx4 v9, s[12:15], s65 offen offset:1024 lds
    v_mfma_f32_16x16x32_bf16 v[132:135], a[168:171], a[216:219], 0
    s_barrier
    ds_read_b64_tr_b16 a[160:161], v16 offset:16384
    v_mfma_f32_16x16x32_bf16 v[132:135], a[172:175], a[220:223], v[132:135]
    v_mfma_f32_16x16x32_bf16 v[140:143], a[172:175], a[212:215], 0
    ds_read_b64_tr_b16 a[162:163], v16 offset:17408
    v_mfma_f32_16x16x32_bf16 v[140:143], a[168:171], a[208:211], v[140:143]
    buffer_load_dwordx4 v10, s[12:15], s65 offen offset:2048 lds
    v_mfma_f32_16x16x32_bf16 v[148:151], a[168:171], a[200:203], 0
    ds_read_b64_tr_b16 a[164:165], v16 offset:24576
    v_mfma_f32_16x16x32_bf16 v[148:151], a[172:175], a[204:207], v[148:151]
    v_mfma_f32_16x16x32_bf16 v[156:159], a[172:175], a[196:199], 0
    ds_read_b64_tr_b16 a[166:167], v16 offset:25600
    v_mfma_f32_16x16x32_bf16 v[156:159], a[168:171], a[192:195], v[156:159]
    s_waitcnt lgkmcnt(8)
    buffer_load_dwordx4 v11, s[12:15], s65 offen offset:3072 lds
    v_mfma_f32_16x16x32_bf16 v[184:187], a[176:179], a[192:195], 0
    ds_read_b64_tr_b16 a[168:169], v17 offset:16384
    v_mfma_f32_16x16x32_bf16 v[184:187], a[180:183], a[196:199], v[184:187]
    s_add_u32 s70, s65, 32768
    v_mfma_f32_16x16x32_bf16 v[176:179], a[180:183], a[204:207], 0
    s_add_u32 m0, s63, 102400
    ds_read_b64_tr_b16 a[170:171], v17 offset:17408
    v_mfma_f32_16x16x32_bf16 v[176:179], a[176:179], a[200:203], v[176:179]
    buffer_load_dwordx4 v8, s[12:15], s70 offen offset:0 lds
    v_mfma_f32_16x16x32_bf16 v[168:171], a[176:179], a[208:211], 0
    ds_read_b64_tr_b16 a[172:173], v17 offset:24576
    v_mfma_f32_16x16x32_bf16 v[168:171], a[180:183], a[212:215], v[168:171]
    v_mfma_f32_16x16x32_bf16 v[160:163], a[180:183], a[220:223], 0
    ds_read_b64_tr_b16 a[174:175], v17 offset:25600
    v_mfma_f32_16x16x32_bf16 v[160:163], a[176:179], a[216:219], v[160:163]
    s_waitcnt lgkmcnt(8)
    buffer_load_dwordx4 v9, s[12:15], s70 offen offset:1024 lds
    v_mfma_f32_16x16x32_bf16 v[164:167], a[184:187], a[216:219], 0
    ds_read_b64_tr_b16 a[176:177], v18 offset:16384
    v_mfma_f32_16x16x32_bf16 v[164:167], a[188:191], a[220:223], v[164:167]
    v_mfma_f32_16x16x32_bf16 v[172:175], a[188:191], a[212:215], 0
    ds_read_b64_tr_b16 a[178:179], v18 offset:17408
    v_mfma_f32_16x16x32_bf16 v[172:175], a[184:187], a[208:211], v[172:175]
    buffer_load_dwordx4 v10, s[12:15], s70 offen offset:2048 lds
    v_mfma_f32_16x16x32_bf16 v[180:183], a[184:187], a[200:203], 0
    ds_read_b64_tr_b16 a[180:181], v18 offset:24576
    v_mfma_f32_16x16x32_bf16 v[180:183], a[188:191], a[204:207], v[180:183]
    v_mfma_f32_16x16x32_bf16 v[188:191], a[188:191], a[196:199], 0
    ds_read_b64_tr_b16 a[182:183], v18 offset:25600
    v_mfma_f32_16x16x32_bf16 v[188:191], a[184:187], a[192:195], v[188:191]
    s_waitcnt lgkmcnt(8)
    buffer_load_dwordx4 v11, s[12:15], s70 offen offset:3072 lds
    v_mfma_f32_16x16x32_bf16 a[0:3], a[192:195], a[160:163], 0
    s_add_u32 s65, s65, 128
    ds_read_b64_tr_b16 a[184:185], v19 offset:16384
    v_mfma_f32_16x16x32_bf16 a[0:3], a[196:199], a[164:167], a[0:3]
    v_mfma_f32_16x16x32_bf16 a[4:7], a[204:207], a[164:167], 0
    ds_read_b64_tr_b16 a[186:187], v19 offset:17408
    v_mfma_f32_16x16x32_bf16 a[4:7], a[200:203], a[160:163], a[4:7]
    global_load_dword v55, v[40:41], off
    v_mfma_f32_16x16x32_bf16 a[64:67], a[208:211], a[160:163], 0
    ds_read_b64_tr_b16 a[188:189], v19 offset:24576
    v_mfma_f32_16x16x32_bf16 a[64:67], a[212:215], a[164:167], a[64:67]
    v_add_co_u32 v40, vcc, v40, v42
    v_mfma_f32_16x16x32_bf16 a[68:71], a[220:223], a[164:167], 0
    ds_read_b64_tr_b16 a[190:191], v19 offset:25600
    v_mfma_f32_16x16x32_bf16 a[68:71], a[216:219], a[160:163], a[68:71]
    s_waitcnt lgkmcnt(8)
    v_addc_co_u32 v41, vcc, 0, v41, vcc
    v_mfma_f32_16x16x32_bf16 a[76:79], a[216:219], a[168:171], 0
    ds_read_b64_tr_b16 a[160:161], v20 offset:16384
    v_mfma_f32_16x16x32_bf16 a[76:79], a[220:223], a[172:175], a[76:79]
    v_mfma_f32_16x16x32_bf16 a[72:75], a[212:215], a[172:175], 0
    ds_read_b64_tr_b16 a[162:163], v20 offset:17408
    v_mfma_f32_16x16x32_bf16 a[72:75], a[208:211], a[168:171], a[72:75]
    v_mfma_f32_16x16x32_bf16 a[12:15], a[200:203], a[168:171], 0
    ds_read_b64_tr_b16 a[164:165], v20 offset:24576
    v_mfma_f32_16x16x32_bf16 a[12:15], a[204:207], a[172:175], a[12:15]
    v_mfma_f32_16x16x32_bf16 a[8:11], a[196:199], a[172:175], 0
    ds_read_b64_tr_b16 a[166:167], v20 offset:25600
    v_mfma_f32_16x16x32_bf16 a[8:11], a[192:195], a[168:171], a[8:11]
    s_waitcnt lgkmcnt(8)
    v_mfma_f32_16x16x32_bf16 a[16:19], a[192:195], a[176:179], 0
    ds_read_b64_tr_b16 a[168:169], v21 offset:16384
    v_mfma_f32_16x16x32_bf16 a[16:19], a[196:199], a[180:183], a[16:19]
    v_mfma_f32_16x16x32_bf16 a[20:23], a[204:207], a[180:183], 0
    ds_read_b64_tr_b16 a[170:171], v21 offset:17408
    v_mfma_f32_16x16x32_bf16 a[20:23], a[200:203], a[176:179], a[20:23]
    v_mfma_f32_16x16x32_bf16 a[80:83], a[208:211], a[176:179], 0
    ds_read_b64_tr_b16 a[172:173], v21 offset:24576
    v_mfma_f32_16x16x32_bf16 a[80:83], a[212:215], a[180:183], a[80:83]
    v_mfma_f32_16x16x32_bf16 a[84:87], a[220:223], a[180:183], 0
    ds_read_b64_tr_b16 a[174:175], v21 offset:25600
    v_mfma_f32_16x16x32_bf16 a[84:87], a[216:219], a[176:179], a[84:87]
    s_waitcnt lgkmcnt(8)
    v_mfma_f32_16x16x32_bf16 a[92:95], a[216:219], a[184:187], 0
    ds_read_b64_tr_b16 a[176:177], v22 offset:16384
    v_mfma_f32_16x16x32_bf16 a[92:95], a[220:223], a[188:191], a[92:95]
    v_mfma_f32_16x16x32_bf16 a[88:91], a[212:215], a[188:191], 0
    ds_read_b64_tr_b16 a[178:179], v22 offset:17408
    v_mfma_f32_16x16x32_bf16 a[88:91], a[208:211], a[184:187], a[88:91]
    v_mfma_f32_16x16x32_bf16 a[28:31], a[200:203], a[184:187], 0
    ds_read_b64_tr_b16 a[180:181], v22 offset:24576
    v_mfma_f32_16x16x32_bf16 a[28:31], a[204:207], a[188:191], a[28:31]
    v_mfma_f32_16x16x32_bf16 a[24:27], a[196:199], a[188:191], 0
    ds_read_b64_tr_b16 a[182:183], v22 offset:25600
    v_mfma_f32_16x16x32_bf16 a[24:27], a[192:195], a[184:187], a[24:27]
    s_waitcnt lgkmcnt(8)
    v_mfma_f32_16x16x32_bf16 a[32:35], a[192:195], a[160:163], 0
    ds_read_b64_tr_b16 a[184:185], v23 offset:16384
    ds_read_b64_tr_b16 a[186:187], v23 offset:17408
    v_mfma_f32_16x16x32_bf16 a[32:35], a[196:199], a[164:167], a[32:35]
    v_mfma_f32_16x16x32_bf16 a[36:39], a[204:207], a[164:167], 0
    ds_read_b64_tr_b16 a[188:189], v23 offset:24576
    v_mfma_f32_16x16x32_bf16 a[36:39], a[200:203], a[160:163], a[36:39]
    v_mfma_f32_16x16x32_bf16 a[96:99], a[208:211], a[160:163], 0
    ds_read_b64_tr_b16 a[190:191], v23 offset:25600
    v_mfma_f32_16x16x32_bf16 a[96:99], a[212:215], a[164:167], a[96:99]
    v_mfma_f32_16x16x32_bf16 a[100:103], a[220:223], a[164:167], 0
    v_mfma_f32_16x16x32_bf16 a[100:103], a[216:219], a[160:163], a[100:103]
    s_waitcnt vmcnt(17) lgkmcnt(0)
    v_mfma_f32_16x16x32_bf16 a[108:111], a[216:219], a[168:171], 0
    s_barrier
    ds_read_b64_tr_b16 a[160:161], v16 offset:32768
    v_mfma_f32_16x16x32_bf16 a[108:111], a[220:223], a[172:175], a[108:111]
    ds_read_b128 a[224:227], v24 offset:32768
    ds_read_b128 a[228:231], v25 offset:32768
    v_mfma_f32_16x16x32_bf16 a[104:107], a[212:215], a[172:175], 0
    s_add_u32 m0, s80, 0
    ds_read_b64_tr_b16 a[162:163], v16 offset:33792
    v_mfma_f32_16x16x32_bf16 a[104:107], a[208:211], a[168:171], a[104:107]
    buffer_load_dwordx4 v4, s[20:23], s64 offen offset:0 lds
    v_mfma_f32_16x16x32_bf16 a[44:47], a[200:203], a[168:171], 0
    ds_read_b64_tr_b16 a[164:165], v16 offset:40960
    v_mfma_f32_16x16x32_bf16 a[44:47], a[204:207], a[172:175], a[44:47]
    ds_read_b128 a[232:235], v24 offset:34816
    ds_read_b128 a[236:239], v25 offset:34816
    v_mfma_f32_16x16x32_bf16 a[40:43], a[196:199], a[172:175], 0
    ds_read_b64_tr_b16 a[166:167], v16 offset:41984
    v_mfma_f32_16x16x32_bf16 a[40:43], a[192:195], a[168:171], a[40:43]
    buffer_load_dwordx4 v5, s[20:23], s64 offen offset:1024 lds
    v_mfma_f32_16x16x32_bf16 a[48:51], a[192:195], a[176:179], 0
    ds_read_b64_tr_b16 a[168:169], v17 offset:32768
    v_mfma_f32_16x16x32_bf16 a[48:51], a[196:199], a[180:183], a[48:51]
    ds_read_b128 a[240:243], v24 offset:36864
    ds_read_b128 a[244:247], v25 offset:36864
    v_mfma_f32_16x16x32_bf16 a[52:55], a[204:207], a[180:183], 0
    ds_read_b64_tr_b16 a[170:171], v17 offset:33792
    v_mfma_f32_16x16x32_bf16 a[52:55], a[200:203], a[176:179], a[52:55]
    buffer_load_dwordx4 v6, s[20:23], s64 offen offset:2048 lds
    v_mfma_f32_16x16x32_bf16 a[112:115], a[208:211], a[176:179], 0
    ds_read_b64_tr_b16 a[172:173], v17 offset:40960
    v_mfma_f32_16x16x32_bf16 a[112:115], a[212:215], a[180:183], a[112:115]
    ds_read_b128 a[248:251], v24 offset:38912
    ds_read_b128 a[252:255], v25 offset:38912
    v_mfma_f32_16x16x32_bf16 a[116:119], a[220:223], a[180:183], 0
    ds_read_b64_tr_b16 a[174:175], v17 offset:41984
    v_mfma_f32_16x16x32_bf16 a[116:119], a[216:219], a[176:179], a[116:119]
    buffer_load_dwordx4 v7, s[20:23], s64 offen offset:3072 lds
    v_mfma_f32_16x16x32_bf16 a[124:127], a[216:219], a[184:187], 0
    ds_read_b64_tr_b16 a[176:177], v18 offset:32768
    v_mfma_f32_16x16x32_bf16 a[124:127], a[220:223], a[188:191], a[124:127]
    buffer_atomic_add v30, v14, s[52:55], s3 offen sc1
    v_mfma_f32_16x16x32_bf16 a[120:123], a[212:215], a[188:191], 0
    s_add_u32 m0, s80, 16384
    ds_read_b64_tr_b16 a[178:179], v18 offset:33792
    v_mfma_f32_16x16x32_bf16 a[120:123], a[208:211], a[184:187], a[120:123]
    buffer_load_dwordx4 v4, s[56:59], s64 offen offset:0 lds
    v_mfma_f32_16x16x32_bf16 a[60:63], a[200:203], a[184:187], 0
    ds_read_b64_tr_b16 a[180:181], v18 offset:40960
    v_mfma_f32_16x16x32_bf16 a[60:63], a[204:207], a[188:191], a[60:63]
    v_mfma_f32_16x16x32_bf16 a[56:59], a[196:199], a[188:191], 0
    ds_read_b64_tr_b16 a[182:183], v18 offset:41984
    v_mfma_f32_16x16x32_bf16 a[56:59], a[192:195], a[184:187], a[56:59]
    s_waitcnt lgkmcnt(5)
    buffer_load_dwordx4 v5, s[56:59], s64 offen offset:1024 lds
    v_mfma_f32_16x16x32_bf16 v[88:91], a[160:163], a[224:227], v[88:91]
    ds_read_b64_tr_b16 a[184:185], v19 offset:32768
    v_mfma_f32_16x16x32_bf16 v[88:91], a[164:167], a[228:231], v[88:91]
    v_mfma_f32_16x16x32_bf16 v[80:83], a[164:167], a[236:239], v[80:83]
    ds_read_b64_tr_b16 a[186:187], v19 offset:33792
    v_mfma_f32_16x16x32_bf16 v[80:83], a[160:163], a[232:235], v[80:83]
    buffer_load_dwordx4 v6, s[56:59], s64 offen offset:2048 lds
    v_mfma_f32_16x16x32_bf16 v[72:75], a[160:163], a[240:243], v[72:75]
    ds_read_b64_tr_b16 a[188:189], v19 offset:40960
    v_mfma_f32_16x16x32_bf16 v[72:75], a[164:167], a[244:247], v[72:75]
    v_mfma_f32_16x16x32_bf16 v[64:67], a[164:167], a[252:255], v[64:67]
    ds_read_b64_tr_b16 a[190:191], v19 offset:41984
    v_mfma_f32_16x16x32_bf16 v[64:67], a[160:163], a[248:251], v[64:67]
    s_waitcnt lgkmcnt(8)
    buffer_load_dwordx4 v7, s[56:59], s64 offen offset:3072 lds
    v_mfma_f32_16x16x32_bf16 v[68:71], a[168:171], a[248:251], v[68:71]
    s_add_u32 s64, s64, 524288
    ds_read_b64_tr_b16 a[160:161], v20 offset:32768
    v_mfma_f32_16x16x32_bf16 v[68:71], a[172:175], a[252:255], v[68:71]
    v_mfma_f32_16x16x32_bf16 v[76:79], a[172:175], a[244:247], v[76:79]
    s_add_u32 m0, s63, 131072
    ds_read_b64_tr_b16 a[162:163], v20 offset:33792
    v_mfma_f32_16x16x32_bf16 v[76:79], a[168:171], a[240:243], v[76:79]
    buffer_load_dwordx4 v8, s[12:15], s65 offen offset:0 lds
    v_mfma_f32_16x16x32_bf16 v[84:87], a[168:171], a[232:235], v[84:87]
    ds_read_b64_tr_b16 a[164:165], v20 offset:40960
    v_mfma_f32_16x16x32_bf16 v[84:87], a[172:175], a[236:239], v[84:87]
    v_mfma_f32_16x16x32_bf16 v[92:95], a[172:175], a[228:231], v[92:95]
    ds_read_b64_tr_b16 a[166:167], v20 offset:41984
    v_mfma_f32_16x16x32_bf16 v[92:95], a[168:171], a[224:227], v[92:95]
    s_waitcnt lgkmcnt(8)
    buffer_load_dwordx4 v9, s[12:15], s65 offen offset:1024 lds
    v_mfma_f32_16x16x32_bf16 v[120:123], a[176:179], a[224:227], v[120:123]
    ds_read_b64_tr_b16 a[168:169], v21 offset:32768
    v_mfma_f32_16x16x32_bf16 v[120:123], a[180:183], a[228:231], v[120:123]
    v_mfma_f32_16x16x32_bf16 v[112:115], a[180:183], a[236:239], v[112:115]
    ds_read_b64_tr_b16 a[170:171], v21 offset:33792
    v_mfma_f32_16x16x32_bf16 v[112:115], a[176:179], a[232:235], v[112:115]
    buffer_load_dwordx4 v10, s[12:15], s65 offen offset:2048 lds
    v_mfma_f32_16x16x32_bf16 v[104:107], a[176:179], a[240:243], v[104:107]
    ds_read_b64_tr_b16 a[172:173], v21 offset:40960
    v_mfma_f32_16x16x32_bf16 v[104:107], a[180:183], a[244:247], v[104:107]
    v_mfma_f32_16x16x32_bf16 v[96:99], a[180:183], a[252:255], v[96:99]
    ds_read_b64_tr_b16 a[174:175], v21 offset:41984
    v_mfma_f32_16x16x32_bf16 v[96:99], a[176:179], a[248:251], v[96:99]
    s_waitcnt lgkmcnt(8)
    buffer_load_dwordx4 v11, s[12:15], s65 offen offset:3072 lds
    v_mfma_f32_16x16x32_bf16 v[100:103], a[184:187], a[248:251], v[100:103]
    ds_read_b64_tr_b16 a[176:177], v22 offset:32768
    v_mfma_f32_16x16x32_bf16 v[100:103], a[188:191], a[252:255], v[100:103]
    s_add_u32 s70, s65, 32768
    v_mfma_f32_16x16x32_bf16 v[108:111], a[188:191], a[244:247], v[108:111]
    s_add_u32 m0, s63, 135168
    ds_read_b64_tr_b16 a[178:179], v22 offset:33792
    v_mfma_f32_16x16x32_bf16 v[108:111], a[184:187], a[240:243], v[108:111]
    buffer_load_dwordx4 v8, s[12:15], s70 offen offset:0 lds
    v_mfma_f32_16x16x32_bf16 v[116:119], a[184:187], a[232:235], v[116:119]
    ds_read_b64_tr_b16 a[180:181], v22 offset:40960
    v_mfma_f32_16x16x32_bf16 v[116:119], a[188:191], a[236:239], v[116:119]
    v_mfma_f32_16x16x32_bf16 v[124:127], a[188:191], a[228:231], v[124:127]
    ds_read_b64_tr_b16 a[182:183], v22 offset:41984
    v_mfma_f32_16x16x32_bf16 v[124:127], a[184:187], a[224:227], v[124:127]
    s_waitcnt lgkmcnt(8)
    buffer_load_dwordx4 v9, s[12:15], s70 offen offset:1024 lds
    v_mfma_f32_16x16x32_bf16 v[152:155], a[160:163], a[224:227], v[152:155]
    ds_read_b64_tr_b16 a[184:185], v23 offset:32768
    v_mfma_f32_16x16x32_bf16 v[152:155], a[164:167], a[228:231], v[152:155]
    v_mfma_f32_16x16x32_bf16 v[144:147], a[164:167], a[236:239], v[144:147]
    ds_read_b64_tr_b16 a[186:187], v23 offset:33792
    v_mfma_f32_16x16x32_bf16 v[144:147], a[160:163], a[232:235], v[144:147]
    buffer_load_dwordx4 v10, s[12:15], s70 offen offset:2048 lds
    v_mfma_f32_16x16x32_bf16 v[136:139], a[160:163], a[240:243], v[136:139]
    ds_read_b64_tr_b16 a[188:189], v23 offset:40960
    v_mfma_f32_16x16x32_bf16 v[136:139], a[164:167], a[244:247], v[136:139]
    v_mfma_f32_16x16x32_bf16 v[128:131], a[164:167], a[252:255], v[128:131]
    ds_read_b64_tr_b16 a[190:191], v23 offset:41984
    v_mfma_f32_16x16x32_bf16 v[128:131], a[160:163], a[248:251], v[128:131]
    s_waitcnt lgkmcnt(8)
    buffer_load_dwordx4 v11, s[12:15], s70 offen offset:3072 lds
    v_mfma_f32_16x16x32_bf16 v[132:135], a[168:171], a[248:251], v[132:135]
    s_add_u32 s65, s65, 128
    ds_read_b64_tr_b16 a[160:161], v16 offset:49152
    v_mfma_f32_16x16x32_bf16 v[132:135], a[172:175], a[252:255], v[132:135]
    v_mfma_f32_16x16x32_bf16 v[140:143], a[172:175], a[244:247], v[140:143]
    ds_read_b64_tr_b16 a[162:163], v16 offset:50176
    v_mfma_f32_16x16x32_bf16 v[140:143], a[168:171], a[240:243], v[140:143]
    global_load_dword v55, v[40:41], off
    v_mfma_f32_16x16x32_bf16 v[148:151], a[168:171], a[232:235], v[148:151]
    ds_read_b64_tr_b16 a[164:165], v16 offset:57344
    v_mfma_f32_16x16x32_bf16 v[148:151], a[172:175], a[236:239], v[148:151]
    v_add_co_u32 v40, vcc, v40, v42
    v_mfma_f32_16x16x32_bf16 v[156:159], a[172:175], a[228:231], v[156:159]
    ds_read_b64_tr_b16 a[166:167], v16 offset:58368
    v_mfma_f32_16x16x32_bf16 v[156:159], a[168:171], a[224:227], v[156:159]
    s_waitcnt lgkmcnt(8)
    v_addc_co_u32 v41, vcc, 0, v41, vcc
    v_mfma_f32_16x16x32_bf16 v[184:187], a[176:179], a[224:227], v[184:187]
    ds_read_b64_tr_b16 a[168:169], v17 offset:49152
    v_mfma_f32_16x16x32_bf16 v[184:187], a[180:183], a[228:231], v[184:187]
    v_mfma_f32_16x16x32_bf16 v[176:179], a[180:183], a[236:239], v[176:179]
    ds_read_b64_tr_b16 a[170:171], v17 offset:50176
    v_add_u32 v16, 65536, v16
    v_mfma_f32_16x16x32_bf16 v[176:179], a[176:179], a[232:235], v[176:179]
    v_mfma_f32_16x16x32_bf16 v[168:171], a[176:179], a[240:243], v[168:171]
    ds_read_b64_tr_b16 a[172:173], v17 offset:57344
    v_mfma_f32_16x16x32_bf16 v[168:171], a[180:183], a[244:247], v[168:171]
    v_mfma_f32_16x16x32_bf16 v[160:163], a[180:183], a[252:255], v[160:163]
    ds_read_b64_tr_b16 a[174:175], v17 offset:58368
    v_mfma_f32_16x16x32_bf16 v[160:163], a[176:179], a[248:251], v[160:163]
    s_waitcnt lgkmcnt(8)
    global_load_dword v55, v[40:41], off
    v_mfma_f32_16x16x32_bf16 v[164:167], a[184:187], a[248:251], v[164:167]
    ds_read_b64_tr_b16 a[176:177], v18 offset:49152
    v_mfma_f32_16x16x32_bf16 v[164:167], a[188:191], a[252:255], v[164:167]
    v_add_co_u32 v40, vcc, v40, v42
    v_mfma_f32_16x16x32_bf16 v[172:175], a[188:191], a[244:247], v[172:175]
    ds_read_b64_tr_b16 a[178:179], v18 offset:50176
    v_add_u32 v17, 65536, v17
    v_mfma_f32_16x16x32_bf16 v[172:175], a[184:187], a[240:243], v[172:175]
    v_addc_co_u32 v41, vcc, 0, v41, vcc
    v_mfma_f32_16x16x32_bf16 v[180:183], a[184:187], a[232:235], v[180:183]
    ds_read_b64_tr_b16 a[180:181], v18 offset:57344
    v_mfma_f32_16x16x32_bf16 v[180:183], a[188:191], a[236:239], v[180:183]
    v_mfma_f32_16x16x32_bf16 v[188:191], a[188:191], a[228:231], v[188:191]
    ds_read_b64_tr_b16 a[182:183], v18 offset:58368
    v_mfma_f32_16x16x32_bf16 v[188:191], a[184:187], a[224:227], v[188:191]
    s_waitcnt lgkmcnt(8)
    v_mfma_f32_16x16x32_bf16 a[0:3], a[224:227], a[160:163], a[0:3]
    ds_read_b64_tr_b16 a[184:185], v19 offset:49152
    v_mfma_f32_16x16x32_bf16 a[0:3], a[228:231], a[164:167], a[0:3]
    v_mfma_f32_16x16x32_bf16 a[4:7], a[236:239], a[164:167], a[4:7]
    ds_read_b64_tr_b16 a[186:187], v19 offset:50176
    v_add_u32 v18, 65536, v18
    v_mfma_f32_16x16x32_bf16 a[4:7], a[232:235], a[160:163], a[4:7]
    v_mfma_f32_16x16x32_bf16 a[64:67], a[240:243], a[160:163], a[64:67]
    ds_read_b64_tr_b16 a[188:189], v19 offset:57344
    v_mfma_f32_16x16x32_bf16 a[64:67], a[244:247], a[164:167], a[64:67]
    v_mfma_f32_16x16x32_bf16 a[68:71], a[252:255], a[164:167], a[68:71]
    ds_read_b64_tr_b16 a[190:191], v19 offset:58368
    v_mfma_f32_16x16x32_bf16 a[68:71], a[248:251], a[160:163], a[68:71]
    s_waitcnt lgkmcnt(8)
    v_mfma_f32_16x16x32_bf16 a[76:79], a[248:251], a[168:171], a[76:79]
    ds_read_b64_tr_b16 a[160:161], v20 offset:49152
    v_mfma_f32_16x16x32_bf16 a[76:79], a[252:255], a[172:175], a[76:79]
    v_mfma_f32_16x16x32_bf16 a[72:75], a[244:247], a[172:175], a[72:75]
    ds_read_b64_tr_b16 a[162:163], v20 offset:50176
    v_add_u32 v19, 65536, v19
    v_mfma_f32_16x16x32_bf16 a[72:75], a[240:243], a[168:171], a[72:75]
    v_mfma_f32_16x16x32_bf16 a[12:15], a[232:235], a[168:171], a[12:15]
    ds_read_b64_tr_b16 a[164:165], v20 offset:57344
    v_mfma_f32_16x16x32_bf16 a[12:15], a[236:239], a[172:175], a[12:15]
    v_mfma_f32_16x16x32_bf16 a[8:11], a[228:231], a[172:175], a[8:11]
    ds_read_b64_tr_b16 a[166:167], v20 offset:58368
    v_mfma_f32_16x16x32_bf16 a[8:11], a[224:227], a[168:171], a[8:11]
    s_waitcnt lgkmcnt(8)
    v_mfma_f32_16x16x32_bf16 a[16:19], a[224:227], a[176:179], a[16:19]
    ds_read_b64_tr_b16 a[168:169], v21 offset:49152
    v_mfma_f32_16x16x32_bf16 a[16:19], a[228:231], a[180:183], a[16:19]
    v_mfma_f32_16x16x32_bf16 a[20:23], a[236:239], a[180:183], a[20:23]
    ds_read_b64_tr_b16 a[170:171], v21 offset:50176
    v_add_u32 v20, 65536, v20
    v_mfma_f32_16x16x32_bf16 a[20:23], a[232:235], a[176:179], a[20:23]
    v_mfma_f32_16x16x32_bf16 a[80:83], a[240:243], a[176:179], a[80:83]
    ds_read_b64_tr_b16 a[172:173], v21 offset:57344
    v_mfma_f32_16x16x32_bf16 a[80:83], a[244:247], a[180:183], a[80:83]
    v_mfma_f32_16x16x32_bf16 a[84:87], a[252:255], a[180:183], a[84:87]
    ds_read_b64_tr_b16 a[174:175], v21 offset:58368
    v_mfma_f32_16x16x32_bf16 a[84:87], a[248:251], a[176:179], a[84:87]
    s_waitcnt lgkmcnt(8)
    v_mfma_f32_16x16x32_bf16 a[92:95], a[248:251], a[184:187], a[92:95]
    ds_read_b64_tr_b16 a[176:177], v22 offset:49152
    v_mfma_f32_16x16x32_bf16 a[92:95], a[252:255], a[188:191], a[92:95]
    v_mfma_f32_16x16x32_bf16 a[88:91], a[244:247], a[188:191], a[88:91]
    ds_read_b64_tr_b16 a[178:179], v22 offset:50176
    v_add_u32 v21, 65536, v21
    v_mfma_f32_16x16x32_bf16 a[88:91], a[240:243], a[184:187], a[88:91]
    buffer_store_dwordx4 v[48:51], v2, s[48:51], s92 offen offset:0 sc1
    v_mfma_f32_16x16x32_bf16 a[28:31], a[232:235], a[184:187], a[28:31]
    ds_read_b64_tr_b16 a[180:181], v22 offset:57344
    v_mfma_f32_16x16x32_bf16 a[28:31], a[236:239], a[188:191], a[28:31]
    v_mfma_f32_16x16x32_bf16 a[24:27], a[228:231], a[188:191], a[24:27]
    ds_read_b64_tr_b16 a[182:183], v22 offset:58368
    v_mfma_f32_16x16x32_bf16 a[24:27], a[224:227], a[184:187], a[24:27]
    s_waitcnt lgkmcnt(8)
    v_mfma_f32_16x16x32_bf16 a[32:35], a[224:227], a[160:163], a[32:35]
    ds_read_b64_tr_b16 a[184:185], v23 offset:49152
    ds_read_b64_tr_b16 a[186:187], v23 offset:50176
    v_mfma_f32_16x16x32_bf16 a[32:35], a[228:231], a[164:167], a[32:35]
    v_mfma_f32_16x16x32_bf16 a[36:39], a[236:239], a[164:167], a[36:39]
    ds_read_b64_tr_b16 a[188:189], v23 offset:57344
    v_add_u32 v22, 65536, v22
    v_mfma_f32_16x16x32_bf16 a[36:39], a[232:235], a[160:163], a[36:39]
    v_mfma_f32_16x16x32_bf16 a[96:99], a[240:243], a[160:163], a[96:99]
    ds_read_b64_tr_b16 a[190:191], v23 offset:58368
    v_mfma_f32_16x16x32_bf16 a[96:99], a[244:247], a[164:167], a[96:99]
    v_mfma_f32_16x16x32_bf16 a[100:103], a[252:255], a[164:167], a[100:103]
    v_mfma_f32_16x16x32_bf16 a[100:103], a[248:251], a[160:163], a[100:103]
    s_waitcnt vmcnt(21) lgkmcnt(0)
    v_mfma_f32_16x16x32_bf16 a[108:111], a[248:251], a[168:171], a[108:111]
    s_barrier
    ds_read_b64_tr_b16 a[160:161], v16 offset:0
    v_mfma_f32_16x16x32_bf16 a[108:111], a[252:255], a[172:175], a[108:111]
    ds_read_b128 a[192:195], v24 offset:0
    ds_read_b128 a[196:199], v25 offset:0
    v_mfma_f32_16x16x32_bf16 a[104:107], a[244:247], a[172:175], a[104:107]
    s_add_u32 m0, s80, 32768
    ds_read_b64_tr_b16 a[162:163], v16 offset:1024
    v_add_u32 v23, 65536, v23
    v_mfma_f32_16x16x32_bf16 a[104:107], a[240:243], a[168:171], a[104:107]
    buffer_load_dwordx4 v4, s[20:23], s64 offen offset:0 lds
    v_mfma_f32_16x16x32_bf16 a[44:47], a[232:235], a[168:171], a[44:47]
    ds_read_b64_tr_b16 a[164:165], v16 offset:8192
    v_mfma_f32_16x16x32_bf16 a[44:47], a[236:239], a[172:175], a[44:47]
    ds_read_b128 a[200:203], v24 offset:2048
    ds_read_b128 a[204:207], v25 offset:2048
    v_mfma_f32_16x16x32_bf16 a[40:43], a[228:231], a[172:175], a[40:43]
    ds_read_b64_tr_b16 a[166:167], v16 offset:9216
    v_mfma_f32_16x16x32_bf16 a[40:43], a[224:227], a[168:171], a[40:43]
    buffer_load_dwordx4 v5, s[20:23], s64 offen offset:1024 lds
    v_mfma_f32_16x16x32_bf16 a[48:51], a[224:227], a[176:179], a[48:51]
    ds_read_b64_tr_b16 a[168:169], v17 offset:0
    v_mfma_f32_16x16x32_bf16 a[48:51], a[228:231], a[180:183], a[48:51]
    ds_read_b128 a[208:211], v24 offset:4096
    ds_read_b128 a[212:215], v25 offset:4096
    v_mfma_f32_16x16x32_bf16 a[52:55], a[236:239], a[180:183], a[52:55]
    ds_read_b64_tr_b16 a[170:171], v17 offset:1024
    v_mfma_f32_16x16x32_bf16 a[52:55], a[232:235], a[176:179], a[52:55]
    buffer_load_dwordx4 v6, s[20:23], s64 offen offset:2048 lds
    v_mfma_f32_16x16x32_bf16 a[112:115], a[240:243], a[176:179], a[112:115]
    ds_read_b64_tr_b16 a[172:173], v17 offset:8192
    v_mfma_f32_16x16x32_bf16 a[112:115], a[244:247], a[180:183], a[112:115]
    ds_read_b128 a[216:219], v24 offset:6144
    ds_read_b128 a[220:223], v25 offset:6144
    v_mfma_f32_16x16x32_bf16 a[116:119], a[252:255], a[180:183], a[116:119]
    ds_read_b64_tr_b16 a[174:175], v17 offset:9216
    v_mfma_f32_16x16x32_bf16 a[116:119], a[248:251], a[176:179], a[116:119]
    buffer_load_dwordx4 v7, s[20:23], s64 offen offset:3072 lds
    v_mfma_f32_16x16x32_bf16 a[124:127], a[248:251], a[184:187], a[124:127]
    ds_read_b64_tr_b16 a[176:177], v18 offset:0
    v_mfma_f32_16x16x32_bf16 a[124:127], a[252:255], a[188:191], a[124:127]
    v_mfma_f32_16x16x32_bf16 a[120:123], a[244:247], a[188:191], a[120:123]
    s_add_u32 m0, s80, 49152
    ds_read_b64_tr_b16 a[178:179], v18 offset:1024
    v_mfma_f32_16x16x32_bf16 a[120:123], a[240:243], a[184:187], a[120:123]
    buffer_load_dwordx4 v4, s[56:59], s64 offen offset:0 lds
    v_mfma_f32_16x16x32_bf16 a[60:63], a[232:235], a[184:187], a[60:63]
    ds_read_b64_tr_b16 a[180:181], v18 offset:8192
    v_mfma_f32_16x16x32_bf16 a[60:63], a[236:239], a[188:191], a[60:63]
    v_mfma_f32_16x16x32_bf16 a[56:59], a[228:231], a[188:191], a[56:59]
    ds_read_b64_tr_b16 a[182:183], v18 offset:9216
    v_mfma_f32_16x16x32_bf16 a[56:59], a[224:227], a[184:187], a[56:59]
    s_waitcnt lgkmcnt(5)
    buffer_load_dwordx4 v5, s[56:59], s64 offen offset:1024 lds
    v_mfma_f32_16x16x32_bf16 v[88:91], a[160:163], a[192:195], v[88:91]
    ds_read_b64_tr_b16 a[184:185], v19 offset:0
    v_mfma_f32_16x16x32_bf16 v[88:91], a[164:167], a[196:199], v[88:91]
    v_mfma_f32_16x16x32_bf16 v[80:83], a[164:167], a[204:207], v[80:83]
    ds_read_b64_tr_b16 a[186:187], v19 offset:1024
    v_mfma_f32_16x16x32_bf16 v[80:83], a[160:163], a[200:203], v[80:83]
    buffer_load_dwordx4 v6, s[56:59], s64 offen offset:2048 lds
    v_mfma_f32_16x16x32_bf16 v[72:75], a[160:163], a[208:211], v[72:75]
    ds_read_b64_tr_b16 a[188:189], v19 offset:8192
    v_mfma_f32_16x16x32_bf16 v[72:75], a[164:167], a[212:215], v[72:75]
    v_mfma_f32_16x16x32_bf16 v[64:67], a[164:167], a[220:223], v[64:67]
    ds_read_b64_tr_b16 a[190:191], v19 offset:9216
    v_mfma_f32_16x16x32_bf16 v[64:67], a[160:163], a[216:219], v[64:67]
    s_waitcnt lgkmcnt(8)
    buffer_load_dwordx4 v7, s[56:59], s64 offen offset:3072 lds
    v_mfma_f32_16x16x32_bf16 v[68:71], a[168:171], a[216:219], v[68:71]
    s_add_u32 s64, s64, 524288
    ds_read_b64_tr_b16 a[160:161], v20 offset:0
    v_mfma_f32_16x16x32_bf16 v[68:71], a[172:175], a[220:223], v[68:71]
    v_mfma_f32_16x16x32_bf16 v[76:79], a[172:175], a[212:215], v[76:79]
    s_add_u32 m0, s63, 98304
    ds_read_b64_tr_b16 a[162:163], v20 offset:1024
    v_mfma_f32_16x16x32_bf16 v[76:79], a[168:171], a[208:211], v[76:79]
    buffer_load_dwordx4 v8, s[12:15], s65 offen offset:0 lds
    v_mfma_f32_16x16x32_bf16 v[84:87], a[168:171], a[200:203], v[84:87]
    ds_read_b64_tr_b16 a[164:165], v20 offset:8192
    v_mfma_f32_16x16x32_bf16 v[84:87], a[172:175], a[204:207], v[84:87]
    v_mfma_f32_16x16x32_bf16 v[92:95], a[172:175], a[196:199], v[92:95]
    ds_read_b64_tr_b16 a[166:167], v20 offset:9216
    v_mfma_f32_16x16x32_bf16 v[92:95], a[168:171], a[192:195], v[92:95]
    s_waitcnt lgkmcnt(8)
    buffer_load_dwordx4 v9, s[12:15], s65 offen offset:1024 lds
    v_mfma_f32_16x16x32_bf16 v[120:123], a[176:179], a[192:195], v[120:123]
    ds_read_b64_tr_b16 a[168:169], v21 offset:0
    v_mfma_f32_16x16x32_bf16 v[120:123], a[180:183], a[196:199], v[120:123]
    v_mfma_f32_16x16x32_bf16 v[112:115], a[180:183], a[204:207], v[112:115]
    ds_read_b64_tr_b16 a[170:171], v21 offset:1024
    v_mfma_f32_16x16x32_bf16 v[112:115], a[176:179], a[200:203], v[112:115]
    buffer_load_dwordx4 v10, s[12:15], s65 offen offset:2048 lds
    v_mfma_f32_16x16x32_bf16 v[104:107], a[176:179], a[208:211], v[104:107]
    ds_read_b64_tr_b16 a[172:173], v21 offset:8192
    v_mfma_f32_16x16x32_bf16 v[104:107], a[180:183], a[212:215], v[104:107]
    v_mfma_f32_16x16x32_bf16 v[96:99], a[180:183], a[220:223], v[96:99]
    ds_read_b64_tr_b16 a[174:175], v21 offset:9216
    v_mfma_f32_16x16x32_bf16 v[96:99], a[176:179], a[216:219], v[96:99]
    s_waitcnt lgkmcnt(8)
    buffer_load_dwordx4 v11, s[12:15], s65 offen offset:3072 lds
    v_mfma_f32_16x16x32_bf16 v[100:103], a[184:187], a[216:219], v[100:103]
    ds_read_b64_tr_b16 a[176:177], v22 offset:0
    v_mfma_f32_16x16x32_bf16 v[100:103], a[188:191], a[220:223], v[100:103]
    s_add_u32 s70, s65, 32768
    v_mfma_f32_16x16x32_bf16 v[108:111], a[188:191], a[212:215], v[108:111]
    s_add_u32 m0, s63, 102400
    ds_read_b64_tr_b16 a[178:179], v22 offset:1024
    v_mfma_f32_16x16x32_bf16 v[108:111], a[184:187], a[208:211], v[108:111]
    buffer_load_dwordx4 v8, s[12:15], s70 offen offset:0 lds
    v_mfma_f32_16x16x32_bf16 v[116:119], a[184:187], a[200:203], v[116:119]
    ds_read_b64_tr_b16 a[180:181], v22 offset:8192
    v_mfma_f32_16x16x32_bf16 v[116:119], a[188:191], a[204:207], v[116:119]
    v_mfma_f32_16x16x32_bf16 v[124:127], a[188:191], a[196:199], v[124:127]
    ds_read_b64_tr_b16 a[182:183], v22 offset:9216
    v_mfma_f32_16x16x32_bf16 v[124:127], a[184:187], a[192:195], v[124:127]
    s_waitcnt lgkmcnt(8)
    buffer_load_dwordx4 v9, s[12:15], s70 offen offset:1024 lds
    v_mfma_f32_16x16x32_bf16 v[152:155], a[160:163], a[192:195], v[152:155]
    ds_read_b64_tr_b16 a[184:185], v23 offset:0
    v_mfma_f32_16x16x32_bf16 v[152:155], a[164:167], a[196:199], v[152:155]
    v_mfma_f32_16x16x32_bf16 v[144:147], a[164:167], a[204:207], v[144:147]
    ds_read_b64_tr_b16 a[186:187], v23 offset:1024
    v_mfma_f32_16x16x32_bf16 v[144:147], a[160:163], a[200:203], v[144:147]
    buffer_load_dwordx4 v10, s[12:15], s70 offen offset:2048 lds
    v_mfma_f32_16x16x32_bf16 v[136:139], a[160:163], a[208:211], v[136:139]
    ds_read_b64_tr_b16 a[188:189], v23 offset:8192
    v_mfma_f32_16x16x32_bf16 v[136:139], a[164:167], a[212:215], v[136:139]
    v_mfma_f32_16x16x32_bf16 v[128:131], a[164:167], a[220:223], v[128:131]
    ds_read_b64_tr_b16 a[190:191], v23 offset:9216
    v_mfma_f32_16x16x32_bf16 v[128:131], a[160:163], a[216:219], v[128:131]
    s_waitcnt lgkmcnt(8)
    buffer_load_dwordx4 v11, s[12:15], s70 offen offset:3072 lds
    v_mfma_f32_16x16x32_bf16 v[132:135], a[168:171], a[216:219], v[132:135]
    s_add_u32 s65, s65, 128
    ds_read_b64_tr_b16 a[160:161], v16 offset:16384
    v_mfma_f32_16x16x32_bf16 v[132:135], a[172:175], a[220:223], v[132:135]
    v_mfma_f32_16x16x32_bf16 v[140:143], a[172:175], a[212:215], v[140:143]
    ds_read_b64_tr_b16 a[162:163], v16 offset:17408
    v_mfma_f32_16x16x32_bf16 v[140:143], a[168:171], a[208:211], v[140:143]
    global_load_dword v55, v[40:41], off
    v_mfma_f32_16x16x32_bf16 v[148:151], a[168:171], a[200:203], v[148:151]
    ds_read_b64_tr_b16 a[164:165], v16 offset:24576
    v_mfma_f32_16x16x32_bf16 v[148:151], a[172:175], a[204:207], v[148:151]
    v_add_co_u32 v40, vcc, v40, v42
    v_mfma_f32_16x16x32_bf16 v[156:159], a[172:175], a[196:199], v[156:159]
    ds_read_b64_tr_b16 a[166:167], v16 offset:25600
    v_mfma_f32_16x16x32_bf16 v[156:159], a[168:171], a[192:195], v[156:159]
    s_waitcnt lgkmcnt(8)
    v_addc_co_u32 v41, vcc, 0, v41, vcc
    v_mfma_f32_16x16x32_bf16 v[184:187], a[176:179], a[192:195], v[184:187]
    ds_read_b64_tr_b16 a[168:169], v17 offset:16384
    v_mfma_f32_16x16x32_bf16 v[184:187], a[180:183], a[196:199], v[184:187]
    v_mfma_f32_16x16x32_bf16 v[176:179], a[180:183], a[204:207], v[176:179]
    ds_read_b64_tr_b16 a[170:171], v17 offset:17408
    v_add_u32 v16, 4294901760, v16
    v_mfma_f32_16x16x32_bf16 v[176:179], a[176:179], a[200:203], v[176:179]
    v_mfma_f32_16x16x32_bf16 v[168:171], a[176:179], a[208:211], v[168:171]
    ds_read_b64_tr_b16 a[172:173], v17 offset:24576
    v_mfma_f32_16x16x32_bf16 v[168:171], a[180:183], a[212:215], v[168:171]
    v_mfma_f32_16x16x32_bf16 v[160:163], a[180:183], a[220:223], v[160:163]
    ds_read_b64_tr_b16 a[174:175], v17 offset:25600
    v_mfma_f32_16x16x32_bf16 v[160:163], a[176:179], a[216:219], v[160:163]
    s_waitcnt lgkmcnt(8)
    global_load_dword v55, v[40:41], off
    v_mfma_f32_16x16x32_bf16 v[164:167], a[184:187], a[216:219], v[164:167]
    ds_read_b64_tr_b16 a[176:177], v18 offset:16384
    v_mfma_f32_16x16x32_bf16 v[164:167], a[188:191], a[220:223], v[164:167]
    v_add_co_u32 v40, vcc, v40, v42
    v_mfma_f32_16x16x32_bf16 v[172:175], a[188:191], a[212:215], v[172:175]
    ds_read_b64_tr_b16 a[178:179], v18 offset:17408
    v_add_u32 v17, 4294901760, v17
    v_mfma_f32_16x16x32_bf16 v[172:175], a[184:187], a[208:211], v[172:175]
    v_addc_co_u32 v41, vcc, 0, v41, vcc
    v_mfma_f32_16x16x32_bf16 v[180:183], a[184:187], a[200:203], v[180:183]
    ds_read_b64_tr_b16 a[180:181], v18 offset:24576
    v_mfma_f32_16x16x32_bf16 v[180:183], a[188:191], a[204:207], v[180:183]
    v_mov_b32 v40, v43
    v_mov_b32 v41, v44
    v_mov_b32 v42, v45
    v_mfma_f32_16x16x32_bf16 v[188:191], a[188:191], a[196:199], v[188:191]
    ds_read_b64_tr_b16 a[182:183], v18 offset:25600
    v_mfma_f32_16x16x32_bf16 v[188:191], a[184:187], a[192:195], v[188:191]
    s_waitcnt lgkmcnt(8)
    v_mfma_f32_16x16x32_bf16 a[0:3], a[192:195], a[160:163], a[0:3]
    ds_read_b64_tr_b16 a[184:185], v19 offset:16384
    v_mfma_f32_16x16x32_bf16 a[0:3], a[196:199], a[164:167], a[0:3]
    v_mfma_f32_16x16x32_bf16 a[4:7], a[204:207], a[164:167], a[4:7]
    ds_read_b64_tr_b16 a[186:187], v19 offset:17408
    v_add_u32 v18, 4294901760, v18
    v_mfma_f32_16x16x32_bf16 a[4:7], a[200:203], a[160:163], a[4:7]
    v_mfma_f32_16x16x32_bf16 a[64:67], a[208:211], a[160:163], a[64:67]
    ds_read_b64_tr_b16 a[188:189], v19 offset:24576
    v_mfma_f32_16x16x32_bf16 a[64:67], a[212:215], a[164:167], a[64:67]
    v_mfma_f32_16x16x32_bf16 a[68:71], a[220:223], a[164:167], a[68:71]
    ds_read_b64_tr_b16 a[190:191], v19 offset:25600
    v_mfma_f32_16x16x32_bf16 a[68:71], a[216:219], a[160:163], a[68:71]
    s_waitcnt lgkmcnt(8)
    v_mfma_f32_16x16x32_bf16 a[76:79], a[216:219], a[168:171], a[76:79]
    ds_read_b64_tr_b16 a[160:161], v20 offset:16384
    v_mfma_f32_16x16x32_bf16 a[76:79], a[220:223], a[172:175], a[76:79]
    v_mfma_f32_16x16x32_bf16 a[72:75], a[212:215], a[172:175], a[72:75]
    ds_read_b64_tr_b16 a[162:163], v20 offset:17408
    v_add_u32 v19, 4294901760, v19
    v_mfma_f32_16x16x32_bf16 a[72:75], a[208:211], a[168:171], a[72:75]
    v_mfma_f32_16x16x32_bf16 a[12:15], a[200:203], a[168:171], a[12:15]
    ds_read_b64_tr_b16 a[164:165], v20 offset:24576
    v_mfma_f32_16x16x32_bf16 a[12:15], a[204:207], a[172:175], a[12:15]
    v_mfma_f32_16x16x32_bf16 a[8:11], a[196:199], a[172:175], a[8:11]
    ds_read_b64_tr_b16 a[166:167], v20 offset:25600
    v_mfma_f32_16x16x32_bf16 a[8:11], a[192:195], a[168:171], a[8:11]
    s_waitcnt lgkmcnt(8)
    v_mfma_f32_16x16x32_bf16 a[16:19], a[192:195], a[176:179], a[16:19]
    ds_read_b64_tr_b16 a[168:169], v21 offset:16384
    v_mfma_f32_16x16x32_bf16 a[16:19], a[196:199], a[180:183], a[16:19]
    v_mfma_f32_16x16x32_bf16 a[20:23], a[204:207], a[180:183], a[20:23]
    ds_read_b64_tr_b16 a[170:171], v21 offset:17408
    v_add_u32 v20, 4294901760, v20
    v_mfma_f32_16x16x32_bf16 a[20:23], a[200:203], a[176:179], a[20:23]
    v_mfma_f32_16x16x32_bf16 a[80:83], a[208:211], a[176:179], a[80:83]
    ds_read_b64_tr_b16 a[172:173], v21 offset:24576
    v_mfma_f32_16x16x32_bf16 a[80:83], a[212:215], a[180:183], a[80:83]
    v_mfma_f32_16x16x32_bf16 a[84:87], a[220:223], a[180:183], a[84:87]
    ds_read_b64_tr_b16 a[174:175], v21 offset:25600
    v_mfma_f32_16x16x32_bf16 a[84:87], a[216:219], a[176:179], a[84:87]
    s_waitcnt lgkmcnt(8)
    v_mfma_f32_16x16x32_bf16 a[92:95], a[216:219], a[184:187], a[92:95]
    ds_read_b64_tr_b16 a[176:177], v22 offset:16384
    v_mfma_f32_16x16x32_bf16 a[92:95], a[220:223], a[188:191], a[92:95]
    v_mfma_f32_16x16x32_bf16 a[88:91], a[212:215], a[188:191], a[88:91]
    ds_read_b64_tr_b16 a[178:179], v22 offset:17408
    v_add_u32 v21, 4294901760, v21
    v_mfma_f32_16x16x32_bf16 a[88:91], a[208:211], a[184:187], a[88:91]
    buffer_store_dwordx4 v[48:51], v2, s[48:51], s92 offen offset:1024 sc1
    v_mfma_f32_16x16x32_bf16 a[28:31], a[200:203], a[184:187], a[28:31]
    ds_read_b64_tr_b16 a[180:181], v22 offset:24576
    v_mfma_f32_16x16x32_bf16 a[28:31], a[204:207], a[188:191], a[28:31]
    v_mfma_f32_16x16x32_bf16 a[24:27], a[196:199], a[188:191], a[24:27]
    ds_read_b64_tr_b16 a[182:183], v22 offset:25600
    v_mfma_f32_16x16x32_bf16 a[24:27], a[192:195], a[184:187], a[24:27]
    s_waitcnt lgkmcnt(8)
    v_mfma_f32_16x16x32_bf16 a[32:35], a[192:195], a[160:163], a[32:35]
    ds_read_b64_tr_b16 a[184:185], v23 offset:16384
    ds_read_b64_tr_b16 a[186:187], v23 offset:17408
    v_mfma_f32_16x16x32_bf16 a[32:35], a[196:199], a[164:167], a[32:35]
    v_mfma_f32_16x16x32_bf16 a[36:39], a[204:207], a[164:167], a[36:39]
    ds_read_b64_tr_b16 a[188:189], v23 offset:24576
    v_add_u32 v22, 4294901760, v22
    v_mfma_f32_16x16x32_bf16 a[36:39], a[200:203], a[160:163], a[36:39]
    v_mfma_f32_16x16x32_bf16 a[96:99], a[208:211], a[160:163], a[96:99]
    ds_read_b64_tr_b16 a[190:191], v23 offset:25600
    v_mfma_f32_16x16x32_bf16 a[96:99], a[212:215], a[164:167], a[96:99]
    v_mfma_f32_16x16x32_bf16 a[100:103], a[220:223], a[164:167], a[100:103]
    v_mfma_f32_16x16x32_bf16 a[100:103], a[216:219], a[160:163], a[100:103]
    s_waitcnt vmcnt(22) lgkmcnt(0)
    v_mfma_f32_16x16x32_bf16 a[108:111], a[216:219], a[168:171], a[108:111]
    s_barrier
    ds_read_b64_tr_b16 a[160:161], v16 offset:0
    v_mfma_f32_16x16x32_bf16 a[108:111], a[220:223], a[172:175], a[108:111]
    ds_read_b128 a[224:227], v24 offset:32768
    ds_read_b128 a[228:231], v25 offset:32768
    v_mfma_f32_16x16x32_bf16 a[104:107], a[212:215], a[172:175], a[104:107]
    s_add_u32 m0, s80, 65536
    ds_read_b64_tr_b16 a[162:163], v16 offset:1024
    v_add_u32 v23, 4294901760, v23
    v_mfma_f32_16x16x32_bf16 a[104:107], a[208:211], a[168:171], a[104:107]
    buffer_load_dwordx4 v4, s[20:23], s64 offen offset:0 lds
    v_mfma_f32_16x16x32_bf16 a[44:47], a[200:203], a[168:171], a[44:47]
    ds_read_b64_tr_b16 a[164:165], v16 offset:8192
    v_mfma_f32_16x16x32_bf16 a[44:47], a[204:207], a[172:175], a[44:47]
    ds_read_b128 a[232:235], v24 offset:34816
    ds_read_b128 a[236:239], v25 offset:34816
    v_mfma_f32_16x16x32_bf16 a[40:43], a[196:199], a[172:175], a[40:43]
    ds_read_b64_tr_b16 a[166:167], v16 offset:9216
    v_mfma_f32_16x16x32_bf16 a[40:43], a[192:195], a[168:171], a[40:43]
    buffer_load_dwordx4 v5, s[20:23], s64 offen offset:1024 lds
    v_mfma_f32_16x16x32_bf16 a[48:51], a[192:195], a[176:179], a[48:51]
    ds_read_b64_tr_b16 a[168:169], v17 offset:0
    v_mfma_f32_16x16x32_bf16 a[48:51], a[196:199], a[180:183], a[48:51]
    ds_read_b128 a[240:243], v24 offset:36864
    ds_read_b128 a[244:247], v25 offset:36864
    v_mfma_f32_16x16x32_bf16 a[52:55], a[204:207], a[180:183], a[52:55]
    ds_read_b64_tr_b16 a[170:171], v17 offset:1024
    v_mfma_f32_16x16x32_bf16 a[52:55], a[200:203], a[176:179], a[52:55]
    buffer_load_dwordx4 v6, s[20:23], s64 offen offset:2048 lds
    v_mfma_f32_16x16x32_bf16 a[112:115], a[208:211], a[176:179], a[112:115]
    ds_read_b64_tr_b16 a[172:173], v17 offset:8192
    v_mfma_f32_16x16x32_bf16 a[112:115], a[212:215], a[180:183], a[112:115]
    ds_read_b128 a[248:251], v24 offset:38912
    ds_read_b128 a[252:255], v25 offset:38912
    v_mfma_f32_16x16x32_bf16 a[116:119], a[220:223], a[180:183], a[116:119]
    ds_read_b64_tr_b16 a[174:175], v17 offset:9216
    v_mfma_f32_16x16x32_bf16 a[116:119], a[216:219], a[176:179], a[116:119]
    buffer_load_dwordx4 v7, s[20:23], s64 offen offset:3072 lds
    v_mfma_f32_16x16x32_bf16 a[124:127], a[216:219], a[184:187], a[124:127]
    ds_read_b64_tr_b16 a[176:177], v18 offset:0
    v_mfma_f32_16x16x32_bf16 a[124:127], a[220:223], a[188:191], a[124:127]
    v_mfma_f32_16x16x32_bf16 a[120:123], a[212:215], a[188:191], a[120:123]
    s_add_u32 m0, s80, 81920
    ds_read_b64_tr_b16 a[178:179], v18 offset:1024
    v_mfma_f32_16x16x32_bf16 a[120:123], a[208:211], a[184:187], a[120:123]
    buffer_load_dwordx4 v4, s[56:59], s64 offen offset:0 lds
    v_mfma_f32_16x16x32_bf16 a[60:63], a[200:203], a[184:187], a[60:63]
    ds_read_b64_tr_b16 a[180:181], v18 offset:8192
    v_mfma_f32_16x16x32_bf16 a[60:63], a[204:207], a[188:191], a[60:63]
    v_mfma_f32_16x16x32_bf16 a[56:59], a[196:199], a[188:191], a[56:59]
    ds_read_b64_tr_b16 a[182:183], v18 offset:9216
    v_mfma_f32_16x16x32_bf16 a[56:59], a[192:195], a[184:187], a[56:59]
    s_waitcnt lgkmcnt(5)
    buffer_load_dwordx4 v5, s[56:59], s64 offen offset:1024 lds
    v_mfma_f32_16x16x32_bf16 v[88:91], a[160:163], a[224:227], v[88:91]
    ds_read_b64_tr_b16 a[184:185], v19 offset:0
    v_mfma_f32_16x16x32_bf16 v[88:91], a[164:167], a[228:231], v[88:91]
    v_mfma_f32_16x16x32_bf16 v[80:83], a[164:167], a[236:239], v[80:83]
    ds_read_b64_tr_b16 a[186:187], v19 offset:1024
    v_mfma_f32_16x16x32_bf16 v[80:83], a[160:163], a[232:235], v[80:83]
    buffer_load_dwordx4 v6, s[56:59], s64 offen offset:2048 lds
    v_mfma_f32_16x16x32_bf16 v[72:75], a[160:163], a[240:243], v[72:75]
    ds_read_b64_tr_b16 a[188:189], v19 offset:8192
    v_mfma_f32_16x16x32_bf16 v[72:75], a[164:167], a[244:247], v[72:75]
    v_mfma_f32_16x16x32_bf16 v[64:67], a[164:167], a[252:255], v[64:67]
    ds_read_b64_tr_b16 a[190:191], v19 offset:9216
    v_mfma_f32_16x16x32_bf16 v[64:67], a[160:163], a[248:251], v[64:67]
    s_waitcnt lgkmcnt(8)
    buffer_load_dwordx4 v7, s[56:59], s64 offen offset:3072 lds
    v_mfma_f32_16x16x32_bf16 v[68:71], a[168:171], a[248:251], v[68:71]
    s_add_u32 s64, s64, 524288
    ds_read_b64_tr_b16 a[160:161], v20 offset:0
    v_mfma_f32_16x16x32_bf16 v[68:71], a[172:175], a[252:255], v[68:71]
    v_mfma_f32_16x16x32_bf16 v[76:79], a[172:175], a[244:247], v[76:79]
    s_add_u32 m0, s63, 131072
    ds_read_b64_tr_b16 a[162:163], v20 offset:1024
    v_mfma_f32_16x16x32_bf16 v[76:79], a[168:171], a[240:243], v[76:79]
    buffer_load_dwordx4 v8, s[12:15], s65 offen offset:0 lds
    v_mfma_f32_16x16x32_bf16 v[84:87], a[168:171], a[232:235], v[84:87]
    ds_read_b64_tr_b16 a[164:165], v20 offset:8192
    v_mfma_f32_16x16x32_bf16 v[84:87], a[172:175], a[236:239], v[84:87]
    v_mfma_f32_16x16x32_bf16 v[92:95], a[172:175], a[228:231], v[92:95]
    ds_read_b64_tr_b16 a[166:167], v20 offset:9216
    v_mfma_f32_16x16x32_bf16 v[92:95], a[168:171], a[224:227], v[92:95]
    s_waitcnt lgkmcnt(8)
    buffer_load_dwordx4 v9, s[12:15], s65 offen offset:1024 lds
    v_mfma_f32_16x16x32_bf16 v[120:123], a[176:179], a[224:227], v[120:123]
    ds_read_b64_tr_b16 a[168:169], v21 offset:0
    v_mfma_f32_16x16x32_bf16 v[120:123], a[180:183], a[228:231], v[120:123]
    v_mfma_f32_16x16x32_bf16 v[112:115], a[180:183], a[236:239], v[112:115]
    ds_read_b64_tr_b16 a[170:171], v21 offset:1024
    v_mfma_f32_16x16x32_bf16 v[112:115], a[176:179], a[232:235], v[112:115]
    buffer_load_dwordx4 v10, s[12:15], s65 offen offset:2048 lds
    v_mfma_f32_16x16x32_bf16 v[104:107], a[176:179], a[240:243], v[104:107]
    ds_read_b64_tr_b16 a[172:173], v21 offset:8192
    v_mfma_f32_16x16x32_bf16 v[104:107], a[180:183], a[244:247], v[104:107]
    v_mfma_f32_16x16x32_bf16 v[96:99], a[180:183], a[252:255], v[96:99]
    ds_read_b64_tr_b16 a[174:175], v21 offset:9216
    v_mfma_f32_16x16x32_bf16 v[96:99], a[176:179], a[248:251], v[96:99]
    s_waitcnt lgkmcnt(8)
    buffer_load_dwordx4 v11, s[12:15], s65 offen offset:3072 lds
    v_mfma_f32_16x16x32_bf16 v[100:103], a[184:187], a[248:251], v[100:103]
    ds_read_b64_tr_b16 a[176:177], v22 offset:0
    v_mfma_f32_16x16x32_bf16 v[100:103], a[188:191], a[252:255], v[100:103]
    s_add_u32 s70, s65, 32768
    v_mfma_f32_16x16x32_bf16 v[108:111], a[188:191], a[244:247], v[108:111]
    s_add_u32 m0, s63, 135168
    ds_read_b64_tr_b16 a[178:179], v22 offset:1024
    v_mfma_f32_16x16x32_bf16 v[108:111], a[184:187], a[240:243], v[108:111]
    buffer_load_dwordx4 v8, s[12:15], s70 offen offset:0 lds
    v_mfma_f32_16x16x32_bf16 v[116:119], a[184:187], a[232:235], v[116:119]
    ds_read_b64_tr_b16 a[180:181], v22 offset:8192
    v_mfma_f32_16x16x32_bf16 v[116:119], a[188:191], a[236:239], v[116:119]
    v_mfma_f32_16x16x32_bf16 v[124:127], a[188:191], a[228:231], v[124:127]
    ds_read_b64_tr_b16 a[182:183], v22 offset:9216
    v_mfma_f32_16x16x32_bf16 v[124:127], a[184:187], a[224:227], v[124:127]
    s_waitcnt lgkmcnt(8)
    buffer_load_dwordx4 v9, s[12:15], s70 offen offset:1024 lds
    v_mfma_f32_16x16x32_bf16 v[152:155], a[160:163], a[224:227], v[152:155]
    ds_read_b64_tr_b16 a[184:185], v23 offset:0
    v_mfma_f32_16x16x32_bf16 v[152:155], a[164:167], a[228:231], v[152:155]
    v_mfma_f32_16x16x32_bf16 v[144:147], a[164:167], a[236:239], v[144:147]
    ds_read_b64_tr_b16 a[186:187], v23 offset:1024
    v_mfma_f32_16x16x32_bf16 v[144:147], a[160:163], a[232:235], v[144:147]
    buffer_load_dwordx4 v10, s[12:15], s70 offen offset:2048 lds
    v_mfma_f32_16x16x32_bf16 v[136:139], a[160:163], a[240:243], v[136:139]
    ds_read_b64_tr_b16 a[188:189], v23 offset:8192
    v_mfma_f32_16x16x32_bf16 v[136:139], a[164:167], a[244:247], v[136:139]
    v_mfma_f32_16x16x32_bf16 v[128:131], a[164:167], a[252:255], v[128:131]
    ds_read_b64_tr_b16 a[190:191], v23 offset:9216
    v_mfma_f32_16x16x32_bf16 v[128:131], a[160:163], a[248:251], v[128:131]
    s_waitcnt lgkmcnt(8)
    buffer_load_dwordx4 v11, s[12:15], s70 offen offset:3072 lds
    v_mfma_f32_16x16x32_bf16 v[132:135], a[168:171], a[248:251], v[132:135]
    s_add_u32 s65, s65, 128
    ds_read_b64_tr_b16 a[160:161], v16 offset:16384
    v_mfma_f32_16x16x32_bf16 v[132:135], a[172:175], a[252:255], v[132:135]
    v_mfma_f32_16x16x32_bf16 v[140:143], a[172:175], a[244:247], v[140:143]
    ds_read_b64_tr_b16 a[162:163], v16 offset:17408
    v_mfma_f32_16x16x32_bf16 v[140:143], a[168:171], a[240:243], v[140:143]
    global_load_dword v55, v[40:41], off
    v_mfma_f32_16x16x32_bf16 v[148:151], a[168:171], a[232:235], v[148:151]
    ds_read_b64_tr_b16 a[164:165], v16 offset:24576
    v_mfma_f32_16x16x32_bf16 v[148:151], a[172:175], a[236:239], v[148:151]
    v_add_co_u32 v40, vcc, v40, v42
    v_mfma_f32_16x16x32_bf16 v[156:159], a[172:175], a[228:231], v[156:159]
    ds_read_b64_tr_b16 a[166:167], v16 offset:25600
    v_mfma_f32_16x16x32_bf16 v[156:159], a[168:171], a[224:227], v[156:159]
    s_waitcnt lgkmcnt(8)
    v_addc_co_u32 v41, vcc, 0, v41, vcc
    v_mfma_f32_16x16x32_bf16 v[184:187], a[176:179], a[224:227], v[184:187]
    ds_read_b64_tr_b16 a[168:169], v17 offset:16384
    v_mfma_f32_16x16x32_bf16 v[184:187], a[180:183], a[228:231], v[184:187]
    v_mfma_f32_16x16x32_bf16 v[176:179], a[180:183], a[236:239], v[176:179]
    ds_read_b64_tr_b16 a[170:171], v17 offset:17408
    v_mfma_f32_16x16x32_bf16 v[176:179], a[176:179], a[232:235], v[176:179]
    v_mfma_f32_16x16x32_bf16 v[168:171], a[176:179], a[240:243], v[168:171]
    ds_read_b64_tr_b16 a[172:173], v17 offset:24576
    v_mfma_f32_16x16x32_bf16 v[168:171], a[180:183], a[244:247], v[168:171]
    v_mfma_f32_16x16x32_bf16 v[160:163], a[180:183], a[252:255], v[160:163]
    ds_read_b64_tr_b16 a[174:175], v17 offset:25600
    v_mfma_f32_16x16x32_bf16 v[160:163], a[176:179], a[248:251], v[160:163]
    s_waitcnt lgkmcnt(8)
    global_load_dword v55, v[40:41], off
    v_mfma_f32_16x16x32_bf16 v[164:167], a[184:187], a[248:251], v[164:167]
    ds_read_b64_tr_b16 a[176:177], v18 offset:16384
    v_mfma_f32_16x16x32_bf16 v[164:167], a[188:191], a[252:255], v[164:167]
    v_add_co_u32 v40, vcc, v40, v42
    v_mfma_f32_16x16x32_bf16 v[172:175], a[188:191], a[244:247], v[172:175]
    ds_read_b64_tr_b16 a[178:179], v18 offset:17408
    v_mfma_f32_16x16x32_bf16 v[172:175], a[184:187], a[240:243], v[172:175]
    v_addc_co_u32 v41, vcc, 0, v41, vcc
    v_mfma_f32_16x16x32_bf16 v[180:183], a[184:187], a[232:235], v[180:183]
    ds_read_b64_tr_b16 a[180:181], v18 offset:24576
    v_mfma_f32_16x16x32_bf16 v[180:183], a[188:191], a[236:239], v[180:183]
    v_mfma_f32_16x16x32_bf16 v[188:191], a[188:191], a[228:231], v[188:191]
    ds_read_b64_tr_b16 a[182:183], v18 offset:25600
    v_mfma_f32_16x16x32_bf16 v[188:191], a[184:187], a[224:227], v[188:191]
    s_waitcnt lgkmcnt(8)
    v_mfma_f32_16x16x32_bf16 a[0:3], a[224:227], a[160:163], a[0:3]
    ds_read_b64_tr_b16 a[184:185], v19 offset:16384
    v_mfma_f32_16x16x32_bf16 a[0:3], a[228:231], a[164:167], a[0:3]
    v_mfma_f32_16x16x32_bf16 a[4:7], a[236:239], a[164:167], a[4:7]
    ds_read_b64_tr_b16 a[186:187], v19 offset:17408
    v_mfma_f32_16x16x32_bf16 a[4:7], a[232:235], a[160:163], a[4:7]
    v_mfma_f32_16x16x32_bf16 a[64:67], a[240:243], a[160:163], a[64:67]
    ds_read_b64_tr_b16 a[188:189], v19 offset:24576
    v_mfma_f32_16x16x32_bf16 a[64:67], a[244:247], a[164:167], a[64:67]
    v_mfma_f32_16x16x32_bf16 a[68:71], a[252:255], a[164:167], a[68:71]
    ds_read_b64_tr_b16 a[190:191], v19 offset:25600
    v_mfma_f32_16x16x32_bf16 a[68:71], a[248:251], a[160:163], a[68:71]
    s_waitcnt lgkmcnt(8)
    v_mfma_f32_16x16x32_bf16 a[76:79], a[248:251], a[168:171], a[76:79]
    ds_read_b64_tr_b16 a[160:161], v20 offset:16384
    v_mfma_f32_16x16x32_bf16 a[76:79], a[252:255], a[172:175], a[76:79]
    v_mfma_f32_16x16x32_bf16 a[72:75], a[244:247], a[172:175], a[72:75]
    ds_read_b64_tr_b16 a[162:163], v20 offset:17408
    v_mfma_f32_16x16x32_bf16 a[72:75], a[240:243], a[168:171], a[72:75]
    v_mfma_f32_16x16x32_bf16 a[12:15], a[232:235], a[168:171], a[12:15]
    ds_read_b64_tr_b16 a[164:165], v20 offset:24576
    v_mfma_f32_16x16x32_bf16 a[12:15], a[236:239], a[172:175], a[12:15]
    v_mfma_f32_16x16x32_bf16 a[8:11], a[228:231], a[172:175], a[8:11]
    ds_read_b64_tr_b16 a[166:167], v20 offset:25600
    v_mfma_f32_16x16x32_bf16 a[8:11], a[224:227], a[168:171], a[8:11]
    s_waitcnt lgkmcnt(8)
    v_mfma_f32_16x16x32_bf16 a[16:19], a[224:227], a[176:179], a[16:19]
    ds_read_b64_tr_b16 a[168:169], v21 offset:16384
    v_mfma_f32_16x16x32_bf16 a[16:19], a[228:231], a[180:183], a[16:19]
    v_mfma_f32_16x16x32_bf16 a[20:23], a[236:239], a[180:183], a[20:23]
    ds_read_b64_tr_b16 a[170:171], v21 offset:17408
    v_mfma_f32_16x16x32_bf16 a[20:23], a[232:235], a[176:179], a[20:23]
    v_mfma_f32_16x16x32_bf16 a[80:83], a[240:243], a[176:179], a[80:83]
    ds_read_b64_tr_b16 a[172:173], v21 offset:24576
    v_mfma_f32_16x16x32_bf16 a[80:83], a[244:247], a[180:183], a[80:83]
    v_mfma_f32_16x16x32_bf16 a[84:87], a[252:255], a[180:183], a[84:87]
    ds_read_b64_tr_b16 a[174:175], v21 offset:25600
    v_mfma_f32_16x16x32_bf16 a[84:87], a[248:251], a[176:179], a[84:87]
    s_waitcnt lgkmcnt(8)
    v_mfma_f32_16x16x32_bf16 a[92:95], a[248:251], a[184:187], a[92:95]
    ds_read_b64_tr_b16 a[176:177], v22 offset:16384
    v_mfma_f32_16x16x32_bf16 a[92:95], a[252:255], a[188:191], a[92:95]
    v_mfma_f32_16x16x32_bf16 a[88:91], a[244:247], a[188:191], a[88:91]
    ds_read_b64_tr_b16 a[178:179], v22 offset:17408
    v_mfma_f32_16x16x32_bf16 a[88:91], a[240:243], a[184:187], a[88:91]
    buffer_store_dwordx4 v[48:51], v2, s[48:51], s93 offen offset:0 sc1
    v_mfma_f32_16x16x32_bf16 a[28:31], a[232:235], a[184:187], a[28:31]
    ds_read_b64_tr_b16 a[180:181], v22 offset:24576
    v_mfma_f32_16x16x32_bf16 a[28:31], a[236:239], a[188:191], a[28:31]
    v_mfma_f32_16x16x32_bf16 a[24:27], a[228:231], a[188:191], a[24:27]
    ds_read_b64_tr_b16 a[182:183], v22 offset:25600
    v_mfma_f32_16x16x32_bf16 a[24:27], a[224:227], a[184:187], a[24:27]
    s_waitcnt lgkmcnt(8)
    v_mfma_f32_16x16x32_bf16 a[32:35], a[224:227], a[160:163], a[32:35]
    ds_read_b64_tr_b16 a[184:185], v23 offset:16384
    ds_read_b64_tr_b16 a[186:187], v23 offset:17408
    v_mfma_f32_16x16x32_bf16 a[32:35], a[228:231], a[164:167], a[32:35]
    v_mfma_f32_16x16x32_bf16 a[36:39], a[236:239], a[164:167], a[36:39]
    ds_read_b64_tr_b16 a[188:189], v23 offset:24576
    v_mfma_f32_16x16x32_bf16 a[36:39], a[232:235], a[160:163], a[36:39]
    v_mfma_f32_16x16x32_bf16 a[96:99], a[240:243], a[160:163], a[96:99]
    ds_read_b64_tr_b16 a[190:191], v23 offset:25600
    v_mfma_f32_16x16x32_bf16 a[96:99], a[244:247], a[164:167], a[96:99]
    v_mfma_f32_16x16x32_bf16 a[100:103], a[252:255], a[164:167], a[100:103]
    v_mfma_f32_16x16x32_bf16 a[100:103], a[248:251], a[160:163], a[100:103]
    s_waitcnt vmcnt(22) lgkmcnt(0)
    v_mfma_f32_16x16x32_bf16 a[108:111], a[248:251], a[168:171], a[108:111]
    s_barrier
    ds_read_b64_tr_b16 a[160:161], v16 offset:32768
    v_mfma_f32_16x16x32_bf16 a[108:111], a[252:255], a[172:175], a[108:111]
    ds_read_b128 a[192:195], v24 offset:0
    ds_read_b128 a[196:199], v25 offset:0
    v_mfma_f32_16x16x32_bf16 a[104:107], a[244:247], a[172:175], a[104:107]
    s_add_u32 m0, s80, 0
    ds_read_b64_tr_b16 a[162:163], v16 offset:33792
    v_mfma_f32_16x16x32_bf16 a[104:107], a[240:243], a[168:171], a[104:107]
    buffer_load_dwordx4 v4, s[20:23], s64 offen offset:0 lds
    v_mfma_f32_16x16x32_bf16 a[44:47], a[232:235], a[168:171], a[44:47]
    ds_read_b64_tr_b16 a[164:165], v16 offset:40960
    v_mfma_f32_16x16x32_bf16 a[44:47], a[236:239], a[172:175], a[44:47]
    ds_read_b128 a[200:203], v24 offset:2048
    ds_read_b128 a[204:207], v25 offset:2048
    v_mfma_f32_16x16x32_bf16 a[40:43], a[228:231], a[172:175], a[40:43]
    ds_read_b64_tr_b16 a[166:167], v16 offset:41984
    v_mfma_f32_16x16x32_bf16 a[40:43], a[224:227], a[168:171], a[40:43]
    buffer_load_dwordx4 v5, s[20:23], s64 offen offset:1024 lds
    v_mfma_f32_16x16x32_bf16 a[48:51], a[224:227], a[176:179], a[48:51]
    ds_read_b64_tr_b16 a[168:169], v17 offset:32768
    v_mfma_f32_16x16x32_bf16 a[48:51], a[228:231], a[180:183], a[48:51]
    ds_read_b128 a[208:211], v24 offset:4096
    ds_read_b128 a[212:215], v25 offset:4096
    v_mfma_f32_16x16x32_bf16 a[52:55], a[236:239], a[180:183], a[52:55]
    ds_read_b64_tr_b16 a[170:171], v17 offset:33792
    v_mfma_f32_16x16x32_bf16 a[52:55], a[232:235], a[176:179], a[52:55]
    buffer_load_dwordx4 v6, s[20:23], s64 offen offset:2048 lds
    v_mfma_f32_16x16x32_bf16 a[112:115], a[240:243], a[176:179], a[112:115]
    ds_read_b64_tr_b16 a[172:173], v17 offset:40960
    v_mfma_f32_16x16x32_bf16 a[112:115], a[244:247], a[180:183], a[112:115]
    ds_read_b128 a[216:219], v24 offset:6144
    ds_read_b128 a[220:223], v25 offset:6144
    v_mfma_f32_16x16x32_bf16 a[116:119], a[252:255], a[180:183], a[116:119]
    ds_read_b64_tr_b16 a[174:175], v17 offset:41984
    v_mfma_f32_16x16x32_bf16 a[116:119], a[248:251], a[176:179], a[116:119]
    buffer_load_dwordx4 v7, s[20:23], s64 offen offset:3072 lds
    v_mfma_f32_16x16x32_bf16 a[124:127], a[248:251], a[184:187], a[124:127]
    ds_read_b64_tr_b16 a[176:177], v18 offset:32768
    v_mfma_f32_16x16x32_bf16 a[124:127], a[252:255], a[188:191], a[124:127]
    v_mfma_f32_16x16x32_bf16 a[120:123], a[244:247], a[188:191], a[120:123]
    s_add_u32 m0, s80, 16384
    ds_read_b64_tr_b16 a[178:179], v18 offset:33792
    v_mfma_f32_16x16x32_bf16 a[120:123], a[240:243], a[184:187], a[120:123]
    buffer_load_dwordx4 v4, s[56:59], s64 offen offset:0 lds
    v_mfma_f32_16x16x32_bf16 a[60:63], a[232:235], a[184:187], a[60:63]
    ds_read_b64_tr_b16 a[180:181], v18 offset:40960
    v_mfma_f32_16x16x32_bf16 a[60:63], a[236:239], a[188:191], a[60:63]
    v_mfma_f32_16x16x32_bf16 a[56:59], a[228:231], a[188:191], a[56:59]
    ds_read_b64_tr_b16 a[182:183], v18 offset:41984
    v_mfma_f32_16x16x32_bf16 a[56:59], a[224:227], a[184:187], a[56:59]
    s_waitcnt lgkmcnt(5)
    buffer_load_dwordx4 v5, s[56:59], s64 offen offset:1024 lds
    v_mfma_f32_16x16x32_bf16 v[88:91], a[160:163], a[192:195], v[88:91]
    ds_read_b64_tr_b16 a[184:185], v19 offset:32768
    v_mfma_f32_16x16x32_bf16 v[88:91], a[164:167], a[196:199], v[88:91]
    v_mfma_f32_16x16x32_bf16 v[80:83], a[164:167], a[204:207], v[80:83]
    ds_read_b64_tr_b16 a[186:187], v19 offset:33792
    v_mfma_f32_16x16x32_bf16 v[80:83], a[160:163], a[200:203], v[80:83]
    buffer_load_dwordx4 v6, s[56:59], s64 offen offset:2048 lds
    v_mfma_f32_16x16x32_bf16 v[72:75], a[160:163], a[208:211], v[72:75]
    ds_read_b64_tr_b16 a[188:189], v19 offset:40960
    v_mfma_f32_16x16x32_bf16 v[72:75], a[164:167], a[212:215], v[72:75]
    v_mfma_f32_16x16x32_bf16 v[64:67], a[164:167], a[220:223], v[64:67]
    ds_read_b64_tr_b16 a[190:191], v19 offset:41984
    v_mfma_f32_16x16x32_bf16 v[64:67], a[160:163], a[216:219], v[64:67]
    s_waitcnt lgkmcnt(8)
    buffer_load_dwordx4 v7, s[56:59], s64 offen offset:3072 lds
    v_mfma_f32_16x16x32_bf16 v[68:71], a[168:171], a[216:219], v[68:71]
    s_add_u32 s64, s64, 524288
    ds_read_b64_tr_b16 a[160:161], v20 offset:32768
    v_mfma_f32_16x16x32_bf16 v[68:71], a[172:175], a[220:223], v[68:71]
    v_mfma_f32_16x16x32_bf16 v[76:79], a[172:175], a[212:215], v[76:79]
    s_add_u32 m0, s63, 98304
    ds_read_b64_tr_b16 a[162:163], v20 offset:33792
    v_mfma_f32_16x16x32_bf16 v[76:79], a[168:171], a[208:211], v[76:79]
    buffer_load_dwordx4 v8, s[12:15], s65 offen offset:0 lds
    v_mfma_f32_16x16x32_bf16 v[84:87], a[168:171], a[200:203], v[84:87]
    ds_read_b64_tr_b16 a[164:165], v20 offset:40960
    v_mfma_f32_16x16x32_bf16 v[84:87], a[172:175], a[204:207], v[84:87]
    v_mfma_f32_16x16x32_bf16 v[92:95], a[172:175], a[196:199], v[92:95]
    ds_read_b64_tr_b16 a[166:167], v20 offset:41984
    v_mfma_f32_16x16x32_bf16 v[92:95], a[168:171], a[192:195], v[92:95]
    s_waitcnt lgkmcnt(8)
    buffer_load_dwordx4 v9, s[12:15], s65 offen offset:1024 lds
    v_mfma_f32_16x16x32_bf16 v[120:123], a[176:179], a[192:195], v[120:123]
    ds_read_b64_tr_b16 a[168:169], v21 offset:32768
    v_mfma_f32_16x16x32_bf16 v[120:123], a[180:183], a[196:199], v[120:123]
    v_mfma_f32_16x16x32_bf16 v[112:115], a[180:183], a[204:207], v[112:115]
    ds_read_b64_tr_b16 a[170:171], v21 offset:33792
    v_mfma_f32_16x16x32_bf16 v[112:115], a[176:179], a[200:203], v[112:115]
    buffer_load_dwordx4 v10, s[12:15], s65 offen offset:2048 lds
    v_mfma_f32_16x16x32_bf16 v[104:107], a[176:179], a[208:211], v[104:107]
    ds_read_b64_tr_b16 a[172:173], v21 offset:40960
    v_mfma_f32_16x16x32_bf16 v[104:107], a[180:183], a[212:215], v[104:107]
    v_mfma_f32_16x16x32_bf16 v[96:99], a[180:183], a[220:223], v[96:99]
    ds_read_b64_tr_b16 a[174:175], v21 offset:41984
    v_mfma_f32_16x16x32_bf16 v[96:99], a[176:179], a[216:219], v[96:99]
    s_waitcnt lgkmcnt(8)
    buffer_load_dwordx4 v11, s[12:15], s65 offen offset:3072 lds
    v_mfma_f32_16x16x32_bf16 v[100:103], a[184:187], a[216:219], v[100:103]
    ds_read_b64_tr_b16 a[176:177], v22 offset:32768
    v_mfma_f32_16x16x32_bf16 v[100:103], a[188:191], a[220:223], v[100:103]
    s_add_u32 s70, s65, 32768
    v_mfma_f32_16x16x32_bf16 v[108:111], a[188:191], a[212:215], v[108:111]
    s_add_u32 m0, s63, 102400
    ds_read_b64_tr_b16 a[178:179], v22 offset:33792
    v_mfma_f32_16x16x32_bf16 v[108:111], a[184:187], a[208:211], v[108:111]
    buffer_load_dwordx4 v8, s[12:15], s70 offen offset:0 lds
    v_mfma_f32_16x16x32_bf16 v[116:119], a[184:187], a[200:203], v[116:119]
    ds_read_b64_tr_b16 a[180:181], v22 offset:40960
    v_mfma_f32_16x16x32_bf16 v[116:119], a[188:191], a[204:207], v[116:119]
    v_mfma_f32_16x16x32_bf16 v[124:127], a[188:191], a[196:199], v[124:127]
    ds_read_b64_tr_b16 a[182:183], v22 offset:41984
    v_mfma_f32_16x16x32_bf16 v[124:127], a[184:187], a[192:195], v[124:127]
    s_waitcnt lgkmcnt(8)
    buffer_load_dwordx4 v9, s[12:15], s70 offen offset:1024 lds
    v_mfma_f32_16x16x32_bf16 v[152:155], a[160:163], a[192:195], v[152:155]
    ds_read_b64_tr_b16 a[184:185], v23 offset:32768
    v_mfma_f32_16x16x32_bf16 v[152:155], a[164:167], a[196:199], v[152:155]
    v_mfma_f32_16x16x32_bf16 v[144:147], a[164:167], a[204:207], v[144:147]
    ds_read_b64_tr_b16 a[186:187], v23 offset:33792
    v_mfma_f32_16x16x32_bf16 v[144:147], a[160:163], a[200:203], v[144:147]
    buffer_load_dwordx4 v10, s[12:15], s70 offen offset:2048 lds
    v_mfma_f32_16x16x32_bf16 v[136:139], a[160:163], a[208:211], v[136:139]
    ds_read_b64_tr_b16 a[188:189], v23 offset:40960
    v_mfma_f32_16x16x32_bf16 v[136:139], a[164:167], a[212:215], v[136:139]
    v_mfma_f32_16x16x32_bf16 v[128:131], a[164:167], a[220:223], v[128:131]
    ds_read_b64_tr_b16 a[190:191], v23 offset:41984
    v_mfma_f32_16x16x32_bf16 v[128:131], a[160:163], a[216:219], v[128:131]
    s_waitcnt lgkmcnt(8)
    buffer_load_dwordx4 v11, s[12:15], s70 offen offset:3072 lds
    v_mfma_f32_16x16x32_bf16 v[132:135], a[168:171], a[216:219], v[132:135]
    s_add_u32 s65, s65, 128
    ds_read_b64_tr_b16 a[160:161], v16 offset:49152
    v_mfma_f32_16x16x32_bf16 v[132:135], a[172:175], a[220:223], v[132:135]
    v_mfma_f32_16x16x32_bf16 v[140:143], a[172:175], a[212:215], v[140:143]
    ds_read_b64_tr_b16 a[162:163], v16 offset:50176
    v_mfma_f32_16x16x32_bf16 v[140:143], a[168:171], a[208:211], v[140:143]
    global_load_dword v55, v[40:41], off
    v_mfma_f32_16x16x32_bf16 v[148:151], a[168:171], a[200:203], v[148:151]
    ds_read_b64_tr_b16 a[164:165], v16 offset:57344
    v_mfma_f32_16x16x32_bf16 v[148:151], a[172:175], a[204:207], v[148:151]
    v_add_co_u32 v40, vcc, v40, v42
    v_mfma_f32_16x16x32_bf16 v[156:159], a[172:175], a[196:199], v[156:159]
    ds_read_b64_tr_b16 a[166:167], v16 offset:58368
    v_mfma_f32_16x16x32_bf16 v[156:159], a[168:171], a[192:195], v[156:159]
    s_waitcnt lgkmcnt(8)
    v_addc_co_u32 v41, vcc, 0, v41, vcc
    v_mfma_f32_16x16x32_bf16 v[184:187], a[176:179], a[192:195], v[184:187]
    ds_read_b64_tr_b16 a[168:169], v17 offset:49152
    v_mfma_f32_16x16x32_bf16 v[184:187], a[180:183], a[196:199], v[184:187]
    v_mfma_f32_16x16x32_bf16 v[176:179], a[180:183], a[204:207], v[176:179]
    ds_read_b64_tr_b16 a[170:171], v17 offset:50176
    v_add_u32 v16, 65536, v16
    v_mfma_f32_16x16x32_bf16 v[176:179], a[176:179], a[200:203], v[176:179]
    v_mfma_f32_16x16x32_bf16 v[168:171], a[176:179], a[208:211], v[168:171]
    ds_read_b64_tr_b16 a[172:173], v17 offset:57344
    v_mfma_f32_16x16x32_bf16 v[168:171], a[180:183], a[212:215], v[168:171]
    v_mfma_f32_16x16x32_bf16 v[160:163], a[180:183], a[220:223], v[160:163]
    ds_read_b64_tr_b16 a[174:175], v17 offset:58368
    v_mfma_f32_16x16x32_bf16 v[160:163], a[176:179], a[216:219], v[160:163]
    s_waitcnt lgkmcnt(8)
    global_load_dword v55, v[40:41], off
    v_mfma_f32_16x16x32_bf16 v[164:167], a[184:187], a[216:219], v[164:167]
    ds_read_b64_tr_b16 a[176:177], v18 offset:49152
    v_mfma_f32_16x16x32_bf16 v[164:167], a[188:191], a[220:223], v[164:167]
    v_add_co_u32 v40, vcc, v40, v42
    v_mfma_f32_16x16x32_bf16 v[172:175], a[188:191], a[212:215], v[172:175]
    ds_read_b64_tr_b16 a[178:179], v18 offset:50176
    v_add_u32 v17, 65536, v17
    v_mfma_f32_16x16x32_bf16 v[172:175], a[184:187], a[208:211], v[172:175]
    v_addc_co_u32 v41, vcc, 0, v41, vcc
    v_mfma_f32_16x16x32_bf16 v[180:183], a[184:187], a[200:203], v[180:183]
    ds_read_b64_tr_b16 a[180:181], v18 offset:57344
    v_mfma_f32_16x16x32_bf16 v[180:183], a[188:191], a[204:207], v[180:183]
    v_mfma_f32_16x16x32_bf16 v[188:191], a[188:191], a[196:199], v[188:191]
    ds_read_b64_tr_b16 a[182:183], v18 offset:58368
    v_mfma_f32_16x16x32_bf16 v[188:191], a[184:187], a[192:195], v[188:191]
    s_waitcnt lgkmcnt(8)
    v_mfma_f32_16x16x32_bf16 a[0:3], a[192:195], a[160:163], a[0:3]
    ds_read_b64_tr_b16 a[184:185], v19 offset:49152
    v_mfma_f32_16x16x32_bf16 a[0:3], a[196:199], a[164:167], a[0:3]
    v_mfma_f32_16x16x32_bf16 a[4:7], a[204:207], a[164:167], a[4:7]
    ds_read_b64_tr_b16 a[186:187], v19 offset:50176
    v_add_u32 v18, 65536, v18
    v_mfma_f32_16x16x32_bf16 a[4:7], a[200:203], a[160:163], a[4:7]
    v_mfma_f32_16x16x32_bf16 a[64:67], a[208:211], a[160:163], a[64:67]
    ds_read_b64_tr_b16 a[188:189], v19 offset:57344
    v_mfma_f32_16x16x32_bf16 a[64:67], a[212:215], a[164:167], a[64:67]
    v_mfma_f32_16x16x32_bf16 a[68:71], a[220:223], a[164:167], a[68:71]
    ds_read_b64_tr_b16 a[190:191], v19 offset:58368
    v_mfma_f32_16x16x32_bf16 a[68:71], a[216:219], a[160:163], a[68:71]
    s_waitcnt lgkmcnt(8)
    v_mfma_f32_16x16x32_bf16 a[76:79], a[216:219], a[168:171], a[76:79]
    ds_read_b64_tr_b16 a[160:161], v20 offset:49152
    v_mfma_f32_16x16x32_bf16 a[76:79], a[220:223], a[172:175], a[76:79]
    v_mfma_f32_16x16x32_bf16 a[72:75], a[212:215], a[172:175], a[72:75]
    ds_read_b64_tr_b16 a[162:163], v20 offset:50176
    v_add_u32 v19, 65536, v19
    v_mfma_f32_16x16x32_bf16 a[72:75], a[208:211], a[168:171], a[72:75]
    v_mfma_f32_16x16x32_bf16 a[12:15], a[200:203], a[168:171], a[12:15]
    ds_read_b64_tr_b16 a[164:165], v20 offset:57344
    v_mfma_f32_16x16x32_bf16 a[12:15], a[204:207], a[172:175], a[12:15]
    v_mfma_f32_16x16x32_bf16 a[8:11], a[196:199], a[172:175], a[8:11]
    ds_read_b64_tr_b16 a[166:167], v20 offset:58368
    v_mfma_f32_16x16x32_bf16 a[8:11], a[192:195], a[168:171], a[8:11]
    s_waitcnt lgkmcnt(8)
    v_mfma_f32_16x16x32_bf16 a[16:19], a[192:195], a[176:179], a[16:19]
    ds_read_b64_tr_b16 a[168:169], v21 offset:49152
    v_mfma_f32_16x16x32_bf16 a[16:19], a[196:199], a[180:183], a[16:19]
    v_mfma_f32_16x16x32_bf16 a[20:23], a[204:207], a[180:183], a[20:23]
    ds_read_b64_tr_b16 a[170:171], v21 offset:50176
    v_add_u32 v20, 65536, v20
    v_mfma_f32_16x16x32_bf16 a[20:23], a[200:203], a[176:179], a[20:23]
    v_mfma_f32_16x16x32_bf16 a[80:83], a[208:211], a[176:179], a[80:83]
    ds_read_b64_tr_b16 a[172:173], v21 offset:57344
    v_mfma_f32_16x16x32_bf16 a[80:83], a[212:215], a[180:183], a[80:83]
    v_mfma_f32_16x16x32_bf16 a[84:87], a[220:223], a[180:183], a[84:87]
    ds_read_b64_tr_b16 a[174:175], v21 offset:58368
    v_mfma_f32_16x16x32_bf16 a[84:87], a[216:219], a[176:179], a[84:87]
    s_waitcnt lgkmcnt(8)
    v_mfma_f32_16x16x32_bf16 a[92:95], a[216:219], a[184:187], a[92:95]
    ds_read_b64_tr_b16 a[176:177], v22 offset:49152
    v_mfma_f32_16x16x32_bf16 a[92:95], a[220:223], a[188:191], a[92:95]
    v_mfma_f32_16x16x32_bf16 a[88:91], a[212:215], a[188:191], a[88:91]
    ds_read_b64_tr_b16 a[178:179], v22 offset:50176
    v_add_u32 v21, 65536, v21
    v_mfma_f32_16x16x32_bf16 a[88:91], a[208:211], a[184:187], a[88:91]
    buffer_store_dwordx4 v[48:51], v2, s[48:51], s93 offen offset:1024 sc1
    v_mfma_f32_16x16x32_bf16 a[28:31], a[200:203], a[184:187], a[28:31]
    ds_read_b64_tr_b16 a[180:181], v22 offset:57344
    v_mfma_f32_16x16x32_bf16 a[28:31], a[204:207], a[188:191], a[28:31]
    v_mfma_f32_16x16x32_bf16 a[24:27], a[196:199], a[188:191], a[24:27]
    ds_read_b64_tr_b16 a[182:183], v22 offset:58368
    v_mfma_f32_16x16x32_bf16 a[24:27], a[192:195], a[184:187], a[24:27]
    s_waitcnt lgkmcnt(8)
    v_mfma_f32_16x16x32_bf16 a[32:35], a[192:195], a[160:163], a[32:35]
    ds_read_b64_tr_b16 a[184:185], v23 offset:49152
    ds_read_b64_tr_b16 a[186:187], v23 offset:50176
    v_mfma_f32_16x16x32_bf16 a[32:35], a[196:199], a[164:167], a[32:35]
    v_mfma_f32_16x16x32_bf16 a[36:39], a[204:207], a[164:167], a[36:39]
    ds_read_b64_tr_b16 a[188:189], v23 offset:57344
    v_add_u32 v22, 65536, v22
    v_mfma_f32_16x16x32_bf16 a[36:39], a[200:203], a[160:163], a[36:39]
    v_mfma_f32_16x16x32_bf16 a[96:99], a[208:211], a[160:163], a[96:99]
    ds_read_b64_tr_b16 a[190:191], v23 offset:58368
    v_mfma_f32_16x16x32_bf16 a[96:99], a[212:215], a[164:167], a[96:99]
    buffer_load_dword v32, v15, s[52:55], 0 offen sc1
    v_mfma_f32_16x16x32_bf16 a[100:103], a[220:223], a[164:167], a[100:103]
    v_mfma_f32_16x16x32_bf16 a[100:103], a[216:219], a[160:163], a[100:103]
    s_waitcnt vmcnt(23) lgkmcnt(0)
    v_mfma_f32_16x16x32_bf16 a[108:111], a[216:219], a[168:171], a[108:111]
    s_barrier
    ds_read_b64_tr_b16 a[160:161], v16 offset:0
    v_mfma_f32_16x16x32_bf16 a[108:111], a[220:223], a[172:175], a[108:111]
    ds_read_b128 a[224:227], v24 offset:32768
    ds_read_b128 a[228:231], v25 offset:32768
    v_mfma_f32_16x16x32_bf16 a[104:107], a[212:215], a[172:175], a[104:107]
    s_add_u32 m0, s80, 32768
    ds_read_b64_tr_b16 a[162:163], v16 offset:1024
    v_add_u32 v23, 65536, v23
    v_mfma_f32_16x16x32_bf16 a[104:107], a[208:211], a[168:171], a[104:107]
    buffer_load_dwordx4 v4, s[20:23], s64 offen offset:0 lds
    v_mfma_f32_16x16x32_bf16 a[44:47], a[200:203], a[168:171], a[44:47]
    ds_read_b64_tr_b16 a[164:165], v16 offset:8192
    v_mfma_f32_16x16x32_bf16 a[44:47], a[204:207], a[172:175], a[44:47]
    ds_read_b128 a[232:235], v24 offset:34816
    ds_read_b128 a[236:239], v25 offset:34816
    v_mfma_f32_16x16x32_bf16 a[40:43], a[196:199], a[172:175], a[40:43]
    ds_read_b64_tr_b16 a[166:167], v16 offset:9216
    v_mfma_f32_16x16x32_bf16 a[40:43], a[192:195], a[168:171], a[40:43]
    buffer_load_dwordx4 v5, s[20:23], s64 offen offset:1024 lds
    v_mfma_f32_16x16x32_bf16 a[48:51], a[192:195], a[176:179], a[48:51]
    ds_read_b64_tr_b16 a[168:169], v17 offset:0
    v_mfma_f32_16x16x32_bf16 a[48:51], a[196:199], a[180:183], a[48:51]
    ds_read_b128 a[240:243], v24 offset:36864
    ds_read_b128 a[244:247], v25 offset:36864
    v_mfma_f32_16x16x32_bf16 a[52:55], a[204:207], a[180:183], a[52:55]
    ds_read_b64_tr_b16 a[170:171], v17 offset:1024
    v_mfma_f32_16x16x32_bf16 a[52:55], a[200:203], a[176:179], a[52:55]
    buffer_load_dwordx4 v6, s[20:23], s64 offen offset:2048 lds
    v_mfma_f32_16x16x32_bf16 a[112:115], a[208:211], a[176:179], a[112:115]
    ds_read_b64_tr_b16 a[172:173], v17 offset:8192
    v_mfma_f32_16x16x32_bf16 a[112:115], a[212:215], a[180:183], a[112:115]
    ds_read_b128 a[248:251], v24 offset:38912
    ds_read_b128 a[252:255], v25 offset:38912
    v_mfma_f32_16x16x32_bf16 a[116:119], a[220:223], a[180:183], a[116:119]
    ds_read_b64_tr_b16 a[174:175], v17 offset:9216
    v_mfma_f32_16x16x32_bf16 a[116:119], a[216:219], a[176:179], a[116:119]
    buffer_load_dwordx4 v7, s[20:23], s64 offen offset:3072 lds
    v_mfma_f32_16x16x32_bf16 a[124:127], a[216:219], a[184:187], a[124:127]
    ds_read_b64_tr_b16 a[176:177], v18 offset:0
    v_mfma_f32_16x16x32_bf16 a[124:127], a[220:223], a[188:191], a[124:127]
    v_mfma_f32_16x16x32_bf16 a[120:123], a[212:215], a[188:191], a[120:123]
    s_add_u32 m0, s80, 49152
    ds_read_b64_tr_b16 a[178:179], v18 offset:1024
    v_mfma_f32_16x16x32_bf16 a[120:123], a[208:211], a[184:187], a[120:123]
    buffer_load_dwordx4 v4, s[56:59], s64 offen offset:0 lds
    v_mfma_f32_16x16x32_bf16 a[60:63], a[200:203], a[184:187], a[60:63]
    ds_read_b64_tr_b16 a[180:181], v18 offset:8192
    v_mfma_f32_16x16x32_bf16 a[60:63], a[204:207], a[188:191], a[60:63]
    v_mfma_f32_16x16x32_bf16 a[56:59], a[196:199], a[188:191], a[56:59]
    ds_read_b64_tr_b16 a[182:183], v18 offset:9216
    v_mfma_f32_16x16x32_bf16 a[56:59], a[192:195], a[184:187], a[56:59]
    s_waitcnt lgkmcnt(5)
    buffer_load_dwordx4 v5, s[56:59], s64 offen offset:1024 lds
    v_mfma_f32_16x16x32_bf16 v[88:91], a[160:163], a[224:227], v[88:91]
    ds_read_b64_tr_b16 a[184:185], v19 offset:0
    v_mfma_f32_16x16x32_bf16 v[88:91], a[164:167], a[228:231], v[88:91]
    v_mfma_f32_16x16x32_bf16 v[80:83], a[164:167], a[236:239], v[80:83]
    ds_read_b64_tr_b16 a[186:187], v19 offset:1024
    v_mfma_f32_16x16x32_bf16 v[80:83], a[160:163], a[232:235], v[80:83]
    buffer_load_dwordx4 v6, s[56:59], s64 offen offset:2048 lds
    v_mfma_f32_16x16x32_bf16 v[72:75], a[160:163], a[240:243], v[72:75]
    ds_read_b64_tr_b16 a[188:189], v19 offset:8192
    v_mfma_f32_16x16x32_bf16 v[72:75], a[164:167], a[244:247], v[72:75]
    v_mfma_f32_16x16x32_bf16 v[64:67], a[164:167], a[252:255], v[64:67]
    ds_read_b64_tr_b16 a[190:191], v19 offset:9216
    v_mfma_f32_16x16x32_bf16 v[64:67], a[160:163], a[248:251], v[64:67]
    s_waitcnt lgkmcnt(8)
    buffer_load_dwordx4 v7, s[56:59], s64 offen offset:3072 lds
    v_mfma_f32_16x16x32_bf16 v[68:71], a[168:171], a[248:251], v[68:71]
    s_sub_u32 s64, s64, 3670016
    ds_read_b64_tr_b16 a[160:161], v20 offset:0
    v_mfma_f32_16x16x32_bf16 v[68:71], a[172:175], a[252:255], v[68:71]
    v_mfma_f32_16x16x32_bf16 v[76:79], a[172:175], a[244:247], v[76:79]
    s_add_u32 m0, s63, 131072
    ds_read_b64_tr_b16 a[162:163], v20 offset:1024
    v_mfma_f32_16x16x32_bf16 v[76:79], a[168:171], a[240:243], v[76:79]
    buffer_load_dwordx4 v8, s[12:15], s65 offen offset:0 lds
    v_mfma_f32_16x16x32_bf16 v[84:87], a[168:171], a[232:235], v[84:87]
    ds_read_b64_tr_b16 a[164:165], v20 offset:8192
    v_mfma_f32_16x16x32_bf16 v[84:87], a[172:175], a[236:239], v[84:87]
    v_mfma_f32_16x16x32_bf16 v[92:95], a[172:175], a[228:231], v[92:95]
    ds_read_b64_tr_b16 a[166:167], v20 offset:9216
    v_mfma_f32_16x16x32_bf16 v[92:95], a[168:171], a[224:227], v[92:95]
    s_waitcnt lgkmcnt(8)
    buffer_load_dwordx4 v9, s[12:15], s65 offen offset:1024 lds
    v_mfma_f32_16x16x32_bf16 v[120:123], a[176:179], a[224:227], v[120:123]
    ds_read_b64_tr_b16 a[168:169], v21 offset:0
    v_mfma_f32_16x16x32_bf16 v[120:123], a[180:183], a[228:231], v[120:123]
    v_mfma_f32_16x16x32_bf16 v[112:115], a[180:183], a[236:239], v[112:115]
    ds_read_b64_tr_b16 a[170:171], v21 offset:1024
    v_mfma_f32_16x16x32_bf16 v[112:115], a[176:179], a[232:235], v[112:115]
    buffer_load_dwordx4 v10, s[12:15], s65 offen offset:2048 lds
    v_mfma_f32_16x16x32_bf16 v[104:107], a[176:179], a[240:243], v[104:107]
    ds_read_b64_tr_b16 a[172:173], v21 offset:8192
    v_mfma_f32_16x16x32_bf16 v[104:107], a[180:183], a[244:247], v[104:107]
    v_mfma_f32_16x16x32_bf16 v[96:99], a[180:183], a[252:255], v[96:99]
    ds_read_b64_tr_b16 a[174:175], v21 offset:9216
    v_mfma_f32_16x16x32_bf16 v[96:99], a[176:179], a[248:251], v[96:99]
    s_waitcnt lgkmcnt(8)
    buffer_load_dwordx4 v11, s[12:15], s65 offen offset:3072 lds
    v_mfma_f32_16x16x32_bf16 v[100:103], a[184:187], a[248:251], v[100:103]
    ds_read_b64_tr_b16 a[176:177], v22 offset:0
    v_mfma_f32_16x16x32_bf16 v[100:103], a[188:191], a[252:255], v[100:103]
    s_add_u32 s70, s65, 32768
    v_mfma_f32_16x16x32_bf16 v[108:111], a[188:191], a[244:247], v[108:111]
    s_add_u32 m0, s63, 135168
    ds_read_b64_tr_b16 a[178:179], v22 offset:1024
    v_mfma_f32_16x16x32_bf16 v[108:111], a[184:187], a[240:243], v[108:111]
    buffer_load_dwordx4 v8, s[12:15], s70 offen offset:0 lds
    v_mfma_f32_16x16x32_bf16 v[116:119], a[184:187], a[232:235], v[116:119]
    ds_read_b64_tr_b16 a[180:181], v22 offset:8192
    v_mfma_f32_16x16x32_bf16 v[116:119], a[188:191], a[236:239], v[116:119]
    v_mfma_f32_16x16x32_bf16 v[124:127], a[188:191], a[228:231], v[124:127]
    ds_read_b64_tr_b16 a[182:183], v22 offset:9216
    v_mfma_f32_16x16x32_bf16 v[124:127], a[184:187], a[224:227], v[124:127]
    s_waitcnt lgkmcnt(8)
    buffer_load_dwordx4 v9, s[12:15], s70 offen offset:1024 lds
    v_mfma_f32_16x16x32_bf16 v[152:155], a[160:163], a[224:227], v[152:155]
    ds_read_b64_tr_b16 a[184:185], v23 offset:0
    v_mfma_f32_16x16x32_bf16 v[152:155], a[164:167], a[228:231], v[152:155]
    v_mfma_f32_16x16x32_bf16 v[144:147], a[164:167], a[236:239], v[144:147]
    ds_read_b64_tr_b16 a[186:187], v23 offset:1024
    v_mfma_f32_16x16x32_bf16 v[144:147], a[160:163], a[232:235], v[144:147]
    buffer_load_dwordx4 v10, s[12:15], s70 offen offset:2048 lds
    v_mfma_f32_16x16x32_bf16 v[136:139], a[160:163], a[240:243], v[136:139]
    ds_read_b64_tr_b16 a[188:189], v23 offset:8192
    v_mfma_f32_16x16x32_bf16 v[136:139], a[164:167], a[244:247], v[136:139]
    v_mfma_f32_16x16x32_bf16 v[128:131], a[164:167], a[252:255], v[128:131]
    ds_read_b64_tr_b16 a[190:191], v23 offset:9216
    v_mfma_f32_16x16x32_bf16 v[128:131], a[160:163], a[248:251], v[128:131]
    s_waitcnt lgkmcnt(8)
    buffer_load_dwordx4 v11, s[12:15], s70 offen offset:3072 lds
    v_mfma_f32_16x16x32_bf16 v[132:135], a[168:171], a[248:251], v[132:135]
    s_mov_b32 s65, s95
    ds_read_b64_tr_b16 a[160:161], v16 offset:16384
    v_mfma_f32_16x16x32_bf16 v[132:135], a[172:175], a[252:255], v[132:135]
    v_mfma_f32_16x16x32_bf16 v[140:143], a[172:175], a[244:247], v[140:143]
    ds_read_b64_tr_b16 a[162:163], v16 offset:17408
    v_mfma_f32_16x16x32_bf16 v[140:143], a[168:171], a[240:243], v[140:143]
    global_load_dword v55, v[40:41], off
    v_mfma_f32_16x16x32_bf16 v[148:151], a[168:171], a[232:235], v[148:151]
    ds_read_b64_tr_b16 a[164:165], v16 offset:24576
    v_mfma_f32_16x16x32_bf16 v[148:151], a[172:175], a[236:239], v[148:151]
    v_add_co_u32 v40, vcc, v40, v42
    v_mfma_f32_16x16x32_bf16 v[156:159], a[172:175], a[228:231], v[156:159]
    ds_read_b64_tr_b16 a[166:167], v16 offset:25600
    v_mfma_f32_16x16x32_bf16 v[156:159], a[168:171], a[224:227], v[156:159]
    s_waitcnt lgkmcnt(8)
    v_addc_co_u32 v41, vcc, 0, v41, vcc
    v_mfma_f32_16x16x32_bf16 v[184:187], a[176:179], a[224:227], v[184:187]
    ds_read_b64_tr_b16 a[168:169], v17 offset:16384
    v_mfma_f32_16x16x32_bf16 v[184:187], a[180:183], a[228:231], v[184:187]
    v_mfma_f32_16x16x32_bf16 v[176:179], a[180:183], a[236:239], v[176:179]
    s_lshr_b32 s88, s2, 3
    ds_read_b64_tr_b16 a[170:171], v17 offset:17408
    v_add_u32 v16, 4294901760, v16
    v_mfma_f32_16x16x32_bf16 v[176:179], a[176:179], a[232:235], v[176:179]
    s_lshl_b32 s88, s88, 2
    v_mfma_f32_16x16x32_bf16 v[168:171], a[176:179], a[240:243], v[168:171]
    s_add_u32 s88, s88, s60
    ds_read_b64_tr_b16 a[172:173], v17 offset:24576
    v_mfma_f32_16x16x32_bf16 v[168:171], a[180:183], a[244:247], v[168:171]
    s_lshl_b32 s88, s88, 8
    v_mfma_f32_16x16x32_bf16 v[160:163], a[180:183], a[252:255], v[160:163]
    s_add_u32 s88, s88, L_c8 - L_pc
    ds_read_b64_tr_b16 a[174:175], v17 offset:25600
    v_min_u32 v33, 1, v1
    v_mfma_f32_16x16x32_bf16 v[160:163], a[176:179], a[248:251], v[160:163]
    s_waitcnt lgkmcnt(8)
    global_load_dword v55, v[40:41], off
    v_mfma_f32_16x16x32_bf16 v[164:167], a[184:187], a[248:251], v[164:167]
    ds_read_b64_tr_b16 a[176:177], v18 offset:16384
    v_lshlrev_b32 v33, 7, v33
    v_mfma_f32_16x16x32_bf16 v[164:167], a[188:191], a[252:255], v[164:167]
    v_add_co_u32 v40, vcc, v40, v42
    v_add_u32 v33, s88, v33
    v_mfma_f32_16x16x32_bf16 v[172:175], a[188:191], a[244:247], v[172:175]
    ds_read_b64_tr_b16 a[178:179], v18 offset:17408
    v_add_u32 v17, 4294901760, v17
    v_mfma_f32_16x16x32_bf16 v[172:175], a[184:187], a[240:243], v[172:175]
    v_addc_co_u32 v41, vcc, 0, v41, vcc
    v_min_u32 v33, L_mishdone - L_pc, v33
    v_mfma_f32_16x16x32_bf16 v[180:183], a[184:187], a[232:235], v[180:183]
    ds_read_b64_tr_b16 a[180:181], v18 offset:24576
    v_mfma_f32_16x16x32_bf16 v[180:183], a[188:191], a[236:239], v[180:183]
    global_load_dword v55, v33, s[90:91]
    v_mfma_f32_16x16x32_bf16 v[188:191], a[188:191], a[228:231], v[188:191]
    ds_read_b64_tr_b16 a[182:183], v18 offset:25600
    v_mfma_f32_16x16x32_bf16 v[188:191], a[184:187], a[224:227], v[188:191]
    s_waitcnt lgkmcnt(8)
    v_mfma_f32_16x16x32_bf16 a[0:3], a[224:227], a[160:163], a[0:3]
    ds_read_b64_tr_b16 a[184:185], v19 offset:16384
    v_mfma_f32_16x16x32_bf16 a[0:3], a[228:231], a[164:167], a[0:3]
    v_mfma_f32_16x16x32_bf16 a[4:7], a[236:239], a[164:167], a[4:7]
    ds_read_b64_tr_b16 a[186:187], v19 offset:17408
    v_add_u32 v18, 4294901760, v18
    v_mfma_f32_16x16x32_bf16 a[4:7], a[232:235], a[160:163], a[4:7]
    v_mfma_f32_16x16x32_bf16 a[64:67], a[240:243], a[160:163], a[64:67]
    ds_read_b64_tr_b16 a[188:189], v19 offset:24576
    v_mfma_f32_16x16x32_bf16 a[64:67], a[244:247], a[164:167], a[64:67]
    v_mfma_f32_16x16x32_bf16 a[68:71], a[252:255], a[164:167], a[68:71]
    ds_read_b64_tr_b16 a[190:191], v19 offset:25600
    v_mfma_f32_16x16x32_bf16 a[68:71], a[248:251], a[160:163], a[68:71]
    s_waitcnt lgkmcnt(8)
    v_mfma_f32_16x16x32_bf16 a[76:79], a[248:251], a[168:171], a[76:79]
    ds_read_b64_tr_b16 a[160:161], v20 offset:16384
    v_mfma_f32_16x16x32_bf16 a[76:79], a[252:255], a[172:175], a[76:79]
    v_mfma_f32_16x16x32_bf16 a[72:75], a[244:247], a[172:175], a[72:75]
    ds_read_b64_tr_b16 a[162:163], v20 offset:17408
    v_add_u32 v19, 4294901760, v19
    v_mfma_f32_16x16x32_bf16 a[72:75], a[240:243], a[168:171], a[72:75]
    v_mfma_f32_16x16x32_bf16 a[12:15], a[232:235], a[168:171], a[12:15]
    ds_read_b64_tr_b16 a[164:165], v20 offset:24576
    v_mfma_f32_16x16x32_bf16 a[12:15], a[236:239], a[172:175], a[12:15]
    v_mfma_f32_16x16x32_bf16 a[8:11], a[228:231], a[172:175], a[8:11]
    ds_read_b64_tr_b16 a[166:167], v20 offset:25600
    v_mfma_f32_16x16x32_bf16 a[8:11], a[224:227], a[168:171], a[8:11]
    s_waitcnt lgkmcnt(8)
    v_mfma_f32_16x16x32_bf16 a[16:19], a[224:227], a[176:179], a[16:19]
    ds_read_b64_tr_b16 a[168:169], v21 offset:16384
    v_mfma_f32_16x16x32_bf16 a[16:19], a[228:231], a[180:183], a[16:19]
    v_mfma_f32_16x16x32_bf16 a[20:23], a[236:239], a[180:183], a[20:23]
    ds_read_b64_tr_b16 a[170:171], v21 offset:17408
    v_add_u32 v20, 4294901760, v20
    v_mfma_f32_16x16x32_bf16 a[20:23], a[232:235], a[176:179], a[20:23]
    v_mfma_f32_16x16x32_bf16 a[80:83], a[240:243], a[176:179], a[80:83]
    ds_read_b64_tr_b16 a[172:173], v21 offset:24576
    v_mfma_f32_16x16x32_bf16 a[80:83], a[244:247], a[180:183], a[80:83]
    v_mfma_f32_16x16x32_bf16 a[84:87], a[252:255], a[180:183], a[84:87]
    ds_read_b64_tr_b16 a[174:175], v21 offset:25600
    v_mfma_f32_16x16x32_bf16 a[84:87], a[248:251], a[176:179], a[84:87]
    s_waitcnt lgkmcnt(8)
    v_mfma_f32_16x16x32_bf16 a[92:95], a[248:251], a[184:187], a[92:95]
    ds_read_b64_tr_b16 a[176:177], v22 offset:16384
    v_mfma_f32_16x16x32_bf16 a[92:95], a[252:255], a[188:191], a[92:95]
    v_mfma_f32_16x16x32_bf16 a[88:91], a[244:247], a[188:191], a[88:91]
    ds_read_b64_tr_b16 a[178:179], v22 offset:17408
    v_add_u32 v21, 4294901760, v21
    v_mfma_f32_16x16x32_bf16 a[88:91], a[240:243], a[184:187], a[88:91]
    buffer_store_dwordx4 v[48:51], v2, s[48:51], s94 offen offset:0 sc1
    v_mfma_f32_16x16x32_bf16 a[28:31], a[232:235], a[184:187], a[28:31]
    ds_read_b64_tr_b16 a[180:181], v22 offset:24576
    v_mfma_f32_16x16x32_bf16 a[28:31], a[236:239], a[188:191], a[28:31]
    v_mfma_f32_16x16x32_bf16 a[24:27], a[228:231], a[188:191], a[24:27]
    ds_read_b64_tr_b16 a[182:183], v22 offset:25600
    v_mfma_f32_16x16x32_bf16 a[24:27], a[224:227], a[184:187], a[24:27]
    s_waitcnt lgkmcnt(8)
    v_mfma_f32_16x16x32_bf16 a[32:35], a[224:227], a[160:163], a[32:35]
    ds_read_b64_tr_b16 a[184:185], v23 offset:16384
    ds_read_b64_tr_b16 a[186:187], v23 offset:17408
    v_mfma_f32_16x16x32_bf16 a[32:35], a[228:231], a[164:167], a[32:35]
    v_mfma_f32_16x16x32_bf16 a[36:39], a[236:239], a[164:167], a[36:39]
    ds_read_b64_tr_b16 a[188:189], v23 offset:24576
    v_add_u32 v22, 4294901760, v22
    v_mfma_f32_16x16x32_bf16 a[36:39], a[232:235], a[160:163], a[36:39]
    v_mfma_f32_16x16x32_bf16 a[96:99], a[240:243], a[160:163], a[96:99]
    ds_read_b64_tr_b16 a[190:191], v23 offset:25600
    v_mfma_f32_16x16x32_bf16 a[96:99], a[244:247], a[164:167], a[96:99]
    v_mfma_f32_16x16x32_bf16 a[100:103], a[252:255], a[164:167], a[100:103]
    v_mfma_f32_16x16x32_bf16 a[100:103], a[248:251], a[160:163], a[100:103]
    s_waitcnt vmcnt(24) lgkmcnt(0)
    v_mfma_f32_16x16x32_bf16 a[108:111], a[248:251], a[168:171], a[108:111]
    s_barrier
    ds_read_b64_tr_b16 a[160:161], v16 offset:0
    v_mfma_f32_16x16x32_bf16 a[108:111], a[252:255], a[172:175], a[108:111]
    ds_read_b128 a[192:195], v24 offset:0
    ds_read_b128 a[196:199], v25 offset:0
    v_mfma_f32_16x16x32_bf16 a[104:107], a[244:247], a[172:175], a[104:107]
    s_add_u32 m0, s80, 65536
    ds_read_b64_tr_b16 a[162:163], v16 offset:1024
    v_add_u32 v23, 4294901760, v23
    v_mfma_f32_16x16x32_bf16 a[104:107], a[240:243], a[168:171], a[104:107]
    buffer_load_dwordx4 v4, s[16:19], s64 offen offset:0 lds
    v_mfma_f32_16x16x32_bf16 a[44:47], a[232:235], a[168:171], a[44:47]
    ds_read_b64_tr_b16 a[164:165], v16 offset:8192
    v_mfma_f32_16x16x32_bf16 a[44:47], a[236:239], a[172:175], a[44:47]
    ds_read_b128 a[200:203], v24 offset:2048
    ds_read_b128 a[204:207], v25 offset:2048
    v_mfma_f32_16x16x32_bf16 a[40:43], a[228:231], a[172:175], a[40:43]
    ds_read_b64_tr_b16 a[166:167], v16 offset:9216
    v_mfma_f32_16x16x32_bf16 a[40:43], a[224:227], a[168:171], a[40:43]
    buffer_load_dwordx4 v5, s[16:19], s64 offen offset:1024 lds
    v_mfma_f32_16x16x32_bf16 a[48:51], a[224:227], a[176:179], a[48:51]
    ds_read_b64_tr_b16 a[168:169], v17 offset:0
    v_mfma_f32_16x16x32_bf16 a[48:51], a[228:231], a[180:183], a[48:51]
    ds_read_b128 a[208:211], v24 offset:4096
    ds_read_b128 a[212:215], v25 offset:4096
    v_mfma_f32_16x16x32_bf16 a[52:55], a[236:239], a[180:183], a[52:55]
    ds_read_b64_tr_b16 a[170:171], v17 offset:1024
    v_mfma_f32_16x16x32_bf16 a[52:55], a[232:235], a[176:179], a[52:55]
    buffer_load_dwordx4 v6, s[16:19], s64 offen offset:2048 lds
    v_mfma_f32_16x16x32_bf16 a[112:115], a[240:243], a[176:179], a[112:115]
    ds_read_b64_tr_b16 a[172:173], v17 offset:8192
    v_mfma_f32_16x16x32_bf16 a[112:115], a[244:247], a[180:183], a[112:115]
    ds_read_b128 a[216:219], v24 offset:6144
    ds_read_b128 a[220:223], v25 offset:6144
    v_mfma_f32_16x16x32_bf16 a[116:119], a[252:255], a[180:183], a[116:119]
    ds_read_b64_tr_b16 a[174:175], v17 offset:9216
    v_mfma_f32_16x16x32_bf16 a[116:119], a[248:251], a[176:179], a[116:119]
    buffer_load_dwordx4 v7, s[16:19], s64 offen offset:3072 lds
    v_mfma_f32_16x16x32_bf16 a[124:127], a[248:251], a[184:187], a[124:127]
    s_add_u32 s64, s64, 524288
    ds_read_b64_tr_b16 a[176:177], v18 offset:0
    v_mfma_f32_16x16x32_bf16 a[124:127], a[252:255], a[188:191], a[124:127]
    s_lshr_b32 s69, s80, 1
    v_mfma_f32_16x16x32_bf16 a[120:123], a[244:247], a[188:191], a[120:123]
    s_add_u32 m0, s69, 81920
    ds_read_b64_tr_b16 a[178:179], v18 offset:1024
    v_mfma_f32_16x16x32_bf16 a[120:123], a[240:243], a[184:187], a[120:123]
    buffer_load_dwordx4 v12, s[28:31], s67 offen offset:0 lds
    v_mfma_f32_16x16x32_bf16 a[60:63], a[232:235], a[184:187], a[60:63]
    ds_read_b64_tr_b16 a[180:181], v18 offset:8192
    v_mfma_f32_16x16x32_bf16 a[60:63], a[236:239], a[188:191], a[60:63]
    v_mfma_f32_16x16x32_bf16 a[56:59], a[228:231], a[188:191], a[56:59]
    ds_read_b64_tr_b16 a[182:183], v18 offset:9216
    v_mfma_f32_16x16x32_bf16 a[56:59], a[224:227], a[184:187], a[56:59]
    s_waitcnt lgkmcnt(5)
    buffer_load_dwordx4 v13, s[28:31], s67 offen offset:1024 lds
    v_mfma_f32_16x16x32_bf16 v[88:91], a[160:163], a[192:195], v[88:91]
    s_add_u32 s67, s67, s74
    ds_read_b64_tr_b16 a[184:185], v19 offset:0
    v_mfma_f32_16x16x32_bf16 v[88:91], a[164:167], a[196:199], v[88:91]
    v_mfma_f32_16x16x32_bf16 v[80:83], a[164:167], a[204:207], v[80:83]
    s_add_u32 m0, s63, 98304
    ds_read_b64_tr_b16 a[186:187], v19 offset:1024
    v_mfma_f32_16x16x32_bf16 v[80:83], a[160:163], a[200:203], v[80:83]
    buffer_load_dwordx4 v8, s[8:11], s65 offen offset:0 lds
    v_mfma_f32_16x16x32_bf16 v[72:75], a[160:163], a[208:211], v[72:75]
    ds_read_b64_tr_b16 a[188:189], v19 offset:8192
    v_mfma_f32_16x16x32_bf16 v[72:75], a[164:167], a[212:215], v[72:75]
    v_mfma_f32_16x16x32_bf16 v[64:67], a[164:167], a[220:223], v[64:67]
    ds_read_b64_tr_b16 a[190:191], v19 offset:9216
    v_mfma_f32_16x16x32_bf16 v[64:67], a[160:163], a[216:219], v[64:67]
    s_waitcnt lgkmcnt(8)
    buffer_load_dwordx4 v9, s[8:11], s65 offen offset:1024 lds
    v_mfma_f32_16x16x32_bf16 v[68:71], a[168:171], a[216:219], v[68:71]
    ds_read_b64_tr_b16 a[160:161], v20 offset:0
    v_mfma_f32_16x16x32_bf16 v[68:71], a[172:175], a[220:223], v[68:71]
    v_mfma_f32_16x16x32_bf16 v[76:79], a[172:175], a[212:215], v[76:79]
    ds_read_b64_tr_b16 a[162:163], v20 offset:1024
    v_mfma_f32_16x16x32_bf16 v[76:79], a[168:171], a[208:211], v[76:79]
    buffer_load_dwordx4 v10, s[8:11], s65 offen offset:2048 lds
    v_mfma_f32_16x16x32_bf16 v[84:87], a[168:171], a[200:203], v[84:87]
    ds_read_b64_tr_b16 a[164:165], v20 offset:8192
    v_mfma_f32_16x16x32_bf16 v[84:87], a[172:175], a[204:207], v[84:87]
    v_mfma_f32_16x16x32_bf16 v[92:95], a[172:175], a[196:199], v[92:95]
    ds_read_b64_tr_b16 a[166:167], v20 offset:9216
    v_mfma_f32_16x16x32_bf16 v[92:95], a[168:171], a[192:195], v[92:95]
    s_waitcnt lgkmcnt(8)
    buffer_load_dwordx4 v11, s[8:11], s65 offen offset:3072 lds
    v_mfma_f32_16x16x32_bf16 v[120:123], a[176:179], a[192:195], v[120:123]
    ds_read_b64_tr_b16 a[168:169], v21 offset:0
    v_mfma_f32_16x16x32_bf16 v[120:123], a[180:183], a[196:199], v[120:123]
    s_add_u32 s70, s65, 32768
    v_mfma_f32_16x16x32_bf16 v[112:115], a[180:183], a[204:207], v[112:115]
    s_add_u32 m0, s63, 102400
    ds_read_b64_tr_b16 a[170:171], v21 offset:1024
    v_mfma_f32_16x16x32_bf16 v[112:115], a[176:179], a[200:203], v[112:115]
    buffer_load_dwordx4 v8, s[8:11], s70 offen offset:0 lds
    v_mfma_f32_16x16x32_bf16 v[104:107], a[176:179], a[208:211], v[104:107]
    ds_read_b64_tr_b16 a[172:173], v21 offset:8192
    v_mfma_f32_16x16x32_bf16 v[104:107], a[180:183], a[212:215], v[104:107]
    v_mfma_f32_16x16x32_bf16 v[96:99], a[180:183], a[220:223], v[96:99]
    ds_read_b64_tr_b16 a[174:175], v21 offset:9216
    v_mfma_f32_16x16x32_bf16 v[96:99], a[176:179], a[216:219], v[96:99]
    s_waitcnt lgkmcnt(8)
    buffer_load_dwordx4 v9, s[8:11], s70 offen offset:1024 lds
    v_mfma_f32_16x16x32_bf16 v[100:103], a[184:187], a[216:219], v[100:103]
    ds_read_b64_tr_b16 a[176:177], v22 offset:0
    v_mfma_f32_16x16x32_bf16 v[100:103], a[188:191], a[220:223], v[100:103]
    v_mfma_f32_16x16x32_bf16 v[108:111], a[188:191], a[212:215], v[108:111]
    ds_read_b64_tr_b16 a[178:179], v22 offset:1024
    v_mfma_f32_16x16x32_bf16 v[108:111], a[184:187], a[208:211], v[108:111]
    buffer_load_dwordx4 v10, s[8:11], s70 offen offset:2048 lds
    v_mfma_f32_16x16x32_bf16 v[116:119], a[184:187], a[200:203], v[116:119]
    ds_read_b64_tr_b16 a[180:181], v22 offset:8192
    v_mfma_f32_16x16x32_bf16 v[116:119], a[188:191], a[204:207], v[116:119]
    v_mfma_f32_16x16x32_bf16 v[124:127], a[188:191], a[196:199], v[124:127]
    ds_read_b64_tr_b16 a[182:183], v22 offset:9216
    v_mfma_f32_16x16x32_bf16 v[124:127], a[184:187], a[192:195], v[124:127]
    s_waitcnt lgkmcnt(8)
    buffer_load_dwordx4 v11, s[8:11], s70 offen offset:3072 lds
    v_mfma_f32_16x16x32_bf16 v[152:155], a[160:163], a[192:195], v[152:155]
    s_add_u32 s65, s65, 128
    ds_read_b64_tr_b16 a[184:185], v23 offset:0
    v_mfma_f32_16x16x32_bf16 v[152:155], a[164:167], a[196:199], v[152:155]
    v_mfma_f32_16x16x32_bf16 v[144:147], a[164:167], a[204:207], v[144:147]
    ds_read_b64_tr_b16 a[186:187], v23 offset:1024
    v_mfma_f32_16x16x32_bf16 v[144:147], a[160:163], a[200:203], v[144:147]
    global_load_dword v55, v[40:41], off
    v_mfma_f32_16x16x32_bf16 v[136:139], a[160:163], a[208:211], v[136:139]
    ds_read_b64_tr_b16 a[188:189], v23 offset:8192
    v_mfma_f32_16x16x32_bf16 v[136:139], a[164:167], a[212:215], v[136:139]
    v_add_co_u32 v40, vcc, v40, v42
    v_mfma_f32_16x16x32_bf16 v[128:131], a[164:167], a[220:223], v[128:131]
    ds_read_b64_tr_b16 a[190:191], v23 offset:9216
    v_mfma_f32_16x16x32_bf16 v[128:131], a[160:163], a[216:219], v[128:131]
    s_waitcnt lgkmcnt(8)
    v_addc_co_u32 v41, vcc, 0, v41, vcc
    v_mfma_f32_16x16x32_bf16 v[132:135], a[168:171], a[216:219], v[132:135]
    ds_read_b64_tr_b16 a[160:161], v16 offset:16384
    v_mfma_f32_16x16x32_bf16 v[132:135], a[172:175], a[220:223], v[132:135]
    v_mfma_f32_16x16x32_bf16 v[140:143], a[172:175], a[212:215], v[140:143]
    ds_read_b64_tr_b16 a[162:163], v16 offset:17408
    v_mfma_f32_16x16x32_bf16 v[140:143], a[168:171], a[208:211], v[140:143]
    v_mfma_f32_16x16x32_bf16 v[148:151], a[168:171], a[200:203], v[148:151]
    ds_read_b64_tr_b16 a[164:165], v16 offset:24576
    v_mfma_f32_16x16x32_bf16 v[148:151], a[172:175], a[204:207], v[148:151]
    v_mfma_f32_16x16x32_bf16 v[156:159], a[172:175], a[196:199], v[156:159]
    ds_read_b64_tr_b16 a[166:167], v16 offset:25600
    v_mfma_f32_16x16x32_bf16 v[156:159], a[168:171], a[192:195], v[156:159]
    s_waitcnt lgkmcnt(8)
    global_load_dword v55, v[40:41], off
    v_mfma_f32_16x16x32_bf16 v[184:187], a[176:179], a[192:195], v[184:187]
    ds_read_b64_tr_b16 a[168:169], v17 offset:16384
    v_mfma_f32_16x16x32_bf16 v[184:187], a[180:183], a[196:199], v[184:187]
    v_add_co_u32 v40, vcc, v40, v42
    v_mfma_f32_16x16x32_bf16 v[176:179], a[180:183], a[204:207], v[176:179]
    ds_read_b64_tr_b16 a[170:171], v17 offset:17408
    v_mfma_f32_16x16x32_bf16 v[176:179], a[176:179], a[200:203], v[176:179]
    v_addc_co_u32 v41, vcc, 0, v41, vcc
    v_mfma_f32_16x16x32_bf16 v[168:171], a[176:179], a[208:211], v[168:171]
    ds_read_b64_tr_b16 a[172:173], v17 offset:24576
    v_mfma_f32_16x16x32_bf16 v[168:171], a[180:183], a[212:215], v[168:171]
    v_mfma_f32_16x16x32_bf16 v[160:163], a[180:183], a[220:223], v[160:163]
    ds_read_b64_tr_b16 a[174:175], v17 offset:25600
    v_mfma_f32_16x16x32_bf16 v[160:163], a[176:179], a[216:219], v[160:163]
    s_waitcnt lgkmcnt(8)
    v_mfma_f32_16x16x32_bf16 v[164:167], a[184:187], a[216:219], v[164:167]
    ds_read_b64_tr_b16 a[176:177], v18 offset:16384
    v_mfma_f32_16x16x32_bf16 v[164:167], a[188:191], a[220:223], v[164:167]
    v_mfma_f32_16x16x32_bf16 v[172:175], a[188:191], a[212:215], v[172:175]
    ds_read_b64_tr_b16 a[178:179], v18 offset:17408
    v_mfma_f32_16x16x32_bf16 v[172:175], a[184:187], a[208:211], v[172:175]
    v_mfma_f32_16x16x32_bf16 v[180:183], a[184:187], a[200:203], v[180:183]
    ds_read_b64_tr_b16 a[180:181], v18 offset:24576
    v_mfma_f32_16x16x32_bf16 v[180:183], a[188:191], a[204:207], v[180:183]
    v_mfma_f32_16x16x32_bf16 v[188:191], a[188:191], a[196:199], v[188:191]
    ds_read_b64_tr_b16 a[182:183], v18 offset:25600
    v_mfma_f32_16x16x32_bf16 v[188:191], a[184:187], a[192:195], v[188:191]
    s_waitcnt lgkmcnt(8)
    v_mfma_f32_16x16x32_bf16 a[0:3], a[192:195], a[160:163], a[0:3]
    ds_read_b64_tr_b16 a[184:185], v19 offset:16384
    v_mfma_f32_16x16x32_bf16 a[0:3], a[196:199], a[164:167], a[0:3]
    v_mfma_f32_16x16x32_bf16 a[4:7], a[204:207], a[164:167], a[4:7]
    ds_read_b64_tr_b16 a[186:187], v19 offset:17408
    v_mfma_f32_16x16x32_bf16 a[4:7], a[200:203], a[160:163], a[4:7]
    v_mfma_f32_16x16x32_bf16 a[64:67], a[208:211], a[160:163], a[64:67]
    ds_read_b64_tr_b16 a[188:189], v19 offset:24576
    v_mfma_f32_16x16x32_bf16 a[64:67], a[212:215], a[164:167], a[64:67]
    v_mfma_f32_16x16x32_bf16 a[68:71], a[220:223], a[164:167], a[68:71]
    ds_read_b64_tr_b16 a[190:191], v19 offset:25600
    v_mfma_f32_16x16x32_bf16 a[68:71], a[216:219], a[160:163], a[68:71]
    s_waitcnt lgkmcnt(8)
    v_mfma_f32_16x16x32_bf16 a[76:79], a[216:219], a[168:171], a[76:79]
    ds_read_b64_tr_b16 a[160:161], v20 offset:16384
    v_mfma_f32_16x16x32_bf16 a[76:79], a[220:223], a[172:175], a[76:79]
    v_mfma_f32_16x16x32_bf16 a[72:75], a[212:215], a[172:175], a[72:75]
    ds_read_b64_tr_b16 a[162:163], v20 offset:17408
    v_mfma_f32_16x16x32_bf16 a[72:75], a[208:211], a[168:171], a[72:75]
    v_mfma_f32_16x16x32_bf16 a[12:15], a[200:203], a[168:171], a[12:15]
    ds_read_b64_tr_b16 a[164:165], v20 offset:24576
    v_mfma_f32_16x16x32_bf16 a[12:15], a[204:207], a[172:175], a[12:15]
    v_mfma_f32_16x16x32_bf16 a[8:11], a[196:199], a[172:175], a[8:11]
    ds_read_b64_tr_b16 a[166:167], v20 offset:25600
    v_mfma_f32_16x16x32_bf16 a[8:11], a[192:195], a[168:171], a[8:11]
    s_waitcnt lgkmcnt(8)
    v_mfma_f32_16x16x32_bf16 a[16:19], a[192:195], a[176:179], a[16:19]
    ds_read_b64_tr_b16 a[168:169], v21 offset:16384
    v_mfma_f32_16x16x32_bf16 a[16:19], a[196:199], a[180:183], a[16:19]
    v_mfma_f32_16x16x32_bf16 a[20:23], a[204:207], a[180:183], a[20:23]
    ds_read_b64_tr_b16 a[170:171], v21 offset:17408
    v_mfma_f32_16x16x32_bf16 a[20:23], a[200:203], a[176:179], a[20:23]
    v_mfma_f32_16x16x32_bf16 a[80:83], a[208:211], a[176:179], a[80:83]
    ds_read_b64_tr_b16 a[172:173], v21 offset:24576
    v_mfma_f32_16x16x32_bf16 a[80:83], a[212:215], a[180:183], a[80:83]
    v_mfma_f32_16x16x32_bf16 a[84:87], a[220:223], a[180:183], a[84:87]
    ds_read_b64_tr_b16 a[174:175], v21 offset:25600
    v_mfma_f32_16x16x32_bf16 a[84:87], a[216:219], a[176:179], a[84:87]
    s_waitcnt lgkmcnt(8)
    v_mfma_f32_16x16x32_bf16 a[92:95], a[216:219], a[184:187], a[92:95]
    ds_read_b64_tr_b16 a[176:177], v22 offset:16384
    v_mfma_f32_16x16x32_bf16 a[92:95], a[220:223], a[188:191], a[92:95]
    v_mfma_f32_16x16x32_bf16 a[88:91], a[212:215], a[188:191], a[88:91]
    ds_read_b64_tr_b16 a[178:179], v22 offset:17408
    v_mfma_f32_16x16x32_bf16 a[88:91], a[208:211], a[184:187], a[88:91]
    buffer_store_dwordx4 v[48:51], v2, s[48:51], s94 offen offset:1024 sc1
    v_mfma_f32_16x16x32_bf16 a[28:31], a[200:203], a[184:187], a[28:31]
    ds_read_b64_tr_b16 a[180:181], v22 offset:24576
    v_mfma_f32_16x16x32_bf16 a[28:31], a[204:207], a[188:191], a[28:31]
    v_mfma_f32_16x16x32_bf16 a[24:27], a[196:199], a[188:191], a[24:27]
    ds_read_b64_tr_b16 a[182:183], v22 offset:25600
    v_mfma_f32_16x16x32_bf16 a[24:27], a[192:195], a[184:187], a[24:27]
    s_waitcnt lgkmcnt(8)
    v_mfma_f32_16x16x32_bf16 a[32:35], a[192:195], a[160:163], a[32:35]
    ds_read_b64_tr_b16 a[184:185], v23 offset:16384
    ds_read_b64_tr_b16 a[186:187], v23 offset:17408
    v_mfma_f32_16x16x32_bf16 a[32:35], a[196:199], a[164:167], a[32:35]
    v_mfma_f32_16x16x32_bf16 a[36:39], a[204:207], a[164:167], a[36:39]
    ds_read_b64_tr_b16 a[188:189], v23 offset:24576
    v_mfma_f32_16x16x32_bf16 a[36:39], a[200:203], a[160:163], a[36:39]
    v_mfma_f32_16x16x32_bf16 a[96:99], a[208:211], a[160:163], a[96:99]
    ds_read_b64_tr_b16 a[190:191], v23 offset:25600
    v_mfma_f32_16x16x32_bf16 a[96:99], a[212:215], a[164:167], a[96:99]
    v_mfma_f32_16x16x32_bf16 a[100:103], a[220:223], a[164:167], a[100:103]
    v_mfma_f32_16x16x32_bf16 a[100:103], a[216:219], a[160:163], a[100:103]
    s_waitcnt vmcnt(21) lgkmcnt(0)
    s_mov_b32 s88, 65536
L_s0_t:
    v_readfirstlane_b32 s71, v32
    s_cmp_ge_u32 s71, 1
    s_cbranch_scc1 L_s0_ok
    s_sub_u32 s88, s88, 1
    s_cmp_eq_u32 s88, 0
    s_cbranch_scc1 L_s0_ok
    s_sleep 1
    buffer_load_dword v32, v15, s[52:55], 0 offen sc1
    s_waitcnt vmcnt(0)
    s_branch L_s0_t
L_s0_ok:
    v_mfma_f32_16x16x32_bf16 a[108:111], a[216:219], a[168:171], a[108:111]
    s_barrier
    ds_read_b64_tr_b16 a[160:161], v16 offset:32768
    v_mfma_f32_16x16x32_bf16 a[108:111], a[220:223], a[172:175], a[108:111]
    ds_read_b128 a[224:227], v24 offset:32768
    ds_read_b128 a[228:231], v25 offset:32768
    v_mfma_f32_16x16x32_bf16 a[104:107], a[212:215], a[172:175], a[104:107]
    s_add_u32 m0, s80, 0
    ds_read_b64_tr_b16 a[162:163], v16 offset:33792
    v_mfma_f32_16x16x32_bf16 a[104:107], a[208:211], a[168:171], a[104:107]
    buffer_load_dwordx4 v4, s[16:19], s64 offen offset:0 lds
    v_mfma_f32_16x16x32_bf16 a[44:47], a[200:203], a[168:171], a[44:47]
    ds_read_b64_tr_b16 a[164:165], v16 offset:40960
    v_mfma_f32_16x16x32_bf16 a[44:47], a[204:207], a[172:175], a[44:47]
    ds_read_b128 a[232:235], v24 offset:34816
    ds_read_b128 a[236:239], v25 offset:34816
    v_mfma_f32_16x16x32_bf16 a[40:43], a[196:199], a[172:175], a[40:43]
    ds_read_b64_tr_b16 a[166:167], v16 offset:41984
    v_mfma_f32_16x16x32_bf16 a[40:43], a[192:195], a[168:171], a[40:43]
    buffer_load_dwordx4 v5, s[16:19], s64 offen offset:1024 lds
    v_mfma_f32_16x16x32_bf16 a[48:51], a[192:195], a[176:179], a[48:51]
    ds_read_b64_tr_b16 a[168:169], v17 offset:32768
    v_mfma_f32_16x16x32_bf16 a[48:51], a[196:199], a[180:183], a[48:51]
    ds_read_b128 a[240:243], v24 offset:36864
    ds_read_b128 a[244:247], v25 offset:36864
    v_mfma_f32_16x16x32_bf16 a[52:55], a[204:207], a[180:183], a[52:55]
    ds_read_b64_tr_b16 a[170:171], v17 offset:33792
    v_mfma_f32_16x16x32_bf16 a[52:55], a[200:203], a[176:179], a[52:55]
    buffer_load_dwordx4 v6, s[16:19], s64 offen offset:2048 lds
    v_mfma_f32_16x16x32_bf16 a[112:115], a[208:211], a[176:179], a[112:115]
    ds_read_b64_tr_b16 a[172:173], v17 offset:40960
    v_mfma_f32_16x16x32_bf16 a[112:115], a[212:215], a[180:183], a[112:115]
    ds_read_b128 a[248:251], v24 offset:38912
    ds_read_b128 a[252:255], v25 offset:38912
    v_mfma_f32_16x16x32_bf16 a[116:119], a[220:223], a[180:183], a[116:119]
    ds_read_b64_tr_b16 a[174:175], v17 offset:41984
    v_mfma_f32_16x16x32_bf16 a[116:119], a[216:219], a[176:179], a[116:119]
    buffer_load_dwordx4 v7, s[16:19], s64 offen offset:3072 lds
    v_mfma_f32_16x16x32_bf16 a[124:127], a[216:219], a[184:187], a[124:127]
    s_add_u32 s64, s64, 524288
    ds_read_b64_tr_b16 a[176:177], v18 offset:32768
    v_mfma_f32_16x16x32_bf16 a[124:127], a[220:223], a[188:191], a[124:127]
    s_lshr_b32 s69, s80, 1
    v_mfma_f32_16x16x32_bf16 a[120:123], a[212:215], a[188:191], a[120:123]
    s_add_u32 m0, s69, 16384
    ds_read_b64_tr_b16 a[178:179], v18 offset:33792
    v_mfma_f32_16x16x32_bf16 a[120:123], a[208:211], a[184:187], a[120:123]
    buffer_load_dwordx4 v12, s[28:31], s67 offen offset:0 lds
    v_mfma_f32_16x16x32_bf16 a[60:63], a[200:203], a[184:187], a[60:63]
    ds_read_b64_tr_b16 a[180:181], v18 offset:40960
    v_mfma_f32_16x16x32_bf16 a[60:63], a[204:207], a[188:191], a[60:63]
    v_mfma_f32_16x16x32_bf16 a[56:59], a[196:199], a[188:191], a[56:59]
    ds_read_b64_tr_b16 a[182:183], v18 offset:41984
    v_mfma_f32_16x16x32_bf16 a[56:59], a[192:195], a[184:187], a[56:59]
    s_waitcnt lgkmcnt(5)
    buffer_load_dwordx4 v13, s[28:31], s67 offen offset:1024 lds
    v_mfma_f32_16x16x32_bf16 v[88:91], a[160:163], a[224:227], v[88:91]
    s_add_u32 s67, s67, s74
    ds_read_b64_tr_b16 a[184:185], v19 offset:32768
    v_mfma_f32_16x16x32_bf16 v[88:91], a[164:167], a[228:231], v[88:91]
    v_mfma_f32_16x16x32_bf16 v[80:83], a[164:167], a[236:239], v[80:83]
    s_add_u32 m0, s63, 131072
    ds_read_b64_tr_b16 a[186:187], v19 offset:33792
    v_mfma_f32_16x16x32_bf16 v[80:83], a[160:163], a[232:235], v[80:83]
    buffer_load_dwordx4 v8, s[8:11], s65 offen offset:0 lds
    v_mfma_f32_16x16x32_bf16 v[72:75], a[160:163], a[240:243], v[72:75]
    ds_read_b64_tr_b16 a[188:189], v19 offset:40960
    v_mfma_f32_16x16x32_bf16 v[72:75], a[164:167], a[244:247], v[72:75]
    v_mfma_f32_16x16x32_bf16 v[64:67], a[164:167], a[252:255], v[64:67]
    ds_read_b64_tr_b16 a[190:191], v19 offset:41984
    v_mfma_f32_16x16x32_bf16 v[64:67], a[160:163], a[248:251], v[64:67]
    s_waitcnt lgkmcnt(8)
    buffer_load_dwordx4 v9, s[8:11], s65 offen offset:1024 lds
    v_mfma_f32_16x16x32_bf16 v[68:71], a[168:171], a[248:251], v[68:71]
    ds_read_b64_tr_b16 a[160:161], v20 offset:32768
    v_mfma_f32_16x16x32_bf16 v[68:71], a[172:175], a[252:255], v[68:71]
    v_mfma_f32_16x16x32_bf16 v[76:79], a[172:175], a[244:247], v[76:79]
    ds_read_b64_tr_b16 a[162:163], v20 offset:33792
    v_mfma_f32_16x16x32_bf16 v[76:79], a[168:171], a[240:243], v[76:79]
    buffer_load_dwordx4 v10, s[8:11], s65 offen offset:2048 lds
    v_mfma_f32_16x16x32_bf16 v[84:87], a[168:171], a[232:235], v[84:87]
    ds_read_b64_tr_b16 a[164:165], v20 offset:40960
    v_mfma_f32_16x16x32_bf16 v[84:87], a[172:175], a[236:239], v[84:87]
    v_mfma_f32_16x16x32_bf16 v[92:95], a[172:175], a[228:231], v[92:95]
    ds_read_b64_tr_b16 a[166:167], v20 offset:41984
    v_mfma_f32_16x16x32_bf16 v[92:95], a[168:171], a[224:227], v[92:95]
    s_waitcnt lgkmcnt(8)
    buffer_load_dwordx4 v11, s[8:11], s65 offen offset:3072 lds
    v_mfma_f32_16x16x32_bf16 v[120:123], a[176:179], a[224:227], v[120:123]
    ds_read_b64_tr_b16 a[168:169], v21 offset:32768
    v_mfma_f32_16x16x32_bf16 v[120:123], a[180:183], a[228:231], v[120:123]
    s_add_u32 s70, s65, 32768
    v_mfma_f32_16x16x32_bf16 v[112:115], a[180:183], a[236:239], v[112:115]
    s_add_u32 m0, s63, 135168
    ds_read_b64_tr_b16 a[170:171], v21 offset:33792
    v_mfma_f32_16x16x32_bf16 v[112:115], a[176:179], a[232:235], v[112:115]
    buffer_load_dwordx4 v8, s[8:11], s70 offen offset:0 lds
    v_mfma_f32_16x16x32_bf16 v[104:107], a[176:179], a[240:243], v[104:107]
    ds_read_b64_tr_b16 a[172:173], v21 offset:40960
    v_mul_f32 v64, s72, v64
    v_mfma_f32_16x16x32_bf16 v[104:107], a[180:183], a[244:247], v[104:107]
    v_mul_f32 v65, s72, v65
    v_mul_f32 v66, s72, v66
    v_mfma_f32_16x16x32_bf16 v[96:99], a[180:183], a[252:255], v[96:99]
    ds_read_b64_tr_b16 a[174:175], v21 offset:41984
    v_mul_f32 v67, s72, v67
    v_mfma_f32_16x16x32_bf16 v[96:99], a[176:179], a[248:251], v[96:99]
    s_waitcnt lgkmcnt(8)
    buffer_load_dwordx4 v9, s[8:11], s70 offen offset:1024 lds
    v_mfma_f32_16x16x32_bf16 v[100:103], a[184:187], a[248:251], v[100:103]
    ds_read_b64_tr_b16 a[176:177], v22 offset:32768
    v_mul_f32 v68, s72, v68
    v_mfma_f32_16x16x32_bf16 v[100:103], a[188:191], a[252:255], v[100:103]
    v_mul_f32 v69, s72, v69
    v_mul_f32 v70, s72, v70
    v_mfma_f32_16x16x32_bf16 v[108:111], a[188:191], a[244:247], v[108:111]
    ds_read_b64_tr_b16 a[178:179], v22 offset:33792
    v_mul_f32 v71, s72, v71
    v_cvt_pk_bf16_f32 v64, v64, v65
    v_mfma_f32_16x16x32_bf16 v[108:111], a[184:187], a[240:243], v[108:111]
    buffer_load_dwordx4 v10, s[8:11], s70 offen offset:2048 lds
    v_mfma_f32_16x16x32_bf16 v[116:119], a[184:187], a[232:235], v[116:119]
    ds_read_b64_tr_b16 a[180:181], v22 offset:40960
    v_cvt_pk_bf16_f32 v65, v66, v67
    v_cvt_pk_bf16_f32 v66, v68, v69
    v_mfma_f32_16x16x32_bf16 v[116:119], a[188:191], a[236:239], v[116:119]
    v_cvt_pk_bf16_f32 v67, v70, v71
    v_mul_f32 v72, s72, v72
    v_mfma_f32_16x16x32_bf16 v[124:127], a[188:191], a[228:231], v[124:127]
    ds_read_b64_tr_b16 a[182:183], v22 offset:41984
    v_mul_f32 v73, s72, v73
    v_mul_f32 v74, s72, v74
    v_mfma_f32_16x16x32_bf16 v[124:127], a[184:187], a[224:227], v[124:127]
    s_waitcnt lgkmcnt(8)
    buffer_load_dwordx4 v11, s[8:11], s70 offen offset:3072 lds
    v_mfma_f32_16x16x32_bf16 v[152:155], a[160:163], a[224:227], v[152:155]
    s_add_u32 s65, s65, 128
    ds_read_b64_tr_b16 a[184:185], v23 offset:32768
    v_mul_f32 v75, s72, v75
    v_mul_f32 v76, s72, v76
    v_mfma_f32_16x16x32_bf16 v[152:155], a[164:167], a[228:231], v[152:155]
    v_mul_f32 v77, s72, v77
    v_mul_f32 v78, s72, v78
    v_mfma_f32_16x16x32_bf16 v[144:147], a[164:167], a[236:239], v[144:147]
    ds_read_b64_tr_b16 a[186:187], v23 offset:33792
    v_mul_f32 v79, s72, v79
    v_mfma_f32_16x16x32_bf16 v[144:147], a[160:163], a[232:235], v[144:147]
    v_cvt_pk_bf16_f32 v72, v72, v73
    v_cvt_pk_bf16_f32 v73, v74, v75
    v_mfma_f32_16x16x32_bf16 v[136:139], a[160:163], a[240:243], v[136:139]
    ds_read_b64_tr_b16 a[188:189], v23 offset:40960
    v_cvt_pk_bf16_f32 v74, v76, v77
    v_mfma_f32_16x16x32_bf16 v[136:139], a[164:167], a[244:247], v[136:139]
    v_cvt_pk_bf16_f32 v75, v78, v79
    v_mul_f32 v80, s72, v80
    v_mfma_f32_16x16x32_bf16 v[128:131], a[164:167], a[252:255], v[128:131]
    ds_read_b64_tr_b16 a[190:191], v23 offset:41984
    v_mul_f32 v81, s72, v81
    v_mfma_f32_16x16x32_bf16 v[128:131], a[160:163], a[248:251], v[128:131]
    s_waitcnt lgkmcnt(8)
    v_mul_f32 v82, s72, v82
    v_mul_f32 v83, s72, v83
    v_mfma_f32_16x16x32_bf16 v[132:135], a[168:171], a[248:251], v[132:135]
    ds_read_b64_tr_b16 a[160:161], v16 offset:49152
    v_mul_f32 v84, s72, v84
    v_mfma_f32_16x16x32_bf16 v[132:135], a[172:175], a[252:255], v[132:135]
    v_mul_f32 v85, s72, v85
    v_mul_f32 v86, s72, v86
    v_mfma_f32_16x16x32_bf16 v[140:143], a[172:175], a[244:247], v[140:143]
    ds_read_b64_tr_b16 a[162:163], v16 offset:50176
    v_mul_f32 v87, s72, v87
    v_mfma_f32_16x16x32_bf16 v[140:143], a[168:171], a[240:243], v[140:143]
    v_cvt_pk_bf16_f32 v80, v80, v81
    v_cvt_pk_bf16_f32 v81, v82, v83
    v_mfma_f32_16x16x32_bf16 v[148:151], a[168:171], a[232:235], v[148:151]
    ds_read_b64_tr_b16 a[164:165], v16 offset:57344
    v_cvt_pk_bf16_f32 v82, v84, v85
    v_mfma_f32_16x16x32_bf16 v[148:151], a[172:175], a[236:239], v[148:151]
    v_cvt_pk_bf16_f32 v83, v86, v87
    v_mul_f32 v88, s72, v88
    v_mfma_f32_16x16x32_bf16 v[156:159], a[172:175], a[228:231], v[156:159]
    ds_read_b64_tr_b16 a[166:167], v16 offset:58368
    v_mul_f32 v89, s72, v89
    v_mfma_f32_16x16x32_bf16 v[156:159], a[168:171], a[224:227], v[156:159]
    s_waitcnt lgkmcnt(8)
    v_mul_f32 v90, s72, v90
    v_mul_f32 v91, s72, v91
    v_mfma_f32_16x16x32_bf16 v[184:187], a[176:179], a[224:227], v[184:187]
    ds_read_b64_tr_b16 a[168:169], v17 offset:49152
    v_mul_f32 v92, s72, v92
    v_mfma_f32_16x16x32_bf16 v[184:187], a[180:183], a[228:231], v[184:187]
    v_mul_f32 v93, s72, v93
    v_mul_f32 v94, s72, v94
    v_mul_f32 v95, s72, v95
    v_cvt_pk_bf16_f32 v88, v88, v89
    v_cvt_pk_bf16_f32 v89, v90, v91
    v_cvt_pk_bf16_f32 v90, v92, v93
    v_mfma_f32_16x16x32_bf16 v[176:179], a[180:183], a[236:239], v[176:179]
    ds_read_b64_tr_b16 a[170:171], v17 offset:50176
    v_add_u32 v16, 65536, v16
    v_cvt_pk_bf16_f32 v91, v94, v95
    v_mfma_f32_16x16x32_bf16 v[176:179], a[176:179], a[232:235], v[176:179]
    v_mul_f32 v96, s72, v96
    v_mul_f32 v97, s72, v97
    v_mfma_f32_16x16x32_bf16 v[168:171], a[176:179], a[240:243], v[168:171]
    ds_read_b64_tr_b16 a[172:173], v17 offset:57344
    v_mul_f32 v98, s72, v98
    v_mfma_f32_16x16x32_bf16 v[168:171], a[180:183], a[244:247], v[168:171]
    s_add_u32 s71, s66, 20480
    buffer_store_dwordx4 v[64:67], v2, s[48:51], s71 offen offset:0 sc1
    v_mfma_f32_16x16x32_bf16 v[160:163], a[180:183], a[252:255], v[160:163]
    ds_read_b64_tr_b16 a[174:175], v17 offset:58368
    v_mul_f32 v99, s72, v99
    v_mfma_f32_16x16x32_bf16 v[160:163], a[176:179], a[248:251], v[160:163]
    s_waitcnt lgkmcnt(8)
    v_mul_f32 v100, s72, v100
    v_mul_f32 v101, s72, v101
    v_mfma_f32_16x16x32_bf16 v[164:167], a[184:187], a[248:251], v[164:167]
    ds_read_b64_tr_b16 a[176:177], v18 offset:49152
    v_mul_f32 v102, s72, v102
    v_mfma_f32_16x16x32_bf16 v[164:167], a[188:191], a[252:255], v[164:167]
    v_mul_f32 v103, s72, v103
    v_cvt_pk_bf16_f32 v96, v96, v97
    v_mfma_f32_16x16x32_bf16 v[172:175], a[188:191], a[244:247], v[172:175]
    ds_read_b64_tr_b16 a[178:179], v18 offset:50176
    v_add_u32 v17, 65536, v17
    v_mfma_f32_16x16x32_bf16 v[172:175], a[184:187], a[240:243], v[172:175]
    v_cvt_pk_bf16_f32 v97, v98, v99
    v_cvt_pk_bf16_f32 v98, v100, v101
    v_mfma_f32_16x16x32_bf16 v[180:183], a[184:187], a[232:235], v[180:183]
    ds_read_b64_tr_b16 a[180:181], v18 offset:57344
    v_cvt_pk_bf16_f32 v99, v102, v103
    v_mfma_f32_16x16x32_bf16 v[180:183], a[188:191], a[236:239], v[180:183]
    s_add_u32 s71, s66, 16384
    buffer_store_dwordx4 v[72:75], v2, s[48:51], s71 offen offset:0 sc1
    v_mfma_f32_16x16x32_bf16 v[188:191], a[188:191], a[228:231], v[188:191]
    ds_read_b64_tr_b16 a[182:183], v18 offset:58368
    v_mul_f32 v104, s72, v104
    v_mul_f32 v105, s72, v105
    v_mfma_f32_16x16x32_bf16 v[188:191], a[184:187], a[224:227], v[188:191]
    s_waitcnt lgkmcnt(8)
    v_mul_f32 v106, s72, v106
    v_mul_f32 v107, s72, v107
    v_mfma_f32_16x16x32_bf16 a[0:3], a[224:227], a[160:163], a[0:3]
    ds_read_b64_tr_b16 a[184:185], v19 offset:49152
    v_mul_f32 v108, s72, v108
    v_mfma_f32_16x16x32_bf16 a[0:3], a[228:231], a[164:167], a[0:3]
    v_mul_f32 v109, s72, v109
    v_mul_f32 v110, s72, v110
    v_mul_f32 v111, s72, v111
    v_mfma_f32_16x16x32_bf16 a[4:7], a[236:239], a[164:167], a[4:7]
    ds_read_b64_tr_b16 a[186:187], v19 offset:50176
    v_add_u32 v18, 65536, v18
    v_mfma_f32_16x16x32_bf16 a[4:7], a[232:235], a[160:163], a[4:7]
    v_cvt_pk_bf16_f32 v104, v104, v105
    v_cvt_pk_bf16_f32 v105, v106, v107
    v_mfma_f32_16x16x32_bf16 a[64:67], a[240:243], a[160:163], a[64:67]
    ds_read_b64_tr_b16 a[188:189], v19 offset:57344
    v_cvt_pk_bf16_f32 v106, v108, v109
    v_mfma_f32_16x16x32_bf16 a[64:67], a[244:247], a[164:167], a[64:67]
    v_cvt_pk_bf16_f32 v107, v110, v111
    v_mul_f32 v112, s72, v112
    v_mfma_f32_16x16x32_bf16 a[68:71], a[252:255], a[164:167], a[68:71]
    ds_read_b64_tr_b16 a[190:191], v19 offset:58368
    v_mul_f32 v113, s72, v113
    v_mul_f32 v114, s72, v114
    v_mfma_f32_16x16x32_bf16 a[68:71], a[248:251], a[160:163], a[68:71]
    s_waitcnt lgkmcnt(8)
    s_add_u32 s71, s66, 4096
    buffer_store_dwordx4 v[80:83], v2, s[48:51], s71 offen offset:0 sc1
    v_mfma_f32_16x16x32_bf16 a[76:79], a[248:251], a[168:171], a[76:79]
    ds_read_b64_tr_b16 a[160:161], v20 offset:49152
    v_mul_f32 v115, s72, v115
    v_mul_f32 v116, s72, v116
    v_mfma_f32_16x16x32_bf16 a[76:79], a[252:255], a[172:175], a[76:79]
    v_mul_f32 v117, s72, v117
    v_mul_f32 v118, s72, v118
    v_mul_f32 v119, s72, v119
    v_mfma_f32_16x16x32_bf16 a[72:75], a[244:247], a[172:175], a[72:75]
    ds_read_b64_tr_b16 a[162:163], v20 offset:50176
    v_add_u32 v19, 65536, v19
    v_mfma_f32_16x16x32_bf16 a[72:75], a[240:243], a[168:171], a[72:75]
    v_cvt_pk_bf16_f32 v112, v112, v113
    v_cvt_pk_bf16_f32 v113, v114, v115
    v_mfma_f32_16x16x32_bf16 a[12:15], a[232:235], a[168:171], a[12:15]
    ds_read_b64_tr_b16 a[164:165], v20 offset:57344
    v_cvt_pk_bf16_f32 v114, v116, v117
    v_mfma_f32_16x16x32_bf16 a[12:15], a[236:239], a[172:175], a[12:15]
    v_cvt_pk_bf16_f32 v115, v118, v119
    v_mul_f32 v120, s72, v120
    v_mfma_f32_16x16x32_bf16 a[8:11], a[228:231], a[172:175], a[8:11]
    ds_read_b64_tr_b16 a[166:167], v20 offset:58368
    v_mul_f32 v121, s72, v121
    v_mul_f32 v122, s72, v122
    v_mfma_f32_16x16x32_bf16 a[8:11], a[224:227], a[168:171], a[8:11]
    s_waitcnt lgkmcnt(8)
    s_add_u32 s71, s66, 0
    buffer_store_dwordx4 v[88:91], v2, s[48:51], s71 offen offset:0 sc1
    v_mfma_f32_16x16x32_bf16 a[16:19], a[224:227], a[176:179], a[16:19]
    ds_read_b64_tr_b16 a[168:169], v21 offset:49152
    v_mul_f32 v123, s72, v123
    v_mul_f32 v124, s72, v124
    v_mfma_f32_16x16x32_bf16 a[16:19], a[228:231], a[180:183], a[16:19]
    v_mul_f32 v125, s72, v125
    v_mul_f32 v126, s72, v126
    v_mul_f32 v127, s72, v127
    v_cvt_pk_bf16_f32 v120, v120, v121
    v_cvt_pk_bf16_f32 v121, v122, v123
    v_cvt_pk_bf16_f32 v122, v124, v125
    v_mfma_f32_16x16x32_bf16 a[20:23], a[236:239], a[180:183], a[20:23]
    ds_read_b64_tr_b16 a[170:171], v21 offset:50176
    v_add_u32 v20, 65536, v20
    v_cvt_pk_bf16_f32 v123, v126, v127
    v_mfma_f32_16x16x32_bf16 a[20:23], a[232:235], a[176:179], a[20:23]
    v_mul_f32 v128, s72, v128
    v_mul_f32 v129, s72, v129
    v_mfma_f32_16x16x32_bf16 a[80:83], a[240:243], a[176:179], a[80:83]
    ds_read_b64_tr_b16 a[172:173], v21 offset:57344
    v_mul_f32 v130, s72, v130
    v_mfma_f32_16x16x32_bf16 a[80:83], a[244:247], a[180:183], a[80:83]
    v_mul_f32 v131, s72, v131
    v_mul_f32 v132, s72, v132
    v_mfma_f32_16x16x32_bf16 a[84:87], a[252:255], a[180:183], a[84:87]
    ds_read_b64_tr_b16 a[174:175], v21 offset:58368
    v_mul_f32 v133, s72, v133
    v_mfma_f32_16x16x32_bf16 a[84:87], a[248:251], a[176:179], a[84:87]
    s_waitcnt lgkmcnt(8)
    v_mul_f32 v134, s72, v134
    v_mul_f32 v135, s72, v135
    v_mfma_f32_16x16x32_bf16 a[92:95], a[248:251], a[184:187], a[92:95]
    ds_read_b64_tr_b16 a[176:177], v22 offset:49152
    v_cvt_pk_bf16_f32 v128, v128, v129
    v_mfma_f32_16x16x32_bf16 a[92:95], a[252:255], a[188:191], a[92:95]
    s_add_u32 s71, s66, 20480
    buffer_store_dwordx4 v[96:99], v2, s[48:51], s71 offen offset:1024 sc1
    v_mfma_f32_16x16x32_bf16 a[88:91], a[244:247], a[188:191], a[88:91]
    ds_read_b64_tr_b16 a[178:179], v22 offset:50176
    v_add_u32 v21, 65536, v21
    v_mfma_f32_16x16x32_bf16 a[88:91], a[240:243], a[184:187], a[88:91]
    v_cvt_pk_bf16_f32 v129, v130, v131
    v_cvt_pk_bf16_f32 v130, v132, v133
    v_mfma_f32_16x16x32_bf16 a[28:31], a[232:235], a[184:187], a[28:31]
    ds_read_b64_tr_b16 a[180:181], v22 offset:57344
    v_cvt_pk_bf16_f32 v131, v134, v135
    v_mfma_f32_16x16x32_bf16 a[28:31], a[236:239], a[188:191], a[28:31]
    v_accvgpr_write_b32 a140, v128
    v_accvgpr_write_b32 a141, v129
    v_mfma_f32_16x16x32_bf16 a[24:27], a[228:231], a[188:191], a[24:27]
    ds_read_b64_tr_b16 a[182:183], v22 offset:58368
    v_accvgpr_write_b32 a142, v130
    v_mfma_f32_16x16x32_bf16 a[24:27], a[224:227], a[184:187], a[24:27]
    s_waitcnt lgkmcnt(8)
    v_accvgpr_write_b32 a143, v131
    v_mul_f32 v136, s72, v136
    v_mul_f32 v137, s72, v137
    v_mul_f32 v138, s72, v138
    v_mfma_f32_16x16x32_bf16 a[32:35], a[224:227], a[160:163], a[32:35]
    ds_read_b64_tr_b16 a[184:185], v23 offset:49152
    ds_read_b64_tr_b16 a[186:187], v23 offset:50176
    v_mfma_f32_16x16x32_bf16 a[32:35], a[228:231], a[164:167], a[32:35]
    s_add_u32 s71, s66, 16384
    buffer_store_dwordx4 v[104:107], v2, s[48:51], s71 offen offset:1024 sc1
    v_mfma_f32_16x16x32_bf16 a[36:39], a[236:239], a[164:167], a[36:39]
    ds_read_b64_tr_b16 a[188:189], v23 offset:57344
    v_add_u32 v22, 65536, v22
    v_mfma_f32_16x16x32_bf16 a[36:39], a[232:235], a[160:163], a[36:39]
    v_mul_f32 v139, s72, v139
    v_mul_f32 v140, s72, v140
    v_mfma_f32_16x16x32_bf16 a[96:99], a[240:243], a[160:163], a[96:99]
    ds_read_b64_tr_b16 a[190:191], v23 offset:58368
    v_mul_f32 v141, s72, v141
    v_mfma_f32_16x16x32_bf16 a[96:99], a[244:247], a[164:167], a[96:99]
    v_mul_f32 v142, s72, v142
    v_mul_f32 v143, s72, v143
    v_mfma_f32_16x16x32_bf16 a[100:103], a[252:255], a[164:167], a[100:103]
    v_cvt_pk_bf16_f32 v136, v136, v137
    v_cvt_pk_bf16_f32 v137, v138, v139
    v_mfma_f32_16x16x32_bf16 a[100:103], a[248:251], a[160:163], a[100:103]
    s_waitcnt vmcnt(23) lgkmcnt(0)
    v_cvt_pk_bf16_f32 v138, v140, v141
    v_cvt_pk_bf16_f32 v139, v142, v143
    v_mfma_f32_16x16x32_bf16 a[108:111], a[248:251], a[168:171], a[108:111]
    s_barrier
    ds_read_b64_tr_b16 a[160:161], v16 offset:0
    v_accvgpr_write_b32 a136, v136
    v_accvgpr_write_b32 a137, v137
    v_accvgpr_write_b32 a138, v138
    v_accvgpr_write_b32 a139, v139
    v_mfma_f32_16x16x32_bf16 a[108:111], a[252:255], a[172:175], a[108:111]
    ds_read_b128 a[192:195], v24 offset:0
    ds_read_b128 a[196:199], v25 offset:0
    v_mfma_f32_16x16x32_bf16 a[104:107], a[244:247], a[172:175], a[104:107]
    s_add_u32 m0, s80, 32768
    ds_read_b64_tr_b16 a[162:163], v16 offset:1024
    v_add_u32 v23, 65536, v23
    v_mfma_f32_16x16x32_bf16 a[104:107], a[240:243], a[168:171], a[104:107]
    buffer_load_dwordx4 v4, s[16:19], s64 offen offset:0 lds
    v_mfma_f32_16x16x32_bf16 a[44:47], a[232:235], a[168:171], a[44:47]
    ds_read_b64_tr_b16 a[164:165], v16 offset:8192
    v_mul_f32 v144, s72, v144
    v_mul_f32 v145, s72, v145
    v_mul_f32 v146, s72, v146
    v_mfma_f32_16x16x32_bf16 a[44:47], a[236:239], a[172:175], a[44:47]
    ds_read_b128 a[200:203], v24 offset:2048
    ds_read_b128 a[204:207], v25 offset:2048
    v_mfma_f32_16x16x32_bf16 a[40:43], a[228:231], a[172:175], a[40:43]
    ds_read_b64_tr_b16 a[166:167], v16 offset:9216
    v_mul_f32 v147, s72, v147
    v_mul_f32 v148, s72, v148
    v_mul_f32 v149, s72, v149
    v_mfma_f32_16x16x32_bf16 a[40:43], a[224:227], a[168:171], a[40:43]
    buffer_load_dwordx4 v5, s[16:19], s64 offen offset:1024 lds
    v_mfma_f32_16x16x32_bf16 a[48:51], a[224:227], a[176:179], a[48:51]
    ds_read_b64_tr_b16 a[168:169], v17 offset:0
    v_mul_f32 v150, s72, v150
    v_mul_f32 v151, s72, v151
    v_cvt_pk_bf16_f32 v144, v144, v145
    v_cvt_pk_bf16_f32 v145, v146, v147
    v_cvt_pk_bf16_f32 v146, v148, v149
    v_cvt_pk_bf16_f32 v147, v150, v151
    v_mfma_f32_16x16x32_bf16 a[48:51], a[228:231], a[180:183], a[48:51]
    ds_read_b128 a[208:211], v24 offset:4096
    ds_read_b128 a[212:215], v25 offset:4096
    v_mfma_f32_16x16x32_bf16 a[52:55], a[236:239], a[180:183], a[52:55]
    ds_read_b64_tr_b16 a[170:171], v17 offset:1024
    v_add_u32 v16, 4294901760, v16
    v_mfma_f32_16x16x32_bf16 a[52:55], a[232:235], a[176:179], a[52:55]
    buffer_load_dwordx4 v6, s[16:19], s64 offen offset:2048 lds
    v_mfma_f32_16x16x32_bf16 a[112:115], a[240:243], a[176:179], a[112:115]
    ds_read_b64_tr_b16 a[172:173], v17 offset:8192
    v_accvgpr_write_b32 a132, v144
    v_accvgpr_write_b32 a133, v145
    v_accvgpr_write_b32 a134, v146
    v_mfma_f32_16x16x32_bf16 a[112:115], a[244:247], a[180:183], a[112:115]
    ds_read_b128 a[216:219], v24 offset:6144
    ds_read_b128 a[220:223], v25 offset:6144
    v_mfma_f32_16x16x32_bf16 a[116:119], a[252:255], a[180:183], a[116:119]
    ds_read_b64_tr_b16 a[174:175], v17 offset:9216
    v_accvgpr_write_b32 a135, v147
    v_mul_f32 v152, s72, v152
    v_mul_f32 v153, s72, v153
    v_mfma_f32_16x16x32_bf16 a[116:119], a[248:251], a[176:179], a[116:119]
    buffer_load_dwordx4 v7, s[16:19], s64 offen offset:3072 lds
    v_mfma_f32_16x16x32_bf16 a[124:127], a[248:251], a[184:187], a[124:127]
    s_add_u32 s64, s64, 524288
    ds_read_b64_tr_b16 a[176:177], v18 offset:0
    v_mul_f32 v154, s72, v154
    v_mul_f32 v155, s72, v155
    v_mul_f32 v156, s72, v156
    v_mul_f32 v157, s72, v157
    v_mul_f32 v158, s72, v158
    v_mul_f32 v159, s72, v159
    v_mfma_f32_16x16x32_bf16 a[124:127], a[252:255], a[188:191], a[124:127]
    s_lshr_b32 s69, s80, 1
    s_add_u32 s71, s66, 4096
    buffer_store_dwordx4 v[112:115], v2, s[48:51], s71 offen offset:1024 sc1
    v_mfma_f32_16x16x32_bf16 a[120:123], a[244:247], a[188:191], a[120:123]
    s_add_u32 m0, s69, 49152
    ds_read_b64_tr_b16 a[178:179], v18 offset:1024
    v_add_u32 v17, 4294901760, v17
    v_mfma_f32_16x16x32_bf16 a[120:123], a[240:243], a[184:187], a[120:123]
    buffer_load_dwordx4 v12, s[28:31], s67 offen offset:0 lds
    v_mfma_f32_16x16x32_bf16 a[60:63], a[232:235], a[184:187], a[60:63]
    ds_read_b64_tr_b16 a[180:181], v18 offset:8192
    v_cvt_pk_bf16_f32 v152, v152, v153
    v_cvt_pk_bf16_f32 v153, v154, v155
    v_cvt_pk_bf16_f32 v154, v156, v157
    v_mfma_f32_16x16x32_bf16 a[60:63], a[236:239], a[188:191], a[60:63]
    s_add_u32 s71, s66, 0
    buffer_store_dwordx4 v[120:123], v2, s[48:51], s71 offen offset:1024 sc1
    v_mfma_f32_16x16x32_bf16 a[56:59], a[228:231], a[188:191], a[56:59]
    ds_read_b64_tr_b16 a[182:183], v18 offset:9216
    v_cvt_pk_bf16_f32 v155, v158, v159
    v_accvgpr_write_b32 a128, v152
    v_accvgpr_write_b32 a129, v153
    v_accvgpr_write_b32 a130, v154
    v_accvgpr_write_b32 a131, v155
    v_mfma_f32_16x16x32_bf16 a[56:59], a[224:227], a[184:187], a[56:59]
    s_waitcnt lgkmcnt(5)
    buffer_load_dwordx4 v13, s[28:31], s67 offen offset:1024 lds
L_c8:
    v_mfma_f32_16x16x32_bf16 v[88:91], a[160:163], a[192:195], 0
    s_add_u32 s67, s67, s74
    ds_read_b64_tr_b16 a[184:185], v19 offset:0
    v_mul_f32 v160, s72, v160
    v_mfma_f32_16x16x32_bf16 v[88:91], a[164:167], a[196:199], v[88:91]
    v_mul_f32 v161, s72, v161
    v_mul_f32 v162, s72, v162
    v_mfma_f32_16x16x32_bf16 v[80:83], a[164:167], a[204:207], 0
    s_add_u32 m0, s63, 98304
    ds_read_b64_tr_b16 a[186:187], v19 offset:1024
    v_add_u32 v18, 4294901760, v18
    v_mfma_f32_16x16x32_bf16 v[80:83], a[160:163], a[200:203], v[80:83]
    buffer_load_dwordx4 v8, s[8:11], s65 offen offset:0 lds
    v_mfma_f32_16x16x32_bf16 v[72:75], a[160:163], a[208:211], 0
    ds_read_b64_tr_b16 a[188:189], v19 offset:8192
    v_mul_f32 v163, s72, v163
    v_mul_f32 v164, s72, v164
    v_mfma_f32_16x16x32_bf16 v[72:75], a[164:167], a[212:215], v[72:75]
    v_mul_f32 v165, s72, v165
    v_mul_f32 v166, s72, v166
    v_mfma_f32_16x16x32_bf16 v[64:67], a[164:167], a[220:223], 0
    ds_read_b64_tr_b16 a[190:191], v19 offset:9216
    v_mul_f32 v167, s72, v167
    v_cvt_pk_bf16_f32 v160, v160, v161
    v_mfma_f32_16x16x32_bf16 v[64:67], a[160:163], a[216:219], v[64:67]
    s_waitcnt lgkmcnt(8)
    buffer_load_dwordx4 v9, s[8:11], s65 offen offset:1024 lds
    v_mfma_f32_16x16x32_bf16 v[68:71], a[168:171], a[216:219], 0
    ds_read_b64_tr_b16 a[160:161], v20 offset:0
    v_cvt_pk_bf16_f32 v161, v162, v163
    v_mfma_f32_16x16x32_bf16 v[68:71], a[172:175], a[220:223], v[68:71]
    v_cvt_pk_bf16_f32 v162, v164, v165
    v_cvt_pk_bf16_f32 v163, v166, v167
    v_accvgpr_write_b32 a156, v160
    v_accvgpr_write_b32 a157, v161
    v_mfma_f32_16x16x32_bf16 v[76:79], a[172:175], a[212:215], 0
    ds_read_b64_tr_b16 a[162:163], v20 offset:1024
    v_add_u32 v19, 4294901760, v19
    v_mfma_f32_16x16x32_bf16 v[76:79], a[168:171], a[208:211], v[76:79]
    buffer_load_dwordx4 v10, s[8:11], s65 offen offset:2048 lds
    v_mfma_f32_16x16x32_bf16 v[84:87], a[168:171], a[200:203], 0
    ds_read_b64_tr_b16 a[164:165], v20 offset:8192
    v_accvgpr_write_b32 a158, v162
    v_accvgpr_write_b32 a159, v163
    v_mfma_f32_16x16x32_bf16 v[84:87], a[172:175], a[204:207], v[84:87]
    v_mul_f32 v168, s72, v168
    v_mul_f32 v169, s72, v169
    v_mfma_f32_16x16x32_bf16 v[92:95], a[172:175], a[196:199], 0
    ds_read_b64_tr_b16 a[166:167], v20 offset:9216
    v_mul_f32 v170, s72, v170
    v_mul_f32 v171, s72, v171
    v_mfma_f32_16x16x32_bf16 v[92:95], a[168:171], a[192:195], v[92:95]
    s_waitcnt lgkmcnt(8)
    buffer_load_dwordx4 v11, s[8:11], s65 offen offset:3072 lds
    v_mfma_f32_16x16x32_bf16 v[120:123], a[176:179], a[192:195], 0
    ds_read_b64_tr_b16 a[168:169], v21 offset:0
    v_mul_f32 v172, s72, v172
    v_mfma_f32_16x16x32_bf16 v[120:123], a[180:183], a[196:199], v[120:123]
    s_add_u32 s70, s65, 32768
    v_mul_f32 v173, s72, v173
    v_mul_f32 v174, s72, v174
    v_mul_f32 v175, s72, v175
    v_cvt_pk_bf16_f32 v168, v168, v169
    v_cvt_pk_bf16_f32 v169, v170, v171
    v_mfma_f32_16x16x32_bf16 v[112:115], a[180:183], a[204:207], 0
    s_add_u32 m0, s63, 102400
    ds_read_b64_tr_b16 a[170:171], v21 offset:1024
    v_add_u32 v20, 4294901760, v20
    v_mfma_f32_16x16x32_bf16 v[112:115], a[176:179], a[200:203], v[112:115]
    buffer_load_dwordx4 v8, s[8:11], s70 offen offset:0 lds
    v_mfma_f32_16x16x32_bf16 v[104:107], a[176:179], a[208:211], 0
    ds_read_b64_tr_b16 a[172:173], v21 offset:8192
    v_cvt_pk_bf16_f32 v170, v172, v173
    v_mfma_f32_16x16x32_bf16 v[104:107], a[180:183], a[212:215], v[104:107]
    v_cvt_pk_bf16_f32 v171, v174, v175
    v_accvgpr_write_b32 a152, v168
    v_mfma_f32_16x16x32_bf16 v[96:99], a[180:183], a[220:223], 0
    ds_read_b64_tr_b16 a[174:175], v21 offset:9216
    v_accvgpr_write_b32 a153, v169
    v_accvgpr_write_b32 a154, v170
    v_mfma_f32_16x16x32_bf16 v[96:99], a[176:179], a[216:219], v[96:99]
    s_waitcnt lgkmcnt(8)
    buffer_load_dwordx4 v9, s[8:11], s70 offen offset:1024 lds
    v_mfma_f32_16x16x32_bf16 v[100:103], a[184:187], a[216:219], 0
    ds_read_b64_tr_b16 a[176:177], v22 offset:0
    v_accvgpr_write_b32 a155, v171
    v_mfma_f32_16x16x32_bf16 v[100:103], a[188:191], a[220:223], v[100:103]
    v_mul_f32 v176, s72, v176
    v_mul_f32 v177, s72, v177
    v_mul_f32 v178, s72, v178
    v_mul_f32 v179, s72, v179
    v_mul_f32 v180, s72, v180
    v_mfma_f32_16x16x32_bf16 v[108:111], a[188:191], a[212:215], 0
    ds_read_b64_tr_b16 a[178:179], v22 offset:1024
    v_add_u32 v21, 4294901760, v21
    v_mfma_f32_16x16x32_bf16 v[108:111], a[184:187], a[208:211], v[108:111]
    buffer_load_dwordx4 v10, s[8:11], s70 offen offset:2048 lds
    v_mfma_f32_16x16x32_bf16 v[116:119], a[184:187], a[200:203], 0
    ds_read_b64_tr_b16 a[180:181], v22 offset:8192
    v_mul_f32 v181, s72, v181
    v_mfma_f32_16x16x32_bf16 v[116:119], a[188:191], a[204:207], v[116:119]
    v_mul_f32 v182, s72, v182
    v_mul_f32 v183, s72, v183
    v_mfma_f32_16x16x32_bf16 v[124:127], a[188:191], a[196:199], 0
    ds_read_b64_tr_b16 a[182:183], v22 offset:9216
    v_cvt_pk_bf16_f32 v176, v176, v177
    v_cvt_pk_bf16_f32 v177, v178, v179
    v_mfma_f32_16x16x32_bf16 v[124:127], a[184:187], a[192:195], v[124:127]
    s_waitcnt lgkmcnt(8)
    buffer_load_dwordx4 v11, s[8:11], s70 offen offset:3072 lds
    v_mfma_f32_16x16x32_bf16 v[152:155], a[160:163], a[192:195], 0
    s_add_u32 s65, s65, 128
    ds_read_b64_tr_b16 a[184:185], v23 offset:0
    v_cvt_pk_bf16_f32 v178, v180, v181
    v_cvt_pk_bf16_f32 v179, v182, v183
    v_mfma_f32_16x16x32_bf16 v[152:155], a[164:167], a[196:199], v[152:155]
    v_accvgpr_write_b32 a148, v176
    v_accvgpr_write_b32 a149, v177
    v_mfma_f32_16x16x32_bf16 v[144:147], a[164:167], a[204:207], 0
    ds_read_b64_tr_b16 a[186:187], v23 offset:1024
    v_add_u32 v22, 4294901760, v22
    v_mfma_f32_16x16x32_bf16 v[144:147], a[160:163], a[200:203], v[144:147]
    v_accvgpr_write_b32 a150, v178
    v_accvgpr_write_b32 a151, v179
    v_mfma_f32_16x16x32_bf16 v[136:139], a[160:163], a[208:211], 0
    ds_read_b64_tr_b16 a[188:189], v23 offset:8192
    v_mul_f32 v184, s72, v184
    v_mfma_f32_16x16x32_bf16 v[136:139], a[164:167], a[212:215], v[136:139]
    v_mul_f32 v185, s72, v185
    v_mul_f32 v186, s72, v186
    v_mfma_f32_16x16x32_bf16 v[128:131], a[164:167], a[220:223], 0
    ds_read_b64_tr_b16 a[190:191], v23 offset:9216
    v_mul_f32 v187, s72, v187
    v_mfma_f32_16x16x32_bf16 v[128:131], a[160:163], a[216:219], v[128:131]
    s_waitcnt lgkmcnt(8)
    v_mul_f32 v188, s72, v188
    v_mul_f32 v189, s72, v189
    v_mfma_f32_16x16x32_bf16 v[132:135], a[168:171], a[216:219], 0
    ds_read_b64_tr_b16 a[160:161], v26 offset:0
    v_mul_f32 v190, s72, v190
    v_mfma_f32_16x16x32_bf16 v[132:135], a[172:175], a[220:223], v[132:135]
    v_mul_f32 v191, s72, v191
    v_cvt_pk_bf16_f32 v184, v184, v185
    v_cvt_pk_bf16_f32 v185, v186, v187
    v_mfma_f32_16x16x32_bf16 v[140:143], a[172:175], a[212:215], 0
    ds_read_b64_tr_b16 a[162:163], v26 offset:512
    v_add_u32 v23, 4294901760, v23
    v_mfma_f32_16x16x32_bf16 v[140:143], a[168:171], a[208:211], v[140:143]
    v_cvt_pk_bf16_f32 v186, v188, v189
    v_cvt_pk_bf16_f32 v187, v190, v191
    v_mfma_f32_16x16x32_bf16 v[148:151], a[168:171], a[200:203], 0
    ds_read_b64_tr_b16 a[164:165], v26 offset:4096
    v_accvgpr_write_b32 a144, v184
    v_accvgpr_write_b32 a145, v185
    v_accvgpr_write_b32 a146, v186
    v_accvgpr_write_b32 a147, v187
    v_mfma_f32_16x16x32_bf16 v[148:151], a[172:175], a[204:207], v[148:151]
    v_lshlrev_b32 v36, 16, v56
    v_mfma_f32_16x16x32_bf16 v[156:159], a[172:175], a[196:199], 0
    ds_read_b64_tr_b16 a[166:167], v26 offset:4608
    v_and_b32 v37, 0xffff0000, v56
    v_mfma_f32_16x16x32_bf16 v[156:159], a[168:171], a[192:195], v[156:159]
    s_waitcnt lgkmcnt(8)
    v_lshlrev_b32 v38, 16, v57
    v_mfma_f32_16x16x32_bf16 v[184:187], a[176:179], a[192:195], 0
    ds_read_b64_tr_b16 a[168:169], v27 offset:0
    v_and_b32 v39, 0xffff0000, v57
    v_mfma_f32_16x16x32_bf16 v[184:187], a[180:183], a[196:199], v[184:187]
    v_lshlrev_b32 v40, 16, v58
    v_mfma_f32_16x16x32_bf16 v[176:179], a[180:183], a[204:207], 0
    ds_read_b64_tr_b16 a[170:171], v27 offset:512
    v_add_u32 v26, 4294901760, v26
    v_mfma_f32_16x16x32_bf16 v[176:179], a[176:179], a[200:203], v[176:179]
    v_and_b32 v41, 0xffff0000, v58
    v_lshlrev_b32 v42, 16, v59
    v_mfma_f32_16x16x32_bf16 v[168:171], a[176:179], a[208:211], 0
    ds_read_b64_tr_b16 a[172:173], v27 offset:4096
    v_and_b32 v43, 0xffff0000, v59
    v_mfma_f32_16x16x32_bf16 v[168:171], a[180:183], a[212:215], v[168:171]
    v_lshlrev_b32 v44, 16, v60
    v_mfma_f32_16x16x32_bf16 v[160:163], a[180:183], a[220:223], 0
    ds_read_b64_tr_b16 a[174:175], v27 offset:4608
    v_and_b32 v45, 0xffff0000, v60
    v_mfma_f32_16x16x32_bf16 v[160:163], a[176:179], a[216:219], v[160:163]
    s_waitcnt lgkmcnt(8)
    v_lshlrev_b32 v46, 16, v61
    v_mfma_f32_16x16x32_bf16 v[164:167], a[184:187], a[216:219], 0
    ds_read_b64_tr_b16 a[176:177], v28 offset:0
    v_and_b32 v47, 0xffff0000, v61
    v_mfma_f32_16x16x32_bf16 v[164:167], a[188:191], a[220:223], v[164:167]
    v_lshlrev_b32 v48, 16, v62
    v_mfma_f32_16x16x32_bf16 v[172:175], a[188:191], a[212:215], 0
    ds_read_b64_tr_b16 a[178:179], v28 offset:512
    v_add_u32 v27, 4294901760, v27
    v_mfma_f32_16x16x32_bf16 v[172:175], a[184:187], a[208:211], v[172:175]
    v_and_b32 v49, 0xffff0000, v62
    v_lshlrev_b32 v50, 16, v63
    v_mfma_f32_16x16x32_bf16 v[180:183], a[184:187], a[200:203], 0
    ds_read_b64_tr_b16 a[180:181], v28 offset:4096
    v_and_b32 v51, 0xffff0000, v63
    v_mfma_f32_16x16x32_bf16 v[180:183], a[188:191], a[204:207], v[180:183]
    s_add_u32 s71, s66, 0
    buffer_store_dwordx4 a[128:131], v2, s[48:51], s71 offen offset:2048 sc1
    v_mfma_f32_16x16x32_bf16 v[188:191], a[188:191], a[196:199], 0
    ds_read_b64_tr_b16 a[182:183], v28 offset:4608
    v_mfma_f32_16x16x32_bf16 v[188:191], a[184:187], a[192:195], v[188:191]
    s_waitcnt lgkmcnt(8)
    s_add_u32 s71, s66, 4096
    buffer_store_dwordx4 a[132:135], v2, s[48:51], s71 offen offset:2048 sc1
    v_mfma_f32_16x16x32_bf16 v[192:195], a[160:163], a[192:195], v[36:39]
    ds_read_b64_tr_b16 a[184:185], v29 offset:0
    ds_read_b64_tr_b16 a[186:187], v29 offset:512
    v_mfma_f32_16x16x32_bf16 v[192:195], a[164:167], a[196:199], v[192:195]
    s_add_u32 s71, s66, 16384
    buffer_store_dwordx4 a[136:139], v2, s[48:51], s71 offen offset:2048 sc1
    v_mfma_f32_16x16x32_bf16 v[208:211], a[164:167], a[204:207], v[36:39]
    ds_read_b64_tr_b16 a[188:189], v29 offset:4096
    v_add_u32 v28, 4294901760, v28
    v_mfma_f32_16x16x32_bf16 v[208:211], a[160:163], a[200:203], v[208:211]
    v_mfma_f32_16x16x32_bf16 v[224:227], a[160:163], a[208:211], v[36:39]
    ds_read_b64_tr_b16 a[190:191], v29 offset:4608
    v_mfma_f32_16x16x32_bf16 v[224:227], a[164:167], a[212:215], v[224:227]
    v_mfma_f32_16x16x32_bf16 v[240:243], a[164:167], a[220:223], v[36:39]
    v_mfma_f32_16x16x32_bf16 v[240:243], a[160:163], a[216:219], v[240:243]
    s_waitcnt vmcnt(25) lgkmcnt(0)
    v_mfma_f32_16x16x32_bf16 v[244:247], a[168:171], a[216:219], v[40:43]
    s_barrier
    ds_read_b64_tr_b16 a[160:161], v16 offset:0
    v_mfma_f32_16x16x32_bf16 v[244:247], a[172:175], a[220:223], v[244:247]
    ds_read_b128 a[224:227], v24 offset:32768
    ds_read_b128 a[228:231], v25 offset:32768
    v_mfma_f32_16x16x32_bf16 v[228:231], a[172:175], a[212:215], v[40:43]
    s_add_u32 m0, s80, 65536
    ds_read_b64_tr_b16 a[162:163], v16 offset:1024
    v_add_u32 v29, 4294901760, v29
    v_mfma_f32_16x16x32_bf16 v[228:231], a[168:171], a[208:211], v[228:231]
    buffer_load_dwordx4 v4, s[16:19], s64 offen offset:0 lds
    v_mfma_f32_16x16x32_bf16 v[212:215], a[168:171], a[200:203], v[40:43]
    ds_read_b64_tr_b16 a[164:165], v16 offset:8192
    v_mfma_f32_16x16x32_bf16 v[212:215], a[172:175], a[204:207], v[212:215]
    ds_read_b128 a[232:235], v24 offset:34816
    ds_read_b128 a[236:239], v25 offset:34816
    v_mfma_f32_16x16x32_bf16 v[196:199], a[172:175], a[196:199], v[40:43]
    ds_read_b64_tr_b16 a[166:167], v16 offset:9216
    v_mfma_f32_16x16x32_bf16 v[196:199], a[168:171], a[192:195], v[196:199]
    buffer_load_dwordx4 v5, s[16:19], s64 offen offset:1024 lds
    v_mfma_f32_16x16x32_bf16 v[200:203], a[176:179], a[192:195], v[44:47]
    ds_read_b64_tr_b16 a[168:169], v17 offset:0
    v_mfma_f32_16x16x32_bf16 v[200:203], a[180:183], a[196:199], v[200:203]
    ds_read_b128 a[240:243], v24 offset:36864
    ds_read_b128 a[244:247], v25 offset:36864
    v_mfma_f32_16x16x32_bf16 v[216:219], a[180:183], a[204:207], v[44:47]
    ds_read_b64_tr_b16 a[170:171], v17 offset:1024
    v_mfma_f32_16x16x32_bf16 v[216:219], a[176:179], a[200:203], v[216:219]
    buffer_load_dwordx4 v6, s[16:19], s64 offen offset:2048 lds
    v_mfma_f32_16x16x32_bf16 v[232:235], a[176:179], a[208:211], v[44:47]
    ds_read_b64_tr_b16 a[172:173], v17 offset:8192
    v_mfma_f32_16x16x32_bf16 v[232:235], a[180:183], a[212:215], v[232:235]
    ds_read_b128 a[248:251], v24 offset:38912
    ds_read_b128 a[252:255], v25 offset:38912
    v_mfma_f32_16x16x32_bf16 v[248:251], a[180:183], a[220:223], v[44:47]
    ds_read_b64_tr_b16 a[174:175], v17 offset:9216
    v_mfma_f32_16x16x32_bf16 v[248:251], a[176:179], a[216:219], v[248:251]
    buffer_load_dwordx4 v7, s[16:19], s64 offen offset:3072 lds
    v_mfma_f32_16x16x32_bf16 v[252:255], a[184:187], a[216:219], v[48:51]
    s_add_u32 s64, s64, 524288
    ds_read_b64_tr_b16 a[176:177], v18 offset:0
    v_mfma_f32_16x16x32_bf16 v[252:255], a[188:191], a[220:223], v[252:255]
    s_lshr_b32 s69, s80, 1
    s_add_u32 s71, s66, 20480
    buffer_store_dwordx4 a[140:143], v2, s[48:51], s71 offen offset:2048 sc1
    v_mfma_f32_16x16x32_bf16 v[236:239], a[188:191], a[212:215], v[48:51]
    s_add_u32 m0, s69, 81920
    ds_read_b64_tr_b16 a[178:179], v18 offset:1024
    v_mfma_f32_16x16x32_bf16 v[236:239], a[184:187], a[208:211], v[236:239]
    buffer_load_dwordx4 v12, s[28:31], s67 offen offset:0 lds
    v_mfma_f32_16x16x32_bf16 v[220:223], a[184:187], a[200:203], v[48:51]
    ds_read_b64_tr_b16 a[180:181], v18 offset:8192
    v_mfma_f32_16x16x32_bf16 v[220:223], a[188:191], a[204:207], v[220:223]
    v_mfma_f32_16x16x32_bf16 v[204:207], a[188:191], a[196:199], v[48:51]
    ds_read_b64_tr_b16 a[182:183], v18 offset:9216
    v_mfma_f32_16x16x32_bf16 v[204:207], a[184:187], a[192:195], v[204:207]
    s_waitcnt lgkmcnt(5)
    buffer_load_dwordx4 v13, s[28:31], s67 offen offset:1024 lds
    v_mfma_f32_16x16x32_bf16 v[88:91], a[160:163], a[224:227], v[88:91]
    s_add_u32 s67, s67, s74
    ds_read_b64_tr_b16 a[184:185], v19 offset:0
    v_mfma_f32_16x16x32_bf16 v[88:91], a[164:167], a[228:231], v[88:91]
    v_mfma_f32_16x16x32_bf16 v[80:83], a[164:167], a[236:239], v[80:83]
    s_add_u32 m0, s63, 131072
    ds_read_b64_tr_b16 a[186:187], v19 offset:1024
    v_mfma_f32_16x16x32_bf16 v[80:83], a[160:163], a[232:235], v[80:83]
    buffer_load_dwordx4 v8, s[8:11], s65 offen offset:0 lds
    v_mfma_f32_16x16x32_bf16 v[72:75], a[160:163], a[240:243], v[72:75]
    ds_read_b64_tr_b16 a[188:189], v19 offset:8192
    v_mfma_f32_16x16x32_bf16 v[72:75], a[164:167], a[244:247], v[72:75]
    s_add_u32 s71, s66, 0
    buffer_store_dwordx4 a[144:147], v2, s[48:51], s71 offen offset:3072 sc1
    v_mfma_f32_16x16x32_bf16 v[64:67], a[164:167], a[252:255], v[64:67]
    ds_read_b64_tr_b16 a[190:191], v19 offset:9216
    v_mfma_f32_16x16x32_bf16 v[64:67], a[160:163], a[248:251], v[64:67]
    s_waitcnt lgkmcnt(8)
    buffer_load_dwordx4 v9, s[8:11], s65 offen offset:1024 lds
    v_mfma_f32_16x16x32_bf16 v[68:71], a[168:171], a[248:251], v[68:71]
    ds_read_b64_tr_b16 a[160:161], v20 offset:0
    v_mfma_f32_16x16x32_bf16 v[68:71], a[172:175], a[252:255], v[68:71]
    v_mfma_f32_16x16x32_bf16 v[76:79], a[172:175], a[244:247], v[76:79]
    ds_read_b64_tr_b16 a[162:163], v20 offset:1024
    v_mfma_f32_16x16x32_bf16 v[76:79], a[168:171], a[240:243], v[76:79]
    buffer_load_dwordx4 v10, s[8:11], s65 offen offset:2048 lds
    v_mfma_f32_16x16x32_bf16 v[84:87], a[168:171], a[232:235], v[84:87]
    ds_read_b64_tr_b16 a[164:165], v20 offset:8192
    v_mfma_f32_16x16x32_bf16 v[84:87], a[172:175], a[236:239], v[84:87]
    v_mfma_f32_16x16x32_bf16 v[92:95], a[172:175], a[228:231], v[92:95]
    ds_read_b64_tr_b16 a[166:167], v20 offset:9216
    v_mfma_f32_16x16x32_bf16 v[92:95], a[168:171], a[224:227], v[92:95]
    s_waitcnt lgkmcnt(8)
    buffer_load_dwordx4 v11, s[8:11], s65 offen offset:3072 lds
    v_mfma_f32_16x16x32_bf16 v[120:123], a[176:179], a[224:227], v[120:123]
    ds_read_b64_tr_b16 a[168:169], v21 offset:0
    v_mfma_f32_16x16x32_bf16 v[120:123], a[180:183], a[228:231], v[120:123]
    s_add_u32 s70, s65, 32768
    v_mfma_f32_16x16x32_bf16 v[112:115], a[180:183], a[236:239], v[112:115]
    s_add_u32 m0, s63, 135168
    ds_read_b64_tr_b16 a[170:171], v21 offset:1024
    v_mfma_f32_16x16x32_bf16 v[112:115], a[176:179], a[232:235], v[112:115]
    buffer_load_dwordx4 v8, s[8:11], s70 offen offset:0 lds
    v_mfma_f32_16x16x32_bf16 v[104:107], a[176:179], a[240:243], v[104:107]
    ds_read_b64_tr_b16 a[172:173], v21 offset:8192
    v_mfma_f32_16x16x32_bf16 v[104:107], a[180:183], a[244:247], v[104:107]
    v_mfma_f32_16x16x32_bf16 v[96:99], a[180:183], a[252:255], v[96:99]
    ds_read_b64_tr_b16 a[174:175], v21 offset:9216
    v_mfma_f32_16x16x32_bf16 v[96:99], a[176:179], a[248:251], v[96:99]
    s_waitcnt lgkmcnt(8)
    buffer_load_dwordx4 v9, s[8:11], s70 offen offset:1024 lds
    v_mfma_f32_16x16x32_bf16 v[100:103], a[184:187], a[248:251], v[100:103]
    ds_read_b64_tr_b16 a[176:177], v22 offset:0
    v_mfma_f32_16x16x32_bf16 v[100:103], a[188:191], a[252:255], v[100:103]
    v_mfma_f32_16x16x32_bf16 v[108:111], a[188:191], a[244:247], v[108:111]
    ds_read_b64_tr_b16 a[178:179], v22 offset:1024
    v_mfma_f32_16x16x32_bf16 v[108:111], a[184:187], a[240:243], v[108:111]
    buffer_load_dwordx4 v10, s[8:11], s70 offen offset:2048 lds
    v_mfma_f32_16x16x32_bf16 v[116:119], a[184:187], a[232:235], v[116:119]
    ds_read_b64_tr_b16 a[180:181], v22 offset:8192
    v_mfma_f32_16x16x32_bf16 v[116:119], a[188:191], a[236:239], v[116:119]
    s_add_u32 s71, s66, 4096
    buffer_store_dwordx4 a[148:151], v2, s[48:51], s71 offen offset:3072 sc1
    v_mfma_f32_16x16x32_bf16 v[124:127], a[188:191], a[228:231], v[124:127]
    ds_read_b64_tr_b16 a[182:183], v22 offset:9216
    v_mfma_f32_16x16x32_bf16 v[124:127], a[184:187], a[224:227], v[124:127]
    s_waitcnt lgkmcnt(8)
    buffer_load_dwordx4 v11, s[8:11], s70 offen offset:3072 lds
    v_mfma_f32_16x16x32_bf16 v[152:155], a[160:163], a[224:227], v[152:155]
    s_add_u32 s65, s65, 128
    ds_read_b64_tr_b16 a[184:185], v23 offset:0
    v_mfma_f32_16x16x32_bf16 v[152:155], a[164:167], a[228:231], v[152:155]
    v_mfma_f32_16x16x32_bf16 v[144:147], a[164:167], a[236:239], v[144:147]
    ds_read_b64_tr_b16 a[186:187], v23 offset:1024
    v_mfma_f32_16x16x32_bf16 v[144:147], a[160:163], a[232:235], v[144:147]
    v_mfma_f32_16x16x32_bf16 v[136:139], a[160:163], a[240:243], v[136:139]
    ds_read_b64_tr_b16 a[188:189], v23 offset:8192
    v_mfma_f32_16x16x32_bf16 v[136:139], a[164:167], a[244:247], v[136:139]
    v_mfma_f32_16x16x32_bf16 v[128:131], a[164:167], a[252:255], v[128:131]
    ds_read_b64_tr_b16 a[190:191], v23 offset:9216
    v_mfma_f32_16x16x32_bf16 v[128:131], a[160:163], a[248:251], v[128:131]
    s_waitcnt lgkmcnt(8)
    v_mfma_f32_16x16x32_bf16 v[132:135], a[168:171], a[248:251], v[132:135]
    ds_read_b64_tr_b16 a[160:161], v26 offset:0
    v_mfma_f32_16x16x32_bf16 v[132:135], a[172:175], a[252:255], v[132:135]
    v_mfma_f32_16x16x32_bf16 v[140:143], a[172:175], a[244:247], v[140:143]
    ds_read_b64_tr_b16 a[162:163], v26 offset:512
    v_mfma_f32_16x16x32_bf16 v[140:143], a[168:171], a[240:243], v[140:143]
    v_mfma_f32_16x16x32_bf16 v[148:151], a[168:171], a[232:235], v[148:151]
    ds_read_b64_tr_b16 a[164:165], v26 offset:4096
    v_mfma_f32_16x16x32_bf16 v[148:151], a[172:175], a[236:239], v[148:151]
    v_mfma_f32_16x16x32_bf16 v[156:159], a[172:175], a[228:231], v[156:159]
    ds_read_b64_tr_b16 a[166:167], v26 offset:4608
    v_mfma_f32_16x16x32_bf16 v[156:159], a[168:171], a[224:227], v[156:159]
    s_waitcnt lgkmcnt(8)
    v_mfma_f32_16x16x32_bf16 v[184:187], a[176:179], a[224:227], v[184:187]
    ds_read_b64_tr_b16 a[168:169], v27 offset:0
    v_mfma_f32_16x16x32_bf16 v[184:187], a[180:183], a[228:231], v[184:187]
    v_mfma_f32_16x16x32_bf16 v[176:179], a[180:183], a[236:239], v[176:179]
    ds_read_b64_tr_b16 a[170:171], v27 offset:512
    v_mfma_f32_16x16x32_bf16 v[176:179], a[176:179], a[232:235], v[176:179]
    s_add_u32 s71, s66, 16384
    buffer_store_dwordx4 a[152:155], v2, s[48:51], s71 offen offset:3072 sc1
    v_mfma_f32_16x16x32_bf16 v[168:171], a[176:179], a[240:243], v[168:171]
    ds_read_b64_tr_b16 a[172:173], v27 offset:4096
    v_mfma_f32_16x16x32_bf16 v[168:171], a[180:183], a[244:247], v[168:171]
    v_mfma_f32_16x16x32_bf16 v[160:163], a[180:183], a[252:255], v[160:163]
    ds_read_b64_tr_b16 a[174:175], v27 offset:4608
    v_mfma_f32_16x16x32_bf16 v[160:163], a[176:179], a[248:251], v[160:163]
    s_waitcnt lgkmcnt(8)
    v_mfma_f32_16x16x32_bf16 v[164:167], a[184:187], a[248:251], v[164:167]
    ds_read_b64_tr_b16 a[176:177], v28 offset:0
    v_mfma_f32_16x16x32_bf16 v[164:167], a[188:191], a[252:255], v[164:167]
    v_mfma_f32_16x16x32_bf16 v[172:175], a[188:191], a[244:247], v[172:175]
    ds_read_b64_tr_b16 a[178:179], v28 offset:512
    v_mfma_f32_16x16x32_bf16 v[172:175], a[184:187], a[240:243], v[172:175]
    v_mfma_f32_16x16x32_bf16 v[180:183], a[184:187], a[232:235], v[180:183]
    ds_read_b64_tr_b16 a[180:181], v28 offset:4096
    v_mfma_f32_16x16x32_bf16 v[180:183], a[188:191], a[236:239], v[180:183]
    v_mfma_f32_16x16x32_bf16 v[188:191], a[188:191], a[228:231], v[188:191]
    ds_read_b64_tr_b16 a[182:183], v28 offset:4608
    v_mfma_f32_16x16x32_bf16 v[188:191], a[184:187], a[224:227], v[188:191]
    s_waitcnt lgkmcnt(8)
    v_mfma_f32_16x16x32_bf16 v[192:195], a[160:163], a[224:227], v[192:195]
    ds_read_b64_tr_b16 a[184:185], v29 offset:0
    ds_read_b64_tr_b16 a[186:187], v29 offset:512
    v_mfma_f32_16x16x32_bf16 v[192:195], a[164:167], a[228:231], v[192:195]
    v_mfma_f32_16x16x32_bf16 v[208:211], a[164:167], a[236:239], v[208:211]
    ds_read_b64_tr_b16 a[188:189], v29 offset:4096
    v_mfma_f32_16x16x32_bf16 v[208:211], a[160:163], a[232:235], v[208:211]
    v_mfma_f32_16x16x32_bf16 v[224:227], a[160:163], a[240:243], v[224:227]
    ds_read_b64_tr_b16 a[190:191], v29 offset:4608
    v_mfma_f32_16x16x32_bf16 v[224:227], a[164:167], a[244:247], v[224:227]
    v_mfma_f32_16x16x32_bf16 v[240:243], a[164:167], a[252:255], v[240:243]
    v_mfma_f32_16x16x32_bf16 v[240:243], a[160:163], a[248:251], v[240:243]
    s_waitcnt vmcnt(21) lgkmcnt(0)
    v_mfma_f32_16x16x32_bf16 v[244:247], a[168:171], a[248:251], v[244:247]
    s_barrier
    ds_read_b64_tr_b16 a[160:161], v16 offset:32768
    v_mfma_f32_16x16x32_bf16 v[244:247], a[172:175], a[252:255], v[244:247]
    ds_read_b128 a[192:195], v24 offset:0
    ds_read_b128 a[196:199], v25 offset:0
    v_mfma_f32_16x16x32_bf16 v[228:231], a[172:175], a[244:247], v[228:231]
    s_add_u32 m0, s80, 0
    ds_read_b64_tr_b16 a[162:163], v16 offset:33792
    v_mfma_f32_16x16x32_bf16 v[228:231], a[168:171], a[240:243], v[228:231]
    buffer_load_dwordx4 v4, s[16:19], s64 offen offset:0 lds
    v_mfma_f32_16x16x32_bf16 v[212:215], a[168:171], a[232:235], v[212:215]
    ds_read_b64_tr_b16 a[164:165], v16 offset:40960
    v_mfma_f32_16x16x32_bf16 v[212:215], a[172:175], a[236:239], v[212:215]
    ds_read_b128 a[200:203], v24 offset:2048
    ds_read_b128 a[204:207], v25 offset:2048
    v_mfma_f32_16x16x32_bf16 v[196:199], a[172:175], a[228:231], v[196:199]
    ds_read_b64_tr_b16 a[166:167], v16 offset:41984
    v_mfma_f32_16x16x32_bf16 v[196:199], a[168:171], a[224:227], v[196:199]
    buffer_load_dwordx4 v5, s[16:19], s64 offen offset:1024 lds
    v_mfma_f32_16x16x32_bf16 v[200:203], a[176:179], a[224:227], v[200:203]
    ds_read_b64_tr_b16 a[168:169], v17 offset:32768
    v_mfma_f32_16x16x32_bf16 v[200:203], a[180:183], a[228:231], v[200:203]
    ds_read_b128 a[208:211], v24 offset:4096
    ds_read_b128 a[212:215], v25 offset:4096
    v_mfma_f32_16x16x32_bf16 v[216:219], a[180:183], a[236:239], v[216:219]
    ds_read_b64_tr_b16 a[170:171], v17 offset:33792
    v_add_u32 v16, 65536, v16
    v_mfma_f32_16x16x32_bf16 v[216:219], a[176:179], a[232:235], v[216:219]
    buffer_load_dwordx4 v6, s[16:19], s64 offen offset:2048 lds
    v_mfma_f32_16x16x32_bf16 v[232:235], a[176:179], a[240:243], v[232:235]
    ds_read_b64_tr_b16 a[172:173], v17 offset:40960
    v_mfma_f32_16x16x32_bf16 v[232:235], a[180:183], a[244:247], v[232:235]
    ds_read_b128 a[216:219], v24 offset:6144
    ds_read_b128 a[220:223], v25 offset:6144
    v_mfma_f32_16x16x32_bf16 v[248:251], a[180:183], a[252:255], v[248:251]
    ds_read_b64_tr_b16 a[174:175], v17 offset:41984
    v_mfma_f32_16x16x32_bf16 v[248:251], a[176:179], a[248:251], v[248:251]
    buffer_load_dwordx4 v7, s[16:19], s64 offen offset:3072 lds
    v_mfma_f32_16x16x32_bf16 v[252:255], a[184:187], a[248:251], v[252:255]
    s_add_u32 s64, s64, 524288
    ds_read_b64_tr_b16 a[176:177], v18 offset:32768
    v_mfma_f32_16x16x32_bf16 v[252:255], a[188:191], a[252:255], v[252:255]
    s_lshr_b32 s69, s80, 1
    s_add_u32 s71, s66, 20480
    buffer_store_dwordx4 a[156:159], v2, s[48:51], s71 offen offset:3072 sc1
    v_mfma_f32_16x16x32_bf16 v[236:239], a[188:191], a[244:247], v[236:239]
    s_add_u32 m0, s69, 16384
    ds_read_b64_tr_b16 a[178:179], v18 offset:33792
    v_add_u32 v17, 65536, v17
    v_mfma_f32_16x16x32_bf16 v[236:239], a[184:187], a[240:243], v[236:239]
    buffer_load_dwordx4 v12, s[28:31], s67 offen offset:0 lds
    v_mfma_f32_16x16x32_bf16 v[220:223], a[184:187], a[232:235], v[220:223]
    ds_read_b64_tr_b16 a[180:181], v18 offset:40960
    v_mfma_f32_16x16x32_bf16 v[220:223], a[188:191], a[236:239], v[220:223]
    v_mfma_f32_16x16x32_bf16 v[204:207], a[188:191], a[228:231], v[204:207]
    ds_read_b64_tr_b16 a[182:183], v18 offset:41984
    v_mfma_f32_16x16x32_bf16 v[204:207], a[184:187], a[224:227], v[204:207]
    s_waitcnt lgkmcnt(5)
    buffer_load_dwordx4 v13, s[28:31], s67 offen offset:1024 lds
    v_mfma_f32_16x16x32_bf16 v[88:91], a[160:163], a[192:195], v[88:91]
    s_add_u32 s67, s67, s74
    ds_read_b64_tr_b16 a[184:185], v19 offset:32768
    v_mfma_f32_16x16x32_bf16 v[88:91], a[164:167], a[196:199], v[88:91]
    v_mfma_f32_16x16x32_bf16 v[80:83], a[164:167], a[204:207], v[80:83]
    s_add_u32 m0, s63, 98304
    ds_read_b64_tr_b16 a[186:187], v19 offset:33792
    v_add_u32 v18, 65536, v18
    v_mfma_f32_16x16x32_bf16 v[80:83], a[160:163], a[200:203], v[80:83]
    buffer_load_dwordx4 v8, s[8:11], s65 offen offset:0 lds
    v_mfma_f32_16x16x32_bf16 v[72:75], a[160:163], a[208:211], v[72:75]
    ds_read_b64_tr_b16 a[188:189], v19 offset:40960
    v_accvgpr_read_b32 v56, a0
    v_mfma_f32_16x16x32_bf16 v[72:75], a[164:167], a[212:215], v[72:75]
    v_accvgpr_read_b32 v57, a1
    v_accvgpr_read_b32 v58, a2
    v_mfma_f32_16x16x32_bf16 v[64:67], a[164:167], a[220:223], v[64:67]
    ds_read_b64_tr_b16 a[190:191], v19 offset:41984
    v_accvgpr_read_b32 v59, a3
    v_mfma_f32_16x16x32_bf16 v[64:67], a[160:163], a[216:219], v[64:67]
    s_waitcnt lgkmcnt(8)
    buffer_load_dwordx4 v9, s[8:11], s65 offen offset:1024 lds
    v_mfma_f32_16x16x32_bf16 v[68:71], a[168:171], a[216:219], v[68:71]
    ds_read_b64_tr_b16 a[160:161], v20 offset:32768
    v_accvgpr_read_b32 v60, a4
    v_mfma_f32_16x16x32_bf16 v[68:71], a[172:175], a[220:223], v[68:71]
    v_accvgpr_read_b32 v61, a5
    v_accvgpr_read_b32 v62, a6
    v_accvgpr_read_b32 v63, a7
    v_cvt_pk_bf16_f32 v56, v56, v57
    v_cvt_pk_bf16_f32 v57, v58, v59
    v_mfma_f32_16x16x32_bf16 v[76:79], a[172:175], a[212:215], v[76:79]
    ds_read_b64_tr_b16 a[162:163], v20 offset:33792
    v_add_u32 v19, 65536, v19
    v_cvt_pk_bf16_f32 v58, v60, v61
    v_mfma_f32_16x16x32_bf16 v[76:79], a[168:171], a[208:211], v[76:79]
    buffer_load_dwordx4 v10, s[8:11], s65 offen offset:2048 lds
    v_cvt_pk_bf16_f32 v59, v62, v63
    v_mfma_f32_16x16x32_bf16 v[84:87], a[168:171], a[200:203], v[84:87]
    ds_read_b64_tr_b16 a[164:165], v20 offset:40960
    v_mfma_f32_16x16x32_bf16 v[84:87], a[172:175], a[204:207], v[84:87]
    s_add_u32 s71, s66, 8192
    buffer_store_dwordx4 v[56:59], v2, s[48:51], s71 offen offset:0 sc1
    v_mfma_f32_16x16x32_bf16 v[92:95], a[172:175], a[196:199], v[92:95]
    ds_read_b64_tr_b16 a[166:167], v20 offset:41984
    v_mfma_f32_16x16x32_bf16 v[92:95], a[168:171], a[192:195], v[92:95]
    s_waitcnt lgkmcnt(8)
    buffer_load_dwordx4 v11, s[8:11], s65 offen offset:3072 lds
    v_mfma_f32_16x16x32_bf16 v[120:123], a[176:179], a[192:195], v[120:123]
    ds_read_b64_tr_b16 a[168:169], v21 offset:32768
    v_mfma_f32_16x16x32_bf16 v[120:123], a[180:183], a[196:199], v[120:123]
    s_add_u32 s70, s65, 32768
    v_mfma_f32_16x16x32_bf16 v[112:115], a[180:183], a[204:207], v[112:115]
    s_add_u32 m0, s63, 102400
    ds_read_b64_tr_b16 a[170:171], v21 offset:33792
    v_add_u32 v20, 65536, v20
    v_mfma_f32_16x16x32_bf16 v[112:115], a[176:179], a[200:203], v[112:115]
    buffer_load_dwordx4 v8, s[8:11], s70 offen offset:0 lds
    v_mfma_f32_16x16x32_bf16 v[104:107], a[176:179], a[208:211], v[104:107]
    ds_read_b64_tr_b16 a[172:173], v21 offset:40960
    v_mfma_f32_16x16x32_bf16 v[104:107], a[180:183], a[212:215], v[104:107]
    v_mfma_f32_16x16x32_bf16 v[96:99], a[180:183], a[220:223], v[96:99]
    ds_read_b64_tr_b16 a[174:175], v21 offset:41984
    v_mfma_f32_16x16x32_bf16 v[96:99], a[176:179], a[216:219], v[96:99]
    s_waitcnt lgkmcnt(8)
    buffer_load_dwordx4 v9, s[8:11], s70 offen offset:1024 lds
    v_mfma_f32_16x16x32_bf16 v[100:103], a[184:187], a[216:219], v[100:103]
    ds_read_b64_tr_b16 a[176:177], v22 offset:32768
    v_mfma_f32_16x16x32_bf16 v[100:103], a[188:191], a[220:223], v[100:103]
    v_mfma_f32_16x16x32_bf16 v[108:111], a[188:191], a[212:215], v[108:111]
    ds_read_b64_tr_b16 a[178:179], v22 offset:33792
    v_add_u32 v21, 65536, v21
    v_mfma_f32_16x16x32_bf16 v[108:111], a[184:187], a[208:211], v[108:111]
    buffer_load_dwordx4 v10, s[8:11], s70 offen offset:2048 lds
    v_mfma_f32_16x16x32_bf16 v[116:119], a[184:187], a[200:203], v[116:119]
    ds_read_b64_tr_b16 a[180:181], v22 offset:40960
    v_accvgpr_read_b32 v56, a8
    v_mfma_f32_16x16x32_bf16 v[116:119], a[188:191], a[204:207], v[116:119]
    v_accvgpr_read_b32 v57, a9
    v_accvgpr_read_b32 v58, a10
    v_mfma_f32_16x16x32_bf16 v[124:127], a[188:191], a[196:199], v[124:127]
    ds_read_b64_tr_b16 a[182:183], v22 offset:41984
    v_accvgpr_read_b32 v59, a11
    v_mfma_f32_16x16x32_bf16 v[124:127], a[184:187], a[192:195], v[124:127]
    s_waitcnt lgkmcnt(8)
    buffer_load_dwordx4 v11, s[8:11], s70 offen offset:3072 lds
    v_mfma_f32_16x16x32_bf16 v[152:155], a[160:163], a[192:195], v[152:155]
    s_add_u32 s65, s65, 128
    ds_read_b64_tr_b16 a[184:185], v23 offset:32768
    v_accvgpr_read_b32 v60, a12
    v_mfma_f32_16x16x32_bf16 v[152:155], a[164:167], a[196:199], v[152:155]
    v_accvgpr_read_b32 v61, a13
    v_accvgpr_read_b32 v62, a14
    v_accvgpr_read_b32 v63, a15
    v_mfma_f32_16x16x32_bf16 v[144:147], a[164:167], a[204:207], v[144:147]
    ds_read_b64_tr_b16 a[186:187], v23 offset:33792
    v_add_u32 v22, 65536, v22
    v_mfma_f32_16x16x32_bf16 v[144:147], a[160:163], a[200:203], v[144:147]
    v_cvt_pk_bf16_f32 v56, v56, v57
    v_cvt_pk_bf16_f32 v57, v58, v59
    v_cvt_pk_bf16_f32 v58, v60, v61
    v_cvt_pk_bf16_f32 v59, v62, v63
    v_mfma_f32_16x16x32_bf16 v[136:139], a[160:163], a[208:211], v[136:139]
    ds_read_b64_tr_b16 a[188:189], v23 offset:40960
    v_mfma_f32_16x16x32_bf16 v[136:139], a[164:167], a[212:215], v[136:139]
    s_add_u32 s71, s66, 8192
    buffer_store_dwordx4 v[56:59], v2, s[48:51], s71 offen offset:1024 sc1
    v_mfma_f32_16x16x32_bf16 v[128:131], a[164:167], a[220:223], v[128:131]
    ds_read_b64_tr_b16 a[190:191], v23 offset:41984
    v_mfma_f32_16x16x32_bf16 v[128:131], a[160:163], a[216:219], v[128:131]
    s_waitcnt lgkmcnt(8)
    v_mfma_f32_16x16x32_bf16 v[132:135], a[168:171], a[216:219], v[132:135]
    ds_read_b64_tr_b16 a[160:161], v26 offset:32768
    v_mfma_f32_16x16x32_bf16 v[132:135], a[172:175], a[220:223], v[132:135]
    v_mfma_f32_16x16x32_bf16 v[140:143], a[172:175], a[212:215], v[140:143]
    ds_read_b64_tr_b16 a[162:163], v26 offset:33280
    v_add_u32 v23, 65536, v23
    v_mfma_f32_16x16x32_bf16 v[140:143], a[168:171], a[208:211], v[140:143]
    v_mfma_f32_16x16x32_bf16 v[148:151], a[168:171], a[200:203], v[148:151]
    ds_read_b64_tr_b16 a[164:165], v26 offset:36864
    v_mfma_f32_16x16x32_bf16 v[148:151], a[172:175], a[204:207], v[148:151]
    v_mfma_f32_16x16x32_bf16 v[156:159], a[172:175], a[196:199], v[156:159]
    ds_read_b64_tr_b16 a[166:167], v26 offset:37376
    v_mfma_f32_16x16x32_bf16 v[156:159], a[168:171], a[192:195], v[156:159]
    s_waitcnt lgkmcnt(8)
    v_mfma_f32_16x16x32_bf16 v[184:187], a[176:179], a[192:195], v[184:187]
    ds_read_b64_tr_b16 a[168:169], v27 offset:32768
    v_mfma_f32_16x16x32_bf16 v[184:187], a[180:183], a[196:199], v[184:187]
    v_mfma_f32_16x16x32_bf16 v[176:179], a[180:183], a[204:207], v[176:179]
    ds_read_b64_tr_b16 a[170:171], v27 offset:33280
    v_add_u32 v26, 65536, v26
    v_mfma_f32_16x16x32_bf16 v[176:179], a[176:179], a[200:203], v[176:179]
    v_accvgpr_read_b32 v56, a16
    v_accvgpr_read_b32 v57, a17
    v_mfma_f32_16x16x32_bf16 v[168:171], a[176:179], a[208:211], v[168:171]
    ds_read_b64_tr_b16 a[172:173], v27 offset:36864
    v_accvgpr_read_b32 v58, a18
    v_mfma_f32_16x16x32_bf16 v[168:171], a[180:183], a[212:215], v[168:171]
    v_accvgpr_read_b32 v59, a19
    v_accvgpr_read_b32 v60, a20
    v_mfma_f32_16x16x32_bf16 v[160:163], a[180:183], a[220:223], v[160:163]
    ds_read_b64_tr_b16 a[174:175], v27 offset:37376
    v_accvgpr_read_b32 v61, a21
    v_mfma_f32_16x16x32_bf16 v[160:163], a[176:179], a[216:219], v[160:163]
    s_waitcnt lgkmcnt(8)
    v_accvgpr_read_b32 v62, a22
    v_accvgpr_read_b32 v63, a23
    v_mfma_f32_16x16x32_bf16 v[164:167], a[184:187], a[216:219], v[164:167]
    ds_read_b64_tr_b16 a[176:177], v28 offset:32768
    v_cvt_pk_bf16_f32 v56, v56, v57
    v_mfma_f32_16x16x32_bf16 v[164:167], a[188:191], a[220:223], v[164:167]
    v_cvt_pk_bf16_f32 v57, v58, v59
    v_mfma_f32_16x16x32_bf16 v[172:175], a[188:191], a[212:215], v[172:175]
    ds_read_b64_tr_b16 a[178:179], v28 offset:33280
    v_add_u32 v27, 65536, v27
    v_mfma_f32_16x16x32_bf16 v[172:175], a[184:187], a[208:211], v[172:175]
    v_cvt_pk_bf16_f32 v58, v60, v61
    v_cvt_pk_bf16_f32 v59, v62, v63
    v_mfma_f32_16x16x32_bf16 v[180:183], a[184:187], a[200:203], v[180:183]
    ds_read_b64_tr_b16 a[180:181], v28 offset:36864
    v_mfma_f32_16x16x32_bf16 v[180:183], a[188:191], a[204:207], v[180:183]
    s_add_u32 s71, s66, 8192
    buffer_store_dwordx4 v[56:59], v2, s[48:51], s71 offen offset:2048 sc1
    v_mfma_f32_16x16x32_bf16 v[188:191], a[188:191], a[196:199], v[188:191]
    ds_read_b64_tr_b16 a[182:183], v28 offset:37376
    v_mfma_f32_16x16x32_bf16 v[188:191], a[184:187], a[192:195], v[188:191]
    s_waitcnt lgkmcnt(8)
    v_mfma_f32_16x16x32_bf16 v[192:195], a[160:163], a[192:195], v[192:195]
    ds_read_b64_tr_b16 a[184:185], v29 offset:32768
    ds_read_b64_tr_b16 a[186:187], v29 offset:33280
    v_mfma_f32_16x16x32_bf16 v[192:195], a[164:167], a[196:199], v[192:195]
    v_mfma_f32_16x16x32_bf16 v[208:211], a[164:167], a[204:207], v[208:211]
    ds_read_b64_tr_b16 a[188:189], v29 offset:36864
    v_add_u32 v28, 65536, v28
    v_mfma_f32_16x16x32_bf16 v[208:211], a[160:163], a[200:203], v[208:211]
    v_mfma_f32_16x16x32_bf16 v[224:227], a[160:163], a[208:211], v[224:227]
    ds_read_b64_tr_b16 a[190:191], v29 offset:37376
    v_mfma_f32_16x16x32_bf16 v[224:227], a[164:167], a[212:215], v[224:227]
    v_mfma_f32_16x16x32_bf16 v[240:243], a[164:167], a[220:223], v[240:243]
    v_mfma_f32_16x16x32_bf16 v[240:243], a[160:163], a[216:219], v[240:243]
    s_waitcnt vmcnt(19) lgkmcnt(0)
    v_mfma_f32_16x16x32_bf16 v[244:247], a[168:171], a[216:219], v[244:247]
    s_barrier
    ds_read_b64_tr_b16 a[160:161], v16 offset:0
    v_mfma_f32_16x16x32_bf16 v[244:247], a[172:175], a[220:223], v[244:247]
    ds_read_b128 a[224:227], v24 offset:32768
    ds_read_b128 a[228:231], v25 offset:32768
    v_mfma_f32_16x16x32_bf16 v[228:231], a[172:175], a[212:215], v[228:231]
    s_add_u32 m0, s80, 32768
    ds_read_b64_tr_b16 a[162:163], v16 offset:1024
    v_add_u32 v29, 65536, v29
    v_mfma_f32_16x16x32_bf16 v[228:231], a[168:171], a[208:211], v[228:231]
    buffer_load_dwordx4 v4, s[16:19], s64 offen offset:0 lds
    v_mfma_f32_16x16x32_bf16 v[212:215], a[168:171], a[200:203], v[212:215]
    ds_read_b64_tr_b16 a[164:165], v16 offset:8192
    v_accvgpr_read_b32 v56, a24
    v_accvgpr_read_b32 v57, a25
    v_mfma_f32_16x16x32_bf16 v[212:215], a[172:175], a[204:207], v[212:215]
    ds_read_b128 a[232:235], v24 offset:34816
    ds_read_b128 a[236:239], v25 offset:34816
    v_mfma_f32_16x16x32_bf16 v[196:199], a[172:175], a[196:199], v[196:199]
    ds_read_b64_tr_b16 a[166:167], v16 offset:9216
    v_accvgpr_read_b32 v58, a26
    v_accvgpr_read_b32 v59, a27
    v_mfma_f32_16x16x32_bf16 v[196:199], a[168:171], a[192:195], v[196:199]
    buffer_load_dwordx4 v5, s[16:19], s64 offen offset:1024 lds
    v_mfma_f32_16x16x32_bf16 v[200:203], a[176:179], a[192:195], v[200:203]
    ds_read_b64_tr_b16 a[168:169], v17 offset:0
    v_accvgpr_read_b32 v60, a28
    v_accvgpr_read_b32 v61, a29
    v_accvgpr_read_b32 v62, a30
    v_accvgpr_read_b32 v63, a31
    v_cvt_pk_bf16_f32 v56, v56, v57
    v_mfma_f32_16x16x32_bf16 v[200:203], a[180:183], a[196:199], v[200:203]
    ds_read_b128 a[240:243], v24 offset:36864
    ds_read_b128 a[244:247], v25 offset:36864
    v_cvt_pk_bf16_f32 v57, v58, v59
    v_mfma_f32_16x16x32_bf16 v[216:219], a[180:183], a[204:207], v[216:219]
    ds_read_b64_tr_b16 a[170:171], v17 offset:1024
    v_add_u32 v16, 4294901760, v16
    v_cvt_pk_bf16_f32 v58, v60, v61
    v_mfma_f32_16x16x32_bf16 v[216:219], a[176:179], a[200:203], v[216:219]
    buffer_load_dwordx4 v6, s[16:19], s64 offen offset:2048 lds
    v_cvt_pk_bf16_f32 v59, v62, v63
    v_mfma_f32_16x16x32_bf16 v[232:235], a[176:179], a[208:211], v[232:235]
    ds_read_b64_tr_b16 a[172:173], v17 offset:8192
    v_mfma_f32_16x16x32_bf16 v[232:235], a[180:183], a[212:215], v[232:235]
    ds_read_b128 a[248:251], v24 offset:38912
    ds_read_b128 a[252:255], v25 offset:38912
    v_mfma_f32_16x16x32_bf16 v[248:251], a[180:183], a[220:223], v[248:251]
    ds_read_b64_tr_b16 a[174:175], v17 offset:9216
    v_mfma_f32_16x16x32_bf16 v[248:251], a[176:179], a[216:219], v[248:251]
    buffer_load_dwordx4 v7, s[16:19], s64 offen offset:3072 lds
    v_mfma_f32_16x16x32_bf16 v[252:255], a[184:187], a[216:219], v[252:255]
    s_add_u32 s64, s64, 524288
    ds_read_b64_tr_b16 a[176:177], v18 offset:0
    v_mfma_f32_16x16x32_bf16 v[252:255], a[188:191], a[220:223], v[252:255]
    s_lshr_b32 s69, s80, 1
    s_add_u32 s71, s66, 8192
    buffer_store_dwordx4 v[56:59], v2, s[48:51], s71 offen offset:3072 sc1
    v_mfma_f32_16x16x32_bf16 v[236:239], a[188:191], a[212:215], v[236:239]
    s_add_u32 m0, s69, 49152
    ds_read_b64_tr_b16 a[178:179], v18 offset:1024
    v_add_u32 v17, 4294901760, v17
    v_mfma_f32_16x16x32_bf16 v[236:239], a[184:187], a[208:211], v[236:239]
    buffer_load_dwordx4 v12, s[28:31], s67 offen offset:0 lds
    v_mfma_f32_16x16x32_bf16 v[220:223], a[184:187], a[200:203], v[220:223]
    ds_read_b64_tr_b16 a[180:181], v18 offset:8192
    v_mfma_f32_16x16x32_bf16 v[220:223], a[188:191], a[204:207], v[220:223]
    v_mfma_f32_16x16x32_bf16 v[204:207], a[188:191], a[196:199], v[204:207]
    ds_read_b64_tr_b16 a[182:183], v18 offset:9216
    v_mfma_f32_16x16x32_bf16 v[204:207], a[184:187], a[192:195], v[204:207]
    s_waitcnt lgkmcnt(5)
    buffer_load_dwordx4 v13, s[28:31], s67 offen offset:1024 lds
    v_mfma_f32_16x16x32_bf16 v[88:91], a[160:163], a[224:227], v[88:91]
    s_add_u32 s67, s67, s74
    ds_read_b64_tr_b16 a[184:185], v19 offset:0
    v_mfma_f32_16x16x32_bf16 v[88:91], a[164:167], a[228:231], v[88:91]
    v_mfma_f32_16x16x32_bf16 v[80:83], a[164:167], a[236:239], v[80:83]
    s_add_u32 m0, s63, 131072
    ds_read_b64_tr_b16 a[186:187], v19 offset:1024
    v_add_u32 v18, 4294901760, v18
    v_mfma_f32_16x16x32_bf16 v[80:83], a[160:163], a[232:235], v[80:83]
    buffer_load_dwordx4 v8, s[8:11], s65 offen offset:0 lds
    v_mfma_f32_16x16x32_bf16 v[72:75], a[160:163], a[240:243], v[72:75]
    ds_read_b64_tr_b16 a[188:189], v19 offset:8192
    v_accvgpr_read_b32 v56, a32
    v_mfma_f32_16x16x32_bf16 v[72:75], a[164:167], a[244:247], v[72:75]
    v_accvgpr_read_b32 v57, a33
    v_accvgpr_read_b32 v58, a34
    v_mfma_f32_16x16x32_bf16 v[64:67], a[164:167], a[252:255], v[64:67]
    ds_read_b64_tr_b16 a[190:191], v19 offset:9216
    v_accvgpr_read_b32 v59, a35
    v_mfma_f32_16x16x32_bf16 v[64:67], a[160:163], a[248:251], v[64:67]
    s_waitcnt lgkmcnt(8)
    buffer_load_dwordx4 v9, s[8:11], s65 offen offset:1024 lds
    v_mfma_f32_16x16x32_bf16 v[68:71], a[168:171], a[248:251], v[68:71]
    ds_read_b64_tr_b16 a[160:161], v20 offset:0
    v_accvgpr_read_b32 v60, a36
    v_mfma_f32_16x16x32_bf16 v[68:71], a[172:175], a[252:255], v[68:71]
    v_accvgpr_read_b32 v61, a37
    v_accvgpr_read_b32 v62, a38
    v_accvgpr_read_b32 v63, a39
    v_cvt_pk_bf16_f32 v56, v56, v57
    v_cvt_pk_bf16_f32 v57, v58, v59
    v_mfma_f32_16x16x32_bf16 v[76:79], a[172:175], a[244:247], v[76:79]
    ds_read_b64_tr_b16 a[162:163], v20 offset:1024
    v_add_u32 v19, 4294901760, v19
    v_cvt_pk_bf16_f32 v58, v60, v61
    v_mfma_f32_16x16x32_bf16 v[76:79], a[168:171], a[240:243], v[76:79]
    buffer_load_dwordx4 v10, s[8:11], s65 offen offset:2048 lds
    v_cvt_pk_bf16_f32 v59, v62, v63
    v_mfma_f32_16x16x32_bf16 v[84:87], a[168:171], a[232:235], v[84:87]
    ds_read_b64_tr_b16 a[164:165], v20 offset:8192
    v_mfma_f32_16x16x32_bf16 v[84:87], a[172:175], a[236:239], v[84:87]
    s_add_u32 s71, s66, 12288
    buffer_store_dwordx4 v[56:59], v2, s[48:51], s71 offen offset:0 sc1
    v_mfma_f32_16x16x32_bf16 v[92:95], a[172:175], a[228:231], v[92:95]
    ds_read_b64_tr_b16 a[166:167], v20 offset:9216
    v_mfma_f32_16x16x32_bf16 v[92:95], a[168:171], a[224:227], v[92:95]
    s_waitcnt lgkmcnt(8)
    buffer_load_dwordx4 v11, s[8:11], s65 offen offset:3072 lds
    v_mfma_f32_16x16x32_bf16 v[120:123], a[176:179], a[224:227], v[120:123]
    ds_read_b64_tr_b16 a[168:169], v21 offset:0
    v_mfma_f32_16x16x32_bf16 v[120:123], a[180:183], a[228:231], v[120:123]
    s_add_u32 s70, s65, 32768
    v_mfma_f32_16x16x32_bf16 v[112:115], a[180:183], a[236:239], v[112:115]
    s_add_u32 m0, s63, 135168
    ds_read_b64_tr_b16 a[170:171], v21 offset:1024
    v_add_u32 v20, 4294901760, v20
    v_mfma_f32_16x16x32_bf16 v[112:115], a[176:179], a[232:235], v[112:115]
    buffer_load_dwordx4 v8, s[8:11], s70 offen offset:0 lds
    v_mfma_f32_16x16x32_bf16 v[104:107], a[176:179], a[240:243], v[104:107]
    ds_read_b64_tr_b16 a[172:173], v21 offset:8192
    v_mfma_f32_16x16x32_bf16 v[104:107], a[180:183], a[244:247], v[104:107]
    v_mfma_f32_16x16x32_bf16 v[96:99], a[180:183], a[252:255], v[96:99]
    ds_read_b64_tr_b16 a[174:175], v21 offset:9216
    v_mfma_f32_16x16x32_bf16 v[96:99], a[176:179], a[248:251], v[96:99]
    s_waitcnt lgkmcnt(8)
    buffer_load_dwordx4 v9, s[8:11], s70 offen offset:1024 lds
    v_mfma_f32_16x16x32_bf16 v[100:103], a[184:187], a[248:251], v[100:103]
    ds_read_b64_tr_b16 a[176:177], v22 offset:0
    v_mfma_f32_16x16x32_bf16 v[100:103], a[188:191], a[252:255], v[100:103]
    v_mfma_f32_16x16x32_bf16 v[108:111], a[188:191], a[244:247], v[108:111]
    ds_read_b64_tr_b16 a[178:179], v22 offset:1024
    v_add_u32 v21, 4294901760, v21
    v_mfma_f32_16x16x32_bf16 v[108:111], a[184:187], a[240:243], v[108:111]
    buffer_load_dwordx4 v10, s[8:11], s70 offen offset:2048 lds
    v_mfma_f32_16x16x32_bf16 v[116:119], a[184:187], a[232:235], v[116:119]
    ds_read_b64_tr_b16 a[180:181], v22 offset:8192
    v_accvgpr_read_b32 v56, a40
    v_mfma_f32_16x16x32_bf16 v[116:119], a[188:191], a[236:239], v[116:119]
    v_accvgpr_read_b32 v57, a41
    v_accvgpr_read_b32 v58, a42
    v_mfma_f32_16x16x32_bf16 v[124:127], a[188:191], a[228:231], v[124:127]
    ds_read_b64_tr_b16 a[182:183], v22 offset:9216
    v_accvgpr_read_b32 v59, a43
    v_mfma_f32_16x16x32_bf16 v[124:127], a[184:187], a[224:227], v[124:127]
    s_waitcnt lgkmcnt(8)
    buffer_load_dwordx4 v11, s[8:11], s70 offen offset:3072 lds
    v_mfma_f32_16x16x32_bf16 v[152:155], a[160:163], a[224:227], v[152:155]
    s_add_u32 s65, s65, 128
    ds_read_b64_tr_b16 a[184:185], v23 offset:0
    v_accvgpr_read_b32 v60, a44
    v_mfma_f32_16x16x32_bf16 v[152:155], a[164:167], a[228:231], v[152:155]
    v_accvgpr_read_b32 v61, a45
    v_accvgpr_read_b32 v62, a46
    v_accvgpr_read_b32 v63, a47
    v_mfma_f32_16x16x32_bf16 v[144:147], a[164:167], a[236:239], v[144:147]
    ds_read_b64_tr_b16 a[186:187], v23 offset:1024
    v_add_u32 v22, 4294901760, v22
    v_mfma_f32_16x16x32_bf16 v[144:147], a[160:163], a[232:235], v[144:147]
    v_cvt_pk_bf16_f32 v56, v56, v57
    v_cvt_pk_bf16_f32 v57, v58, v59
    v_cvt_pk_bf16_f32 v58, v60, v61
    v_cvt_pk_bf16_f32 v59, v62, v63
    v_mfma_f32_16x16x32_bf16 v[136:139], a[160:163], a[240:243], v[136:139]
    ds_read_b64_tr_b16 a[188:189], v23 offset:8192
    v_mfma_f32_16x16x32_bf16 v[136:139], a[164:167], a[244:247], v[136:139]
    s_add_u32 s71, s66, 12288
    buffer_store_dwordx4 v[56:59], v2, s[48:51], s71 offen offset:1024 sc1
    v_mfma_f32_16x16x32_bf16 v[128:131], a[164:167], a[252:255], v[128:131]
    ds_read_b64_tr_b16 a[190:191], v23 offset:9216
    v_mfma_f32_16x16x32_bf16 v[128:131], a[160:163], a[248:251], v[128:131]
    s_waitcnt lgkmcnt(8)
    v_mfma_f32_16x16x32_bf16 v[132:135], a[168:171], a[248:251], v[132:135]
    ds_read_b64_tr_b16 a[160:161], v26 offset:0
    v_mfma_f32_16x16x32_bf16 v[132:135], a[172:175], a[252:255], v[132:135]
    v_mfma_f32_16x16x32_bf16 v[140:143], a[172:175], a[244:247], v[140:143]
    ds_read_b64_tr_b16 a[162:163], v26 offset:512
    v_add_u32 v23, 4294901760, v23
    v_mfma_f32_16x16x32_bf16 v[140:143], a[168:171], a[240:243], v[140:143]
    v_mfma_f32_16x16x32_bf16 v[148:151], a[168:171], a[232:235], v[148:151]
    ds_read_b64_tr_b16 a[164:165], v26 offset:4096
    v_mfma_f32_16x16x32_bf16 v[148:151], a[172:175], a[236:239], v[148:151]
    v_mfma_f32_16x16x32_bf16 v[156:159], a[172:175], a[228:231], v[156:159]
    ds_read_b64_tr_b16 a[166:167], v26 offset:4608
    v_mfma_f32_16x16x32_bf16 v[156:159], a[168:171], a[224:227], v[156:159]
    s_waitcnt lgkmcnt(8)
    v_mfma_f32_16x16x32_bf16 v[184:187], a[176:179], a[224:227], v[184:187]
    ds_read_b64_tr_b16 a[168:169], v27 offset:0
    v_mfma_f32_16x16x32_bf16 v[184:187], a[180:183], a[228:231], v[184:187]
    v_mfma_f32_16x16x32_bf16 v[176:179], a[180:183], a[236:239], v[176:179]
    s_lshr_b32 s88, s2, 3
    ds_read_b64_tr_b16 a[170:171], v27 offset:512
    v_add_u32 v26, 4294901760, v26
    v_mfma_f32_16x16x32_bf16 v[176:179], a[176:179], a[232:235], v[176:179]
    s_lshl_b32 s88, s88, 2
    v_accvgpr_read_b32 v56, a48
    v_accvgpr_read_b32 v57, a49
    v_mfma_f32_16x16x32_bf16 v[168:171], a[176:179], a[240:243], v[168:171]
    s_add_u32 s88, s88, s60
    ds_read_b64_tr_b16 a[172:173], v27 offset:4096
    v_accvgpr_read_b32 v58, a50
    v_mfma_f32_16x16x32_bf16 v[168:171], a[180:183], a[244:247], v[168:171]
    s_lshl_b32 s88, s88, 8
    v_accvgpr_read_b32 v59, a51
    v_accvgpr_read_b32 v60, a52
    v_mfma_f32_16x16x32_bf16 v[160:163], a[180:183], a[252:255], v[160:163]
    s_add_u32 s88, s88, L_mishdone - L_pc
    ds_read_b64_tr_b16 a[174:175], v27 offset:4608
    v_min_u32 v33, 1, v1
    v_accvgpr_read_b32 v61, a53
    v_mfma_f32_16x16x32_bf16 v[160:163], a[176:179], a[248:251], v[160:163]
    s_waitcnt lgkmcnt(8)
    v_lshlrev_b32 v33, 7, v33
    v_add_u32 v33, s88, v33
    v_accvgpr_read_b32 v62, a54
    v_accvgpr_read_b32 v63, a55
    v_mfma_f32_16x16x32_bf16 v[164:167], a[184:187], a[248:251], v[164:167]
    ds_read_b64_tr_b16 a[176:177], v28 offset:0
    v_min_u32 v33, L_end34 - L_pc, v33
    v_mfma_f32_16x16x32_bf16 v[164:167], a[188:191], a[252:255], v[164:167]
    global_load_dword v55, v33, s[90:91]
    v_mfma_f32_16x16x32_bf16 v[172:175], a[188:191], a[244:247], v[172:175]
    ds_read_b64_tr_b16 a[178:179], v28 offset:512
    v_add_u32 v27, 4294901760, v27
    v_mfma_f32_16x16x32_bf16 v[172:175], a[184:187], a[240:243], v[172:175]
    v_cvt_pk_bf16_f32 v56, v56, v57
    v_cvt_pk_bf16_f32 v57, v58, v59
    v_cvt_pk_bf16_f32 v58, v60, v61
    v_cvt_pk_bf16_f32 v59, v62, v63
    v_mfma_f32_16x16x32_bf16 v[180:183], a[184:187], a[232:235], v[180:183]
    ds_read_b64_tr_b16 a[180:181], v28 offset:4096
    v_mfma_f32_16x16x32_bf16 v[180:183], a[188:191], a[236:239], v[180:183]
    s_add_u32 s71, s66, 12288
    buffer_store_dwordx4 v[56:59], v2, s[48:51], s71 offen offset:2048 sc1
    v_mfma_f32_16x16x32_bf16 v[188:191], a[188:191], a[228:231], v[188:191]
    ds_read_b64_tr_b16 a[182:183], v28 offset:4608
    v_mfma_f32_16x16x32_bf16 v[188:191], a[184:187], a[224:227], v[188:191]
    s_waitcnt lgkmcnt(8)
    v_mfma_f32_16x16x32_bf16 v[192:195], a[160:163], a[224:227], v[192:195]
    ds_read_b64_tr_b16 a[184:185], v29 offset:0
    ds_read_b64_tr_b16 a[186:187], v29 offset:512
    v_mfma_f32_16x16x32_bf16 v[192:195], a[164:167], a[228:231], v[192:195]
    v_mfma_f32_16x16x32_bf16 v[208:211], a[164:167], a[236:239], v[208:211]
    ds_read_b64_tr_b16 a[188:189], v29 offset:4096
    v_add_u32 v28, 4294901760, v28
    v_mfma_f32_16x16x32_bf16 v[208:211], a[160:163], a[232:235], v[208:211]
    v_mfma_f32_16x16x32_bf16 v[224:227], a[160:163], a[240:243], v[224:227]
    ds_read_b64_tr_b16 a[190:191], v29 offset:4608
    v_mfma_f32_16x16x32_bf16 v[224:227], a[164:167], a[244:247], v[224:227]
    v_mfma_f32_16x16x32_bf16 v[240:243], a[164:167], a[252:255], v[240:243]
    v_mfma_f32_16x16x32_bf16 v[240:243], a[160:163], a[248:251], v[240:243]
    s_waitcnt vmcnt(21) lgkmcnt(0)
    v_mfma_f32_16x16x32_bf16 v[244:247], a[168:171], a[248:251], v[244:247]
    s_barrier
    ds_read_b64_tr_b16 a[160:161], v16 offset:0
    v_mfma_f32_16x16x32_bf16 v[244:247], a[172:175], a[252:255], v[244:247]
    ds_read_b128 a[192:195], v24 offset:0
    ds_read_b128 a[196:199], v25 offset:0
    v_mfma_f32_16x16x32_bf16 v[228:231], a[172:175], a[244:247], v[228:231]
    s_add_u32 m0, s80, 65536
    ds_read_b64_tr_b16 a[162:163], v16 offset:1024
    v_add_u32 v29, 4294901760, v29
    v_mfma_f32_16x16x32_bf16 v[228:231], a[168:171], a[240:243], v[228:231]
    buffer_load_dwordx4 v4, s[16:19], s64 offen offset:0 lds
    v_mfma_f32_16x16x32_bf16 v[212:215], a[168:171], a[232:235], v[212:215]
    ds_read_b64_tr_b16 a[164:165], v16 offset:8192
    v_accvgpr_read_b32 v56, a56
    v_accvgpr_read_b32 v57, a57
    v_mfma_f32_16x16x32_bf16 v[212:215], a[172:175], a[236:239], v[212:215]
    ds_read_b128 a[200:203], v24 offset:2048
    ds_read_b128 a[204:207], v25 offset:2048
    v_mfma_f32_16x16x32_bf16 v[196:199], a[172:175], a[228:231], v[196:199]
    ds_read_b64_tr_b16 a[166:167], v16 offset:9216
    v_accvgpr_read_b32 v58, a58
    v_accvgpr_read_b32 v59, a59
    v_mfma_f32_16x16x32_bf16 v[196:199], a[168:171], a[224:227], v[196:199]
    buffer_load_dwordx4 v5, s[16:19], s64 offen offset:1024 lds
    v_mfma_f32_16x16x32_bf16 v[200:203], a[176:179], a[224:227], v[200:203]
    ds_read_b64_tr_b16 a[168:169], v17 offset:0
    v_accvgpr_read_b32 v60, a60
    v_accvgpr_read_b32 v61, a61
    v_mfma_f32_16x16x32_bf16 v[200:203], a[180:183], a[228:231], v[200:203]
    ds_read_b128 a[208:211], v24 offset:4096
    ds_read_b128 a[212:215], v25 offset:4096
    v_mfma_f32_16x16x32_bf16 v[216:219], a[180:183], a[236:239], v[216:219]
    ds_read_b64_tr_b16 a[170:171], v17 offset:1024
    v_accvgpr_read_b32 v62, a62
    v_accvgpr_read_b32 v63, a63
    v_cvt_pk_bf16_f32 v56, v56, v57
    v_cvt_pk_bf16_f32 v57, v58, v59
    v_cvt_pk_bf16_f32 v58, v60, v61
    v_mfma_f32_16x16x32_bf16 v[216:219], a[176:179], a[232:235], v[216:219]
    buffer_load_dwordx4 v6, s[16:19], s64 offen offset:2048 lds
    v_cvt_pk_bf16_f32 v59, v62, v63
    v_mfma_f32_16x16x32_bf16 v[232:235], a[176:179], a[240:243], v[232:235]
    ds_read_b64_tr_b16 a[172:173], v17 offset:8192
    v_mfma_f32_16x16x32_bf16 v[232:235], a[180:183], a[244:247], v[232:235]
    ds_read_b128 a[216:219], v24 offset:6144
    ds_read_b128 a[220:223], v25 offset:6144
    v_mfma_f32_16x16x32_bf16 v[248:251], a[180:183], a[252:255], v[248:251]
    ds_read_b64_tr_b16 a[174:175], v17 offset:9216
    v_mfma_f32_16x16x32_bf16 v[248:251], a[176:179], a[248:251], v[248:251]
    buffer_load_dwordx4 v7, s[16:19], s64 offen offset:3072 lds
    v_mfma_f32_16x16x32_bf16 v[252:255], a[184:187], a[248:251], v[252:255]
    s_add_u32 s64, s64, 524288
    ds_read_b64_tr_b16 a[176:177], v18 offset:0
    v_mfma_f32_16x16x32_bf16 v[252:255], a[188:191], a[252:255], v[252:255]
    s_lshr_b32 s69, s80, 1
    s_add_u32 s71, s66, 12288
    buffer_store_dwordx4 v[56:59], v2, s[48:51], s71 offen offset:3072 sc1
    v_mfma_f32_16x16x32_bf16 v[236:239], a[188:191], a[244:247], v[236:239]
    s_add_u32 m0, s69, 81920
    ds_read_b64_tr_b16 a[178:179], v18 offset:1024
    v_accvgpr_write_b32 a0, 0
    v_mfma_f32_16x16x32_bf16 v[236:239], a[184:187], a[240:243], v[236:239]
    buffer_load_dwordx4 v12, s[28:31], s67 offen offset:0 lds
    v_mfma_f32_16x16x32_bf16 v[220:223], a[184:187], a[232:235], v[220:223]
    ds_read_b64_tr_b16 a[180:181], v18 offset:8192
    v_accvgpr_write_b32 a1, 0
    v_mfma_f32_16x16x32_bf16 v[220:223], a[188:191], a[236:239], v[220:223]
    v_accvgpr_write_b32 a2, 0
    v_accvgpr_write_b32 a3, 0
    v_mfma_f32_16x16x32_bf16 v[204:207], a[188:191], a[228:231], v[204:207]
    ds_read_b64_tr_b16 a[182:183], v18 offset:9216
    v_accvgpr_write_b32 a4, 0
    v_mfma_f32_16x16x32_bf16 v[204:207], a[184:187], a[224:227], v[204:207]
    s_waitcnt lgkmcnt(5)
    buffer_load_dwordx4 v13, s[28:31], s67 offen offset:1024 lds
    v_mfma_f32_16x16x32_bf16 v[88:91], a[160:163], a[192:195], v[88:91]
    s_add_u32 s67, s67, s74
    ds_read_b64_tr_b16 a[184:185], v19 offset:0
    v_accvgpr_write_b32 a5, 0
    v_mfma_f32_16x16x32_bf16 v[88:91], a[164:167], a[196:199], v[88:91]
    v_accvgpr_write_b32 a6, 0
    v_accvgpr_write_b32 a7, 0
    v_mfma_f32_16x16x32_bf16 v[80:83], a[164:167], a[204:207], v[80:83]
    s_add_u32 m0, s63, 98304
    ds_read_b64_tr_b16 a[186:187], v19 offset:1024
    v_accvgpr_read_b32 v56, a64
    v_mfma_f32_16x16x32_bf16 v[80:83], a[160:163], a[200:203], v[80:83]
    buffer_load_dwordx4 v8, s[8:11], s65 offen offset:0 lds
    v_mfma_f32_16x16x32_bf16 v[72:75], a[160:163], a[208:211], v[72:75]
    ds_read_b64_tr_b16 a[188:189], v19 offset:8192
    v_accvgpr_read_b32 v57, a65
    v_mfma_f32_16x16x32_bf16 v[72:75], a[164:167], a[212:215], v[72:75]
    v_accvgpr_read_b32 v58, a66
    v_accvgpr_read_b32 v59, a67
    v_mfma_f32_16x16x32_bf16 v[64:67], a[164:167], a[220:223], v[64:67]
    ds_read_b64_tr_b16 a[190:191], v19 offset:9216
    v_accvgpr_read_b32 v60, a68
    v_mfma_f32_16x16x32_bf16 v[64:67], a[160:163], a[216:219], v[64:67]
    s_waitcnt lgkmcnt(8)
    buffer_load_dwordx4 v9, s[8:11], s65 offen offset:1024 lds
    v_mfma_f32_16x16x32_bf16 v[68:71], a[168:171], a[216:219], v[68:71]
    ds_read_b64_tr_b16 a[160:161], v20 offset:0
    v_accvgpr_read_b32 v61, a69
    v_mfma_f32_16x16x32_bf16 v[68:71], a[172:175], a[220:223], v[68:71]
    v_accvgpr_read_b32 v62, a70
    v_accvgpr_read_b32 v63, a71
    v_mfma_f32_16x16x32_bf16 v[76:79], a[172:175], a[212:215], v[76:79]
    ds_read_b64_tr_b16 a[162:163], v20 offset:1024
    v_cvt_pk_bf16_f32 v56, v56, v57
    v_cvt_pk_bf16_f32 v57, v58, v59
    v_cvt_pk_bf16_f32 v58, v60, v61
    v_mfma_f32_16x16x32_bf16 v[76:79], a[168:171], a[208:211], v[76:79]
    buffer_load_dwordx4 v10, s[8:11], s65 offen offset:2048 lds
    v_cvt_pk_bf16_f32 v59, v62, v63
    v_mfma_f32_16x16x32_bf16 v[84:87], a[168:171], a[200:203], v[84:87]
    ds_read_b64_tr_b16 a[164:165], v20 offset:8192
    v_accvgpr_write_b32 a8, 0
    v_mfma_f32_16x16x32_bf16 v[84:87], a[172:175], a[204:207], v[84:87]
    s_add_u32 s71, s66, 24576
    buffer_store_dwordx4 v[56:59], v2, s[48:51], s71 offen offset:0 sc1
    v_mfma_f32_16x16x32_bf16 v[92:95], a[172:175], a[196:199], v[92:95]
    ds_read_b64_tr_b16 a[166:167], v20 offset:9216
    v_accvgpr_write_b32 a9, 0
    v_mfma_f32_16x16x32_bf16 v[92:95], a[168:171], a[192:195], v[92:95]
    s_waitcnt lgkmcnt(8)
    buffer_load_dwordx4 v11, s[8:11], s65 offen offset:3072 lds
    v_mfma_f32_16x16x32_bf16 v[120:123], a[176:179], a[192:195], v[120:123]
    ds_read_b64_tr_b16 a[168:169], v21 offset:0
    v_accvgpr_write_b32 a10, 0
    v_mfma_f32_16x16x32_bf16 v[120:123], a[180:183], a[196:199], v[120:123]
    s_add_u32 s70, s65, 32768
    v_accvgpr_write_b32 a11, 0
    v_accvgpr_write_b32 a12, 0
    v_mfma_f32_16x16x32_bf16 v[112:115], a[180:183], a[204:207], v[112:115]
    s_add_u32 m0, s63, 102400
    ds_read_b64_tr_b16 a[170:171], v21 offset:1024
    v_accvgpr_write_b32 a13, 0
    v_mfma_f32_16x16x32_bf16 v[112:115], a[176:179], a[200:203], v[112:115]
    buffer_load_dwordx4 v8, s[8:11], s70 offen offset:0 lds
    v_mfma_f32_16x16x32_bf16 v[104:107], a[176:179], a[208:211], v[104:107]
    ds_read_b64_tr_b16 a[172:173], v21 offset:8192
    v_accvgpr_write_b32 a14, 0
    v_mfma_f32_16x16x32_bf16 v[104:107], a[180:183], a[212:215], v[104:107]
    v_accvgpr_write_b32 a15, 0
    v_accvgpr_write_b32 a16, 0
    v_mfma_f32_16x16x32_bf16 v[96:99], a[180:183], a[220:223], v[96:99]
    ds_read_b64_tr_b16 a[174:175], v21 offset:9216
    v_accvgpr_write_b32 a17, 0
    v_mfma_f32_16x16x32_bf16 v[96:99], a[176:179], a[216:219], v[96:99]
    s_waitcnt lgkmcnt(8)
    buffer_load_dwordx4 v9, s[8:11], s70 offen offset:1024 lds
    v_mfma_f32_16x16x32_bf16 v[100:103], a[184:187], a[216:219], v[100:103]
    ds_read_b64_tr_b16 a[176:177], v22 offset:0
    v_accvgpr_write_b32 a18, 0
    v_mfma_f32_16x16x32_bf16 v[100:103], a[188:191], a[220:223], v[100:103]
    v_accvgpr_write_b32 a19, 0
    v_accvgpr_write_b32 a20, 0
    v_mfma_f32_16x16x32_bf16 v[108:111], a[188:191], a[212:215], v[108:111]
    ds_read_b64_tr_b16 a[178:179], v22 offset:1024
    v_accvgpr_read_b32 v56, a72
    v_mfma_f32_16x16x32_bf16 v[108:111], a[184:187], a[208:211], v[108:111]
    buffer_load_dwordx4 v10, s[8:11], s70 offen offset:2048 lds
    v_mfma_f32_16x16x32_bf16 v[116:119], a[184:187], a[200:203], v[116:119]
    ds_read_b64_tr_b16 a[180:181], v22 offset:8192
    v_accvgpr_read_b32 v57, a73
    v_mfma_f32_16x16x32_bf16 v[116:119], a[188:191], a[204:207], v[116:119]
    v_accvgpr_read_b32 v58, a74
    v_accvgpr_read_b32 v59, a75
    v_mfma_f32_16x16x32_bf16 v[124:127], a[188:191], a[196:199], v[124:127]
    ds_read_b64_tr_b16 a[182:183], v22 offset:9216
    v_accvgpr_read_b32 v60, a76
    v_mfma_f32_16x16x32_bf16 v[124:127], a[184:187], a[192:195], v[124:127]
    s_waitcnt lgkmcnt(8)
    buffer_load_dwordx4 v11, s[8:11], s70 offen offset:3072 lds
    v_mfma_f32_16x16x32_bf16 v[152:155], a[160:163], a[192:195], v[152:155]
    s_add_u32 s65, s65, 128
    ds_read_b64_tr_b16 a[184:185], v23 offset:0
    v_accvgpr_read_b32 v61, a77
    v_mfma_f32_16x16x32_bf16 v[152:155], a[164:167], a[196:199], v[152:155]
    v_accvgpr_read_b32 v62, a78
    v_accvgpr_read_b32 v63, a79
    v_mfma_f32_16x16x32_bf16 v[144:147], a[164:167], a[204:207], v[144:147]
    ds_read_b64_tr_b16 a[186:187], v23 offset:1024
    v_cvt_pk_bf16_f32 v56, v56, v57
    v_mfma_f32_16x16x32_bf16 v[144:147], a[160:163], a[200:203], v[144:147]
    v_cvt_pk_bf16_f32 v57, v58, v59
    v_cvt_pk_bf16_f32 v58, v60, v61
    v_cvt_pk_bf16_f32 v59, v62, v63
    v_mfma_f32_16x16x32_bf16 v[136:139], a[160:163], a[208:211], v[136:139]
    ds_read_b64_tr_b16 a[188:189], v23 offset:8192
    v_accvgpr_write_b32 a21, 0
    v_mfma_f32_16x16x32_bf16 v[136:139], a[164:167], a[212:215], v[136:139]
    s_add_u32 s71, s66, 24576
    buffer_store_dwordx4 v[56:59], v2, s[48:51], s71 offen offset:1024 sc1
    v_mfma_f32_16x16x32_bf16 v[128:131], a[164:167], a[220:223], v[128:131]
    ds_read_b64_tr_b16 a[190:191], v23 offset:9216
    v_accvgpr_write_b32 a22, 0
    v_mfma_f32_16x16x32_bf16 v[128:131], a[160:163], a[216:219], v[128:131]
    s_waitcnt lgkmcnt(8)
    v_accvgpr_write_b32 a23, 0
    v_accvgpr_write_b32 a24, 0
    v_mfma_f32_16x16x32_bf16 v[132:135], a[168:171], a[216:219], v[132:135]
    ds_read_b64_tr_b16 a[160:161], v26 offset:0
    v_accvgpr_write_b32 a25, 0
    v_mfma_f32_16x16x32_bf16 v[132:135], a[172:175], a[220:223], v[132:135]
    v_accvgpr_write_b32 a26, 0
    v_accvgpr_write_b32 a27, 0
    v_mfma_f32_16x16x32_bf16 v[140:143], a[172:175], a[212:215], v[140:143]
    ds_read_b64_tr_b16 a[162:163], v26 offset:512
    v_accvgpr_write_b32 a28, 0
    v_mfma_f32_16x16x32_bf16 v[140:143], a[168:171], a[208:211], v[140:143]
    v_accvgpr_write_b32 a29, 0
    v_accvgpr_write_b32 a30, 0
    v_mfma_f32_16x16x32_bf16 v[148:151], a[168:171], a[200:203], v[148:151]
    ds_read_b64_tr_b16 a[164:165], v26 offset:4096
    v_accvgpr_write_b32 a31, 0
    v_mfma_f32_16x16x32_bf16 v[148:151], a[172:175], a[204:207], v[148:151]
    v_accvgpr_write_b32 a32, 0
    v_accvgpr_write_b32 a33, 0
    v_mfma_f32_16x16x32_bf16 v[156:159], a[172:175], a[196:199], v[156:159]
    ds_read_b64_tr_b16 a[166:167], v26 offset:4608
    v_accvgpr_write_b32 a34, 0
    v_mfma_f32_16x16x32_bf16 v[156:159], a[168:171], a[192:195], v[156:159]
    s_waitcnt lgkmcnt(8)
    v_accvgpr_write_b32 a35, 0
    v_accvgpr_write_b32 a36, 0
    v_mfma_f32_16x16x32_bf16 v[184:187], a[176:179], a[192:195], v[184:187]
    ds_read_b64_tr_b16 a[168:169], v27 offset:0
    v_accvgpr_write_b32 a37, 0
    v_mfma_f32_16x16x32_bf16 v[184:187], a[180:183], a[196:199], v[184:187]
    v_accvgpr_write_b32 a38, 0
    v_accvgpr_write_b32 a39, 0
    v_mfma_f32_16x16x32_bf16 v[176:179], a[180:183], a[204:207], v[176:179]
    ds_read_b64_tr_b16 a[170:171], v27 offset:512
    v_lshlrev_b32 v33, 7, v1
    v_mfma_f32_16x16x32_bf16 v[176:179], a[176:179], a[200:203], v[176:179]
    v_add_u32 v33, L_xdone - L_pc, v33
    v_min_u32 v33, L_codeend - L_pc, v33
    v_mfma_f32_16x16x32_bf16 v[168:171], a[176:179], a[208:211], v[168:171]
    ds_read_b64_tr_b16 a[172:173], v27 offset:4096
    v_accvgpr_read_b32 v56, a80
    v_accvgpr_read_b32 v57, a81
    v_mfma_f32_16x16x32_bf16 v[168:171], a[180:183], a[212:215], v[168:171]
    s_mov_b64 exec, 0xfffff
    global_load_dword v55, v33, s[90:91]
    s_mov_b64 exec, -1
    v_mfma_f32_16x16x32_bf16 v[160:163], a[180:183], a[220:223], v[160:163]
    ds_read_b64_tr_b16 a[174:175], v27 offset:4608
    v_accvgpr_read_b32 v58, a82
    v_mfma_f32_16x16x32_bf16 v[160:163], a[176:179], a[216:219], v[160:163]
    s_waitcnt lgkmcnt(8)
    v_accvgpr_read_b32 v59, a83
    v_accvgpr_read_b32 v60, a84
    v_mfma_f32_16x16x32_bf16 v[164:167], a[184:187], a[216:219], v[164:167]
    ds_read_b64_tr_b16 a[176:177], v28 offset:0
    v_accvgpr_read_b32 v61, a85
    v_mfma_f32_16x16x32_bf16 v[164:167], a[188:191], a[220:223], v[164:167]
    v_accvgpr_read_b32 v62, a86
    v_accvgpr_read_b32 v63, a87
    v_mfma_f32_16x16x32_bf16 v[172:175], a[188:191], a[212:215], v[172:175]
    ds_read_b64_tr_b16 a[178:179], v28 offset:512
    v_cvt_pk_bf16_f32 v56, v56, v57
    v_mfma_f32_16x16x32_bf16 v[172:175], a[184:187], a[208:211], v[172:175]
    v_cvt_pk_bf16_f32 v57, v58, v59
    v_cvt_pk_bf16_f32 v58, v60, v61
    v_cvt_pk_bf16_f32 v59, v62, v63
    v_mfma_f32_16x16x32_bf16 v[180:183], a[184:187], a[200:203], v[180:183]
    ds_read_b64_tr_b16 a[180:181], v28 offset:4096
    v_accvgpr_write_b32 a40, 0
    v_mfma_f32_16x16x32_bf16 v[180:183], a[188:191], a[204:207], v[180:183]
    s_add_u32 s71, s66, 24576
    buffer_store_dwordx4 v[56:59], v2, s[48:51], s71 offen offset:2048 sc1
    v_mfma_f32_16x16x32_bf16 v[188:191], a[188:191], a[196:199], v[188:191]
    ds_read_b64_tr_b16 a[182:183], v28 offset:4608
    v_accvgpr_write_b32 a41, 0
    v_mfma_f32_16x16x32_bf16 v[188:191], a[184:187], a[192:195], v[188:191]
    s_waitcnt lgkmcnt(8)
    v_accvgpr_write_b32 a42, 0
    v_accvgpr_write_b32 a43, 0
    v_mfma_f32_16x16x32_bf16 v[192:195], a[160:163], a[192:195], v[192:195]
    ds_read_b64_tr_b16 a[184:185], v29 offset:0
    ds_read_b64_tr_b16 a[186:187], v29 offset:512
    v_mfma_f32_16x16x32_bf16 v[192:195], a[164:167], a[196:199], v[192:195]
    v_accvgpr_write_b32 a44, 0
    v_accvgpr_write_b32 a45, 0
    v_mfma_f32_16x16x32_bf16 v[208:211], a[164:167], a[204:207], v[208:211]
    ds_read_b64_tr_b16 a[188:189], v29 offset:4096
    v_accvgpr_write_b32 a46, 0
    v_mfma_f32_16x16x32_bf16 v[208:211], a[160:163], a[200:203], v[208:211]
    v_accvgpr_write_b32 a47, 0
    v_accvgpr_write_b32 a48, 0
    v_mfma_f32_16x16x32_bf16 v[224:227], a[160:163], a[208:211], v[224:227]
    ds_read_b64_tr_b16 a[190:191], v29 offset:4608
    v_accvgpr_write_b32 a49, 0
    v_mfma_f32_16x16x32_bf16 v[224:227], a[164:167], a[212:215], v[224:227]
    v_accvgpr_write_b32 a50, 0
    v_accvgpr_write_b32 a51, 0
    v_mfma_f32_16x16x32_bf16 v[240:243], a[164:167], a[220:223], v[240:243]
    v_accvgpr_write_b32 a52, 0
    v_accvgpr_write_b32 a53, 0
    v_mfma_f32_16x16x32_bf16 v[240:243], a[160:163], a[216:219], v[240:243]
    s_waitcnt vmcnt(22) lgkmcnt(0)
    v_accvgpr_write_b32 a54, 0
    v_accvgpr_write_b32 a55, 0
    v_mfma_f32_16x16x32_bf16 v[244:247], a[168:171], a[216:219], v[244:247]
    s_barrier
    ds_read_b64_tr_b16 a[160:161], v16 offset:32768
    v_accvgpr_write_b32 a56, 0
    v_mfma_f32_16x16x32_bf16 v[244:247], a[172:175], a[220:223], v[244:247]
    ds_read_b128 a[224:227], v24 offset:32768
    ds_read_b128 a[228:231], v25 offset:32768
    v_mfma_f32_16x16x32_bf16 v[228:231], a[172:175], a[212:215], v[228:231]
    s_add_u32 m0, s80, 0
    ds_read_b64_tr_b16 a[162:163], v16 offset:33792
    v_accvgpr_read_b32 v56, a88
    v_mfma_f32_16x16x32_bf16 v[228:231], a[168:171], a[208:211], v[228:231]
    buffer_load_dwordx4 v4, s[16:19], s64 offen offset:0 lds
    v_mfma_f32_16x16x32_bf16 v[212:215], a[168:171], a[200:203], v[212:215]
    ds_read_b64_tr_b16 a[164:165], v16 offset:40960
    v_accvgpr_read_b32 v57, a89
    v_mfma_f32_16x16x32_bf16 v[212:215], a[172:175], a[204:207], v[212:215]
    ds_read_b128 a[232:235], v24 offset:34816
    ds_read_b128 a[236:239], v25 offset:34816
    v_mfma_f32_16x16x32_bf16 v[196:199], a[172:175], a[196:199], v[196:199]
    ds_read_b64_tr_b16 a[166:167], v16 offset:41984
    v_accvgpr_read_b32 v58, a90
    v_accvgpr_read_b32 v59, a91
    v_mfma_f32_16x16x32_bf16 v[196:199], a[168:171], a[192:195], v[196:199]
    buffer_load_dwordx4 v5, s[16:19], s64 offen offset:1024 lds
    v_mfma_f32_16x16x32_bf16 v[200:203], a[176:179], a[192:195], v[200:203]
    ds_read_b64_tr_b16 a[168:169], v17 offset:32768
    v_accvgpr_read_b32 v60, a92
    v_accvgpr_read_b32 v61, a93
    v_accvgpr_read_b32 v62, a94
    v_accvgpr_read_b32 v63, a95
    v_cvt_pk_bf16_f32 v56, v56, v57
    v_mfma_f32_16x16x32_bf16 v[200:203], a[180:183], a[196:199], v[200:203]
    ds_read_b128 a[240:243], v24 offset:36864
    ds_read_b128 a[244:247], v25 offset:36864
    v_cvt_pk_bf16_f32 v57, v58, v59
    v_mfma_f32_16x16x32_bf16 v[216:219], a[180:183], a[204:207], v[216:219]
    ds_read_b64_tr_b16 a[170:171], v17 offset:33792
    v_add_u32 v16, 65536, v16
    v_cvt_pk_bf16_f32 v58, v60, v61
    v_mfma_f32_16x16x32_bf16 v[216:219], a[176:179], a[200:203], v[216:219]
    buffer_load_dwordx4 v6, s[16:19], s64 offen offset:2048 lds
    v_cvt_pk_bf16_f32 v59, v62, v63
    v_mfma_f32_16x16x32_bf16 v[232:235], a[176:179], a[208:211], v[232:235]
    ds_read_b64_tr_b16 a[172:173], v17 offset:40960
    v_accvgpr_write_b32 a57, 0
    v_mfma_f32_16x16x32_bf16 v[232:235], a[180:183], a[212:215], v[232:235]
    ds_read_b128 a[248:251], v24 offset:38912
    ds_read_b128 a[252:255], v25 offset:38912
    v_mfma_f32_16x16x32_bf16 v[248:251], a[180:183], a[220:223], v[248:251]
    ds_read_b64_tr_b16 a[174:175], v17 offset:41984
    v_accvgpr_write_b32 a58, 0
    v_mfma_f32_16x16x32_bf16 v[248:251], a[176:179], a[216:219], v[248:251]
    buffer_load_dwordx4 v7, s[16:19], s64 offen offset:3072 lds
    v_mfma_f32_16x16x32_bf16 v[252:255], a[184:187], a[216:219], v[252:255]
    s_add_u32 s64, s64, 524288
    ds_read_b64_tr_b16 a[176:177], v18 offset:32768
    v_accvgpr_write_b32 a59, 0
    v_mfma_f32_16x16x32_bf16 v[252:255], a[188:191], a[220:223], v[252:255]
    s_lshr_b32 s69, s80, 1
    s_add_u32 s71, s66, 24576
    buffer_store_dwordx4 v[56:59], v2, s[48:51], s71 offen offset:3072 sc1
    v_mfma_f32_16x16x32_bf16 v[236:239], a[188:191], a[212:215], v[236:239]
    s_add_u32 m0, s69, 16384
    ds_read_b64_tr_b16 a[178:179], v18 offset:33792
    v_add_u32 v17, 65536, v17
    v_mfma_f32_16x16x32_bf16 v[236:239], a[184:187], a[208:211], v[236:239]
    buffer_load_dwordx4 v12, s[28:31], s67 offen offset:0 lds
    v_mfma_f32_16x16x32_bf16 v[220:223], a[184:187], a[200:203], v[220:223]
    ds_read_b64_tr_b16 a[180:181], v18 offset:40960
    v_accvgpr_write_b32 a60, 0
    v_mfma_f32_16x16x32_bf16 v[220:223], a[188:191], a[204:207], v[220:223]
    v_accvgpr_write_b32 a61, 0
    v_accvgpr_write_b32 a62, 0
    v_mfma_f32_16x16x32_bf16 v[204:207], a[188:191], a[196:199], v[204:207]
    ds_read_b64_tr_b16 a[182:183], v18 offset:41984
    v_accvgpr_write_b32 a63, 0
    v_mfma_f32_16x16x32_bf16 v[204:207], a[184:187], a[192:195], v[204:207]
    s_waitcnt lgkmcnt(5)
    buffer_load_dwordx4 v13, s[28:31], s67 offen offset:1024 lds
    v_mfma_f32_16x16x32_bf16 v[88:91], a[160:163], a[224:227], v[88:91]
    s_add_u32 s67, s67, s74
    ds_read_b64_tr_b16 a[184:185], v19 offset:32768
    v_mfma_f32_16x16x32_bf16 v[88:91], a[164:167], a[228:231], v[88:91]
    v_mfma_f32_16x16x32_bf16 v[80:83], a[164:167], a[236:239], v[80:83]
    s_add_u32 m0, s63, 131072
    ds_read_b64_tr_b16 a[186:187], v19 offset:33792
    v_add_u32 v18, 65536, v18
    v_mfma_f32_16x16x32_bf16 v[80:83], a[160:163], a[232:235], v[80:83]
    buffer_load_dwordx4 v8, s[8:11], s65 offen offset:0 lds
    v_mfma_f32_16x16x32_bf16 v[72:75], a[160:163], a[240:243], v[72:75]
    ds_read_b64_tr_b16 a[188:189], v19 offset:40960
    v_accvgpr_read_b32 v56, a96
    v_mfma_f32_16x16x32_bf16 v[72:75], a[164:167], a[244:247], v[72:75]
    v_accvgpr_read_b32 v57, a97
    v_accvgpr_read_b32 v58, a98
    v_mfma_f32_16x16x32_bf16 v[64:67], a[164:167], a[252:255], v[64:67]
    ds_read_b64_tr_b16 a[190:191], v19 offset:41984
    v_accvgpr_read_b32 v59, a99
    v_mfma_f32_16x16x32_bf16 v[64:67], a[160:163], a[248:251], v[64:67]
    s_waitcnt lgkmcnt(8)
    buffer_load_dwordx4 v9, s[8:11], s65 offen offset:1024 lds
    v_mfma_f32_16x16x32_bf16 v[68:71], a[168:171], a[248:251], v[68:71]
    ds_read_b64_tr_b16 a[160:161], v20 offset:32768
    v_accvgpr_read_b32 v60, a100
    v_mfma_f32_16x16x32_bf16 v[68:71], a[172:175], a[252:255], v[68:71]
    v_accvgpr_read_b32 v61, a101
    v_accvgpr_read_b32 v62, a102
    v_accvgpr_read_b32 v63, a103
    v_cvt_pk_bf16_f32 v56, v56, v57
    v_cvt_pk_bf16_f32 v57, v58, v59
    v_mfma_f32_16x16x32_bf16 v[76:79], a[172:175], a[244:247], v[76:79]
    ds_read_b64_tr_b16 a[162:163], v20 offset:33792
    v_add_u32 v19, 65536, v19
    v_cvt_pk_bf16_f32 v58, v60, v61
    v_mfma_f32_16x16x32_bf16 v[76:79], a[168:171], a[240:243], v[76:79]
    buffer_load_dwordx4 v10, s[8:11], s65 offen offset:2048 lds
    v_cvt_pk_bf16_f32 v59, v62, v63
    v_mfma_f32_16x16x32_bf16 v[84:87], a[168:171], a[232:235], v[84:87]
    ds_read_b64_tr_b16 a[164:165], v20 offset:40960
    v_mfma_f32_16x16x32_bf16 v[84:87], a[172:175], a[236:239], v[84:87]
    s_add_u32 s71, s66, 28672
    buffer_store_dwordx4 v[56:59], v2, s[48:51], s71 offen offset:0 sc1
    v_mfma_f32_16x16x32_bf16 v[92:95], a[172:175], a[228:231], v[92:95]
    ds_read_b64_tr_b16 a[166:167], v20 offset:41984
    v_mfma_f32_16x16x32_bf16 v[92:95], a[168:171], a[224:227], v[92:95]
    s_waitcnt lgkmcnt(8)
    buffer_load_dwordx4 v11, s[8:11], s65 offen offset:3072 lds
    v_mfma_f32_16x16x32_bf16 v[120:123], a[176:179], a[224:227], v[120:123]
    ds_read_b64_tr_b16 a[168:169], v21 offset:32768
    v_mfma_f32_16x16x32_bf16 v[120:123], a[180:183], a[228:231], v[120:123]
    s_add_u32 s70, s65, 32768
    v_mfma_f32_16x16x32_bf16 v[112:115], a[180:183], a[236:239], v[112:115]
    s_add_u32 m0, s63, 135168
    ds_read_b64_tr_b16 a[170:171], v21 offset:33792
    v_add_u32 v20, 65536, v20
    v_mfma_f32_16x16x32_bf16 v[112:115], a[176:179], a[232:235], v[112:115]
    buffer_load_dwordx4 v8, s[8:11], s70 offen offset:0 lds
    v_mfma_f32_16x16x32_bf16 v[104:107], a[176:179], a[240:243], v[104:107]
    ds_read_b64_tr_b16 a[172:173], v21 offset:40960
    v_mfma_f32_16x16x32_bf16 v[104:107], a[180:183], a[244:247], v[104:107]
    v_mfma_f32_16x16x32_bf16 v[96:99], a[180:183], a[252:255], v[96:99]
    ds_read_b64_tr_b16 a[174:175], v21 offset:41984
    v_mfma_f32_16x16x32_bf16 v[96:99], a[176:179], a[248:251], v[96:99]
    s_waitcnt lgkmcnt(8)
    buffer_load_dwordx4 v9, s[8:11], s70 offen offset:1024 lds
    v_mfma_f32_16x16x32_bf16 v[100:103], a[184:187], a[248:251], v[100:103]
    ds_read_b64_tr_b16 a[176:177], v22 offset:32768
    v_mfma_f32_16x16x32_bf16 v[100:103], a[188:191], a[252:255], v[100:103]
    v_mfma_f32_16x16x32_bf16 v[108:111], a[188:191], a[244:247], v[108:111]
    ds_read_b64_tr_b16 a[178:179], v22 offset:33792
    v_add_u32 v21, 65536, v21
    v_mfma_f32_16x16x32_bf16 v[108:111], a[184:187], a[240:243], v[108:111]
    buffer_load_dwordx4 v10, s[8:11], s70 offen offset:2048 lds
    v_mfma_f32_16x16x32_bf16 v[116:119], a[184:187], a[232:235], v[116:119]
    ds_read_b64_tr_b16 a[180:181], v22 offset:40960
    v_accvgpr_read_b32 v56, a104
    v_mfma_f32_16x16x32_bf16 v[116:119], a[188:191], a[236:239], v[116:119]
    v_accvgpr_read_b32 v57, a105
    v_accvgpr_read_b32 v58, a106
    v_mfma_f32_16x16x32_bf16 v[124:127], a[188:191], a[228:231], v[124:127]
    ds_read_b64_tr_b16 a[182:183], v22 offset:41984
    v_accvgpr_read_b32 v59, a107
    v_mfma_f32_16x16x32_bf16 v[124:127], a[184:187], a[224:227], v[124:127]
    s_waitcnt lgkmcnt(8)
    buffer_load_dwordx4 v11, s[8:11], s70 offen offset:3072 lds
    v_mfma_f32_16x16x32_bf16 v[152:155], a[160:163], a[224:227], v[152:155]
    s_add_u32 s65, s65, 128
    ds_read_b64_tr_b16 a[184:185], v23 offset:32768
    v_accvgpr_read_b32 v60, a108
    v_mfma_f32_16x16x32_bf16 v[152:155], a[164:167], a[228:231], v[152:155]
    v_accvgpr_read_b32 v61, a109
    v_accvgpr_read_b32 v62, a110
    v_accvgpr_read_b32 v63, a111
    v_mfma_f32_16x16x32_bf16 v[144:147], a[164:167], a[236:239], v[144:147]
    ds_read_b64_tr_b16 a[186:187], v23 offset:33792
    v_add_u32 v22, 65536, v22
    v_mfma_f32_16x16x32_bf16 v[144:147], a[160:163], a[232:235], v[144:147]
    v_cvt_pk_bf16_f32 v56, v56, v57
    v_cvt_pk_bf16_f32 v57, v58, v59
    v_cvt_pk_bf16_f32 v58, v60, v61
    v_cvt_pk_bf16_f32 v59, v62, v63
    v_mfma_f32_16x16x32_bf16 v[136:139], a[160:163], a[240:243], v[136:139]
    ds_read_b64_tr_b16 a[188:189], v23 offset:40960
    v_mfma_f32_16x16x32_bf16 v[136:139], a[164:167], a[244:247], v[136:139]
    s_add_u32 s71, s66, 28672
    buffer_store_dwordx4 v[56:59], v2, s[48:51], s71 offen offset:1024 sc1
    v_mfma_f32_16x16x32_bf16 v[128:131], a[164:167], a[252:255], v[128:131]
    ds_read_b64_tr_b16 a[190:191], v23 offset:41984
    v_mfma_f32_16x16x32_bf16 v[128:131], a[160:163], a[248:251], v[128:131]
    s_waitcnt lgkmcnt(8)
    v_mfma_f32_16x16x32_bf16 v[132:135], a[168:171], a[248:251], v[132:135]
    ds_read_b64_tr_b16 a[160:161], v26 offset:32768
    v_mfma_f32_16x16x32_bf16 v[132:135], a[172:175], a[252:255], v[132:135]
    v_mfma_f32_16x16x32_bf16 v[140:143], a[172:175], a[244:247], v[140:143]
    ds_read_b64_tr_b16 a[162:163], v26 offset:33280
    v_add_u32 v23, 65536, v23
    v_mfma_f32_16x16x32_bf16 v[140:143], a[168:171], a[240:243], v[140:143]
    v_mfma_f32_16x16x32_bf16 v[148:151], a[168:171], a[232:235], v[148:151]
    ds_read_b64_tr_b16 a[164:165], v26 offset:36864
    v_mfma_f32_16x16x32_bf16 v[148:151], a[172:175], a[236:239], v[148:151]
    v_mfma_f32_16x16x32_bf16 v[156:159], a[172:175], a[228:231], v[156:159]
    ds_read_b64_tr_b16 a[166:167], v26 offset:37376
    v_mfma_f32_16x16x32_bf16 v[156:159], a[168:171], a[224:227], v[156:159]
    s_waitcnt lgkmcnt(8)
    v_mfma_f32_16x16x32_bf16 v[184:187], a[176:179], a[224:227], v[184:187]
    ds_read_b64_tr_b16 a[168:169], v27 offset:32768
    v_mfma_f32_16x16x32_bf16 v[184:187], a[180:183], a[228:231], v[184:187]
    v_mfma_f32_16x16x32_bf16 v[176:179], a[180:183], a[236:239], v[176:179]
    ds_read_b64_tr_b16 a[170:171], v27 offset:33280
    v_add_u32 v26, 65536, v26
    v_mfma_f32_16x16x32_bf16 v[176:179], a[176:179], a[232:235], v[176:179]
    v_accvgpr_read_b32 v56, a112
    v_accvgpr_read_b32 v57, a113
    v_mfma_f32_16x16x32_bf16 v[168:171], a[176:179], a[240:243], v[168:171]
    ds_read_b64_tr_b16 a[172:173], v27 offset:36864
    v_accvgpr_read_b32 v58, a114
    v_mfma_f32_16x16x32_bf16 v[168:171], a[180:183], a[244:247], v[168:171]
    v_accvgpr_read_b32 v59, a115
    v_accvgpr_read_b32 v60, a116
    v_mfma_f32_16x16x32_bf16 v[160:163], a[180:183], a[252:255], v[160:163]
    ds_read_b64_tr_b16 a[174:175], v27 offset:37376
    v_accvgpr_read_b32 v61, a117
    v_mfma_f32_16x16x32_bf16 v[160:163], a[176:179], a[248:251], v[160:163]
    s_waitcnt lgkmcnt(8)
    v_accvgpr_read_b32 v62, a118
    v_accvgpr_read_b32 v63, a119
    v_mfma_f32_16x16x32_bf16 v[164:167], a[184:187], a[248:251], v[164:167]
    ds_read_b64_tr_b16 a[176:177], v28 offset:32768
    v_cvt_pk_bf16_f32 v56, v56, v57
    v_mfma_f32_16x16x32_bf16 v[164:167], a[188:191], a[252:255], v[164:167]
    v_cvt_pk_bf16_f32 v57, v58, v59
    v_mfma_f32_16x16x32_bf16 v[172:175], a[188:191], a[244:247], v[172:175]
    ds_read_b64_tr_b16 a[178:179], v28 offset:33280
    v_add_u32 v27, 65536, v27
    v_mfma_f32_16x16x32_bf16 v[172:175], a[184:187], a[240:243], v[172:175]
    v_cvt_pk_bf16_f32 v58, v60, v61
    v_cvt_pk_bf16_f32 v59, v62, v63
    v_mfma_f32_16x16x32_bf16 v[180:183], a[184:187], a[232:235], v[180:183]
    ds_read_b64_tr_b16 a[180:181], v28 offset:36864
    v_mfma_f32_16x16x32_bf16 v[180:183], a[188:191], a[236:239], v[180:183]
    s_add_u32 s71, s66, 28672
    buffer_store_dwordx4 v[56:59], v2, s[48:51], s71 offen offset:2048 sc1
    v_mfma_f32_16x16x32_bf16 v[188:191], a[188:191], a[228:231], v[188:191]
    ds_read_b64_tr_b16 a[182:183], v28 offset:37376
    v_mfma_f32_16x16x32_bf16 v[188:191], a[184:187], a[224:227], v[188:191]
    s_waitcnt lgkmcnt(8)
    v_mfma_f32_16x16x32_bf16 v[192:195], a[160:163], a[224:227], v[192:195]
    ds_read_b64_tr_b16 a[184:185], v29 offset:32768
    ds_read_b64_tr_b16 a[186:187], v29 offset:33280
    v_mfma_f32_16x16x32_bf16 v[192:195], a[164:167], a[228:231], v[192:195]
    v_mfma_f32_16x16x32_bf16 v[208:211], a[164:167], a[236:239], v[208:211]
    ds_read_b64_tr_b16 a[188:189], v29 offset:36864
    v_add_u32 v28, 65536, v28
    v_mfma_f32_16x16x32_bf16 v[208:211], a[160:163], a[232:235], v[208:211]
    v_mfma_f32_16x16x32_bf16 v[224:227], a[160:163], a[240:243], v[224:227]
    ds_read_b64_tr_b16 a[190:191], v29 offset:37376
    v_mfma_f32_16x16x32_bf16 v[224:227], a[164:167], a[244:247], v[224:227]
    v_mfma_f32_16x16x32_bf16 v[240:243], a[164:167], a[252:255], v[240:243]
    v_mfma_f32_16x16x32_bf16 v[240:243], a[160:163], a[248:251], v[240:243]
    s_waitcnt vmcnt(21) lgkmcnt(0)
    v_mfma_f32_16x16x32_bf16 v[244:247], a[168:171], a[248:251], v[244:247]
    s_barrier
    ds_read_b64_tr_b16 a[160:161], v16 offset:0
    v_mfma_f32_16x16x32_bf16 v[244:247], a[172:175], a[252:255], v[244:247]
    ds_read_b128 a[192:195], v24 offset:0
    ds_read_b128 a[196:199], v25 offset:0
    v_mfma_f32_16x16x32_bf16 v[228:231], a[172:175], a[244:247], v[228:231]
    ds_read_b64_tr_b16 a[162:163], v16 offset:1024
    v_add_u32 v29, 65536, v29
    v_mfma_f32_16x16x32_bf16 v[228:231], a[168:171], a[240:243], v[228:231]
    v_accvgpr_read_b32 v56, a120
    v_accvgpr_read_b32 v57, a121
    v_mfma_f32_16x16x32_bf16 v[212:215], a[168:171], a[232:235], v[212:215]
    ds_read_b64_tr_b16 a[164:165], v16 offset:8192
    v_accvgpr_read_b32 v58, a122
    v_mfma_f32_16x16x32_bf16 v[212:215], a[172:175], a[236:239], v[212:215]
    ds_read_b128 a[200:203], v24 offset:2048
    ds_read_b128 a[204:207], v25 offset:2048
    v_mfma_f32_16x16x32_bf16 v[196:199], a[172:175], a[228:231], v[196:199]
    ds_read_b64_tr_b16 a[166:167], v16 offset:9216
    v_accvgpr_read_b32 v59, a123
    v_mfma_f32_16x16x32_bf16 v[196:199], a[168:171], a[224:227], v[196:199]
    v_accvgpr_read_b32 v60, a124
    v_accvgpr_read_b32 v61, a125
    v_mfma_f32_16x16x32_bf16 v[200:203], a[176:179], a[224:227], v[200:203]
    ds_read_b64_tr_b16 a[168:169], v17 offset:0
    v_accvgpr_read_b32 v62, a126
    v_accvgpr_read_b32 v63, a127
    v_mfma_f32_16x16x32_bf16 v[200:203], a[180:183], a[228:231], v[200:203]
    ds_read_b128 a[208:211], v24 offset:4096
    ds_read_b128 a[212:215], v25 offset:4096
    v_mfma_f32_16x16x32_bf16 v[216:219], a[180:183], a[236:239], v[216:219]
    ds_read_b64_tr_b16 a[170:171], v17 offset:1024
    v_add_u32 v16, 4294901760, v16
    v_mfma_f32_16x16x32_bf16 v[216:219], a[176:179], a[232:235], v[216:219]
    v_cvt_pk_bf16_f32 v56, v56, v57
    v_cvt_pk_bf16_f32 v57, v58, v59
    v_cvt_pk_bf16_f32 v58, v60, v61
    v_cvt_pk_bf16_f32 v59, v62, v63
    v_mfma_f32_16x16x32_bf16 v[232:235], a[176:179], a[240:243], v[232:235]
    ds_read_b64_tr_b16 a[172:173], v17 offset:8192
    v_mfma_f32_16x16x32_bf16 v[232:235], a[180:183], a[244:247], v[232:235]
    ds_read_b128 a[216:219], v24 offset:6144
    ds_read_b128 a[220:223], v25 offset:6144
    v_mfma_f32_16x16x32_bf16 v[248:251], a[180:183], a[252:255], v[248:251]
    ds_read_b64_tr_b16 a[174:175], v17 offset:9216
    v_mfma_f32_16x16x32_bf16 v[248:251], a[176:179], a[248:251], v[248:251]
    s_add_u32 s71, s66, 28672
    buffer_store_dwordx4 v[56:59], v2, s[48:51], s71 offen offset:3072 sc1
    v_mfma_f32_16x16x32_bf16 v[252:255], a[184:187], a[248:251], v[252:255]
    ds_read_b64_tr_b16 a[176:177], v18 offset:0
    v_mfma_f32_16x16x32_bf16 v[252:255], a[188:191], a[252:255], v[252:255]
    v_lshrrev_b32 v36, 4, v1
    v_lshlrev_b32 v36, 2, v36
    v_mfma_f32_16x16x32_bf16 v[236:239], a[188:191], a[244:247], v[236:239]
    ds_read_b64_tr_b16 a[178:179], v18 offset:1024
    v_add_u32 v17, 4294901760, v17
    v_mfma_f32_16x16x32_bf16 v[236:239], a[184:187], a[240:243], v[236:239]
    v_and_b32 v37, 15, v1
    v_sub_u32 v37, v37, v36
    v_mfma_f32_16x16x32_bf16 v[220:223], a[184:187], a[232:235], v[220:223]
    ds_read_b64_tr_b16 a[180:181], v18 offset:8192
    v_cmp_le_i32 s[4:5], 0, v37
    v_mfma_f32_16x16x32_bf16 v[220:223], a[188:191], a[236:239], v[220:223]
    v_cmp_le_i32 s[6:7], 1, v37
    v_cmp_le_i32 s[56:57], 2, v37
    v_mfma_f32_16x16x32_bf16 v[204:207], a[188:191], a[228:231], v[204:207]
    ds_read_b64_tr_b16 a[182:183], v18 offset:9216
    v_cmp_le_i32 s[58:59], 3, v37
    v_mfma_f32_16x16x32_bf16 v[204:207], a[184:187], a[224:227], v[204:207]
    s_waitcnt lgkmcnt(5)
    v_mov_b32 v5, 0xff800000
    v_mov_b32 v6, 0x4e800000
    v_mfma_f32_16x16x32_bf16 v[88:91], a[160:163], a[192:195], v[88:91]
    ds_read_b64_tr_b16 a[184:185], v19 offset:0
    v_mov_b32 v9, 1
    v_mfma_f32_16x16x32_bf16 v[88:91], a[164:167], a[196:199], v[88:91]
    s_lshl_b32 s83, s62, 1
    v_mfma_f32_16x16x32_bf16 v[80:83], a[164:167], a[204:207], v[80:83]
    s_add_u32 s83, s83, 2
    ds_read_b64_tr_b16 a[186:187], v19 offset:1024
    v_add_u32 v18, 4294901760, v18
    v_mfma_f32_16x16x32_bf16 v[80:83], a[160:163], a[200:203], v[80:83]
    s_lshl_b32 s79, s62, 2
    v_mfma_f32_16x16x32_bf16 v[72:75], a[160:163], a[208:211], v[72:75]
    s_cmp_ge_u32 s60, 2
    ds_read_b64_tr_b16 a[188:189], v19 offset:8192
    v_mfma_f32_16x16x32_bf16 v[72:75], a[164:167], a[212:215], v[72:75]
    s_cselect_b32 s95, 3, 4
    v_mfma_f32_16x16x32_bf16 v[64:67], a[164:167], a[220:223], v[64:67]
    s_lshl_b32 s89, s61, 20
    ds_read_b64_tr_b16 a[190:191], v19 offset:9216
    v_mfma_f32_16x16x32_bf16 v[64:67], a[160:163], a[216:219], v[64:67]
    s_waitcnt lgkmcnt(8)
    v_mfma_f32_16x16x32_bf16 v[68:71], a[168:171], a[216:219], v[68:71]
    s_add_u32 s89, s89, s80
    ds_read_b64_tr_b16 a[160:161], v20 offset:0
    v_mfma_f32_16x16x32_bf16 v[68:71], a[172:175], a[220:223], v[68:71]
    s_lshl_b32 s69, s62, 3
    v_mfma_f32_16x16x32_bf16 v[76:79], a[172:175], a[212:215], v[76:79]
    s_sub_u32 s69, 58, s69
    ds_read_b64_tr_b16 a[162:163], v20 offset:1024
    v_add_u32 v19, 4294901760, v19
    v_mfma_f32_16x16x32_bf16 v[76:79], a[168:171], a[208:211], v[76:79]
    s_lshl_b32 s98, s69, 14
    v_mfma_f32_16x16x32_bf16 v[84:87], a[168:171], a[200:203], v[84:87]
    s_mov_b32 s82, 1073741824
    ds_read_b64_tr_b16 a[164:165], v20 offset:8192
    v_mfma_f32_16x16x32_bf16 v[84:87], a[172:175], a[204:207], v[84:87]
    s_lshl_b32 s69, s2, 1
    v_mfma_f32_16x16x32_bf16 v[92:95], a[172:175], a[196:199], v[92:95]
    s_and_b32 s70, s60, 1
    ds_read_b64_tr_b16 a[166:167], v20 offset:9216
    v_mfma_f32_16x16x32_bf16 v[92:95], a[168:171], a[192:195], v[92:95]
    s_waitcnt lgkmcnt(8)
    v_mfma_f32_16x16x32_bf16 v[120:123], a[176:179], a[192:195], v[120:123]
    s_add_u32 s69, s69, s70
    ds_read_b64_tr_b16 a[168:169], v21 offset:0
    v_mfma_f32_16x16x32_bf16 v[120:123], a[180:183], a[196:199], v[120:123]
    s_lshl_b32 s93, s69, 13
    v_mfma_f32_16x16x32_bf16 v[112:115], a[180:183], a[204:207], v[112:115]
    s_mul_i32 s94, s69, 3584
    ds_read_b64_tr_b16 a[170:171], v21 offset:1024
    v_add_u32 v20, 4294901760, v20
    v_mfma_f32_16x16x32_bf16 v[112:115], a[176:179], a[200:203], v[112:115]
    s_cmp_lt_u32 s60, 2
    v_mfma_f32_16x16x32_bf16 v[104:107], a[176:179], a[208:211], v[104:107]
    s_cselect_b32 s93, 1073741824, s93
    ds_read_b64_tr_b16 a[172:173], v21 offset:8192
    v_mfma_f32_16x16x32_bf16 v[104:107], a[180:183], a[212:215], v[104:107]
    s_cselect_b32 s94, 1073741824, s94
    v_lshlrev_b32 v36, 7, v1
    v_mov_b32 v37, 1073741824
    v_mfma_f32_16x16x32_bf16 v[96:99], a[180:183], a[220:223], v[96:99]
    ds_read_b64_tr_b16 a[174:175], v21 offset:9216
    v_cmp_gt_u32 vcc, 4, v1
    v_mfma_f32_16x16x32_bf16 v[96:99], a[176:179], a[216:219], v[96:99]
    s_waitcnt lgkmcnt(8)
    v_mfma_f32_16x16x32_bf16 v[100:103], a[184:187], a[216:219], v[100:103]
    ds_read_b64_tr_b16 a[176:177], v22 offset:0
    v_cndmask_b32 v7, v37, v36, vcc
    v_mfma_f32_16x16x32_bf16 v[100:103], a[188:191], a[220:223], v[100:103]
    v_cmp_gt_u32 vcc, 2, v1
    v_mfma_f32_16x16x32_bf16 v[108:111], a[188:191], a[212:215], v[108:111]
    ds_read_b64_tr_b16 a[178:179], v22 offset:1024
    v_add_u32 v21, 4294901760, v21
    v_mfma_f32_16x16x32_bf16 v[108:111], a[184:187], a[208:211], v[108:111]
    v_cndmask_b32 v8, v37, v36, vcc
    v_add_u32 v4, 65536, v2
    v_mfma_f32_16x16x32_bf16 v[116:119], a[184:187], a[200:203], v[116:119]
    s_and_b32 s69, s62, 3
    ds_read_b64_tr_b16 a[180:181], v22 offset:8192
    v_mfma_f32_16x16x32_bf16 v[116:119], a[188:191], a[204:207], v[116:119]
    s_lshl_b32 s69, s69, 2
    v_mfma_f32_16x16x32_bf16 v[124:127], a[188:191], a[196:199], v[124:127]
    s_lshr_b32 s70, s62, 2
    ds_read_b64_tr_b16 a[182:183], v22 offset:9216
    v_mfma_f32_16x16x32_bf16 v[124:127], a[184:187], a[192:195], v[124:127]
    s_waitcnt lgkmcnt(8)
    v_mfma_f32_16x16x32_bf16 v[152:155], a[160:163], a[192:195], v[152:155]
    s_lshl_b32 s70, s70, 7
    ds_read_b64_tr_b16 a[184:185], v23 offset:0
    v_mfma_f32_16x16x32_bf16 v[152:155], a[164:167], a[196:199], v[152:155]
    s_add_u32 s69, s69, s70
    v_mfma_f32_16x16x32_bf16 v[144:147], a[164:167], a[204:207], v[144:147]
    s_add_u32 s69, s69, 64
    ds_read_b64_tr_b16 a[186:187], v23 offset:1024
    v_add_u32 v22, 4294901760, v22
    v_mfma_f32_16x16x32_bf16 v[144:147], a[160:163], a[200:203], v[144:147]
    v_mov_b32 v38, 1073741824
    v_mov_b32 v39, s69
    v_mfma_f32_16x16x32_bf16 v[136:139], a[160:163], a[208:211], v[136:139]
    ds_read_b64_tr_b16 a[188:189], v23 offset:8192
    v_cmp_eq_u32 vcc, 192, v0
    v_mfma_f32_16x16x32_bf16 v[136:139], a[164:167], a[212:215], v[136:139]
    v_mfma_f32_16x16x32_bf16 v[128:131], a[164:167], a[220:223], v[128:131]
    ds_read_b64_tr_b16 a[190:191], v23 offset:9216
    v_cndmask_b32 v14, v38, v39, vcc
    v_mfma_f32_16x16x32_bf16 v[128:131], a[160:163], a[216:219], v[128:131]
    s_waitcnt lgkmcnt(8)
    v_and_b32 v36, 3, v1
    v_lshlrev_b32 v36, 2, v36
    v_mfma_f32_16x16x32_bf16 v[132:135], a[168:171], a[216:219], v[132:135]
    ds_read_b64_tr_b16 a[160:161], v26 offset:0
    v_and_b32 v37, 4, v1
    v_mfma_f32_16x16x32_bf16 v[132:135], a[172:175], a[220:223], v[132:135]
    v_lshl_add_u32 v36, v37, 5, v36
    v_add_u32 v15, 64, v36
    v_mfma_f32_16x16x32_bf16 v[140:143], a[172:175], a[212:215], v[140:143]
    s_lshl_b32 s69, s73, 1
    ds_read_b64_tr_b16 a[162:163], v26 offset:512
    v_add_u32 v23, 4294901760, v23
    v_mfma_f32_16x16x32_bf16 v[140:143], a[168:171], a[208:211], v[140:143]
    s_add_u32 s71, s69, 2
    v_mfma_f32_16x16x32_bf16 v[148:151], a[168:171], a[200:203], v[148:151]
    s_cmp_eq_u32 s60, 2
    ds_read_b64_tr_b16 a[164:165], v26 offset:4096
    v_mfma_f32_16x16x32_bf16 v[148:151], a[172:175], a[204:207], v[148:151]
    s_cselect_b32 s70, 32, 98
    v_mfma_f32_16x16x32_bf16 v[156:159], a[172:175], a[196:199], v[156:159]
    s_cmp_lt_u32 s60, 2
    ds_read_b64_tr_b16 a[166:167], v26 offset:4608
    v_mfma_f32_16x16x32_bf16 v[156:159], a[168:171], a[192:195], v[156:159]
    s_waitcnt lgkmcnt(8)
    v_mfma_f32_16x16x32_bf16 v[184:187], a[176:179], a[192:195], v[184:187]
    s_cselect_b32 s76, s71, 34
    ds_read_b64_tr_b16 a[168:169], v27 offset:0
    v_mfma_f32_16x16x32_bf16 v[184:187], a[180:183], a[196:199], v[184:187]
    s_cselect_b32 s77, s69, s70
    v_mfma_f32_16x16x32_bf16 v[176:179], a[180:183], a[204:207], v[176:179]
    s_add_u32 s78, s77, 1
    ds_read_b64_tr_b16 a[170:171], v27 offset:512
    v_add_u32 v26, 4294901760, v26
    v_mfma_f32_16x16x32_bf16 v[176:179], a[176:179], a[200:203], v[176:179]
    s_mov_b32 s75, 0
    v_mfma_f32_16x16x32_bf16 v[168:171], a[176:179], a[208:211], v[168:171]
    s_max_u32 s43, s77, 2
    ds_read_b64_tr_b16 a[172:173], v27 offset:4096
    v_mfma_f32_16x16x32_bf16 v[168:171], a[180:183], a[212:215], v[168:171]
    s_min_u32 s43, s43, s76
    v_mfma_f32_16x16x32_bf16 v[160:163], a[180:183], a[220:223], v[160:163]
    s_cmp_eq_u32 s62, 6
    ds_read_b64_tr_b16 a[174:175], v27 offset:4608
    v_mfma_f32_16x16x32_bf16 v[160:163], a[176:179], a[216:219], v[160:163]
    s_waitcnt lgkmcnt(8)
    v_mfma_f32_16x16x32_bf16 v[164:167], a[184:187], a[216:219], v[164:167]
    s_cselect_b32 s100, 25, 29
    ds_read_b64_tr_b16 a[176:177], v28 offset:0
    v_mfma_f32_16x16x32_bf16 v[164:167], a[188:191], a[220:223], v[164:167]
    s_mov_b32 s99, 1073741824
    v_lshrrev_b32 v36, 4, v1
    v_and_b32 v37, 15, v1
    v_mfma_f32_16x16x32_bf16 v[172:175], a[188:191], a[212:215], v[172:175]
    ds_read_b64_tr_b16 a[178:179], v28 offset:512
    v_add_u32 v27, 4294901760, v27
    v_mfma_f32_16x16x32_bf16 v[172:175], a[184:187], a[208:211], v[172:175]
    v_lshlrev_b32 v54, 1, v36
    v_xor_b32 v54, v37, v54
    v_mfma_f32_16x16x32_bf16 v[180:183], a[184:187], a[200:203], v[180:183]
    ds_read_b64_tr_b16 a[180:181], v28 offset:4096
    v_lshlrev_b32 v54, 4, v54
    v_mfma_f32_16x16x32_bf16 v[180:183], a[188:191], a[204:207], v[180:183]
    v_lshl_add_u32 v54, v36, 10, v54
    v_add_u32 v10, 0, v54
    v_mfma_f32_16x16x32_bf16 v[188:191], a[188:191], a[196:199], v[188:191]
    ds_read_b64_tr_b16 a[182:183], v28 offset:4608
    v_xor_b32 v11, 128, v54
    v_mfma_f32_16x16x32_bf16 v[188:191], a[184:187], a[192:195], v[188:191]
    s_waitcnt lgkmcnt(8)
    v_add_u32 v11, 3072, v11
    v_add_u32 v12, 6144, v54
    v_mfma_f32_16x16x32_bf16 v[192:195], a[160:163], a[192:195], v[192:195]
    ds_read_b64_tr_b16 a[184:185], v29 offset:0
    ds_read_b64_tr_b16 a[186:187], v29 offset:512
    v_mfma_f32_16x16x32_bf16 v[192:195], a[164:167], a[196:199], v[192:195]
    v_xor_b32 v13, 128, v54
    v_add_u32 v13, 9216, v13
    v_mfma_f32_16x16x32_bf16 v[208:211], a[164:167], a[204:207], v[208:211]
    ds_read_b64_tr_b16 a[188:189], v29 offset:4096
    v_add_u32 v28, 4294901760, v28
    v_mfma_f32_16x16x32_bf16 v[208:211], a[160:163], a[200:203], v[208:211]
    v_lshrrev_b32 v54, 2, v37
    v_lshl_add_u32 v39, v36, 2, v54
    v_mfma_f32_16x16x32_bf16 v[224:227], a[160:163], a[208:211], v[224:227]
    ds_read_b64_tr_b16 a[190:191], v29 offset:4608
    v_and_b32 v54, 7, v39
    v_mfma_f32_16x16x32_bf16 v[224:227], a[164:167], a[212:215], v[224:227]
    v_lshlrev_b32 v54, 5, v54
    v_lshl_add_u32 v54, v39, 8, v54
    v_mfma_f32_16x16x32_bf16 v[240:243], a[164:167], a[220:223], v[240:243]
    v_and_b32 v40, 3, v37
    v_lshl_add_u32 v54, v40, 3, v54
    v_mfma_f32_16x16x32_bf16 v[240:243], a[160:163], a[216:219], v[240:243]
    s_waitcnt vmcnt(0) lgkmcnt(0)
    v_mfma_f32_16x16x32_bf16 v[244:247], a[168:171], a[216:219], v[244:247]
    s_barrier
    ds_read_b64_tr_b16 a[160:161], v26 offset:0
    v_mfma_f32_16x16x32_bf16 v[244:247], a[172:175], a[220:223], v[244:247]
    s_and_b32 s69, s60, 2
    ds_read_b128 a[224:227], v24 offset:32768
    ds_read_b128 a[228:231], v25 offset:32768
    v_mfma_f32_16x16x32_bf16 v[228:231], a[172:175], a[212:215], v[228:231]
    s_lshl_b32 s69, s69, 6
    ds_read_b64_tr_b16 a[162:163], v26 offset:512
    v_add_u32 v29, 4294901760, v29
    v_mfma_f32_16x16x32_bf16 v[228:231], a[168:171], a[208:211], v[228:231]
    v_xor_b32 v54, s69, v54
    v_mfma_f32_16x16x32_bf16 v[212:215], a[168:171], a[200:203], v[212:215]
    s_mul_i32 s64, s84, 458752
    ds_read_b64_tr_b16 a[164:165], v26 offset:4096
    v_mfma_f32_16x16x32_bf16 v[212:215], a[172:175], a[204:207], v[212:215]
    s_lshl_b32 s69, s60, 14
    ds_read_b128 a[232:235], v24 offset:34816
    ds_read_b128 a[236:239], v25 offset:34816
    v_mfma_f32_16x16x32_bf16 v[196:199], a[172:175], a[196:199], v[196:199]
    s_add_u32 s64, s64, s69
    ds_read_b64_tr_b16 a[166:167], v26 offset:4608
    v_mfma_f32_16x16x32_bf16 v[196:199], a[168:171], a[192:195], v[196:199]
    s_lshl_b32 s69, s86, 8
    v_mfma_f32_16x16x32_bf16 v[200:203], a[176:179], a[192:195], v[200:203]
    s_add_u32 s64, s64, s69
    ds_read_b64_tr_b16 a[168:169], v27 offset:0
    v_mfma_f32_16x16x32_bf16 v[200:203], a[180:183], a[196:199], v[200:203]
    s_lshl_b32 s66, s60, 12
    ds_read_b128 a[240:243], v24 offset:36864
    ds_read_b128 a[244:247], v25 offset:36864
    v_mfma_f32_16x16x32_bf16 v[216:219], a[180:183], a[204:207], v[216:219]
    s_and_b32 s69, s60, 1
    ds_read_b64_tr_b16 a[170:171], v27 offset:512
    v_mfma_f32_16x16x32_bf16 v[216:219], a[176:179], a[200:203], v[216:219]
    s_lshl_b32 s65, s85, 1
    v_mfma_f32_16x16x32_bf16 v[232:235], a[176:179], a[208:211], v[232:235]
    s_add_u32 s65, s65, s69
    ds_read_b64_tr_b16 a[172:173], v27 offset:4096
    v_mfma_f32_16x16x32_bf16 v[232:235], a[180:183], a[212:215], v[232:235]
    s_mul_i32 s65, s65, 753664
    ds_read_b128 a[248:251], v24 offset:38912
    ds_read_b128 a[252:255], v25 offset:38912
    v_mfma_f32_16x16x32_bf16 v[248:251], a[180:183], a[220:223], v[248:251]
    s_mul_i32 s69, s84, 57344
    ds_read_b64_tr_b16 a[174:175], v27 offset:4608
    v_mfma_f32_16x16x32_bf16 v[248:251], a[176:179], a[216:219], v[248:251]
    s_add_u32 s65, s65, s69
    v_mfma_f32_16x16x32_bf16 v[252:255], a[184:187], a[216:219], v[252:255]
    s_and_b32 s69, s60, 2
    ds_read_b64_tr_b16 a[176:177], v28 offset:0
    v_mfma_f32_16x16x32_bf16 v[252:255], a[188:191], a[220:223], v[252:255]
    s_lshl_b32 s69, s69, 11
    buffer_atomic_add v30, v52, s[48:51], 0 offen sc1
    v_mfma_f32_16x16x32_bf16 v[236:239], a[188:191], a[212:215], v[236:239]
    s_add_u32 s65, s65, s69
    ds_read_b64_tr_b16 a[178:179], v28 offset:512
    v_mfma_f32_16x16x32_bf16 v[236:239], a[184:187], a[208:211], v[236:239]
    s_add_u32 s65, s65, 33554432
    v_mov_b32 v31, 0
    v_mfma_f32_16x16x32_bf16 v[220:223], a[184:187], a[200:203], v[220:223]
    s_sub_u32 s92, s65, 253952
    ds_read_b64_tr_b16 a[180:181], v28 offset:4096
    v_mfma_f32_16x16x32_bf16 v[220:223], a[188:191], a[204:207], v[220:223]
    s_add_u32 s65, s65, 24576
    v_mfma_f32_16x16x32_bf16 v[204:207], a[188:191], a[196:199], v[204:207]
    s_mul_i32 s68, s73, 753664
    ds_read_b64_tr_b16 a[182:183], v28 offset:4608
    v_mfma_f32_16x16x32_bf16 v[204:207], a[184:187], a[192:195], v[204:207]
    s_waitcnt lgkmcnt(5)
    v_mfma_f32_16x16x32_bf16 v[192:195], a[160:163], a[224:227], v[192:195]
    s_lshl_b32 s101, s42, 13
    ds_read_b64_tr_b16 a[184:185], v29 offset:0
    v_mfma_f32_16x16x32_bf16 v[192:195], a[164:167], a[228:231], v[192:195]
    s_add_u32 s68, s68, s101
    v_mfma_f32_16x16x32_bf16 v[208:211], a[164:167], a[236:239], v[208:211]
    s_add_u32 s68, s68, 33554432
    ds_read_b64_tr_b16 a[186:187], v29 offset:512
    v_mfma_f32_16x16x32_bf16 v[208:211], a[160:163], a[232:235], v[208:211]
    s_cmp_ge_u32 s42, 28
    v_mfma_f32_16x16x32_bf16 v[224:227], a[160:163], a[240:243], v[224:227]
    s_cselect_b32 s68, 1073741824, s68
    ds_read_b64_tr_b16 a[188:189], v29 offset:4096
    v_mfma_f32_16x16x32_bf16 v[224:227], a[164:167], a[244:247], v[224:227]
    s_add_u32 s101, s68, 4096
    v_mfma_f32_16x16x32_bf16 v[240:243], a[164:167], a[252:255], v[240:243]
    s_mov_b32 s0, 0xbfb8aa3b
    ds_read_b64_tr_b16 a[190:191], v29 offset:4608
    v_mfma_f32_16x16x32_bf16 v[240:243], a[160:163], a[248:251], v[240:243]
    s_waitcnt lgkmcnt(8)
    v_mfma_f32_16x16x32_bf16 v[244:247], a[168:171], a[248:251], v[244:247]
    s_mov_b32 s1, 0x3fb504f3
    ds_read_b64_tr_b16 a[160:161], v16 offset:0
    v_mfma_f32_16x16x32_bf16 v[244:247], a[172:175], a[252:255], v[244:247]
    s_and_b32 s69, s60, 1
    v_mfma_f32_16x16x32_bf16 v[228:231], a[172:175], a[244:247], v[228:231]
    s_lshl_b32 s69, s69, 14
    ds_read_b64_tr_b16 a[162:163], v16 offset:1024
    v_mfma_f32_16x16x32_bf16 v[228:231], a[168:171], a[240:243], v[228:231]
    s_cmp_ge_u32 s60, 2
    v_mfma_f32_16x16x32_bf16 v[212:215], a[168:171], a[232:235], v[212:215]
    s_cselect_b32 s70, 131072, 0
    ds_read_b64_tr_b16 a[164:165], v16 offset:8192
    v_mfma_f32_16x16x32_bf16 v[212:215], a[172:175], a[236:239], v[212:215]
    s_cselect_b64 s[90:91], -1, 0
    v_mfma_f32_16x16x32_bf16 v[196:199], a[172:175], a[228:231], v[196:199]
    s_add_u32 s69, s69, s70
    ds_read_b64_tr_b16 a[166:167], v16 offset:9216
    v_add_u32 v35, s69, v2
    v_mfma_f32_16x16x32_bf16 v[196:199], a[168:171], a[224:227], v[196:199]
    s_waitcnt lgkmcnt(8)
    v_mfma_f32_16x16x32_bf16 v[200:203], a[176:179], a[224:227], v[200:203]
    ds_read_b64_tr_b16 a[168:169], v17 offset:0
    v_mfma_f32_16x16x32_bf16 v[200:203], a[180:183], a[228:231], v[200:203]
    v_mfma_f32_16x16x32_bf16 v[216:219], a[180:183], a[236:239], v[216:219]
    ds_read_b64_tr_b16 a[170:171], v17 offset:1024
    v_mfma_f32_16x16x32_bf16 v[216:219], a[176:179], a[232:235], v[216:219]
    v_mfma_f32_16x16x32_bf16 v[232:235], a[176:179], a[240:243], v[232:235]
    ds_read_b64_tr_b16 a[172:173], v17 offset:8192
    v_mfma_f32_16x16x32_bf16 v[232:235], a[180:183], a[244:247], v[232:235]
    v_mfma_f32_16x16x32_bf16 v[248:251], a[180:183], a[252:255], v[248:251]
    ds_read_b64_tr_b16 a[174:175], v17 offset:9216
    v_mfma_f32_16x16x32_bf16 v[248:251], a[176:179], a[248:251], v[248:251]
    s_waitcnt lgkmcnt(8)
    v_mfma_f32_16x16x32_bf16 v[252:255], a[184:187], a[248:251], v[252:255]
    ds_read_b64_tr_b16 a[176:177], v18 offset:0
    v_mfma_f32_16x16x32_bf16 v[252:255], a[188:191], a[252:255], v[252:255]
    v_mfma_f32_16x16x32_bf16 v[236:239], a[188:191], a[244:247], v[236:239]
    ds_read_b64_tr_b16 a[178:179], v18 offset:1024
    v_mfma_f32_16x16x32_bf16 v[236:239], a[184:187], a[240:243], v[236:239]
    v_mfma_f32_16x16x32_bf16 v[220:223], a[184:187], a[232:235], v[220:223]
    ds_read_b64_tr_b16 a[180:181], v18 offset:8192
    v_mfma_f32_16x16x32_bf16 v[220:223], a[188:191], a[236:239], v[220:223]
    v_mfma_f32_16x16x32_bf16 v[204:207], a[188:191], a[228:231], v[204:207]
    ds_read_b64_tr_b16 a[182:183], v18 offset:9216
    v_mfma_f32_16x16x32_bf16 v[204:207], a[184:187], a[224:227], v[204:207]
    s_waitcnt lgkmcnt(8)
    v_mfma_f32_16x16x32_bf16 v[88:91], a[160:163], a[224:227], v[88:91]
    ds_read_b64_tr_b16 a[184:185], v19 offset:0
    v_mfma_f32_16x16x32_bf16 v[88:91], a[164:167], a[228:231], v[88:91]
    v_mfma_f32_16x16x32_bf16 v[80:83], a[164:167], a[236:239], v[80:83]
    ds_read_b64_tr_b16 a[186:187], v19 offset:1024
    v_mfma_f32_16x16x32_bf16 v[80:83], a[160:163], a[232:235], v[80:83]
    v_fma_f32 v36, v248, s0, 0.5
    v_mfma_f32_16x16x32_bf16 v[72:75], a[160:163], a[240:243], v[72:75]
    ds_read_b64_tr_b16 a[188:189], v19 offset:8192
    v_fma_f32 v37, v249, s0, 0.5
    v_mfma_f32_16x16x32_bf16 v[72:75], a[164:167], a[244:247], v[72:75]
    v_fma_f32 v38, v250, s0, 0.5
    v_mfma_f32_16x16x32_bf16 v[64:67], a[164:167], a[252:255], v[64:67]
    ds_read_b64_tr_b16 a[190:191], v19 offset:9216
    v_fma_f32 v39, v251, s0, 0.5
    v_mfma_f32_16x16x32_bf16 v[64:67], a[160:163], a[248:251], v[64:67]
    s_waitcnt lgkmcnt(8)
    v_fma_f32 v40, v252, s0, 0.5
    v_mfma_f32_16x16x32_bf16 v[68:71], a[168:171], a[248:251], v[68:71]
    ds_read_b64_tr_b16 a[160:161], v20 offset:0
    v_fma_f32 v41, v253, s0, 0.5
    v_mfma_f32_16x16x32_bf16 v[68:71], a[172:175], a[252:255], v[68:71]
    v_fma_f32 v42, v254, s0, 0.5
    v_mfma_f32_16x16x32_bf16 v[76:79], a[172:175], a[244:247], v[76:79]
    ds_read_b64_tr_b16 a[162:163], v20 offset:1024
    v_fma_f32 v43, v255, s0, 0.5
    v_mfma_f32_16x16x32_bf16 v[76:79], a[168:171], a[240:243], v[76:79]
    v_exp_f32 v36, v36
    v_mfma_f32_16x16x32_bf16 v[84:87], a[168:171], a[232:235], v[84:87]
    ds_read_b64_tr_b16 a[164:165], v20 offset:8192
    v_mfma_f32_16x16x32_bf16 v[84:87], a[172:175], a[236:239], v[84:87]
    v_exp_f32 v37, v37
    v_mfma_f32_16x16x32_bf16 v[92:95], a[172:175], a[228:231], v[92:95]
    ds_read_b64_tr_b16 a[166:167], v20 offset:9216
    v_mfma_f32_16x16x32_bf16 v[92:95], a[168:171], a[224:227], v[92:95]
    s_waitcnt lgkmcnt(8)
    v_exp_f32 v38, v38
    v_mfma_f32_16x16x32_bf16 v[120:123], a[176:179], a[224:227], v[120:123]
    ds_read_b64_tr_b16 a[168:169], v21 offset:0
    v_mfma_f32_16x16x32_bf16 v[120:123], a[180:183], a[228:231], v[120:123]
    v_exp_f32 v39, v39
    v_exp_f32 v40, v40
    v_exp_f32 v41, v41
    v_exp_f32 v42, v42
    v_mfma_f32_16x16x32_bf16 v[112:115], a[180:183], a[236:239], v[112:115]
    ds_read_b64_tr_b16 a[170:171], v21 offset:1024
    v_exp_f32 v43, v43
    v_mfma_f32_16x16x32_bf16 v[112:115], a[176:179], a[232:235], v[112:115]
    v_cvt_pk_bf16_f32 v64, v64, v65
    v_cvt_pk_bf16_f32 v65, v66, v67
    v_mfma_f32_16x16x32_bf16 v[104:107], a[176:179], a[240:243], v[104:107]
    ds_read_b64_tr_b16 a[172:173], v21 offset:8192
    v_cvt_pk_bf16_f32 v66, v68, v69
    v_mfma_f32_16x16x32_bf16 v[104:107], a[180:183], a[244:247], v[104:107]
    v_cvt_pk_bf16_f32 v67, v70, v71
    v_fma_f32 v44, v36, s1, 1.0
    v_fma_f32 v45, v37, s1, 1.0
    v_fma_f32 v46, v38, s1, 1.0
    v_mfma_f32_16x16x32_bf16 v[96:99], a[180:183], a[252:255], v[96:99]
    ds_read_b64_tr_b16 a[174:175], v21 offset:9216
    v_cvt_pk_bf16_f32 v68, v72, v73
    v_mfma_f32_16x16x32_bf16 v[96:99], a[176:179], a[248:251], v[96:99]
    s_waitcnt lgkmcnt(8)
    v_cvt_pk_bf16_f32 v69, v74, v75
    v_cvt_pk_bf16_f32 v70, v76, v77
    v_mfma_f32_16x16x32_bf16 v[100:103], a[184:187], a[248:251], v[100:103]
    ds_read_b64_tr_b16 a[176:177], v22 offset:0
    v_cvt_pk_bf16_f32 v71, v78, v79
    v_mfma_f32_16x16x32_bf16 v[100:103], a[188:191], a[252:255], v[100:103]
    v_cvt_pk_bf16_f32 v72, v80, v81
    v_fma_f32 v47, v39, s1, 1.0
    v_fma_f32 v48, v40, s1, 1.0
    v_fma_f32 v49, v41, s1, 1.0
    v_fma_f32 v50, v42, s1, 1.0
    v_mfma_f32_16x16x32_bf16 v[108:111], a[188:191], a[244:247], v[108:111]
    ds_read_b64_tr_b16 a[178:179], v22 offset:1024
    v_cvt_pk_bf16_f32 v73, v82, v83
    v_mfma_f32_16x16x32_bf16 v[108:111], a[184:187], a[240:243], v[108:111]
    v_cvt_pk_bf16_f32 v74, v84, v85
    v_cvt_pk_bf16_f32 v75, v86, v87
    v_mfma_f32_16x16x32_bf16 v[116:119], a[184:187], a[232:235], v[116:119]
    ds_read_b64_tr_b16 a[180:181], v22 offset:8192
    v_cvt_pk_bf16_f32 v76, v88, v89
    v_mfma_f32_16x16x32_bf16 v[116:119], a[188:191], a[236:239], v[116:119]
    v_cvt_pk_bf16_f32 v77, v90, v91
    v_fma_f32 v51, v43, s1, 1.0
    v_fma_f32 v36, v36, v36, v44
    v_mfma_f32_16x16x32_bf16 v[124:127], a[188:191], a[228:231], v[124:127]
    ds_read_b64_tr_b16 a[182:183], v22 offset:9216
    v_cvt_pk_bf16_f32 v78, v92, v93
    v_mfma_f32_16x16x32_bf16 v[124:127], a[184:187], a[224:227], v[124:127]
    s_waitcnt lgkmcnt(8)
    v_cvt_pk_bf16_f32 v79, v94, v95
    v_fma_f32 v37, v37, v37, v45
    v_fma_f32 v38, v38, v38, v46
    v_mfma_f32_16x16x32_bf16 v[152:155], a[160:163], a[224:227], v[152:155]
    ds_read_b64_tr_b16 a[184:185], v23 offset:0
    ds_read_b64_tr_b16 a[186:187], v23 offset:1024
    v_mfma_f32_16x16x32_bf16 v[152:155], a[164:167], a[228:231], v[152:155]
    v_fma_f32 v39, v39, v39, v47
    v_fma_f32 v40, v40, v40, v48
    v_mfma_f32_16x16x32_bf16 v[144:147], a[164:167], a[236:239], v[144:147]
    ds_read_b64_tr_b16 a[188:189], v23 offset:8192
    v_fma_f32 v41, v41, v41, v49
    v_fma_f32 v42, v42, v42, v50
    v_mfma_f32_16x16x32_bf16 v[144:147], a[160:163], a[232:235], v[144:147]
    v_cvt_pk_bf16_f32 v80, v96, v97
    v_cvt_pk_bf16_f32 v81, v98, v99
    v_mfma_f32_16x16x32_bf16 v[136:139], a[160:163], a[240:243], v[136:139]
    ds_read_b64_tr_b16 a[190:191], v23 offset:9216
    v_cvt_pk_bf16_f32 v82, v100, v101
    v_mfma_f32_16x16x32_bf16 v[136:139], a[164:167], a[244:247], v[136:139]
    v_cvt_pk_bf16_f32 v83, v102, v103
    v_fma_f32 v43, v43, v43, v51
    v_rcp_f32 v36, v36
    v_rcp_f32 v37, v37
    v_rcp_f32 v38, v38
    v_mfma_f32_16x16x32_bf16 v[128:131], a[164:167], a[252:255], v[128:131]
    v_cvt_pk_bf16_f32 v84, v104, v105
    v_rcp_f32 v39, v39
    v_mfma_f32_16x16x32_bf16 v[128:131], a[160:163], a[248:251], v[128:131]
    s_waitcnt vmcnt(1) lgkmcnt(0)
    v_cvt_pk_bf16_f32 v85, v106, v107
    v_cvt_pk_bf16_f32 v86, v108, v109
    v_rcp_f32 v40, v40
    v_mfma_f32_16x16x32_bf16 v[132:135], a[168:171], a[248:251], v[132:135]
    s_barrier
    v_cvt_pk_bf16_f32 v87, v110, v111
    v_rcp_f32 v41, v41
    v_mfma_f32_16x16x32_bf16 v[132:135], a[172:175], a[252:255], v[132:135]
    s_and_b32 s69, s60, 1
    buffer_load_dword v32, v53, s[48:51], 0 offen sc1
    v_cvt_pk_bf16_f32 v88, v112, v113
    v_rcp_f32 v42, v42
    v_mfma_f32_16x16x32_bf16 v[140:143], a[172:175], a[244:247], v[140:143]
    s_lshl_b32 s69, s69, 12
    v_cvt_pk_bf16_f32 v89, v114, v115
    v_rcp_f32 v43, v43
    v_mfma_f32_16x16x32_bf16 v[140:143], a[168:171], a[240:243], v[140:143]
    s_add_u32 s69, s69, 65536
    v_add_u32 v24, s69, v2
    v_xor_b32 v16, 0, v54
    v_add_u32 v20, 131072, v16
    v_mul_f32 v44, v44, v36 clamp
    v_mfma_f32_16x16x32_bf16 v[148:151], a[168:171], a[232:235], v[148:151]
    v_xor_b32 v17, 32, v54
    v_add_u32 v21, 131072, v17
    v_xor_b32 v18, 64, v54
    v_mul_f32 v45, v45, v37 clamp
    v_mfma_f32_16x16x32_bf16 v[148:151], a[172:175], a[236:239], v[148:151]
    v_add_u32 v22, 131072, v18
    v_xor_b32 v19, 96, v54
    v_add_u32 v23, 131072, v19
    v_mfma_f32_16x16x32_bf16 v[156:159], a[172:175], a[228:231], v[156:159]
    v_cvt_pk_bf16_f32 v90, v116, v117
    v_cvt_pk_bf16_f32 v91, v118, v119
    v_mfma_f32_16x16x32_bf16 v[156:159], a[168:171], a[224:227], v[156:159]
    v_cvt_pk_bf16_f32 v92, v120, v121
    v_cvt_pk_bf16_f32 v93, v122, v123
    v_cvt_pk_bf16_f32 v94, v124, v125
    v_cvt_pk_bf16_f32 v95, v126, v127
    v_mfma_f32_16x16x32_bf16 v[184:187], a[176:179], a[224:227], v[184:187]
    v_mul_f32 v46, v46, v38 clamp
    v_mul_f32 v47, v47, v39 clamp
    v_mfma_f32_16x16x32_bf16 v[184:187], a[180:183], a[228:231], v[184:187]
    v_mul_f32 v48, v48, v40 clamp
    v_mul_f32 v49, v49, v41 clamp
    v_mfma_f32_16x16x32_bf16 v[176:179], a[180:183], a[236:239], v[176:179]
    v_mul_f32 v50, v50, v42 clamp
    v_mul_f32 v51, v51, v43 clamp
    v_mfma_f32_16x16x32_bf16 v[176:179], a[176:179], a[232:235], v[176:179]
    v_cvt_pk_bf16_f32 v96, v128, v129
    v_cvt_pk_bf16_f32 v97, v130, v131
    v_mfma_f32_16x16x32_bf16 v[168:171], a[176:179], a[240:243], v[168:171]
    v_cvt_pk_bf16_f32 v98, v132, v133
    v_mul_f32 v248, v248, v44
    v_mfma_f32_16x16x32_bf16 v[168:171], a[180:183], a[244:247], v[168:171]
    v_cvt_pk_bf16_f32 v99, v134, v135
    v_mul_f32 v249, v249, v45
    v_mfma_f32_16x16x32_bf16 v[160:163], a[180:183], a[252:255], v[160:163]
    v_cvt_pk_bf16_f32 v100, v136, v137
    v_mul_f32 v250, v250, v46
    v_mfma_f32_16x16x32_bf16 v[160:163], a[176:179], a[248:251], v[160:163]
    v_cvt_pk_bf16_f32 v101, v138, v139
    v_cvt_pk_bf16_f32 v102, v140, v141
    v_mfma_f32_16x16x32_bf16 v[164:167], a[184:187], a[248:251], v[164:167]
    v_cvt_pk_bf16_f32 v103, v142, v143
    v_mul_f32 v251, v251, v47
    v_mfma_f32_16x16x32_bf16 v[164:167], a[188:191], a[252:255], v[164:167]
    v_cvt_pk_bf16_f32 v104, v144, v145
    v_mul_f32 v252, v252, v48
    v_mfma_f32_16x16x32_bf16 v[172:175], a[188:191], a[244:247], v[172:175]
    v_cvt_pk_bf16_f32 v105, v146, v147
    v_mul_f32 v253, v253, v49
    v_mfma_f32_16x16x32_bf16 v[172:175], a[184:187], a[240:243], v[172:175]
    v_cvt_pk_bf16_f32 v106, v148, v149
    v_cvt_pk_bf16_f32 v107, v150, v151
    v_mfma_f32_16x16x32_bf16 v[180:183], a[184:187], a[232:235], v[180:183]
    v_cvt_pk_bf16_f32 v108, v152, v153
    v_mul_f32 v254, v254, v50
    v_mfma_f32_16x16x32_bf16 v[180:183], a[188:191], a[236:239], v[180:183]
    v_cvt_pk_bf16_f32 v109, v154, v155
    v_mul_f32 v255, v255, v51
    v_mfma_f32_16x16x32_bf16 v[188:191], a[188:191], a[228:231], v[188:191]
    v_cvt_pk_bf16_f32 v110, v156, v157
    v_cvt_pk_bf16_f32 v248, v248, v249
    v_mfma_f32_16x16x32_bf16 v[188:191], a[184:187], a[224:227], v[188:191]
    v_cvt_pk_bf16_f32 v111, v158, v159
    v_cvt_pk_bf16_f32 v249, v250, v251
    v_cvt_pk_bf16_f32 v250, v252, v253
    v_cvt_pk_bf16_f32 v251, v254, v255
    s_nop 3
    v_cvt_pk_bf16_f32 v112, v160, v161
    v_cvt_pk_bf16_f32 v113, v162, v163
    v_cvt_pk_bf16_f32 v114, v164, v165
    v_cvt_pk_bf16_f32 v115, v166, v167
    v_cvt_pk_bf16_f32 v116, v168, v169
    v_cvt_pk_bf16_f32 v117, v170, v171
    v_cvt_pk_bf16_f32 v118, v172, v173
    v_cvt_pk_bf16_f32 v119, v174, v175
    v_cvt_pk_bf16_f32 v120, v176, v177
    v_cvt_pk_bf16_f32 v121, v178, v179
    v_cvt_pk_bf16_f32 v122, v180, v181
    v_cvt_pk_bf16_f32 v123, v182, v183
    v_cvt_pk_bf16_f32 v124, v184, v185
    v_cvt_pk_bf16_f32 v125, v186, v187
    v_cvt_pk_bf16_f32 v126, v188, v189
    v_cvt_pk_bf16_f32 v127, v190, v191
    s_cmp_ge_u32 s42, 28
    s_cbranch_scc1 L_nomish
    s_waitcnt vmcnt(0)
    s_mov_b32 s88, 65536
L_s1a_t:
    v_readfirstlane_b32 s69, v32
    s_cmp_ge_u32 s69, 8
    s_cbranch_scc1 L_s1a_ok
    s_sub_u32 s88, s88, 1
    s_cmp_eq_u32 s88, 0
    s_cbranch_scc1 L_s1a_ok
    s_sleep 1
    buffer_load_dword v32, v53, s[48:51], 0 offen sc1
    s_waitcnt vmcnt(0)
    s_branch L_s1a_t
L_s1a_ok:
    buffer_store_dwordx4 v[248:251], v2, s[48:51], s101 offen offset:3072 sc1
    v_pk_fma_f32 v[128:129], v[232:233], s[0:1], 0.5 op_sel_hi:[1,0,0]
    v_pk_fma_f32 v[130:131], v[234:235], s[0:1], 0.5 op_sel_hi:[1,0,0]
    v_pk_fma_f32 v[132:133], v[236:237], s[0:1], 0.5 op_sel_hi:[1,0,0]
    v_pk_fma_f32 v[134:135], v[238:239], s[0:1], 0.5 op_sel_hi:[1,0,0]
    v_exp_f32 v128, v128
    v_exp_f32 v129, v129
    s_cmp_ge_u32 s60, 2
    s_cselect_b32 s70, 1073741824, s89
    s_cselect_b32 s71, 0, 16384
    s_add_u32 s71, s71, s89
    s_add_u32 m0, s80, 81920
    s_nop 0
    buffer_load_dwordx4 v2, s[48:51], s70 offen offset:0 sc1 lds
    v_exp_f32 v130, v130
    v_exp_f32 v131, v131
    v_exp_f32 v132, v132
    v_exp_f32 v133, v133
    v_exp_f32 v134, v134
    v_exp_f32 v135, v135
    s_mov_b64 exec, s[90:91]
    ds_write_b128 v35, v[64:67] offset:0
    s_mov_b64 exec, -1
    v_pk_fma_f32 v[136:137], v[128:129], s[0:1], 1.0 op_sel:[0,1,0] op_sel_hi:[1,1,0]
    v_pk_fma_f32 v[138:139], v[130:131], s[0:1], 1.0 op_sel:[0,1,0] op_sel_hi:[1,1,0]
    v_pk_fma_f32 v[140:141], v[132:133], s[0:1], 1.0 op_sel:[0,1,0] op_sel_hi:[1,1,0]
    v_pk_fma_f32 v[142:143], v[134:135], s[0:1], 1.0 op_sel:[0,1,0] op_sel_hi:[1,1,0]
    v_pk_fma_f32 v[128:129], v[128:129], v[128:129], v[136:137]
    v_pk_fma_f32 v[130:131], v[130:131], v[130:131], v[138:139]
    buffer_load_dwordx4 v2, s[48:51], s70 offen offset:1024 sc1 lds
    v_pk_fma_f32 v[132:133], v[132:133], v[132:133], v[140:141]
    v_pk_fma_f32 v[134:135], v[134:135], v[134:135], v[142:143]
    v_rcp_f32 v128, v128
    v_rcp_f32 v129, v129
    v_rcp_f32 v130, v130
    v_rcp_f32 v131, v131
    buffer_load_dwordx4 v2, s[48:51], s70 offen offset:2048 sc1 lds
    v_rcp_f32 v132, v132
    v_rcp_f32 v133, v133
    v_rcp_f32 v134, v134
    v_rcp_f32 v135, v135
    v_pk_mul_f32 v[136:137], v[136:137], v[128:129] clamp
    v_pk_mul_f32 v[138:139], v[138:139], v[130:131] clamp
    buffer_load_dwordx4 v2, s[48:51], s70 offen offset:3072 sc1 lds
    v_pk_mul_f32 v[140:141], v[140:141], v[132:133] clamp
    v_pk_mul_f32 v[142:143], v[142:143], v[134:135] clamp
    v_pk_mul_f32 v[232:233], v[232:233], v[136:137]
    v_pk_mul_f32 v[234:235], v[234:235], v[138:139]
    v_pk_mul_f32 v[236:237], v[236:237], v[140:141]
    v_pk_mul_f32 v[238:239], v[238:239], v[142:143]
    v_cvt_pk_bf16_f32 v232, v232, v233
    v_cvt_pk_bf16_f32 v233, v234, v235
    v_cvt_pk_bf16_f32 v234, v236, v237
    v_cvt_pk_bf16_f32 v235, v238, v239
    buffer_store_dwordx4 v[232:235], v2, s[48:51], s101 offen offset:2048 sc1
    v_pk_fma_f32 v[128:129], v[216:217], s[0:1], 0.5 op_sel_hi:[1,0,0]
    v_pk_fma_f32 v[130:131], v[218:219], s[0:1], 0.5 op_sel_hi:[1,0,0]
    v_pk_fma_f32 v[132:133], v[220:221], s[0:1], 0.5 op_sel_hi:[1,0,0]
    v_pk_fma_f32 v[134:135], v[222:223], s[0:1], 0.5 op_sel_hi:[1,0,0]
    v_exp_f32 v128, v128
    v_exp_f32 v129, v129
    s_add_u32 m0, s80, 98304
    s_nop 0
    buffer_load_dwordx4 v2, s[48:51], s71 offen offset:0 sc1 lds
    v_exp_f32 v130, v130
    v_exp_f32 v131, v131
    v_exp_f32 v132, v132
    v_exp_f32 v133, v133
    v_exp_f32 v134, v134
    v_exp_f32 v135, v135
    s_mov_b64 exec, s[90:91]
    ds_write_b128 v35, v[68:71] offset:1024
    s_mov_b64 exec, -1
    v_pk_fma_f32 v[136:137], v[128:129], s[0:1], 1.0 op_sel:[0,1,0] op_sel_hi:[1,1,0]
    v_pk_fma_f32 v[138:139], v[130:131], s[0:1], 1.0 op_sel:[0,1,0] op_sel_hi:[1,1,0]
    v_pk_fma_f32 v[140:141], v[132:133], s[0:1], 1.0 op_sel:[0,1,0] op_sel_hi:[1,1,0]
    v_pk_fma_f32 v[142:143], v[134:135], s[0:1], 1.0 op_sel:[0,1,0] op_sel_hi:[1,1,0]
    v_pk_fma_f32 v[128:129], v[128:129], v[128:129], v[136:137]
    v_pk_fma_f32 v[130:131], v[130:131], v[130:131], v[138:139]
    buffer_load_dwordx4 v2, s[48:51], s71 offen offset:1024 sc1 lds
    v_pk_fma_f32 v[132:133], v[132:133], v[132:133], v[140:141]
    v_pk_fma_f32 v[134:135], v[134:135], v[134:135], v[142:143]
    v_rcp_f32 v128, v128
    v_rcp_f32 v129, v129
    v_rcp_f32 v130, v130
    v_rcp_f32 v131, v131
    buffer_load_dwordx4 v2, s[48:51], s71 offen offset:2048 sc1 lds
    v_rcp_f32 v132, v132
    v_rcp_f32 v133, v133
    v_rcp_f32 v134, v134
    v_rcp_f32 v135, v135
    v_pk_mul_f32 v[136:137], v[136:137], v[128:129] clamp
    v_pk_mul_f32 v[138:139], v[138:139], v[130:131] clamp
    buffer_load_dwordx4 v2, s[48:51], s71 offen offset:3072 sc1 lds
    v_pk_mul_f32 v[140:141], v[140:141], v[132:133] clamp
    v_pk_mul_f32 v[142:143], v[142:143], v[134:135] clamp
    v_pk_mul_f32 v[216:217], v[216:217], v[136:137]
    v_pk_mul_f32 v[218:219], v[218:219], v[138:139]
    v_pk_mul_f32 v[220:221], v[220:221], v[140:141]
    v_pk_mul_f32 v[222:223], v[222:223], v[142:143]
    v_cvt_pk_bf16_f32 v216, v216, v217
    v_cvt_pk_bf16_f32 v217, v218, v219
    v_cvt_pk_bf16_f32 v218, v220, v221
    v_cvt_pk_bf16_f32 v219, v222, v223
    buffer_store_dwordx4 v[216:219], v2, s[48:51], s101 offen offset:1024 sc1
    v_pk_fma_f32 v[128:129], v[200:201], s[0:1], 0.5 op_sel_hi:[1,0,0]
    v_pk_fma_f32 v[130:131], v[202:203], s[0:1], 0.5 op_sel_hi:[1,0,0]
    v_pk_fma_f32 v[132:133], v[204:205], s[0:1], 0.5 op_sel_hi:[1,0,0]
    v_pk_fma_f32 v[134:135], v[206:207], s[0:1], 0.5 op_sel_hi:[1,0,0]
    v_exp_f32 v128, v128
    v_exp_f32 v129, v129
    s_add_u32 m0, s80, 114688
    s_add_u32 s71, s71, 16384
    buffer_load_dwordx4 v2, s[48:51], s71 offen offset:0 sc1 lds
    v_exp_f32 v130, v130
    v_exp_f32 v131, v131
    v_exp_f32 v132, v132
    v_exp_f32 v133, v133
    v_exp_f32 v134, v134
    v_exp_f32 v135, v135
    s_mov_b64 exec, s[90:91]
    ds_write_b128 v35, v[72:75] offset:2048
    s_mov_b64 exec, -1
    v_pk_fma_f32 v[136:137], v[128:129], s[0:1], 1.0 op_sel:[0,1,0] op_sel_hi:[1,1,0]
    v_pk_fma_f32 v[138:139], v[130:131], s[0:1], 1.0 op_sel:[0,1,0] op_sel_hi:[1,1,0]
    v_pk_fma_f32 v[140:141], v[132:133], s[0:1], 1.0 op_sel:[0,1,0] op_sel_hi:[1,1,0]
    v_pk_fma_f32 v[142:143], v[134:135], s[0:1], 1.0 op_sel:[0,1,0] op_sel_hi:[1,1,0]
    v_pk_fma_f32 v[128:129], v[128:129], v[128:129], v[136:137]
    v_pk_fma_f32 v[130:131], v[130:131], v[130:131], v[138:139]
    buffer_load_dwordx4 v2, s[48:51], s71 offen offset:1024 sc1 lds
    v_pk_fma_f32 v[132:133], v[132:133], v[132:133], v[140:141]
    v_pk_fma_f32 v[134:135], v[134:135], v[134:135], v[142:143]
    v_rcp_f32 v128, v128
    v_rcp_f32 v129, v129
    v_rcp_f32 v130, v130
    v_rcp_f32 v131, v131
    s_mov_b64 exec, s[90:91]
    ds_write_b128 v35, v[76:79] offset:3072
    s_mov_b64 exec, -1
    v_rcp_f32 v132, v132
    v_rcp_f32 v133, v133
    v_rcp_f32 v134, v134
    v_rcp_f32 v135, v135
    v_pk_mul_f32 v[136:137], v[136:137], v[128:129] clamp
    v_pk_mul_f32 v[138:139], v[138:139], v[130:131] clamp
    s_mov_b64 exec, s[90:91]
    ds_write_b128 v35, v[80:83] offset:4096
    s_mov_b64 exec, -1
    v_pk_mul_f32 v[140:141], v[140:141], v[132:133] clamp
    v_pk_mul_f32 v[142:143], v[142:143], v[134:135] clamp
    v_pk_mul_f32 v[200:201], v[200:201], v[136:137]
    v_pk_mul_f32 v[202:203], v[202:203], v[138:139]
    v_pk_mul_f32 v[204:205], v[204:205], v[140:141]
    v_pk_mul_f32 v[206:207], v[206:207], v[142:143]
    v_cvt_pk_bf16_f32 v200, v200, v201
    v_cvt_pk_bf16_f32 v201, v202, v203
    v_cvt_pk_bf16_f32 v202, v204, v205
    v_cvt_pk_bf16_f32 v203, v206, v207
    buffer_store_dwordx4 v[200:203], v2, s[48:51], s101 offen offset:0 sc1
    v_pk_fma_f32 v[128:129], v[240:241], s[0:1], 0.5 op_sel_hi:[1,0,0]
    v_pk_fma_f32 v[130:131], v[242:243], s[0:1], 0.5 op_sel_hi:[1,0,0]
    v_pk_fma_f32 v[132:133], v[244:245], s[0:1], 0.5 op_sel_hi:[1,0,0]
    v_pk_fma_f32 v[134:135], v[246:247], s[0:1], 0.5 op_sel_hi:[1,0,0]
    v_exp_f32 v128, v128
    v_exp_f32 v129, v129
    buffer_load_dwordx4 v2, s[48:51], s71 offen offset:2048 sc1 lds
    v_exp_f32 v130, v130
    v_exp_f32 v131, v131
    v_exp_f32 v132, v132
    v_exp_f32 v133, v133
    v_exp_f32 v134, v134
    v_exp_f32 v135, v135
    s_mov_b64 exec, s[90:91]
    ds_write_b128 v35, v[84:87] offset:5120
    s_mov_b64 exec, -1
    v_pk_fma_f32 v[136:137], v[128:129], s[0:1], 1.0 op_sel:[0,1,0] op_sel_hi:[1,1,0]
    v_pk_fma_f32 v[138:139], v[130:131], s[0:1], 1.0 op_sel:[0,1,0] op_sel_hi:[1,1,0]
    v_pk_fma_f32 v[140:141], v[132:133], s[0:1], 1.0 op_sel:[0,1,0] op_sel_hi:[1,1,0]
    v_pk_fma_f32 v[142:143], v[134:135], s[0:1], 1.0 op_sel:[0,1,0] op_sel_hi:[1,1,0]
    v_pk_fma_f32 v[128:129], v[128:129], v[128:129], v[136:137]
    v_pk_fma_f32 v[130:131], v[130:131], v[130:131], v[138:139]
    buffer_load_dwordx4 v2, s[48:51], s71 offen offset:3072 sc1 lds
    v_pk_fma_f32 v[132:133], v[132:133], v[132:133], v[140:141]
    v_pk_fma_f32 v[134:135], v[134:135], v[134:135], v[142:143]
    v_rcp_f32 v128, v128
    v_rcp_f32 v129, v129
    v_rcp_f32 v130, v130
    v_rcp_f32 v131, v131
    s_mov_b64 exec, s[90:91]
    ds_write_b128 v35, v[88:91] offset:6144
    s_mov_b64 exec, -1
    v_rcp_f32 v132, v132
    v_rcp_f32 v133, v133
    v_rcp_f32 v134, v134
    v_rcp_f32 v135, v135
    v_pk_mul_f32 v[136:137], v[136:137], v[128:129] clamp
    v_pk_mul_f32 v[138:139], v[138:139], v[130:131] clamp
    s_mov_b64 exec, s[90:91]
    ds_write_b128 v35, v[92:95] offset:7168
    s_mov_b64 exec, -1
    v_pk_mul_f32 v[140:141], v[140:141], v[132:133] clamp
    v_pk_mul_f32 v[142:143], v[142:143], v[134:135] clamp
    v_pk_mul_f32 v[240:241], v[240:241], v[136:137]
    v_pk_mul_f32 v[242:243], v[242:243], v[138:139]
    v_pk_mul_f32 v[244:245], v[244:245], v[140:141]
    v_pk_mul_f32 v[246:247], v[246:247], v[142:143]
    v_cvt_pk_bf16_f32 v240, v240, v241
    v_cvt_pk_bf16_f32 v241, v242, v243
    v_cvt_pk_bf16_f32 v242, v244, v245
    v_cvt_pk_bf16_f32 v243, v246, v247
    buffer_store_dwordx4 v[240:243], v2, s[48:51], s68 offen offset:3072 sc1
    v_pk_fma_f32 v[128:129], v[224:225], s[0:1], 0.5 op_sel_hi:[1,0,0]
    v_pk_fma_f32 v[130:131], v[226:227], s[0:1], 0.5 op_sel_hi:[1,0,0]
    v_pk_fma_f32 v[132:133], v[228:229], s[0:1], 0.5 op_sel_hi:[1,0,0]
    v_pk_fma_f32 v[134:135], v[230:231], s[0:1], 0.5 op_sel_hi:[1,0,0]
    v_exp_f32 v128, v128
    v_exp_f32 v129, v129
    s_add_u32 m0, s80, 65536
    s_add_u32 s71, s71, 16384
    buffer_load_dwordx4 v2, s[48:51], s71 offen offset:0 sc1 lds
    v_exp_f32 v130, v130
    v_exp_f32 v131, v131
    v_exp_f32 v132, v132
    v_exp_f32 v133, v133
    v_exp_f32 v134, v134
    v_exp_f32 v135, v135
    s_mov_b64 exec, s[90:91]
    ds_write_b128 v35, v[96:99] offset:8192
    s_mov_b64 exec, -1
    v_pk_fma_f32 v[136:137], v[128:129], s[0:1], 1.0 op_sel:[0,1,0] op_sel_hi:[1,1,0]
    v_pk_fma_f32 v[138:139], v[130:131], s[0:1], 1.0 op_sel:[0,1,0] op_sel_hi:[1,1,0]
    v_pk_fma_f32 v[140:141], v[132:133], s[0:1], 1.0 op_sel:[0,1,0] op_sel_hi:[1,1,0]
    v_pk_fma_f32 v[142:143], v[134:135], s[0:1], 1.0 op_sel:[0,1,0] op_sel_hi:[1,1,0]
    v_pk_fma_f32 v[128:129], v[128:129], v[128:129], v[136:137]
    v_pk_fma_f32 v[130:131], v[130:131], v[130:131], v[138:139]
    buffer_load_dwordx4 v2, s[48:51], s71 offen offset:1024 sc1 lds
    v_pk_fma_f32 v[132:133], v[132:133], v[132:133], v[140:141]
    v_pk_fma_f32 v[134:135], v[134:135], v[134:135], v[142:143]
    v_rcp_f32 v128, v128
    v_rcp_f32 v129, v129
    v_rcp_f32 v130, v130
    v_rcp_f32 v131, v131
    s_mov_b64 exec, s[90:91]
    ds_write_b128 v35, v[100:103] offset:9216
    s_mov_b64 exec, -1
    v_rcp_f32 v132, v132
    v_rcp_f32 v133, v133
    v_rcp_f32 v134, v134
    v_rcp_f32 v135, v135
    v_pk_mul_f32 v[136:137], v[136:137], v[128:129] clamp
    v_pk_mul_f32 v[138:139], v[138:139], v[130:131] clamp
    s_mov_b64 exec, s[90:91]
    ds_write_b128 v35, v[104:107] offset:10240
    s_mov_b64 exec, -1
    v_pk_mul_f32 v[140:141], v[140:141], v[132:133] clamp
    v_pk_mul_f32 v[142:143], v[142:143], v[134:135] clamp
    v_pk_mul_f32 v[224:225], v[224:225], v[136:137]
    v_pk_mul_f32 v[226:227], v[226:227], v[138:139]
    v_pk_mul_f32 v[228:229], v[228:229], v[140:141]
    v_pk_mul_f32 v[230:231], v[230:231], v[142:143]
    v_cvt_pk_bf16_f32 v224, v224, v225
    v_cvt_pk_bf16_f32 v225, v226, v227
    v_cvt_pk_bf16_f32 v226, v228, v229
    v_cvt_pk_bf16_f32 v227, v230, v231
    buffer_store_dwordx4 v[224:227], v2, s[48:51], s68 offen offset:2048 sc1
    v_pk_fma_f32 v[128:129], v[208:209], s[0:1], 0.5 op_sel_hi:[1,0,0]
    v_pk_fma_f32 v[130:131], v[210:211], s[0:1], 0.5 op_sel_hi:[1,0,0]
    v_pk_fma_f32 v[132:133], v[212:213], s[0:1], 0.5 op_sel_hi:[1,0,0]
    v_pk_fma_f32 v[134:135], v[214:215], s[0:1], 0.5 op_sel_hi:[1,0,0]
    v_exp_f32 v128, v128
    v_exp_f32 v129, v129
    buffer_load_dwordx4 v2, s[48:51], s71 offen offset:2048 sc1 lds
    v_exp_f32 v130, v130
    v_exp_f32 v131, v131
    v_exp_f32 v132, v132
    v_exp_f32 v133, v133
    v_exp_f32 v134, v134
    v_exp_f32 v135, v135
    s_mov_b64 exec, s[90:91]
    ds_write_b128 v35, v[108:111] offset:11264
    s_mov_b64 exec, -1
    v_pk_fma_f32 v[136:137], v[128:129], s[0:1], 1.0 op_sel:[0,1,0] op_sel_hi:[1,1,0]
    v_pk_fma_f32 v[138:139], v[130:131], s[0:1], 1.0 op_sel:[0,1,0] op_sel_hi:[1,1,0]
    v_pk_fma_f32 v[140:141], v[132:133], s[0:1], 1.0 op_sel:[0,1,0] op_sel_hi:[1,1,0]
    v_pk_fma_f32 v[142:143], v[134:135], s[0:1], 1.0 op_sel:[0,1,0] op_sel_hi:[1,1,0]
    v_pk_fma_f32 v[128:129], v[128:129], v[128:129], v[136:137]
    v_pk_fma_f32 v[130:131], v[130:131], v[130:131], v[138:139]
    buffer_load_dwordx4 v2, s[48:51], s71 offen offset:3072 sc1 lds
    v_pk_fma_f32 v[132:133], v[132:133], v[132:133], v[140:141]
    v_pk_fma_f32 v[134:135], v[134:135], v[134:135], v[142:143]
    v_rcp_f32 v128, v128
    v_rcp_f32 v129, v129
    v_rcp_f32 v130, v130
    v_rcp_f32 v131, v131
    s_mov_b64 exec, s[90:91]
    ds_write_b128 v35, v[112:115] offset:12288
    s_mov_b64 exec, -1
    v_rcp_f32 v132, v132
    v_rcp_f32 v133, v133
    v_rcp_f32 v134, v134
    v_rcp_f32 v135, v135
    v_pk_mul_f32 v[136:137], v[136:137], v[128:129] clamp
    v_pk_mul_f32 v[138:139], v[138:139], v[130:131] clamp
    s_mov_b64 exec, s[90:91]
    ds_write_b128 v35, v[116:119] offset:13312
    s_mov_b64 exec, -1
    v_pk_mul_f32 v[140:141], v[140:141], v[132:133] clamp
    v_pk_mul_f32 v[142:143], v[142:143], v[134:135] clamp
    v_pk_mul_f32 v[208:209], v[208:209], v[136:137]
    v_pk_mul_f32 v[210:211], v[210:211], v[138:139]
    v_pk_mul_f32 v[212:213], v[212:213], v[140:141]
    v_pk_mul_f32 v[214:215], v[214:215], v[142:143]
    v_cvt_pk_bf16_f32 v208, v208, v209
    v_cvt_pk_bf16_f32 v209, v210, v211
    v_cvt_pk_bf16_f32 v210, v212, v213
    v_cvt_pk_bf16_f32 v211, v214, v215
    buffer_store_dwordx4 v[208:211], v2, s[48:51], s68 offen offset:1024 sc1
    v_pk_fma_f32 v[128:129], v[192:193], s[0:1], 0.5 op_sel_hi:[1,0,0]
    v_pk_fma_f32 v[130:131], v[194:195], s[0:1], 0.5 op_sel_hi:[1,0,0]
    v_pk_fma_f32 v[132:133], v[196:197], s[0:1], 0.5 op_sel_hi:[1,0,0]
    v_pk_fma_f32 v[134:135], v[198:199], s[0:1], 0.5 op_sel_hi:[1,0,0]
    v_exp_f32 v128, v128
    v_exp_f32 v129, v129
    v_exp_f32 v130, v130
    v_exp_f32 v131, v131
    v_exp_f32 v132, v132
    v_exp_f32 v133, v133
    v_exp_f32 v134, v134
    v_exp_f32 v135, v135
    v_pk_fma_f32 v[136:137], v[128:129], s[0:1], 1.0 op_sel:[0,1,0] op_sel_hi:[1,1,0]
    s_mov_b64 exec, s[90:91]
    ds_write_b128 v35, v[120:123] offset:14336
    s_mov_b64 exec, -1
    v_pk_fma_f32 v[138:139], v[130:131], s[0:1], 1.0 op_sel:[0,1,0] op_sel_hi:[1,1,0]
    v_pk_fma_f32 v[140:141], v[132:133], s[0:1], 1.0 op_sel:[0,1,0] op_sel_hi:[1,1,0]
    v_pk_fma_f32 v[142:143], v[134:135], s[0:1], 1.0 op_sel:[0,1,0] op_sel_hi:[1,1,0]
    v_pk_fma_f32 v[128:129], v[128:129], v[128:129], v[136:137]
    v_pk_fma_f32 v[130:131], v[130:131], v[130:131], v[138:139]
    v_pk_fma_f32 v[132:133], v[132:133], v[132:133], v[140:141]
    v_pk_fma_f32 v[134:135], v[134:135], v[134:135], v[142:143]
    v_rcp_f32 v128, v128
    v_rcp_f32 v129, v129
    v_rcp_f32 v130, v130
    v_rcp_f32 v131, v131
    v_rcp_f32 v132, v132
    v_rcp_f32 v133, v133
    s_mov_b64 exec, s[90:91]
    ds_write_b128 v35, v[124:127] offset:15360
    s_mov_b64 exec, -1
    v_rcp_f32 v134, v134
    v_rcp_f32 v135, v135
    v_pk_mul_f32 v[136:137], v[136:137], v[128:129] clamp
    v_pk_mul_f32 v[138:139], v[138:139], v[130:131] clamp
    v_pk_mul_f32 v[140:141], v[140:141], v[132:133] clamp
    v_pk_mul_f32 v[142:143], v[142:143], v[134:135] clamp
    v_pk_mul_f32 v[192:193], v[192:193], v[136:137]
    v_pk_mul_f32 v[194:195], v[194:195], v[138:139]
    v_pk_mul_f32 v[196:197], v[196:197], v[140:141]
    v_pk_mul_f32 v[198:199], v[198:199], v[142:143]
    v_cvt_pk_bf16_f32 v192, v192, v193
    v_cvt_pk_bf16_f32 v193, v194, v195
    v_cvt_pk_bf16_f32 v194, v196, v197
    v_cvt_pk_bf16_f32 v195, v198, v199
    buffer_store_dwordx4 v[192:195], v2, s[48:51], s68 offen offset:0 sc1
    s_branch L_mishdone
L_nomish:
    buffer_load_dword v32, v53, s[48:51], 0 offen sc1
    ds_write_b128 v35, v[64:67] offset:0
    ds_write_b128 v35, v[68:71] offset:1024
    ds_write_b128 v35, v[72:75] offset:2048
    ds_write_b128 v35, v[76:79] offset:3072
    ds_write_b128 v35, v[80:83] offset:4096
    ds_write_b128 v35, v[84:87] offset:5120
    ds_write_b128 v35, v[88:91] offset:6144
    ds_write_b128 v35, v[92:95] offset:7168
    ds_write_b128 v35, v[96:99] offset:8192
    ds_write_b128 v35, v[100:103] offset:9216
    ds_write_b128 v35, v[104:107] offset:10240
    ds_write_b128 v35, v[108:111] offset:11264
    ds_write_b128 v35, v[112:115] offset:12288
    ds_write_b128 v35, v[116:119] offset:13312
    ds_write_b128 v35, v[120:123] offset:14336
    ds_write_b128 v35, v[124:127] offset:15360
    s_waitcnt vmcnt(0)
    s_mov_b32 s88, 65536
L_s1b_t:
    v_readfirstlane_b32 s69, v32
    s_cmp_ge_u32 s69, 8
    s_cbranch_scc1 L_s1b_ok
    s_sub_u32 s88, s88, 1
    s_cmp_eq_u32 s88, 0
    s_cbranch_scc1 L_s1b_ok
    s_sleep 1
    buffer_load_dword v32, v53, s[48:51], 0 offen sc1
    s_waitcnt vmcnt(0)
    s_branch L_s1b_t
L_s1b_ok:
    s_cmp_ge_u32 s60, 2
    s_cselect_b32 s70, 1073741824, s89
    s_cselect_b32 s71, 0, 16384
    s_add_u32 s71, s71, s89
    s_add_u32 m0, s80, 81920
    s_nop 0
    buffer_load_dwordx4 v2, s[48:51], s70 offen offset:0 sc1 lds
    buffer_load_dwordx4 v2, s[48:51], s70 offen offset:1024 sc1 lds
    buffer_load_dwordx4 v2, s[48:51], s70 offen offset:2048 sc1 lds
    buffer_load_dwordx4 v2, s[48:51], s70 offen offset:3072 sc1 lds
    s_add_u32 m0, s80, 98304
    s_nop 0
    buffer_load_dwordx4 v2, s[48:51], s71 offen offset:0 sc1 lds
    buffer_load_dwordx4 v2, s[48:51], s71 offen offset:1024 sc1 lds
    buffer_load_dwordx4 v2, s[48:51], s71 offen offset:2048 sc1 lds
    buffer_load_dwordx4 v2, s[48:51], s71 offen offset:3072 sc1 lds
    s_add_u32 m0, s80, 114688
    s_add_u32 s71, s71, 16384
    buffer_load_dwordx4 v2, s[48:51], s71 offen offset:0 sc1 lds
    buffer_load_dwordx4 v2, s[48:51], s71 offen offset:1024 sc1 lds
    buffer_load_dwordx4 v2, s[48:51], s71 offen offset:2048 sc1 lds
    buffer_load_dwordx4 v2, s[48:51], s71 offen offset:3072 sc1 lds
    s_add_u32 m0, s80, 65536
    s_add_u32 s71, s71, 16384
    buffer_load_dwordx4 v2, s[48:51], s71 offen offset:0 sc1 lds
    buffer_load_dwordx4 v2, s[48:51], s71 offen offset:1024 sc1 lds
    buffer_load_dwordx4 v2, s[48:51], s71 offen offset:2048 sc1 lds
    buffer_load_dwordx4 v2, s[48:51], s71 offen offset:3072 sc1 lds
    s_waitcnt vmcnt(0)
    s_cmp_lg_u32 s42, 28
    s_cbranch_scc1 L_mishdone
    v_permlane32_swap_b32 v193, v194
    v_permlane32_swap_b32 v209, v210
    v_permlane32_swap_b32 v225, v226
    v_permlane32_swap_b32 v241, v242
    v_add_f32 v192, v192, v194
    v_mul_f32 v192, 0xbfb8aa3b, v192
    v_exp_f32 v192, v192
    v_add_f32 v208, v208, v210
    v_mul_f32 v208, 0xbfb8aa3b, v208
    v_exp_f32 v208, v208
    v_add_f32 v224, v224, v226
    v_mul_f32 v224, 0xbfb8aa3b, v224
    v_exp_f32 v224, v224
    v_add_f32 v240, v240, v242
    v_mul_f32 v240, 0xbfb8aa3b, v240
    v_exp_f32 v240, v240
    v_lshlrev_b32 v33, 2, v1
    v_mov_b32 v34, 1073741824
    v_cmp_gt_u32 vcc, 16, v1
    s_lshl_b32 s69, s73, 8
    s_add_u32 s69, s69, 58720256
    v_cndmask_b32 v33, v34, v33, vcc
    v_add_f32 v192, 1.0, v192
    v_rcp_f32 v192, v192
    v_add_f32 v208, 1.0, v208
    v_rcp_f32 v208, v208
    v_add_f32 v224, 1.0, v224
    v_rcp_f32 v224, v224
    v_add_f32 v240, 1.0, v240
    v_rcp_f32 v240, v240
    s_nop 0
    buffer_store_dword v192, v33, s[48:51], s69 offen offset:0 sc1
    buffer_store_dword v208, v33, s[48:51], s69 offen offset:64 sc1
    buffer_store_dword v224, v33, s[48:51], s69 offen offset:128 sc1
    buffer_store_dword v240, v33, s[48:51], s69 offen offset:192 sc1
L_mishdone:
    s_mov_b32 s69, 0x3e803e80
    v_accvgpr_write_b32 a224, s69
    v_accvgpr_write_b32 a225, s69
    v_accvgpr_write_b32 a226, s69
    v_accvgpr_write_b32 a227, s69
    s_waitcnt vmcnt(14) lgkmcnt(0)
    s_barrier
    ds_read_b128 a[128:131], v4 offset:16384
    ds_read_b128 a[132:135], v4 offset:17408
    ds_read_b128 a[136:139], v4 offset:18432
    ds_read_b128 a[140:143], v4 offset:19456
    ds_read_b128 a[156:159], v4 offset:23552
    ds_read_b128 a[152:155], v4 offset:22528
    ds_read_b128 a[148:151], v4 offset:21504
    ds_read_b128 a[144:147], v4 offset:20480
    s_waitcnt lgkmcnt(0)
L_start:
    v_mfma_f32_16x16x32_bf16 v[144:147], a[128:131], v[68:71], 0
    s_xor_b32 m0, s80, 0
    v_mfma_f32_16x16x32_bf16 v[144:147], a[132:135], v[84:87], v[144:147]
    buffer_load_dwordx4 v2, s[48:51], s82 offen offset:0 sc1 lds
    v_mfma_f32_16x16x32_bf16 v[144:147], a[136:139], v[100:103], v[144:147]
    v_mfma_f32_16x16x32_bf16 v[144:147], a[140:143], v[116:119], v[144:147]
    v_mfma_f32_16x16x32_bf16 v[148:151], a[156:159], v[116:119], 0
    buffer_load_dwordx4 v2, s[48:51], s82 offen offset:1024 sc1 lds
    v_mfma_f32_16x16x32_bf16 v[148:151], a[152:155], v[100:103], v[148:151]
    s_add_u32 s69, s75, s95
    v_mfma_f32_16x16x32_bf16 v[148:151], a[148:151], v[84:87], v[148:151]
    s_lshr_b32 s3, s69, 1
    v_mfma_f32_16x16x32_bf16 v[148:151], a[144:147], v[68:71], v[148:151]
    s_sub_i32 s3, s3, s83
    buffer_load_dwordx4 v2, s[48:51], s82 offen offset:2048 sc1 lds
    v_mfma_f32_16x16x32_bf16 v[156:159], a[144:147], v[64:67], 0
    s_max_i32 s71, s3, 0
    v_mfma_f32_16x16x32_bf16 v[156:159], a[148:151], v[80:83], v[156:159]
    s_lshl_b32 s71, s71, 1
    v_mfma_f32_16x16x32_bf16 v[156:159], a[152:155], v[96:99], v[156:159]
    s_add_u32 s71, s71, s69
    buffer_load_dwordx4 v2, s[48:51], s82 offen offset:3072 sc1 lds
    v_mfma_f32_16x16x32_bf16 v[156:159], a[156:159], v[112:115], v[156:159]
    s_lshl_b32 s71, s71, 14
    v_xor_b32 v4, 32768, v4
    v_mfma_f32_16x16x32_bf16 v[152:155], a[140:143], v[112:115], 0
    s_add_u32 s71, s71, s89
    v_mfma_f32_16x16x32_bf16 v[152:155], a[136:139], v[96:99], v[152:155]
    s_cmp_ge_u32 s69, 34
    v_max3_f32 v228, v144, v145, v146
    v_max3_f32 v228, v228, v147, v148
    v_mfma_f32_16x16x32_bf16 v[152:155], a[132:135], v[80:83], v[152:155]
    s_cselect_b32 s99, 1073741824, s71
    v_max3_f32 v228, v228, v149, v150
    v_max_f32 v228, v228, v151
    v_mfma_f32_16x16x32_bf16 v[152:155], a[128:131], v[64:67], v[152:155]
    s_lshl_b32 s71, s75, 13
    v_mov_b32 v44, 0
    v_mov_b32 v45, 0
    v_mfma_f32_16x16x32_bf16 v[128:131], a[128:131], v[76:79], 0
    s_add_u32 s71, s71, s92
    v_mfma_f32_16x16x32_bf16 v[128:131], a[132:135], v[92:95], v[128:131]
    s_cmp_ge_u32 s75, 31
    v_mfma_f32_16x16x32_bf16 v[128:131], a[136:139], v[108:111], v[128:131]
    s_cselect_b32 s81, s71, s99
    v_mfma_f32_16x16x32_bf16 v[128:131], a[140:143], v[124:127], v[128:131]
    s_add_u32 s75, s75, 1
    v_max3_f32 v230, v152, v153, v154
    v_max3_f32 v230, v230, v155, v156
    v_mfma_f32_16x16x32_bf16 v[132:135], a[156:159], v[124:127], 0
    s_cmp_eq_u32 s3, 0
    v_max3_f32 v230, v230, v157, v158
    v_max_f32 v230, v230, v159
    v_mfma_f32_16x16x32_bf16 v[132:135], a[152:155], v[108:111], v[132:135]
    s_cselect_b32 s71, s98, 4294934528
    v_mov_b32 v232, v228
    v_mov_b32 v233, v230
    v_mfma_f32_16x16x32_bf16 v[132:135], a[148:151], v[92:95], v[132:135]
    s_add_u32 s71, s71, s99
    v_mfma_f32_16x16x32_bf16 v[132:135], a[144:147], v[76:79], v[132:135]
    s_cmp_lt_i32 s3, 0
    v_permlane16_swap_b32 v228, v232
    v_permlane16_swap_b32 v230, v233
    v_mfma_f32_16x16x32_bf16 v[140:143], a[144:147], v[72:75], 0
    s_cselect_b32 s82, 1073741824, s71
    v_max_f32 v228, v228, v232
    v_max_f32 v230, v230, v233
    v_mfma_f32_16x16x32_bf16 v[140:143], a[148:151], v[88:91], v[140:143]
    s_xor_b32 s80, s80, 32768
    v_mov_b32 v232, v228
    v_mov_b32 v233, v230
    v_mfma_f32_16x16x32_bf16 v[140:143], a[152:155], v[104:107], v[140:143]
    s_xor_b32 m0, s80, 114688
    v_mfma_f32_16x16x32_bf16 v[140:143], a[156:159], v[120:123], v[140:143]
    s_cmp_eq_u32 s75, s78
    v_permlane32_swap_b32 v228, v232
    v_permlane32_swap_b32 v230, v233
    v_mfma_f32_16x16x32_bf16 v[136:139], a[140:143], v[120:123], 0
    s_waitcnt vmcnt(31)
    v_max_f32 v228, v228, v232
    v_max_f32 v230, v230, v233
    v_mfma_f32_16x16x32_bf16 v[136:139], a[136:139], v[104:107], v[136:139]
    v_mfma_f32_16x16x32_bf16 v[136:139], a[132:135], v[88:91], v[136:139]
    s_barrier
    ds_read_b128 a[156:159], v4 offset:7168
    ds_read_b128 a[152:155], v4 offset:6144
    v_mfma_f32_16x16x32_bf16 v[136:139], a[128:131], v[72:75], v[136:139]
    ds_read_b128 a[148:151], v4 offset:5120
    ds_read_b128 a[144:147], v4 offset:4096
    ds_read_b128 a[128:131], v4 offset:0
    ds_read_b128 a[132:135], v4 offset:1024
    ds_read_b128 a[136:139], v4 offset:2048
    ds_read_b128 a[140:143], v4 offset:3072
L_start2:
    s_cbranch_scc1 L_st_m
L_st_mr:
    buffer_load_dword v30, v7, s[24:27], s93 offen
    s_add_u32 s93, s93, 512
    v_max3_f32 v224, v128, v129, v130
    v_max3_f32 v224, v224, v131, v132
    v_max3_f32 v224, v224, v133, v134
    v_max_f32 v224, v224, v135
    v_max3_f32 v226, v136, v137, v138
    v_max3_f32 v226, v226, v139, v140
    v_max3_f32 v226, v226, v141, v142
    v_max_f32 v226, v226, v143
    v_mov_b32 v232, v224
    v_mov_b32 v233, v226
    s_nop 1
    v_permlane16_swap_b32 v224, v232
    v_permlane16_swap_b32 v226, v233
    v_max_f32 v224, v224, v232
    v_max_f32 v226, v226, v233
    v_mov_b32 v232, v224
    v_mov_b32 v233, v226
    s_nop 1
    v_permlane32_swap_b32 v224, v232
    v_permlane32_swap_b32 v226, v233
    v_max_f32 v224, v224, v232
    v_max_f32 v226, v226, v233
    v_pk_add_f32 v[128:129], v[128:129], v[224:225] op_sel_hi:[1,0] neg_lo:[0,1] neg_hi:[0,1]
    v_pk_add_f32 v[130:131], v[130:131], v[224:225] op_sel_hi:[1,0] neg_lo:[0,1] neg_hi:[0,1]
    v_pk_add_f32 v[132:133], v[132:133], v[224:225] op_sel_hi:[1,0] neg_lo:[0,1] neg_hi:[0,1]
    v_pk_add_f32 v[134:135], v[134:135], v[224:225] op_sel_hi:[1,0] neg_lo:[0,1] neg_hi:[0,1]
    v_sub_f32 v48, 0, v224
    v_sub_f32 v49, 0, v224
    v_sub_f32 v50, 0, v224
    v_sub_f32 v51, 0, v224
    buffer_load_dwordx4 v2, s[48:51], s81 offen offset:0 sc1 lds
    v_pk_add_f32 v[136:137], v[136:137], v[226:227] op_sel_hi:[1,0] neg_lo:[0,1] neg_hi:[0,1]
    v_pk_add_f32 v[138:139], v[138:139], v[226:227] op_sel_hi:[1,0] neg_lo:[0,1] neg_hi:[0,1]
    v_pk_add_f32 v[140:141], v[140:141], v[226:227] op_sel_hi:[1,0] neg_lo:[0,1] neg_hi:[0,1]
    v_pk_add_f32 v[142:143], v[142:143], v[226:227] op_sel_hi:[1,0] neg_lo:[0,1] neg_hi:[0,1]
    v_sub_f32 v52, 0, v226
    v_sub_f32 v53, 0, v226
    v_sub_f32 v54, 0, v226
    v_sub_f32 v55, 0, v226
    buffer_load_dwordx4 v2, s[48:51], s81 offen offset:1024 sc1 lds
    v_pk_add_f32 v[144:145], v[144:145], v[228:229] op_sel_hi:[1,0] neg_lo:[0,1] neg_hi:[0,1]
    v_pk_add_f32 v[146:147], v[146:147], v[228:229] op_sel_hi:[1,0] neg_lo:[0,1] neg_hi:[0,1]
    v_pk_add_f32 v[148:149], v[148:149], v[228:229] op_sel_hi:[1,0] neg_lo:[0,1] neg_hi:[0,1]
    v_pk_add_f32 v[150:151], v[150:151], v[228:229] op_sel_hi:[1,0] neg_lo:[0,1] neg_hi:[0,1]
    v_sub_f32 v56, 0, v228
    v_sub_f32 v57, 0, v228
    v_sub_f32 v58, 0, v228
    v_sub_f32 v59, 0, v228
    buffer_load_dwordx4 v2, s[48:51], s81 offen offset:2048 sc1 lds
    v_pk_add_f32 v[152:153], v[152:153], v[230:231] op_sel_hi:[1,0] neg_lo:[0,1] neg_hi:[0,1]
    v_pk_add_f32 v[154:155], v[154:155], v[230:231] op_sel_hi:[1,0] neg_lo:[0,1] neg_hi:[0,1]
    v_pk_add_f32 v[156:157], v[156:157], v[230:231] op_sel_hi:[1,0] neg_lo:[0,1] neg_hi:[0,1]
    v_pk_add_f32 v[158:159], v[158:159], v[230:231] op_sel_hi:[1,0] neg_lo:[0,1] neg_hi:[0,1]
    v_sub_f32 v60, 0, v230
    v_sub_f32 v61, 0, v230
    v_sub_f32 v62, 0, v230
    v_sub_f32 v63, 0, v230
    buffer_load_dwordx4 v2, s[48:51], s81 offen offset:3072 sc1 lds
    v_exp_f32 v32, v144
    v_exp_f32 v33, v145
    v_exp_f32 v34, v146
    v_exp_f32 v35, v147
    v_exp_f32 v36, v148
    v_exp_f32 v37, v149
    v_exp_f32 v38, v150
    v_exp_f32 v39, v151
    v_add_f32 v46, v32, v33
    v_add_f32 v46, v46, v34
    v_add_f32 v46, v46, v35
    v_add_f32 v46, v46, v36
    v_add_f32 v46, v46, v37
    v_add_f32 v46, v46, v38
    v_add_f32 v46, v46, v39
    v_cvt_pk_bf16_f32 v200, v32, v33
    v_cvt_pk_bf16_f32 v201, v34, v35
    v_cvt_pk_bf16_f32 v202, v36, v37
    v_cvt_pk_bf16_f32 v203, v38, v39
    v_exp_f32 v32, v152
    v_exp_f32 v33, v153
    v_exp_f32 v34, v154
    v_exp_f32 v35, v155
    v_exp_f32 v36, v156
    v_exp_f32 v37, v157
    v_exp_f32 v38, v158
    v_exp_f32 v39, v159
    v_add_f32 v47, v32, v33
    v_add_f32 v47, v47, v34
    v_add_f32 v47, v47, v35
    v_add_f32 v47, v47, v36
    v_add_f32 v47, v47, v37
    v_add_f32 v47, v47, v38
    v_add_f32 v47, v47, v39
    v_cvt_pk_bf16_f32 v204, v32, v33
    v_cvt_pk_bf16_f32 v205, v34, v35
    v_cvt_pk_bf16_f32 v206, v36, v37
    v_cvt_pk_bf16_f32 v207, v38, v39
    s_waitcnt lgkmcnt(0)
    v_mfma_f32_16x16x32_bf16 v[160:163], a[128:131], v[76:79], v[48:51]
    v_exp_f32 v32, v128
    v_mfma_f32_16x16x32_bf16 v[160:163], a[132:135], v[92:95], v[160:163]
    v_mfma_f32_16x16x32_bf16 v[160:163], a[136:139], v[108:111], v[160:163]
    s_waitcnt lgkmcnt(0)
    v_exp_f32 v33, v129
    v_mfma_f32_16x16x32_bf16 v[160:163], a[140:143], v[124:127], v[160:163]
    s_xor_b32 m0, s80, 49152
    ds_read_b128 a[160:163], v4 offset:8192
    ds_read_b128 a[164:167], v4 offset:9216
    v_mfma_f32_16x16x32_bf16 v[164:167], a[156:159], v[124:127], v[48:51]
    s_add_u32 s69, s75, s95
    v_exp_f32 v34, v130
    v_mfma_f32_16x16x32_bf16 v[164:167], a[152:155], v[108:111], v[164:167]
    s_lshr_b32 s3, s69, 1
    v_add_f32 v40, v32, v33
    v_cvt_pk_bf16_f32 v192, v32, v33
    v_mfma_f32_16x16x32_bf16 v[164:167], a[148:151], v[92:95], v[164:167]
    s_sub_i32 s3, s3, s83
    v_exp_f32 v35, v131
    v_mfma_f32_16x16x32_bf16 v[164:167], a[144:147], v[76:79], v[164:167]
    s_max_i32 s71, s3, 0
    ds_read_b128 a[168:171], v4 offset:10240
    v_add_f32 v40, v40, v34
    v_mfma_f32_16x16x32_bf16 v[172:175], a[144:147], v[72:75], v[52:55]
    s_lshl_b32 s71, s71, 1
    v_exp_f32 v36, v132
    v_mfma_f32_16x16x32_bf16 v[172:175], a[148:151], v[88:91], v[172:175]
    s_add_u32 s71, s71, s69
    v_add_f32 v40, v40, v35
    v_cvt_pk_bf16_f32 v193, v34, v35
    v_mfma_f32_16x16x32_bf16 v[172:175], a[152:155], v[104:107], v[172:175]
    s_lshl_b32 s71, s71, 14
    v_exp_f32 v37, v133
    v_mfma_f32_16x16x32_bf16 v[172:175], a[156:159], v[120:123], v[172:175]
    s_add_u32 s71, s71, s89
    ds_read_b128 a[172:175], v4 offset:11264
    v_add_f32 v40, v40, v36
    v_mfma_f32_16x16x32_bf16 v[168:171], a[140:143], v[120:123], v[52:55]
    s_cmp_ge_u32 s69, 34
    v_exp_f32 v38, v134
    v_mfma_f32_16x16x32_bf16 v[168:171], a[136:139], v[104:107], v[168:171]
    s_cselect_b32 s99, 1073741824, s71
    v_add_f32 v40, v40, v37
    v_cvt_pk_bf16_f32 v194, v36, v37
    v_mfma_f32_16x16x32_bf16 v[168:171], a[132:135], v[88:91], v[168:171]
    s_lshl_b32 s71, s75, 13
    v_exp_f32 v39, v135
    v_mfma_f32_16x16x32_bf16 v[168:171], a[128:131], v[72:75], v[168:171]
    s_add_u32 s71, s71, s92
    ds_read_b128 a[176:179], v4 offset:12288
    v_add_f32 v40, v40, v38
    v_mfma_f32_16x16x32_bf16 v[176:179], a[128:131], v[68:71], v[56:59]
    s_cmp_ge_u32 s75, 31
    v_exp_f32 v32, v136
    v_mfma_f32_16x16x32_bf16 v[176:179], a[132:135], v[84:87], v[176:179]
    s_cselect_b32 s81, s71, s99
    v_add_f32 v40, v40, v39
    v_cvt_pk_bf16_f32 v195, v38, v39
    v_mfma_f32_16x16x32_bf16 v[176:179], a[136:139], v[100:103], v[176:179]
    v_exp_f32 v33, v137
    v_mfma_f32_16x16x32_bf16 v[176:179], a[140:143], v[116:119], v[176:179]
    buffer_load_dwordx4 v2, s[48:51], s82 offen offset:0 sc1 lds
    v_mfma_f32_16x16x32_bf16 v[180:183], a[156:159], v[116:119], v[56:59]
    v_exp_f32 v34, v138
    v_mfma_f32_16x16x32_bf16 v[180:183], a[152:155], v[100:103], v[180:183]
    ds_read_b128 a[180:183], v4 offset:13312
    v_cvt_pk_bf16_f32 v196, v32, v33
    v_mfma_f32_16x16x32_bf16 v[180:183], a[148:151], v[84:87], v[180:183]
    v_exp_f32 v35, v139
    v_mfma_f32_16x16x32_bf16 v[180:183], a[144:147], v[68:71], v[180:183]
    buffer_load_dwordx4 v2, s[48:51], s82 offen offset:1024 sc1 lds
    v_mfma_f32_16x16x32_bf16 v[188:191], a[144:147], v[64:67], v[60:63]
    v_exp_f32 v36, v140
    v_mfma_f32_16x16x32_bf16 v[188:191], a[148:151], v[80:83], v[188:191]
    s_cmp_eq_u32 s75, s78
    ds_read_b128 a[184:187], v4 offset:14336
    ds_read_b128 a[188:191], v4 offset:15360
    v_cvt_pk_bf16_f32 v197, v34, v35
    v_mfma_f32_16x16x32_bf16 v[188:191], a[152:155], v[96:99], v[188:191]
    s_cbranch_scc1 L_ffy_m
L_ffy_mr:
    v_exp_f32 v37, v141
    v_mfma_f32_16x16x32_bf16 v[188:191], a[156:159], v[112:115], v[188:191]
    buffer_load_dwordx4 v2, s[48:51], s82 offen offset:2048 sc1 lds
    v_mfma_f32_16x16x32_bf16 v[184:187], a[140:143], v[112:115], v[60:63]
    v_exp_f32 v38, v142
    v_mfma_f32_16x16x32_bf16 v[184:187], a[136:139], v[96:99], v[184:187]
    v_cvt_pk_bf16_f32 v198, v36, v37
    v_mfma_f32_16x16x32_bf16 v[184:187], a[132:135], v[80:83], v[184:187]
    s_waitcnt lgkmcnt(0)
    v_exp_f32 v39, v143
    v_mfma_f32_16x16x32_bf16 v[184:187], a[128:131], v[64:67], v[184:187]
    buffer_load_dwordx4 v2, s[48:51], s82 offen offset:3072 sc1 lds
    v_mfma_f32_16x16x32_bf16 a[64:67], a[160:163], v[200:203], 0
    s_waitcnt vmcnt(17)
    s_barrier
    v_cvt_pk_bf16_f32 v199, v38, v39
    v_exp_f32 v32, v160
    v_mfma_f32_16x16x32_bf16 a[68:71], a[164:167], v[200:203], 0
    s_xor_b32 m0, s80, 65536
    buffer_load_dword v30, v8, s[36:39], s94 offen
    v_exp_f32 v33, v161
    v_mfma_f32_16x16x32_bf16 a[72:75], a[168:171], v[200:203], 0
    s_add_u32 s75, s75, 1
    v_exp_f32 v34, v162
    v_add_f32 v40, v40, v32
    v_mfma_f32_16x16x32_bf16 a[76:79], a[172:175], v[200:203], 0
    s_cmp_eq_u32 s3, 0
    ds_read_b128 a[128:131], v4 offset:16384
    v_exp_f32 v35, v163
    v_add_f32 v40, v40, v33
    v_cvt_pk_bf16_f32 v208, v32, v33
    v_mfma_f32_16x16x32_bf16 a[80:83], a[176:179], v[200:203], 0
    s_cselect_b32 s71, s98, 4294934528
    ds_read_b128 a[132:135], v4 offset:17408
    v_exp_f32 v36, v164
    v_add_f32 v40, v40, v34
    v_mfma_f32_16x16x32_bf16 a[84:87], a[180:183], v[200:203], 0
    s_add_u32 s71, s71, s99
    ds_read_b128 a[136:139], v4 offset:18432
    v_exp_f32 v37, v165
    v_add_f32 v40, v40, v35
    v_cvt_pk_bf16_f32 v209, v34, v35
    v_mfma_f32_16x16x32_bf16 a[88:91], a[184:187], v[200:203], 0
    s_cmp_lt_i32 s3, 0
    ds_read_b128 a[140:143], v4 offset:19456
    v_exp_f32 v38, v166
    v_add_f32 v40, v40, v36
    v_mfma_f32_16x16x32_bf16 a[92:95], a[188:191], v[200:203], 0
    s_cselect_b32 s82, 1073741824, s71
    ds_read_b128 a[156:159], v4 offset:23552
    v_exp_f32 v39, v167
    v_add_f32 v40, v40, v37
    v_cvt_pk_bf16_f32 v210, v36, v37
    v_mfma_f32_16x16x32_bf16 a[124:127], a[188:191], v[204:207], 0
    ds_read_b128 a[152:155], v4 offset:22528
    v_exp_f32 v32, v168
    v_add_f32 v40, v40, v38
    v_mfma_f32_16x16x32_bf16 a[120:123], a[184:187], v[204:207], 0
    s_sub_u32 s69, s75, 1
    ds_read_b128 a[148:151], v4 offset:21504
    v_exp_f32 v33, v169
    v_add_f32 v40, v40, v39
    v_cvt_pk_bf16_f32 v211, v38, v39
    v_mfma_f32_16x16x32_bf16 a[116:119], a[180:183], v[204:207], 0
    s_cmp_eq_u32 s69, s78
    ds_read_b128 a[144:147], v4 offset:20480
    v_exp_f32 v34, v170
    v_mfma_f32_16x16x32_bf16 a[112:115], a[176:179], v[204:207], 0
    s_cbranch_scc1 L_ff_m
L_ff_mr:
    v_exp_f32 v35, v171
    v_cvt_pk_bf16_f32 v212, v32, v33
    v_mfma_f32_16x16x32_bf16 a[108:111], a[172:175], v[204:207], 0
    buffer_load_dwordx4 v2, s[48:51], s81 offen offset:0 sc1 lds
    v_exp_f32 v36, v172
    v_mfma_f32_16x16x32_bf16 a[104:107], a[168:171], v[204:207], 0
    buffer_load_dwordx4 v2, s[48:51], s81 offen offset:1024 sc1 lds
    v_exp_f32 v37, v173
    v_cvt_pk_bf16_f32 v213, v34, v35
    v_mfma_f32_16x16x32_bf16 a[100:103], a[164:167], v[204:207], 0
    buffer_load_dwordx4 v2, s[48:51], s81 offen offset:2048 sc1 lds
    v_exp_f32 v38, v174
    v_mfma_f32_16x16x32_bf16 a[96:99], a[160:163], v[204:207], 0
    s_add_u32 s94, s94, 256
    buffer_load_dwordx4 v2, s[48:51], s81 offen offset:3072 sc1 lds
    v_exp_f32 v39, v175
    v_cvt_pk_bf16_f32 v214, v36, v37
    s_waitcnt lgkmcnt(0)
    s_cmp_eq_u32 s75, s43
    s_cbranch_scc1 L_short
    v_mfma_f32_16x16x32_bf16 v[144:147], a[128:131], v[68:71], v[56:59]
    v_exp_f32 v32, v176
    v_mfma_f32_16x16x32_bf16 v[144:147], a[132:135], v[84:87], v[144:147]
    v_cvt_pk_bf16_f32 v215, v38, v39
    v_mfma_f32_16x16x32_bf16 v[144:147], a[136:139], v[100:103], v[144:147]
    s_waitcnt lgkmcnt(0)
    v_exp_f32 v33, v177
    v_mfma_f32_16x16x32_bf16 v[144:147], a[140:143], v[116:119], v[144:147]
    s_xor_b32 m0, s80, 0
    ds_read_b128 a[192:195], v4 offset:24576
    ds_read_b128 a[196:199], v4 offset:25600
    v_mfma_f32_16x16x32_bf16 v[252:255], a[224:227], v[196:199], 0
    buffer_load_dwordx4 v2, s[48:51], s82 offen offset:0 sc1 lds
    v_exp_f32 v34, v178
    v_mfma_f32_16x16x32_bf16 v[252:255], a[224:227], v[212:215], v[252:255]
    v_add_f32 v42, v32, v33
    v_cvt_pk_bf16_f32 v216, v32, v33
    v_mfma_f32_16x16x32_bf16 v[148:151], a[156:159], v[116:119], v[56:59]
    v_exp_f32 v35, v179
    v_mfma_f32_16x16x32_bf16 v[148:151], a[152:155], v[100:103], v[148:151]
    ds_read_b128 a[200:203], v4 offset:26624
    v_add_f32 v42, v42, v34
    v_mfma_f32_16x16x32_bf16 v[148:151], a[148:151], v[84:87], v[148:151]
    v_exp_f32 v36, v180
    v_mfma_f32_16x16x32_bf16 v[148:151], a[144:147], v[68:71], v[148:151]
    v_add_f32 v42, v42, v35
    v_cvt_pk_bf16_f32 v217, v34, v35
    v_mfma_f32_16x16x32_bf16 v[156:159], a[144:147], v[64:67], v[60:63]
    v_exp_f32 v37, v181
    v_mfma_f32_16x16x32_bf16 v[156:159], a[148:151], v[80:83], v[156:159]
    v_add_f32 v42, v42, v36
    v_max_f32 v224, v40, v252
    v_mfma_f32_16x16x32_bf16 v[156:159], a[152:155], v[96:99], v[156:159]
    v_exp_f32 v38, v182
    v_mfma_f32_16x16x32_bf16 v[156:159], a[156:159], v[112:115], v[156:159]
    v_add_f32 v42, v42, v37
    v_cvt_pk_bf16_f32 v218, v36, v37
    v_mfma_f32_16x16x32_bf16 v[152:155], a[140:143], v[112:115], v[60:63]
    v_exp_f32 v39, v183
    v_mfma_f32_16x16x32_bf16 v[152:155], a[136:139], v[96:99], v[152:155]
    v_add_f32 v42, v42, v38
    v_cmp_lt_f32 vcc, v6, v224
    v_mfma_f32_16x16x32_bf16 v[152:155], a[132:135], v[80:83], v[152:155]
    s_cbranch_vccnz L_sc_s
L_sc_sr:
    v_exp_f32 v32, v184
    v_mfma_f32_16x16x32_bf16 v[152:155], a[128:131], v[64:67], v[152:155]
    s_add_u32 s69, s75, s95
    v_add_f32 v42, v42, v39
    v_cvt_pk_bf16_f32 v219, v38, v39
    v_mfma_f32_16x16x32_bf16 v[128:131], a[128:131], v[76:79], v[48:51]
    s_lshr_b32 s3, s69, 1
    v_exp_f32 v33, v185
    v_mfma_f32_16x16x32_bf16 v[128:131], a[132:135], v[92:95], v[128:131]
    s_sub_i32 s3, s3, s83
    ds_read_b128 a[204:207], v4 offset:27648
    ds_read_b128 a[208:211], v4 offset:28672
    v_mfma_f32_16x16x32_bf16 v[128:131], a[136:139], v[108:111], v[128:131]
    s_max_i32 s71, s3, 0
    v_exp_f32 v34, v186
    v_mfma_f32_16x16x32_bf16 v[128:131], a[140:143], v[124:127], v[128:131]
    s_lshl_b32 s71, s71, 1
    ds_read_b128 a[212:215], v4 offset:29696
    v_cvt_pk_bf16_f32 v220, v32, v33
    v_mfma_f32_16x16x32_bf16 v[132:135], a[156:159], v[124:127], v[48:51]
    s_add_u32 s71, s71, s69
    v_exp_f32 v35, v187
    v_mfma_f32_16x16x32_bf16 v[132:135], a[152:155], v[108:111], v[132:135]
    s_lshl_b32 s71, s71, 14
    buffer_load_dwordx4 v2, s[48:51], s82 offen offset:1024 sc1 lds
    v_mfma_f32_16x16x32_bf16 v[132:135], a[148:151], v[92:95], v[132:135]
    s_add_u32 s71, s71, s89
    v_exp_f32 v36, v188
    v_mfma_f32_16x16x32_bf16 v[132:135], a[144:147], v[76:79], v[132:135]
    s_cmp_ge_u32 s69, 34
    ds_read_b128 a[216:219], v4 offset:30720
    v_cvt_pk_bf16_f32 v221, v34, v35
    v_mfma_f32_16x16x32_bf16 v[140:143], a[144:147], v[72:75], v[52:55]
    s_cselect_b32 s99, 1073741824, s71
    v_exp_f32 v37, v189
    v_mfma_f32_16x16x32_bf16 v[140:143], a[148:151], v[88:91], v[140:143]
    s_lshl_b32 s71, s75, 13
    buffer_load_dwordx4 v2, s[48:51], s82 offen offset:2048 sc1 lds
    v_mfma_f32_16x16x32_bf16 v[140:143], a[152:155], v[104:107], v[140:143]
    s_add_u32 s71, s71, s92
    v_exp_f32 v38, v190
    v_mfma_f32_16x16x32_bf16 v[140:143], a[156:159], v[120:123], v[140:143]
    s_cmp_ge_u32 s75, 31
    ds_read_b128 a[220:223], v4 offset:31744
    v_cvt_pk_bf16_f32 v222, v36, v37
    v_mfma_f32_16x16x32_bf16 v[136:139], a[140:143], v[120:123], v[52:55]
    s_cselect_b32 s81, s71, s99
    v_exp_f32 v39, v191
    v_mfma_f32_16x16x32_bf16 v[136:139], a[136:139], v[104:107], v[136:139]
    v_mfma_f32_16x16x32_bf16 v[136:139], a[132:135], v[88:91], v[136:139]
    buffer_load_dwordx4 v2, s[48:51], s82 offen offset:3072 sc1 lds
    v_mfma_f32_16x16x32_bf16 v[136:139], a[128:131], v[72:75], v[136:139]
    s_waitcnt lgkmcnt(0)
    v_cvt_pk_bf16_f32 v223, v38, v39
    v_add_f32 v44, v44, v40
    v_mfma_f32_16x16x32_bf16 a[0:3], a[160:163], v[192:195], 0
    s_waitcnt vmcnt(18)
    s_barrier
    v_exp_f32 v32, v144
    v_mfma_f32_16x16x32_bf16 a[0:3], a[192:195], v[208:211], a[0:3]
    s_xor_b32 s80, s80, 32768
    v_add_f32 v45, v45, v252
    v_xor_b32 v4, 32768, v4
    v_mfma_f32_16x16x32_bf16 a[4:7], a[196:199], v[208:211], 0
    s_xor_b32 m0, s80, 114688
    v_exp_f32 v33, v145
    v_mfma_f32_16x16x32_bf16 a[4:7], a[164:167], v[192:195], a[4:7]
    s_add_u32 s75, s75, 1
    ds_read_b128 a[128:131], v4 offset:0
    ds_read_b128 a[132:135], v4 offset:1024
    v_add_f32 v42, v42, v32
    v_mfma_f32_16x16x32_bf16 a[8:11], a[168:171], v[192:195], 0
    s_cmp_eq_u32 s3, 0
    v_exp_f32 v34, v146
    v_mfma_f32_16x16x32_bf16 a[8:11], a[200:203], v[208:211], a[8:11]
    s_cselect_b32 s71, s98, 4294934528
    v_add_f32 v42, v42, v33
    v_cvt_pk_bf16_f32 v200, v32, v33
    v_mfma_f32_16x16x32_bf16 a[12:15], a[204:207], v[208:211], 0
    s_add_u32 s71, s71, s99
    v_exp_f32 v35, v147
    v_mfma_f32_16x16x32_bf16 a[12:15], a[172:175], v[192:195], a[12:15]
    s_cmp_lt_i32 s3, 0
    ds_read_b128 a[136:139], v4 offset:2048
    v_add_f32 v42, v42, v34
    v_mfma_f32_16x16x32_bf16 a[16:19], a[176:179], v[192:195], 0
    s_cselect_b32 s82, 1073741824, s71
    v_exp_f32 v36, v148
    v_mfma_f32_16x16x32_bf16 a[16:19], a[208:211], v[208:211], a[16:19]
    v_add_f32 v42, v42, v35
    v_cvt_pk_bf16_f32 v201, v34, v35
    v_mfma_f32_16x16x32_bf16 a[20:23], a[212:215], v[208:211], 0
    buffer_atomic_add v9, v14, s[52:55], 0 offen sc1
    v_exp_f32 v37, v149
    v_mfma_f32_16x16x32_bf16 a[20:23], a[180:183], v[192:195], a[20:23]
    ds_read_b128 a[140:143], v4 offset:3072
    v_add_f32 v42, v42, v36
    v_mfma_f32_16x16x32_bf16 a[24:27], a[184:187], v[192:195], 0
    buffer_load_dword v30, v7, s[24:27], s93 offen
    v_exp_f32 v38, v150
    v_mfma_f32_16x16x32_bf16 a[24:27], a[216:219], v[208:211], a[24:27]
    v_add_f32 v42, v42, v37
    v_cvt_pk_bf16_f32 v202, v36, v37
    v_mfma_f32_16x16x32_bf16 a[28:31], a[220:223], v[208:211], 0
    v_exp_f32 v39, v151
    v_mfma_f32_16x16x32_bf16 a[28:31], a[188:191], v[192:195], a[28:31]
    ds_read_b128 a[156:159], v4 offset:7168
    v_add_f32 v42, v42, v38
    v_mfma_f32_16x16x32_bf16 a[60:63], a[188:191], v[196:199], 0
    v_exp_f32 v32, v152
    v_mfma_f32_16x16x32_bf16 a[60:63], a[220:223], v[212:215], a[60:63]
    v_add_f32 v42, v42, v39
    v_cvt_pk_bf16_f32 v203, v38, v39
    v_mfma_f32_16x16x32_bf16 a[56:59], a[216:219], v[212:215], 0
    v_exp_f32 v33, v153
    v_mfma_f32_16x16x32_bf16 a[56:59], a[184:187], v[196:199], a[56:59]
    buffer_load_dwordx4 v2, s[48:51], s81 offen offset:0 sc1 lds
    v_mfma_f32_16x16x32_bf16 a[52:55], a[180:183], v[196:199], 0
    v_exp_f32 v34, v154
    v_mfma_f32_16x16x32_bf16 a[52:55], a[212:215], v[212:215], a[52:55]
    ds_read_b128 a[152:155], v4 offset:6144
    v_cvt_pk_bf16_f32 v204, v32, v33
    v_mfma_f32_16x16x32_bf16 a[48:51], a[208:211], v[212:215], 0
    v_exp_f32 v35, v155
    v_mfma_f32_16x16x32_bf16 a[48:51], a[176:179], v[196:199], a[48:51]
    buffer_load_dwordx4 v2, s[48:51], s81 offen offset:1024 sc1 lds
    v_mfma_f32_16x16x32_bf16 a[44:47], a[172:175], v[196:199], 0
    v_exp_f32 v36, v156
    v_mfma_f32_16x16x32_bf16 a[44:47], a[204:207], v[212:215], a[44:47]
    ds_read_b128 a[148:151], v4 offset:5120
    v_cvt_pk_bf16_f32 v205, v34, v35
    v_mfma_f32_16x16x32_bf16 a[40:43], a[200:203], v[212:215], 0
    v_exp_f32 v37, v157
    v_mfma_f32_16x16x32_bf16 a[40:43], a[168:171], v[196:199], a[40:43]
    buffer_load_dwordx4 v2, s[48:51], s81 offen offset:2048 sc1 lds
    v_mfma_f32_16x16x32_bf16 a[36:39], a[164:167], v[196:199], 0
    v_exp_f32 v38, v158
    v_mfma_f32_16x16x32_bf16 a[36:39], a[196:199], v[212:215], a[36:39]
    s_add_u32 s93, s93, 512
    ds_read_b128 a[144:147], v4 offset:4096
    v_cvt_pk_bf16_f32 v206, v36, v37
    v_mfma_f32_16x16x32_bf16 a[32:35], a[192:195], v[212:215], 0
    v_exp_f32 v39, v159
    v_mfma_f32_16x16x32_bf16 a[32:35], a[160:163], v[196:199], a[32:35]
    s_waitcnt lgkmcnt(1)
    buffer_load_dwordx4 v2, s[48:51], s81 offen offset:3072 sc1 lds
    s_cmp_ge_u32 s75, s79
    s_cbranch_scc1 L_later1
    s_branch L_both1
.p2align 4
L_both:
    v_mfma_f32_16x16x32_bf16 v[144:147], a[128:131], v[68:71], v[56:59]
    v_exp_f32 v32, v176
    v_mfma_f32_16x16x32_bf16 v[144:147], a[132:135], v[84:87], v[144:147]
    v_cvt_pk_bf16_f32 v215, v38, v39
    v_mfma_f32_16x16x32_bf16 v[144:147], a[136:139], v[100:103], v[144:147]
    s_waitcnt lgkmcnt(0)
    v_exp_f32 v33, v177
    v_mfma_f32_16x16x32_bf16 v[144:147], a[140:143], v[116:119], v[144:147]
    ds_read_b128 a[192:195], v4 offset:24576
    ds_read_b128 a[196:199], v4 offset:25600
    v_mfma_f32_16x16x32_bf16 v[252:255], a[224:227], v[196:199], 0
    v_exp_f32 v34, v178
    v_mfma_f32_16x16x32_bf16 v[252:255], a[224:227], v[212:215], v[252:255]
    v_add_f32 v42, v32, v33
    v_cvt_pk_bf16_f32 v216, v32, v33
    v_mfma_f32_16x16x32_bf16 v[148:151], a[156:159], v[116:119], v[56:59]
    v_exp_f32 v35, v179
    v_mfma_f32_16x16x32_bf16 v[148:151], a[152:155], v[100:103], v[148:151]
    ds_read_b128 a[200:203], v4 offset:26624
    v_add_f32 v42, v42, v34
    v_mfma_f32_16x16x32_bf16 v[148:151], a[148:151], v[84:87], v[148:151]
    v_exp_f32 v36, v180
    v_mfma_f32_16x16x32_bf16 v[148:151], a[144:147], v[68:71], v[148:151]
    v_add_f32 v42, v42, v35
    v_cvt_pk_bf16_f32 v217, v34, v35
    v_mfma_f32_16x16x32_bf16 v[156:159], a[144:147], v[64:67], v[60:63]
    v_exp_f32 v37, v181
    v_mfma_f32_16x16x32_bf16 v[156:159], a[148:151], v[80:83], v[156:159]
    v_add_f32 v42, v42, v36
    v_max_f32 v224, v40, v252
    v_mfma_f32_16x16x32_bf16 v[156:159], a[152:155], v[96:99], v[156:159]
    v_exp_f32 v38, v182
    v_mfma_f32_16x16x32_bf16 v[156:159], a[156:159], v[112:115], v[156:159]
    v_add_f32 v42, v42, v37
    v_cvt_pk_bf16_f32 v218, v36, v37
    v_mfma_f32_16x16x32_bf16 v[152:155], a[140:143], v[112:115], v[60:63]
    v_exp_f32 v39, v183
    v_mfma_f32_16x16x32_bf16 v[152:155], a[136:139], v[96:99], v[152:155]
    v_add_f32 v42, v42, v38
    v_cmp_lt_f32 vcc, v6, v224
    v_mfma_f32_16x16x32_bf16 v[152:155], a[132:135], v[80:83], v[152:155]
    s_cbranch_vccnz L_b0_s
L_b0_sr:
    v_exp_f32 v32, v184
    v_mfma_f32_16x16x32_bf16 v[152:155], a[128:131], v[64:67], v[152:155]
    s_add_u32 s69, s75, s95
    v_add_f32 v42, v42, v39
    v_cvt_pk_bf16_f32 v219, v38, v39
    v_mfma_f32_16x16x32_bf16 v[128:131], a[128:131], v[76:79], v[48:51]
    s_lshr_b32 s3, s69, 1
    v_exp_f32 v33, v185
    v_mfma_f32_16x16x32_bf16 v[128:131], a[132:135], v[92:95], v[128:131]
    s_sub_i32 s3, s3, s83
    ds_read_b128 a[204:207], v4 offset:27648
    ds_read_b128 a[208:211], v4 offset:28672
    v_mfma_f32_16x16x32_bf16 v[128:131], a[136:139], v[108:111], v[128:131]
    s_max_i32 s71, s3, 0
    v_exp_f32 v34, v186
    v_mfma_f32_16x16x32_bf16 v[128:131], a[140:143], v[124:127], v[128:131]
    s_lshl_b32 s71, s71, 1
    ds_read_b128 a[212:215], v4 offset:29696
    v_cvt_pk_bf16_f32 v220, v32, v33
    v_mfma_f32_16x16x32_bf16 v[132:135], a[156:159], v[124:127], v[48:51]
    s_add_u32 s71, s71, s69
    v_exp_f32 v35, v187
    v_mfma_f32_16x16x32_bf16 v[132:135], a[152:155], v[108:111], v[132:135]
    s_lshl_b32 s71, s71, 14
    ds_read_b128 a[216:219], v4 offset:30720
    ds_read_b128 a[220:223], v4 offset:31744
    v_mfma_f32_16x16x32_bf16 v[132:135], a[148:151], v[92:95], v[132:135]
    s_add_u32 s81, s71, s89
    v_exp_f32 v36, v188
    v_mfma_f32_16x16x32_bf16 v[132:135], a[144:147], v[76:79], v[132:135]
    v_cvt_pk_bf16_f32 v221, v34, v35
    v_mfma_f32_16x16x32_bf16 v[140:143], a[144:147], v[72:75], v[52:55]
    v_exp_f32 v37, v189
    v_mfma_f32_16x16x32_bf16 v[140:143], a[148:151], v[88:91], v[140:143]
    v_mfma_f32_16x16x32_bf16 v[140:143], a[152:155], v[104:107], v[140:143]
    v_exp_f32 v38, v190
    v_mfma_f32_16x16x32_bf16 v[140:143], a[156:159], v[120:123], v[140:143]
    v_cvt_pk_bf16_f32 v222, v36, v37
    v_mfma_f32_16x16x32_bf16 v[136:139], a[140:143], v[120:123], v[52:55]
    v_exp_f32 v39, v191
    v_mfma_f32_16x16x32_bf16 v[136:139], a[136:139], v[104:107], v[136:139]
    v_mfma_f32_16x16x32_bf16 v[136:139], a[132:135], v[88:91], v[136:139]
    v_mfma_f32_16x16x32_bf16 v[136:139], a[128:131], v[72:75], v[136:139]
    s_waitcnt lgkmcnt(0)
    v_cvt_pk_bf16_f32 v223, v38, v39
    v_add_f32 v44, v44, v40
    v_mfma_f32_16x16x32_bf16 a[0:3], a[160:163], v[192:195], a[0:3]
    s_waitcnt vmcnt(10)
    s_barrier
    v_exp_f32 v32, v144
    v_mfma_f32_16x16x32_bf16 a[0:3], a[192:195], v[208:211], a[0:3]
    s_xor_b32 s80, s80, 32768
    v_add_f32 v45, v45, v252
    v_xor_b32 v4, 32768, v4
    v_mfma_f32_16x16x32_bf16 a[4:7], a[196:199], v[208:211], a[4:7]
    s_xor_b32 m0, s80, 114688
    v_exp_f32 v33, v145
    v_mfma_f32_16x16x32_bf16 a[4:7], a[164:167], v[192:195], a[4:7]
    s_add_u32 s75, s75, 1
    ds_read_b128 a[128:131], v4 offset:0
    ds_read_b128 a[132:135], v4 offset:1024
    v_add_f32 v42, v42, v32
    v_mfma_f32_16x16x32_bf16 a[8:11], a[168:171], v[192:195], a[8:11]
    v_exp_f32 v34, v146
    v_mfma_f32_16x16x32_bf16 a[8:11], a[200:203], v[208:211], a[8:11]
    v_add_f32 v42, v42, v33
    v_cvt_pk_bf16_f32 v200, v32, v33
    v_mfma_f32_16x16x32_bf16 a[12:15], a[204:207], v[208:211], a[12:15]
    v_exp_f32 v35, v147
    v_mfma_f32_16x16x32_bf16 a[12:15], a[172:175], v[192:195], a[12:15]
    ds_read_b128 a[136:139], v4 offset:2048
    v_add_f32 v42, v42, v34
    v_mfma_f32_16x16x32_bf16 a[16:19], a[176:179], v[192:195], a[16:19]
    v_exp_f32 v36, v148
    v_mfma_f32_16x16x32_bf16 a[16:19], a[208:211], v[208:211], a[16:19]
    v_add_f32 v42, v42, v35
    v_cvt_pk_bf16_f32 v201, v34, v35
    v_mfma_f32_16x16x32_bf16 a[20:23], a[212:215], v[208:211], a[20:23]
    v_exp_f32 v37, v149
    v_mfma_f32_16x16x32_bf16 a[20:23], a[180:183], v[192:195], a[20:23]
    ds_read_b128 a[140:143], v4 offset:3072
    v_add_f32 v42, v42, v36
    v_mfma_f32_16x16x32_bf16 a[24:27], a[184:187], v[192:195], a[24:27]
    buffer_load_dword v30, v7, s[24:27], s93 offen
    v_exp_f32 v38, v150
    v_mfma_f32_16x16x32_bf16 a[24:27], a[216:219], v[208:211], a[24:27]
    v_add_f32 v42, v42, v37
    v_cvt_pk_bf16_f32 v202, v36, v37
    v_mfma_f32_16x16x32_bf16 a[28:31], a[220:223], v[208:211], a[28:31]
    v_exp_f32 v39, v151
    v_mfma_f32_16x16x32_bf16 a[28:31], a[188:191], v[192:195], a[28:31]
    ds_read_b128 a[156:159], v4 offset:7168
    v_add_f32 v42, v42, v38
    v_mfma_f32_16x16x32_bf16 a[60:63], a[188:191], v[196:199], a[60:63]
    v_exp_f32 v32, v152
    v_mfma_f32_16x16x32_bf16 a[60:63], a[220:223], v[212:215], a[60:63]
    v_add_f32 v42, v42, v39
    v_cvt_pk_bf16_f32 v203, v38, v39
    v_mfma_f32_16x16x32_bf16 a[56:59], a[216:219], v[212:215], a[56:59]
    v_exp_f32 v33, v153
    v_mfma_f32_16x16x32_bf16 a[56:59], a[184:187], v[196:199], a[56:59]
    buffer_load_dwordx4 v2, s[48:51], s81 offen offset:0 sc1 lds
    v_mfma_f32_16x16x32_bf16 a[52:55], a[180:183], v[196:199], a[52:55]
    v_exp_f32 v34, v154
    v_mfma_f32_16x16x32_bf16 a[52:55], a[212:215], v[212:215], a[52:55]
    ds_read_b128 a[152:155], v4 offset:6144
    v_cvt_pk_bf16_f32 v204, v32, v33
    v_mfma_f32_16x16x32_bf16 a[48:51], a[208:211], v[212:215], a[48:51]
    v_exp_f32 v35, v155
    v_mfma_f32_16x16x32_bf16 a[48:51], a[176:179], v[196:199], a[48:51]
    buffer_load_dwordx4 v2, s[48:51], s81 offen offset:1024 sc1 lds
    v_mfma_f32_16x16x32_bf16 a[44:47], a[172:175], v[196:199], a[44:47]
    v_exp_f32 v36, v156
    v_mfma_f32_16x16x32_bf16 a[44:47], a[204:207], v[212:215], a[44:47]
    ds_read_b128 a[148:151], v4 offset:5120
    v_cvt_pk_bf16_f32 v205, v34, v35
    v_mfma_f32_16x16x32_bf16 a[40:43], a[200:203], v[212:215], a[40:43]
    v_exp_f32 v37, v157
    v_mfma_f32_16x16x32_bf16 a[40:43], a[168:171], v[196:199], a[40:43]
    buffer_load_dwordx4 v2, s[48:51], s81 offen offset:2048 sc1 lds
    v_mfma_f32_16x16x32_bf16 a[36:39], a[164:167], v[196:199], a[36:39]
    v_exp_f32 v38, v158
    v_mfma_f32_16x16x32_bf16 a[36:39], a[196:199], v[212:215], a[36:39]
    s_add_u32 s93, s93, 512
    ds_read_b128 a[144:147], v4 offset:4096
    v_cvt_pk_bf16_f32 v206, v36, v37
    v_mfma_f32_16x16x32_bf16 a[32:35], a[192:195], v[212:215], a[32:35]
    v_exp_f32 v39, v159
    v_mfma_f32_16x16x32_bf16 a[32:35], a[160:163], v[196:199], a[32:35]
    s_waitcnt lgkmcnt(1)
    buffer_load_dwordx4 v2, s[48:51], s81 offen offset:3072 sc1 lds
L_both1:
    v_mfma_f32_16x16x32_bf16 v[160:163], a[128:131], v[76:79], v[48:51]
    v_exp_f32 v32, v128
    v_mfma_f32_16x16x32_bf16 v[160:163], a[132:135], v[92:95], v[160:163]
    v_cvt_pk_bf16_f32 v207, v38, v39
    v_mfma_f32_16x16x32_bf16 v[160:163], a[136:139], v[108:111], v[160:163]
    s_waitcnt lgkmcnt(0)
    v_exp_f32 v33, v129
    v_mfma_f32_16x16x32_bf16 v[160:163], a[140:143], v[124:127], v[160:163]
    ds_read_b128 a[160:163], v4 offset:8192
    ds_read_b128 a[164:167], v4 offset:9216
    v_mfma_f32_16x16x32_bf16 v[252:255], a[224:227], v[204:207], 0
    v_exp_f32 v34, v130
    v_mfma_f32_16x16x32_bf16 v[252:255], a[224:227], v[220:223], v[252:255]
    v_add_f32 v40, v32, v33
    v_cvt_pk_bf16_f32 v192, v32, v33
    v_mfma_f32_16x16x32_bf16 v[164:167], a[156:159], v[124:127], v[48:51]
    v_exp_f32 v35, v131
    v_mfma_f32_16x16x32_bf16 v[164:167], a[152:155], v[108:111], v[164:167]
    ds_read_b128 a[168:171], v4 offset:10240
    v_add_f32 v40, v40, v34
    v_mfma_f32_16x16x32_bf16 v[164:167], a[148:151], v[92:95], v[164:167]
    v_exp_f32 v36, v132
    v_mfma_f32_16x16x32_bf16 v[164:167], a[144:147], v[76:79], v[164:167]
    v_add_f32 v40, v40, v35
    v_cvt_pk_bf16_f32 v193, v34, v35
    v_mfma_f32_16x16x32_bf16 v[172:175], a[144:147], v[72:75], v[52:55]
    v_exp_f32 v37, v133
    v_mfma_f32_16x16x32_bf16 v[172:175], a[148:151], v[88:91], v[172:175]
    v_add_f32 v40, v40, v36
    v_max_f32 v224, v42, v252
    v_mfma_f32_16x16x32_bf16 v[172:175], a[152:155], v[104:107], v[172:175]
    v_exp_f32 v38, v134
    v_mfma_f32_16x16x32_bf16 v[172:175], a[156:159], v[120:123], v[172:175]
    v_add_f32 v40, v40, v37
    v_cvt_pk_bf16_f32 v194, v36, v37
    v_mfma_f32_16x16x32_bf16 v[168:171], a[140:143], v[120:123], v[52:55]
    v_exp_f32 v39, v135
    v_mfma_f32_16x16x32_bf16 v[168:171], a[136:139], v[104:107], v[168:171]
    v_add_f32 v40, v40, v38
    v_cmp_lt_f32 vcc, v6, v224
    v_mfma_f32_16x16x32_bf16 v[168:171], a[132:135], v[88:91], v[168:171]
    s_cbranch_vccnz L_b1_s
L_b1_sr:
    v_exp_f32 v32, v136
    v_mfma_f32_16x16x32_bf16 v[168:171], a[128:131], v[72:75], v[168:171]
    s_add_u32 s69, s75, s95
    v_add_f32 v40, v40, v39
    v_cvt_pk_bf16_f32 v195, v38, v39
    v_mfma_f32_16x16x32_bf16 v[176:179], a[128:131], v[68:71], v[56:59]
    s_lshr_b32 s3, s69, 1
    v_exp_f32 v33, v137
    v_mfma_f32_16x16x32_bf16 v[176:179], a[132:135], v[84:87], v[176:179]
    s_sub_i32 s3, s3, s83
    ds_read_b128 a[172:175], v4 offset:11264
    ds_read_b128 a[176:179], v4 offset:12288
    v_mfma_f32_16x16x32_bf16 v[176:179], a[136:139], v[100:103], v[176:179]
    s_max_i32 s71, s3, 0
    v_exp_f32 v34, v138
    v_mfma_f32_16x16x32_bf16 v[176:179], a[140:143], v[116:119], v[176:179]
    s_lshl_b32 s71, s71, 1
    ds_read_b128 a[180:183], v4 offset:13312
    v_cvt_pk_bf16_f32 v196, v32, v33
    v_mfma_f32_16x16x32_bf16 v[180:183], a[156:159], v[116:119], v[56:59]
    s_add_u32 s71, s71, s69
    v_exp_f32 v35, v139
    v_mfma_f32_16x16x32_bf16 v[180:183], a[152:155], v[100:103], v[180:183]
    s_lshl_b32 s71, s71, 14
    ds_read_b128 a[184:187], v4 offset:14336
    ds_read_b128 a[188:191], v4 offset:15360
    v_mfma_f32_16x16x32_bf16 v[180:183], a[148:151], v[84:87], v[180:183]
    s_add_u32 s81, s71, s89
    v_exp_f32 v36, v140
    v_mfma_f32_16x16x32_bf16 v[180:183], a[144:147], v[68:71], v[180:183]
    v_cvt_pk_bf16_f32 v197, v34, v35
    v_mfma_f32_16x16x32_bf16 v[188:191], a[144:147], v[64:67], v[60:63]
    v_exp_f32 v37, v141
    v_mfma_f32_16x16x32_bf16 v[188:191], a[148:151], v[80:83], v[188:191]
    v_mfma_f32_16x16x32_bf16 v[188:191], a[152:155], v[96:99], v[188:191]
    v_exp_f32 v38, v142
    v_mfma_f32_16x16x32_bf16 v[188:191], a[156:159], v[112:115], v[188:191]
    v_cvt_pk_bf16_f32 v198, v36, v37
    v_mfma_f32_16x16x32_bf16 v[184:187], a[140:143], v[112:115], v[60:63]
    v_exp_f32 v39, v143
    v_mfma_f32_16x16x32_bf16 v[184:187], a[136:139], v[96:99], v[184:187]
    v_mfma_f32_16x16x32_bf16 v[184:187], a[132:135], v[80:83], v[184:187]
    v_mfma_f32_16x16x32_bf16 v[184:187], a[128:131], v[64:67], v[184:187]
    s_waitcnt lgkmcnt(0)
    v_cvt_pk_bf16_f32 v199, v38, v39
    v_add_f32 v46, v46, v42
    v_mfma_f32_16x16x32_bf16 a[64:67], a[192:195], v[216:219], a[64:67]
    s_waitcnt vmcnt(10)
    s_barrier
    v_exp_f32 v32, v160
    v_mfma_f32_16x16x32_bf16 a[64:67], a[160:163], v[200:203], a[64:67]
    s_xor_b32 m0, s80, 65536
    ds_read_b128 a[128:131], v4 offset:16384
    v_add_f32 v47, v47, v252
    v_mfma_f32_16x16x32_bf16 a[68:71], a[164:167], v[200:203], a[68:71]
    s_add_u32 s75, s75, 1
    v_exp_f32 v33, v161
    v_mfma_f32_16x16x32_bf16 a[68:71], a[196:199], v[216:219], a[68:71]
    ds_read_b128 a[132:135], v4 offset:17408
    v_add_f32 v40, v40, v32
    v_mfma_f32_16x16x32_bf16 a[72:75], a[200:203], v[216:219], a[72:75]
    v_exp_f32 v34, v162
    v_mfma_f32_16x16x32_bf16 a[72:75], a[168:171], v[200:203], a[72:75]
    v_add_f32 v40, v40, v33
    v_cvt_pk_bf16_f32 v208, v32, v33
    v_mfma_f32_16x16x32_bf16 a[76:79], a[172:175], v[200:203], a[76:79]
    v_exp_f32 v35, v163
    v_mfma_f32_16x16x32_bf16 a[76:79], a[204:207], v[216:219], a[76:79]
    ds_read_b128 a[136:139], v4 offset:18432
    v_add_f32 v40, v40, v34
    v_mfma_f32_16x16x32_bf16 a[80:83], a[208:211], v[216:219], a[80:83]
    v_exp_f32 v36, v164
    v_mfma_f32_16x16x32_bf16 a[80:83], a[176:179], v[200:203], a[80:83]
    v_add_f32 v40, v40, v35
    v_cvt_pk_bf16_f32 v209, v34, v35
    v_mfma_f32_16x16x32_bf16 a[84:87], a[180:183], v[200:203], a[84:87]
    v_exp_f32 v37, v165
    v_mfma_f32_16x16x32_bf16 a[84:87], a[212:215], v[216:219], a[84:87]
    ds_read_b128 a[140:143], v4 offset:19456
    v_add_f32 v40, v40, v36
    v_mfma_f32_16x16x32_bf16 a[88:91], a[216:219], v[216:219], a[88:91]
    buffer_load_dword v30, v8, s[36:39], s94 offen
    v_exp_f32 v38, v166
    v_mfma_f32_16x16x32_bf16 a[88:91], a[184:187], v[200:203], a[88:91]
    v_add_f32 v40, v40, v37
    v_cvt_pk_bf16_f32 v210, v36, v37
    v_mfma_f32_16x16x32_bf16 a[92:95], a[188:191], v[200:203], a[92:95]
    v_exp_f32 v39, v167
    v_mfma_f32_16x16x32_bf16 a[92:95], a[220:223], v[216:219], a[92:95]
    ds_read_b128 a[156:159], v4 offset:23552
    v_add_f32 v40, v40, v38
    v_mfma_f32_16x16x32_bf16 a[124:127], a[220:223], v[220:223], a[124:127]
    v_exp_f32 v32, v168
    v_mfma_f32_16x16x32_bf16 a[124:127], a[188:191], v[204:207], a[124:127]
    v_add_f32 v40, v40, v39
    v_cvt_pk_bf16_f32 v211, v38, v39
    v_mfma_f32_16x16x32_bf16 a[120:123], a[184:187], v[204:207], a[120:123]
    v_exp_f32 v33, v169
    v_mfma_f32_16x16x32_bf16 a[120:123], a[216:219], v[220:223], a[120:123]
    buffer_load_dwordx4 v2, s[48:51], s81 offen offset:0 sc1 lds
    v_mfma_f32_16x16x32_bf16 a[116:119], a[212:215], v[220:223], a[116:119]
    v_exp_f32 v34, v170
    v_mfma_f32_16x16x32_bf16 a[116:119], a[180:183], v[204:207], a[116:119]
    ds_read_b128 a[152:155], v4 offset:22528
    v_cvt_pk_bf16_f32 v212, v32, v33
    v_mfma_f32_16x16x32_bf16 a[112:115], a[176:179], v[204:207], a[112:115]
    v_exp_f32 v35, v171
    v_mfma_f32_16x16x32_bf16 a[112:115], a[208:211], v[220:223], a[112:115]
    buffer_load_dwordx4 v2, s[48:51], s81 offen offset:1024 sc1 lds
    v_mfma_f32_16x16x32_bf16 a[108:111], a[204:207], v[220:223], a[108:111]
    v_exp_f32 v36, v172
    v_mfma_f32_16x16x32_bf16 a[108:111], a[172:175], v[204:207], a[108:111]
    ds_read_b128 a[148:151], v4 offset:21504
    v_cvt_pk_bf16_f32 v213, v34, v35
    v_mfma_f32_16x16x32_bf16 a[104:107], a[168:171], v[204:207], a[104:107]
    v_exp_f32 v37, v173
    v_mfma_f32_16x16x32_bf16 a[104:107], a[200:203], v[220:223], a[104:107]
    buffer_load_dwordx4 v2, s[48:51], s81 offen offset:2048 sc1 lds
    v_mfma_f32_16x16x32_bf16 a[100:103], a[196:199], v[220:223], a[100:103]
    v_exp_f32 v38, v174
    v_mfma_f32_16x16x32_bf16 a[100:103], a[164:167], v[204:207], a[100:103]
    s_add_u32 s94, s94, 256
    ds_read_b128 a[144:147], v4 offset:20480
    v_cvt_pk_bf16_f32 v214, v36, v37
    v_mfma_f32_16x16x32_bf16 a[96:99], a[160:163], v[204:207], a[96:99]
    s_cmp_lt_u32 s75, s79
    v_exp_f32 v39, v175
    v_mfma_f32_16x16x32_bf16 a[96:99], a[192:195], v[220:223], a[96:99]
    s_waitcnt lgkmcnt(1)
    buffer_load_dwordx4 v2, s[48:51], s81 offen offset:3072 sc1 lds
    s_cbranch_scc1 L_both
    s_cmp_eq_u32 s75, s43
    s_cbranch_scc1 L_exit
.p2align 4
L_later:
    v_mfma_f32_16x16x32_bf16 v[144:147], a[128:131], v[68:71], v[56:59]
    v_exp_f32 v32, v176
    v_mfma_f32_16x16x32_bf16 v[144:147], a[132:135], v[84:87], v[144:147]
    v_cvt_pk_bf16_f32 v215, v38, v39
    v_mfma_f32_16x16x32_bf16 v[144:147], a[136:139], v[100:103], v[144:147]
    s_waitcnt lgkmcnt(0)
    v_exp_f32 v33, v177
    v_mfma_f32_16x16x32_bf16 v[144:147], a[140:143], v[116:119], v[144:147]
    s_xor_b32 m0, s80, 0
    ds_read_b128 a[192:195], v4 offset:24576
    ds_read_b128 a[196:199], v4 offset:25600
    v_mfma_f32_16x16x32_bf16 v[252:255], a[224:227], v[196:199], 0
    buffer_load_dwordx4 v2, s[48:51], s82 offen offset:0 sc1 lds
    v_exp_f32 v34, v178
    v_mfma_f32_16x16x32_bf16 v[252:255], a[224:227], v[212:215], v[252:255]
    v_add_f32 v42, v32, v33
    v_cvt_pk_bf16_f32 v216, v32, v33
    v_mfma_f32_16x16x32_bf16 v[148:151], a[156:159], v[116:119], v[56:59]
    v_exp_f32 v35, v179
    v_mfma_f32_16x16x32_bf16 v[148:151], a[152:155], v[100:103], v[148:151]
    ds_read_b128 a[200:203], v4 offset:26624
    v_add_f32 v42, v42, v34
    v_mfma_f32_16x16x32_bf16 v[148:151], a[148:151], v[84:87], v[148:151]
    v_exp_f32 v36, v180
    v_mfma_f32_16x16x32_bf16 v[148:151], a[144:147], v[68:71], v[148:151]
    v_add_f32 v42, v42, v35
    v_cvt_pk_bf16_f32 v217, v34, v35
    v_mfma_f32_16x16x32_bf16 v[156:159], a[144:147], v[64:67], v[60:63]
    v_exp_f32 v37, v181
    v_mfma_f32_16x16x32_bf16 v[156:159], a[148:151], v[80:83], v[156:159]
    v_add_f32 v42, v42, v36
    v_max_f32 v224, v40, v252
    v_mfma_f32_16x16x32_bf16 v[156:159], a[152:155], v[96:99], v[156:159]
    v_exp_f32 v38, v182
    v_mfma_f32_16x16x32_bf16 v[156:159], a[156:159], v[112:115], v[156:159]
    v_add_f32 v42, v42, v37
    v_cvt_pk_bf16_f32 v218, v36, v37
    v_mfma_f32_16x16x32_bf16 v[152:155], a[140:143], v[112:115], v[60:63]
    v_exp_f32 v39, v183
    v_mfma_f32_16x16x32_bf16 v[152:155], a[136:139], v[96:99], v[152:155]
    v_add_f32 v42, v42, v38
    v_cmp_lt_f32 vcc, v6, v224
    v_mfma_f32_16x16x32_bf16 v[152:155], a[132:135], v[80:83], v[152:155]
    s_cbranch_vccnz L_l0_s
L_l0_sr:
    v_exp_f32 v32, v184
    v_mfma_f32_16x16x32_bf16 v[152:155], a[128:131], v[64:67], v[152:155]
    s_add_u32 s69, s75, s95
    v_add_f32 v42, v42, v39
    v_cvt_pk_bf16_f32 v219, v38, v39
    v_mfma_f32_16x16x32_bf16 v[128:131], a[128:131], v[76:79], v[48:51]
    s_lshr_b32 s3, s69, 1
    v_exp_f32 v33, v185
    v_mfma_f32_16x16x32_bf16 v[128:131], a[132:135], v[92:95], v[128:131]
    s_sub_i32 s3, s3, s83
    ds_read_b128 a[204:207], v4 offset:27648
    ds_read_b128 a[208:211], v4 offset:28672
    v_mfma_f32_16x16x32_bf16 v[128:131], a[136:139], v[108:111], v[128:131]
    s_max_i32 s71, s3, 0
    v_exp_f32 v34, v186
    v_mfma_f32_16x16x32_bf16 v[128:131], a[140:143], v[124:127], v[128:131]
    s_lshl_b32 s71, s71, 1
    ds_read_b128 a[212:215], v4 offset:29696
    v_cvt_pk_bf16_f32 v220, v32, v33
    v_mfma_f32_16x16x32_bf16 v[132:135], a[156:159], v[124:127], v[48:51]
    s_add_u32 s71, s71, s69
    v_exp_f32 v35, v187
    v_mfma_f32_16x16x32_bf16 v[132:135], a[152:155], v[108:111], v[132:135]
    s_lshl_b32 s71, s71, 14
    buffer_load_dwordx4 v2, s[48:51], s82 offen offset:1024 sc1 lds
    v_mfma_f32_16x16x32_bf16 v[132:135], a[148:151], v[92:95], v[132:135]
    s_add_u32 s71, s71, s89
    v_exp_f32 v36, v188
    v_mfma_f32_16x16x32_bf16 v[132:135], a[144:147], v[76:79], v[132:135]
    s_cmp_ge_u32 s69, 34
    ds_read_b128 a[216:219], v4 offset:30720
    v_cvt_pk_bf16_f32 v221, v34, v35
    v_mfma_f32_16x16x32_bf16 v[140:143], a[144:147], v[72:75], v[52:55]
    s_cselect_b32 s99, 1073741824, s71
    v_exp_f32 v37, v189
    v_mfma_f32_16x16x32_bf16 v[140:143], a[148:151], v[88:91], v[140:143]
    s_lshl_b32 s71, s75, 13
    buffer_load_dwordx4 v2, s[48:51], s82 offen offset:2048 sc1 lds
    v_mfma_f32_16x16x32_bf16 v[140:143], a[152:155], v[104:107], v[140:143]
    s_add_u32 s71, s71, s92
    v_exp_f32 v38, v190
    v_mfma_f32_16x16x32_bf16 v[140:143], a[156:159], v[120:123], v[140:143]
    s_cmp_ge_u32 s75, 31
    ds_read_b128 a[220:223], v4 offset:31744
    v_cvt_pk_bf16_f32 v222, v36, v37
    v_mfma_f32_16x16x32_bf16 v[136:139], a[140:143], v[120:123], v[52:55]
    s_cselect_b32 s81, s71, s99
    v_exp_f32 v39, v191
    v_mfma_f32_16x16x32_bf16 v[136:139], a[136:139], v[104:107], v[136:139]
    v_mfma_f32_16x16x32_bf16 v[136:139], a[132:135], v[88:91], v[136:139]
    buffer_load_dwordx4 v2, s[48:51], s82 offen offset:3072 sc1 lds
    v_mfma_f32_16x16x32_bf16 v[136:139], a[128:131], v[72:75], v[136:139]
    s_waitcnt lgkmcnt(0)
    v_cvt_pk_bf16_f32 v223, v38, v39
    v_add_f32 v44, v44, v40
    v_mfma_f32_16x16x32_bf16 a[0:3], a[160:163], v[192:195], a[0:3]
    s_waitcnt vmcnt(14)
    s_barrier
    v_exp_f32 v32, v144
    v_mfma_f32_16x16x32_bf16 a[0:3], a[192:195], v[208:211], a[0:3]
    s_xor_b32 s80, s80, 32768
    v_add_f32 v45, v45, v252
    v_xor_b32 v4, 32768, v4
    v_mfma_f32_16x16x32_bf16 a[4:7], a[196:199], v[208:211], a[4:7]
    s_xor_b32 m0, s80, 114688
    v_exp_f32 v33, v145
    v_mfma_f32_16x16x32_bf16 a[4:7], a[164:167], v[192:195], a[4:7]
    s_add_u32 s75, s75, 1
    ds_read_b128 a[128:131], v4 offset:0
    ds_read_b128 a[132:135], v4 offset:1024
    v_add_f32 v42, v42, v32
    v_mfma_f32_16x16x32_bf16 a[8:11], a[168:171], v[192:195], a[8:11]
    s_cmp_eq_u32 s3, 0
    v_exp_f32 v34, v146
    v_mfma_f32_16x16x32_bf16 a[8:11], a[200:203], v[208:211], a[8:11]
    s_cselect_b32 s71, s98, 4294934528
    v_add_f32 v42, v42, v33
    v_cvt_pk_bf16_f32 v200, v32, v33
    v_mfma_f32_16x16x32_bf16 a[12:15], a[204:207], v[208:211], a[12:15]
    s_add_u32 s71, s71, s99
    v_exp_f32 v35, v147
    v_mfma_f32_16x16x32_bf16 a[12:15], a[172:175], v[192:195], a[12:15]
    s_cmp_lt_i32 s3, 0
    ds_read_b128 a[136:139], v4 offset:2048
    v_add_f32 v42, v42, v34
    v_mfma_f32_16x16x32_bf16 a[16:19], a[176:179], v[192:195], a[16:19]
    s_cselect_b32 s82, 1073741824, s71
    v_exp_f32 v36, v148
    v_mfma_f32_16x16x32_bf16 a[16:19], a[208:211], v[208:211], a[16:19]
    v_add_f32 v42, v42, v35
    v_cvt_pk_bf16_f32 v201, v34, v35
    v_mfma_f32_16x16x32_bf16 a[20:23], a[212:215], v[208:211], a[20:23]
    v_exp_f32 v37, v149
    v_mfma_f32_16x16x32_bf16 a[20:23], a[180:183], v[192:195], a[20:23]
    ds_read_b128 a[140:143], v4 offset:3072
    v_add_f32 v42, v42, v36
    v_mfma_f32_16x16x32_bf16 a[24:27], a[184:187], v[192:195], a[24:27]
    buffer_load_dword v30, v7, s[24:27], s93 offen
    v_exp_f32 v38, v150
    v_mfma_f32_16x16x32_bf16 a[24:27], a[216:219], v[208:211], a[24:27]
    v_add_f32 v42, v42, v37
    v_cvt_pk_bf16_f32 v202, v36, v37
    v_mfma_f32_16x16x32_bf16 a[28:31], a[220:223], v[208:211], a[28:31]
    v_exp_f32 v39, v151
    v_mfma_f32_16x16x32_bf16 a[28:31], a[188:191], v[192:195], a[28:31]
    ds_read_b128 a[156:159], v4 offset:7168
    v_add_f32 v42, v42, v38
    v_mfma_f32_16x16x32_bf16 a[60:63], a[188:191], v[196:199], a[60:63]
    v_exp_f32 v32, v152
    v_mfma_f32_16x16x32_bf16 a[60:63], a[220:223], v[212:215], a[60:63]
    v_add_f32 v42, v42, v39
    v_cvt_pk_bf16_f32 v203, v38, v39
    v_mfma_f32_16x16x32_bf16 a[56:59], a[216:219], v[212:215], a[56:59]
    v_exp_f32 v33, v153
    v_mfma_f32_16x16x32_bf16 a[56:59], a[184:187], v[196:199], a[56:59]
    buffer_load_dwordx4 v2, s[48:51], s81 offen offset:0 sc1 lds
    v_mfma_f32_16x16x32_bf16 a[52:55], a[180:183], v[196:199], a[52:55]
    v_exp_f32 v34, v154
    v_mfma_f32_16x16x32_bf16 a[52:55], a[212:215], v[212:215], a[52:55]
    ds_read_b128 a[152:155], v4 offset:6144
    v_cvt_pk_bf16_f32 v204, v32, v33
    v_mfma_f32_16x16x32_bf16 a[48:51], a[208:211], v[212:215], a[48:51]
    v_exp_f32 v35, v155
    v_mfma_f32_16x16x32_bf16 a[48:51], a[176:179], v[196:199], a[48:51]
    buffer_load_dwordx4 v2, s[48:51], s81 offen offset:1024 sc1 lds
    v_mfma_f32_16x16x32_bf16 a[44:47], a[172:175], v[196:199], a[44:47]
    v_exp_f32 v36, v156
    v_mfma_f32_16x16x32_bf16 a[44:47], a[204:207], v[212:215], a[44:47]
    ds_read_b128 a[148:151], v4 offset:5120
    v_cvt_pk_bf16_f32 v205, v34, v35
    v_mfma_f32_16x16x32_bf16 a[40:43], a[200:203], v[212:215], a[40:43]
    v_exp_f32 v37, v157
    v_mfma_f32_16x16x32_bf16 a[40:43], a[168:171], v[196:199], a[40:43]
    buffer_load_dwordx4 v2, s[48:51], s81 offen offset:2048 sc1 lds
    v_mfma_f32_16x16x32_bf16 a[36:39], a[164:167], v[196:199], a[36:39]
    v_exp_f32 v38, v158
    v_mfma_f32_16x16x32_bf16 a[36:39], a[196:199], v[212:215], a[36:39]
    s_add_u32 s93, s93, 512
    ds_read_b128 a[144:147], v4 offset:4096
    v_cvt_pk_bf16_f32 v206, v36, v37
    v_mfma_f32_16x16x32_bf16 a[32:35], a[192:195], v[212:215], a[32:35]
    v_exp_f32 v39, v159
    v_mfma_f32_16x16x32_bf16 a[32:35], a[160:163], v[196:199], a[32:35]
    s_waitcnt lgkmcnt(1)
    buffer_load_dwordx4 v2, s[48:51], s81 offen offset:3072 sc1 lds
L_later1:
    v_mfma_f32_16x16x32_bf16 v[160:163], a[128:131], v[76:79], v[48:51]
    v_exp_f32 v32, v128
    v_mfma_f32_16x16x32_bf16 v[160:163], a[132:135], v[92:95], v[160:163]
    v_cvt_pk_bf16_f32 v207, v38, v39
    v_mfma_f32_16x16x32_bf16 v[160:163], a[136:139], v[108:111], v[160:163]
    s_waitcnt lgkmcnt(0)
    v_exp_f32 v33, v129
    v_mfma_f32_16x16x32_bf16 v[160:163], a[140:143], v[124:127], v[160:163]
    s_xor_b32 m0, s80, 49152
    ds_read_b128 a[160:163], v4 offset:8192
    ds_read_b128 a[164:167], v4 offset:9216
    v_mfma_f32_16x16x32_bf16 v[252:255], a[224:227], v[204:207], 0
    buffer_load_dwordx4 v2, s[48:51], s82 offen offset:0 sc1 lds
    v_exp_f32 v34, v130
    v_mfma_f32_16x16x32_bf16 v[252:255], a[224:227], v[220:223], v[252:255]
    v_add_f32 v40, v32, v33
    v_cvt_pk_bf16_f32 v192, v32, v33
    v_mfma_f32_16x16x32_bf16 v[164:167], a[156:159], v[124:127], v[48:51]
    s_cmp_eq_u32 s75, s100
    v_exp_f32 v35, v131
    v_mfma_f32_16x16x32_bf16 v[164:167], a[152:155], v[108:111], v[164:167]
    s_cbranch_scc1 L_ev
L_evr:
    ds_read_b128 a[168:171], v4 offset:10240
    v_add_f32 v40, v40, v34
    v_mfma_f32_16x16x32_bf16 v[164:167], a[148:151], v[92:95], v[164:167]
    v_exp_f32 v36, v132
    v_mfma_f32_16x16x32_bf16 v[164:167], a[144:147], v[76:79], v[164:167]
    v_add_f32 v40, v40, v35
    v_cvt_pk_bf16_f32 v193, v34, v35
    v_mfma_f32_16x16x32_bf16 v[172:175], a[144:147], v[72:75], v[52:55]
    v_exp_f32 v37, v133
    v_mfma_f32_16x16x32_bf16 v[172:175], a[148:151], v[88:91], v[172:175]
    v_add_f32 v40, v40, v36
    v_max_f32 v224, v42, v252
    v_mfma_f32_16x16x32_bf16 v[172:175], a[152:155], v[104:107], v[172:175]
    v_exp_f32 v38, v134
    v_mfma_f32_16x16x32_bf16 v[172:175], a[156:159], v[120:123], v[172:175]
    v_add_f32 v40, v40, v37
    v_cvt_pk_bf16_f32 v194, v36, v37
    v_mfma_f32_16x16x32_bf16 v[168:171], a[140:143], v[120:123], v[52:55]
    v_exp_f32 v39, v135
    v_mfma_f32_16x16x32_bf16 v[168:171], a[136:139], v[104:107], v[168:171]
    v_add_f32 v40, v40, v38
    v_cmp_lt_f32 vcc, v6, v224
    v_mfma_f32_16x16x32_bf16 v[168:171], a[132:135], v[88:91], v[168:171]
    s_cbranch_vccnz L_l1_s
L_l1_sr:
    v_exp_f32 v32, v136
    v_mfma_f32_16x16x32_bf16 v[168:171], a[128:131], v[72:75], v[168:171]
    s_add_u32 s69, s75, s95
    v_add_f32 v40, v40, v39
    v_cvt_pk_bf16_f32 v195, v38, v39
    v_mfma_f32_16x16x32_bf16 v[176:179], a[128:131], v[68:71], v[56:59]
    s_lshr_b32 s3, s69, 1
    v_exp_f32 v33, v137
    v_mfma_f32_16x16x32_bf16 v[176:179], a[132:135], v[84:87], v[176:179]
    s_sub_i32 s3, s3, s83
    ds_read_b128 a[172:175], v4 offset:11264
    ds_read_b128 a[176:179], v4 offset:12288
    v_mfma_f32_16x16x32_bf16 v[176:179], a[136:139], v[100:103], v[176:179]
    s_max_i32 s71, s3, 0
    v_exp_f32 v34, v138
    v_mfma_f32_16x16x32_bf16 v[176:179], a[140:143], v[116:119], v[176:179]
    s_lshl_b32 s71, s71, 1
    ds_read_b128 a[180:183], v4 offset:13312
    v_cvt_pk_bf16_f32 v196, v32, v33
    v_mfma_f32_16x16x32_bf16 v[180:183], a[156:159], v[116:119], v[56:59]
    s_add_u32 s71, s71, s69
    v_exp_f32 v35, v139
    v_mfma_f32_16x16x32_bf16 v[180:183], a[152:155], v[100:103], v[180:183]
    s_lshl_b32 s71, s71, 14
    buffer_load_dwordx4 v2, s[48:51], s82 offen offset:1024 sc1 lds
    v_mfma_f32_16x16x32_bf16 v[180:183], a[148:151], v[84:87], v[180:183]
    s_add_u32 s71, s71, s89
    v_exp_f32 v36, v140
    v_mfma_f32_16x16x32_bf16 v[180:183], a[144:147], v[68:71], v[180:183]
    s_cmp_ge_u32 s69, 34
    ds_read_b128 a[184:187], v4 offset:14336
    v_cvt_pk_bf16_f32 v197, v34, v35
    v_mfma_f32_16x16x32_bf16 v[188:191], a[144:147], v[64:67], v[60:63]
    s_cselect_b32 s99, 1073741824, s71
    v_exp_f32 v37, v141
    v_mfma_f32_16x16x32_bf16 v[188:191], a[148:151], v[80:83], v[188:191]
    s_lshl_b32 s71, s75, 13
    buffer_load_dwordx4 v2, s[48:51], s82 offen offset:2048 sc1 lds
    v_mfma_f32_16x16x32_bf16 v[188:191], a[152:155], v[96:99], v[188:191]
    s_add_u32 s71, s71, s92
    v_exp_f32 v38, v142
    v_mfma_f32_16x16x32_bf16 v[188:191], a[156:159], v[112:115], v[188:191]
    s_cmp_ge_u32 s75, 31
    ds_read_b128 a[188:191], v4 offset:15360
    v_cvt_pk_bf16_f32 v198, v36, v37
    v_mfma_f32_16x16x32_bf16 v[184:187], a[140:143], v[112:115], v[60:63]
    s_cselect_b32 s81, s71, s99
    v_exp_f32 v39, v143
    v_mfma_f32_16x16x32_bf16 v[184:187], a[136:139], v[96:99], v[184:187]
    v_mfma_f32_16x16x32_bf16 v[184:187], a[132:135], v[80:83], v[184:187]
    buffer_load_dwordx4 v2, s[48:51], s82 offen offset:3072 sc1 lds
    v_mfma_f32_16x16x32_bf16 v[184:187], a[128:131], v[64:67], v[184:187]
    s_waitcnt lgkmcnt(0)
    v_cvt_pk_bf16_f32 v199, v38, v39
    v_add_f32 v46, v46, v42
    v_mfma_f32_16x16x32_bf16 a[64:67], a[192:195], v[216:219], a[64:67]
    s_waitcnt vmcnt(18)
    s_barrier
    v_exp_f32 v32, v160
    v_mfma_f32_16x16x32_bf16 a[64:67], a[160:163], v[200:203], a[64:67]
    s_xor_b32 m0, s80, 65536
    ds_read_b128 a[128:131], v4 offset:16384
    v_add_f32 v47, v47, v252
    v_mfma_f32_16x16x32_bf16 a[68:71], a[164:167], v[200:203], a[68:71]
    s_add_u32 s75, s75, 1
    v_exp_f32 v33, v161
    v_mfma_f32_16x16x32_bf16 a[68:71], a[196:199], v[216:219], a[68:71]
    s_cmp_eq_u32 s3, 0
    ds_read_b128 a[132:135], v4 offset:17408
    v_add_f32 v40, v40, v32
    v_mfma_f32_16x16x32_bf16 a[72:75], a[200:203], v[216:219], a[72:75]
    s_cselect_b32 s71, s98, 4294934528
    v_exp_f32 v34, v162
    v_mfma_f32_16x16x32_bf16 a[72:75], a[168:171], v[200:203], a[72:75]
    s_add_u32 s71, s71, s99
    v_add_f32 v40, v40, v33
    v_cvt_pk_bf16_f32 v208, v32, v33
    v_mfma_f32_16x16x32_bf16 a[76:79], a[172:175], v[200:203], a[76:79]
    s_cmp_lt_i32 s3, 0
    v_exp_f32 v35, v163
    v_mfma_f32_16x16x32_bf16 a[76:79], a[204:207], v[216:219], a[76:79]
    s_cselect_b32 s82, 1073741824, s71
    ds_read_b128 a[136:139], v4 offset:18432
    v_add_f32 v40, v40, v34
    v_mfma_f32_16x16x32_bf16 a[80:83], a[208:211], v[216:219], a[80:83]
    v_exp_f32 v36, v164
    v_mfma_f32_16x16x32_bf16 a[80:83], a[176:179], v[200:203], a[80:83]
    v_add_f32 v40, v40, v35
    v_cvt_pk_bf16_f32 v209, v34, v35
    v_mfma_f32_16x16x32_bf16 a[84:87], a[180:183], v[200:203], a[84:87]
    v_exp_f32 v37, v165
    v_mfma_f32_16x16x32_bf16 a[84:87], a[212:215], v[216:219], a[84:87]
    ds_read_b128 a[140:143], v4 offset:19456
    v_add_f32 v40, v40, v36
    v_mfma_f32_16x16x32_bf16 a[88:91], a[216:219], v[216:219], a[88:91]
    buffer_load_dword v30, v8, s[36:39], s94 offen
    v_exp_f32 v38, v166
    v_mfma_f32_16x16x32_bf16 a[88:91], a[184:187], v[200:203], a[88:91]
    v_add_f32 v40, v40, v37
    v_cvt_pk_bf16_f32 v210, v36, v37
    v_mfma_f32_16x16x32_bf16 a[92:95], a[188:191], v[200:203], a[92:95]
    v_exp_f32 v39, v167
    v_mfma_f32_16x16x32_bf16 a[92:95], a[220:223], v[216:219], a[92:95]
    ds_read_b128 a[156:159], v4 offset:23552
    v_add_f32 v40, v40, v38
    v_mfma_f32_16x16x32_bf16 a[124:127], a[220:223], v[220:223], a[124:127]
    v_exp_f32 v32, v168
    v_mfma_f32_16x16x32_bf16 a[124:127], a[188:191], v[204:207], a[124:127]
    v_add_f32 v40, v40, v39
    v_cvt_pk_bf16_f32 v211, v38, v39
    v_mfma_f32_16x16x32_bf16 a[120:123], a[184:187], v[204:207], a[120:123]
    v_exp_f32 v33, v169
    v_mfma_f32_16x16x32_bf16 a[120:123], a[216:219], v[220:223], a[120:123]
    buffer_load_dwordx4 v2, s[48:51], s81 offen offset:0 sc1 lds
    v_mfma_f32_16x16x32_bf16 a[116:119], a[212:215], v[220:223], a[116:119]
    v_exp_f32 v34, v170
    v_mfma_f32_16x16x32_bf16 a[116:119], a[180:183], v[204:207], a[116:119]
    ds_read_b128 a[152:155], v4 offset:22528
    v_cvt_pk_bf16_f32 v212, v32, v33
    v_mfma_f32_16x16x32_bf16 a[112:115], a[176:179], v[204:207], a[112:115]
    v_exp_f32 v35, v171
    v_mfma_f32_16x16x32_bf16 a[112:115], a[208:211], v[220:223], a[112:115]
    buffer_load_dwordx4 v2, s[48:51], s81 offen offset:1024 sc1 lds
    v_mfma_f32_16x16x32_bf16 a[108:111], a[204:207], v[220:223], a[108:111]
    v_exp_f32 v36, v172
    v_mfma_f32_16x16x32_bf16 a[108:111], a[172:175], v[204:207], a[108:111]
    ds_read_b128 a[148:151], v4 offset:21504
    v_cvt_pk_bf16_f32 v213, v34, v35
    v_mfma_f32_16x16x32_bf16 a[104:107], a[168:171], v[204:207], a[104:107]
    v_exp_f32 v37, v173
    v_mfma_f32_16x16x32_bf16 a[104:107], a[200:203], v[220:223], a[104:107]
    buffer_load_dwordx4 v2, s[48:51], s81 offen offset:2048 sc1 lds
    v_mfma_f32_16x16x32_bf16 a[100:103], a[196:199], v[220:223], a[100:103]
    v_exp_f32 v38, v174
    v_mfma_f32_16x16x32_bf16 a[100:103], a[164:167], v[204:207], a[100:103]
    s_add_u32 s94, s94, 256
    ds_read_b128 a[144:147], v4 offset:20480
    v_cvt_pk_bf16_f32 v214, v36, v37
    v_mfma_f32_16x16x32_bf16 a[96:99], a[160:163], v[204:207], a[96:99]
    s_cmp_lg_u32 s75, s43
    v_exp_f32 v39, v175
    v_mfma_f32_16x16x32_bf16 a[96:99], a[192:195], v[220:223], a[96:99]
    s_waitcnt lgkmcnt(1)
    buffer_load_dwordx4 v2, s[48:51], s81 offen offset:3072 sc1 lds
L_ltest2:
    s_cbranch_scc1 L_later
L_exit:
    s_cmp_eq_u32 s75, s76
    s_cbranch_scc1 L_endd
    v_mfma_f32_16x16x32_bf16 v[144:147], a[128:131], v[68:71], v[56:59]
    v_exp_f32 v32, v176
    v_mfma_f32_16x16x32_bf16 v[144:147], a[132:135], v[84:87], v[144:147]
    v_cvt_pk_bf16_f32 v215, v38, v39
    v_mfma_f32_16x16x32_bf16 v[144:147], a[136:139], v[100:103], v[144:147]
    s_waitcnt lgkmcnt(0)
    v_exp_f32 v33, v177
    v_mfma_f32_16x16x32_bf16 v[144:147], a[140:143], v[116:119], v[144:147]
    s_xor_b32 m0, s80, 0
    ds_read_b128 a[192:195], v4 offset:24576
    ds_read_b128 a[196:199], v4 offset:25600
    v_mfma_f32_16x16x32_bf16 v[252:255], a[224:227], v[196:199], 0
    buffer_load_dwordx4 v2, s[48:51], s82 offen offset:0 sc1 lds
    v_exp_f32 v34, v178
    v_mfma_f32_16x16x32_bf16 v[252:255], a[224:227], v[212:215], v[252:255]
    v_add_f32 v42, v32, v33
    v_cvt_pk_bf16_f32 v216, v32, v33
    v_mfma_f32_16x16x32_bf16 v[148:151], a[156:159], v[116:119], v[56:59]
    v_exp_f32 v35, v179
    v_mfma_f32_16x16x32_bf16 v[148:151], a[152:155], v[100:103], v[148:151]
    ds_read_b128 a[200:203], v4 offset:26624
    v_add_f32 v42, v42, v34
    v_mfma_f32_16x16x32_bf16 v[148:151], a[148:151], v[84:87], v[148:151]
    v_exp_f32 v36, v180
    v_mfma_f32_16x16x32_bf16 v[148:151], a[144:147], v[68:71], v[148:151]
    v_add_f32 v42, v42, v35
    v_cvt_pk_bf16_f32 v217, v34, v35
    v_mfma_f32_16x16x32_bf16 v[156:159], a[144:147], v[64:67], v[60:63]
    v_exp_f32 v37, v181
    v_mfma_f32_16x16x32_bf16 v[156:159], a[148:151], v[80:83], v[156:159]
    v_add_f32 v42, v42, v36
    v_max_f32 v224, v40, v252
    v_mfma_f32_16x16x32_bf16 v[156:159], a[152:155], v[96:99], v[156:159]
    v_exp_f32 v38, v182
    v_mfma_f32_16x16x32_bf16 v[156:159], a[156:159], v[112:115], v[156:159]
    v_add_f32 v42, v42, v37
    v_cvt_pk_bf16_f32 v218, v36, v37
    v_mfma_f32_16x16x32_bf16 v[152:155], a[140:143], v[112:115], v[60:63]
    v_exp_f32 v39, v183
    v_mfma_f32_16x16x32_bf16 v[152:155], a[136:139], v[96:99], v[152:155]
    v_add_f32 v42, v42, v38
    v_cmp_lt_f32 vcc, v6, v224
    v_mfma_f32_16x16x32_bf16 v[152:155], a[132:135], v[80:83], v[152:155]
    s_cbranch_vccnz L_d0_s
L_d0_sr:
    v_exp_f32 v32, v184
    v_mfma_f32_16x16x32_bf16 v[152:155], a[128:131], v[64:67], v[152:155]
    s_add_u32 s69, s75, s95
    v_add_f32 v42, v42, v39
    v_cvt_pk_bf16_f32 v219, v38, v39
    v_mfma_f32_16x16x32_bf16 v[128:131], a[128:131], v[76:79], v[48:51]
    s_lshr_b32 s3, s69, 1
    v_exp_f32 v33, v185
    v_mfma_f32_16x16x32_bf16 v[128:131], a[132:135], v[92:95], v[128:131]
    s_sub_i32 s3, s3, s83
    ds_read_b128 a[204:207], v4 offset:27648
    ds_read_b128 a[208:211], v4 offset:28672
    v_mfma_f32_16x16x32_bf16 v[128:131], a[136:139], v[108:111], v[128:131]
    s_max_i32 s71, s3, 0
    v_exp_f32 v34, v186
    v_mfma_f32_16x16x32_bf16 v[128:131], a[140:143], v[124:127], v[128:131]
    s_lshl_b32 s71, s71, 1
    ds_read_b128 a[212:215], v4 offset:29696
    v_cvt_pk_bf16_f32 v220, v32, v33
    s_add_u32 s71, s71, s69
    v_exp_f32 v35, v187
    s_lshl_b32 s71, s71, 14
    buffer_load_dwordx4 v2, s[48:51], s82 offen offset:1024 sc1 lds
    s_add_u32 s71, s71, s89
    v_exp_f32 v36, v188
    s_cmp_ge_u32 s69, 34
    ds_read_b128 a[216:219], v4 offset:30720
    v_cvt_pk_bf16_f32 v221, v34, v35
    v_mfma_f32_16x16x32_bf16 v[140:143], a[144:147], v[72:75], v[52:55]
    s_cselect_b32 s99, 1073741824, s71
    v_exp_f32 v37, v189
    v_mfma_f32_16x16x32_bf16 v[140:143], a[148:151], v[88:91], v[140:143]
    s_lshl_b32 s71, s75, 13
    buffer_load_dwordx4 v2, s[48:51], s82 offen offset:2048 sc1 lds
    v_mfma_f32_16x16x32_bf16 v[140:143], a[152:155], v[104:107], v[140:143]
    s_add_u32 s71, s71, s92
    v_exp_f32 v38, v190
    v_mfma_f32_16x16x32_bf16 v[140:143], a[156:159], v[120:123], v[140:143]
    s_cmp_ge_u32 s75, 31
    ds_read_b128 a[220:223], v4 offset:31744
    v_cvt_pk_bf16_f32 v222, v36, v37
    v_mfma_f32_16x16x32_bf16 v[136:139], a[140:143], v[120:123], v[52:55]
    s_cselect_b32 s81, s71, s99
    v_exp_f32 v39, v191
    v_mfma_f32_16x16x32_bf16 v[136:139], a[136:139], v[104:107], v[136:139]
    v_mfma_f32_16x16x32_bf16 v[136:139], a[132:135], v[88:91], v[136:139]
    buffer_load_dwordx4 v2, s[48:51], s82 offen offset:3072 sc1 lds
    v_mfma_f32_16x16x32_bf16 v[136:139], a[128:131], v[72:75], v[136:139]
    s_waitcnt lgkmcnt(0)
    v_cvt_pk_bf16_f32 v223, v38, v39
    v_add_f32 v44, v44, v40
    v_mfma_f32_16x16x32_bf16 a[0:3], a[160:163], v[192:195], a[0:3]
    s_waitcnt vmcnt(14)
    s_barrier
    v_exp_f32 v32, v144
    v_mfma_f32_16x16x32_bf16 a[0:3], a[192:195], v[208:211], a[0:3]
    s_xor_b32 s80, s80, 32768
    v_add_f32 v45, v45, v252
    v_xor_b32 v4, 32768, v4
    v_mfma_f32_16x16x32_bf16 a[4:7], a[196:199], v[208:211], a[4:7]
    s_xor_b32 m0, s80, 114688
    v_exp_f32 v33, v145
    v_mfma_f32_16x16x32_bf16 a[4:7], a[164:167], v[192:195], a[4:7]
    s_add_u32 s75, s75, 1
    ds_read_b128 a[128:131], v4 offset:0
    ds_read_b128 a[132:135], v4 offset:1024
    v_add_f32 v42, v42, v32
    v_mfma_f32_16x16x32_bf16 a[8:11], a[168:171], v[192:195], a[8:11]
    s_cmp_eq_u32 s3, 0
    v_exp_f32 v34, v146
    v_mfma_f32_16x16x32_bf16 a[8:11], a[200:203], v[208:211], a[8:11]
    s_cselect_b32 s71, s98, 4294934528
    v_add_f32 v42, v42, v33
    v_cvt_pk_bf16_f32 v200, v32, v33
    v_mfma_f32_16x16x32_bf16 a[12:15], a[204:207], v[208:211], a[12:15]
    s_add_u32 s71, s71, s99
    v_exp_f32 v35, v147
    v_mov_b32 v132, v5
    v_mfma_f32_16x16x32_bf16 a[12:15], a[172:175], v[192:195], a[12:15]
    s_cmp_lt_i32 s3, 0
    ds_read_b128 a[136:139], v4 offset:2048
    v_add_f32 v42, v42, v34
    v_mfma_f32_16x16x32_bf16 a[16:19], a[176:179], v[192:195], a[16:19]
    s_cselect_b32 s82, 1073741824, s71
    v_exp_f32 v36, v148
    v_mov_b32 v133, v5
    v_mfma_f32_16x16x32_bf16 a[16:19], a[208:211], v[208:211], a[16:19]
    v_add_f32 v42, v42, v35
    v_cvt_pk_bf16_f32 v201, v34, v35
    v_mfma_f32_16x16x32_bf16 a[20:23], a[212:215], v[208:211], a[20:23]
    v_exp_f32 v37, v149
    v_mov_b32 v134, v5
    v_mfma_f32_16x16x32_bf16 a[20:23], a[180:183], v[192:195], a[20:23]
    ds_read_b128 a[140:143], v4 offset:3072
    v_add_f32 v42, v42, v36
    v_mfma_f32_16x16x32_bf16 a[24:27], a[184:187], v[192:195], a[24:27]
    buffer_load_dword v30, v7, s[24:27], s93 offen
    v_exp_f32 v38, v150
    v_mov_b32 v135, v5
    v_mfma_f32_16x16x32_bf16 a[24:27], a[216:219], v[208:211], a[24:27]
    v_add_f32 v42, v42, v37
    v_cvt_pk_bf16_f32 v202, v36, v37
    v_mfma_f32_16x16x32_bf16 a[28:31], a[220:223], v[208:211], a[28:31]
    v_exp_f32 v39, v151
    v_cndmask_b32 v128, v5, v128, s[4:5]
    v_mfma_f32_16x16x32_bf16 a[28:31], a[188:191], v[192:195], a[28:31]
    ds_read_b128 a[156:159], v4 offset:7168
    v_add_f32 v42, v42, v38
    v_mfma_f32_16x16x32_bf16 a[60:63], a[188:191], v[196:199], a[60:63]
    v_exp_f32 v32, v152
    v_cndmask_b32 v129, v5, v129, s[6:7]
    v_mfma_f32_16x16x32_bf16 a[60:63], a[220:223], v[212:215], a[60:63]
    v_add_f32 v42, v42, v39
    v_cvt_pk_bf16_f32 v203, v38, v39
    v_mfma_f32_16x16x32_bf16 a[56:59], a[216:219], v[212:215], a[56:59]
    v_exp_f32 v33, v153
    v_cndmask_b32 v130, v5, v130, s[56:57]
    v_mfma_f32_16x16x32_bf16 a[56:59], a[184:187], v[196:199], a[56:59]
    buffer_load_dwordx4 v2, s[48:51], s81 offen offset:0 sc1 lds
    v_mfma_f32_16x16x32_bf16 a[52:55], a[180:183], v[196:199], a[52:55]
    v_exp_f32 v34, v154
    v_cndmask_b32 v131, v5, v131, s[58:59]
    v_mfma_f32_16x16x32_bf16 a[52:55], a[212:215], v[212:215], a[52:55]
    ds_read_b128 a[152:155], v4 offset:6144
    v_cvt_pk_bf16_f32 v204, v32, v33
    v_mfma_f32_16x16x32_bf16 a[48:51], a[208:211], v[212:215], a[48:51]
    v_exp_f32 v35, v155
    v_cndmask_b32 v140, v5, v140, s[4:5]
    v_mfma_f32_16x16x32_bf16 a[48:51], a[176:179], v[196:199], a[48:51]
    buffer_load_dwordx4 v2, s[48:51], s81 offen offset:1024 sc1 lds
    v_mfma_f32_16x16x32_bf16 a[44:47], a[172:175], v[196:199], a[44:47]
    v_exp_f32 v36, v156
    v_cndmask_b32 v141, v5, v141, s[6:7]
    v_mfma_f32_16x16x32_bf16 a[44:47], a[204:207], v[212:215], a[44:47]
    ds_read_b128 a[148:151], v4 offset:5120
    v_cvt_pk_bf16_f32 v205, v34, v35
    v_mfma_f32_16x16x32_bf16 a[40:43], a[200:203], v[212:215], a[40:43]
    v_exp_f32 v37, v157
    v_cndmask_b32 v142, v5, v142, s[56:57]
    v_mfma_f32_16x16x32_bf16 a[40:43], a[168:171], v[196:199], a[40:43]
    buffer_load_dwordx4 v2, s[48:51], s81 offen offset:2048 sc1 lds
    v_mfma_f32_16x16x32_bf16 a[36:39], a[164:167], v[196:199], a[36:39]
    v_exp_f32 v38, v158
    v_cndmask_b32 v143, v5, v143, s[58:59]
    v_mfma_f32_16x16x32_bf16 a[36:39], a[196:199], v[212:215], a[36:39]
    s_add_u32 s93, s93, 512
    ds_read_b128 a[144:147], v4 offset:4096
    v_cvt_pk_bf16_f32 v206, v36, v37
    v_mfma_f32_16x16x32_bf16 a[32:35], a[192:195], v[212:215], a[32:35]
    v_exp_f32 v39, v159
    v_mfma_f32_16x16x32_bf16 a[32:35], a[160:163], v[196:199], a[32:35]
    s_waitcnt lgkmcnt(1)
    buffer_load_dwordx4 v2, s[48:51], s81 offen offset:3072 sc1 lds
    v_exp_f32 v32, v128
    v_cvt_pk_bf16_f32 v207, v38, v39
    s_waitcnt lgkmcnt(0)
    v_exp_f32 v33, v129
    s_xor_b32 m0, s80, 49152
    ds_read_b128 a[160:163], v4 offset:8192
    ds_read_b128 a[164:167], v4 offset:9216
    v_mfma_f32_16x16x32_bf16 v[252:255], a[224:227], v[204:207], 0
    buffer_load_dwordx4 v2, s[48:51], s82 offen offset:0 sc1 lds
    v_exp_f32 v34, v130
    v_mfma_f32_16x16x32_bf16 v[252:255], a[224:227], v[220:223], v[252:255]
    v_add_f32 v40, v32, v33
    v_cvt_pk_bf16_f32 v192, v32, v33
    s_cmp_eq_u32 s75, s100
    v_exp_f32 v35, v131
    s_cbranch_scc1 L_evd
L_evrd:
    ds_read_b128 a[168:171], v4 offset:10240
    v_add_f32 v40, v40, v34
    v_exp_f32 v36, v132
    v_add_f32 v40, v40, v35
    v_cvt_pk_bf16_f32 v193, v34, v35
    v_exp_f32 v37, v133
    v_add_f32 v40, v40, v36
    v_max_f32 v224, v42, v252
    v_exp_f32 v38, v134
    v_add_f32 v40, v40, v37
    v_cvt_pk_bf16_f32 v194, v36, v37
    v_exp_f32 v39, v135
    v_add_f32 v40, v40, v38
    v_cmp_lt_f32 vcc, v6, v224
    s_cbranch_vccnz L_d1_s
L_d1_sr:
    v_exp_f32 v32, v136
    s_add_u32 s69, s75, s95
    v_add_f32 v40, v40, v39
    v_cvt_pk_bf16_f32 v195, v38, v39
    v_mfma_f32_16x16x32_bf16 v[176:179], a[128:131], v[68:71], v[56:59]
    s_lshr_b32 s3, s69, 1
    v_exp_f32 v33, v137
    v_mfma_f32_16x16x32_bf16 v[176:179], a[132:135], v[84:87], v[176:179]
    s_sub_i32 s3, s3, s83
    ds_read_b128 a[172:175], v4 offset:11264
    ds_read_b128 a[176:179], v4 offset:12288
    v_mfma_f32_16x16x32_bf16 v[176:179], a[136:139], v[100:103], v[176:179]
    s_max_i32 s71, s3, 0
    v_exp_f32 v34, v138
    v_mfma_f32_16x16x32_bf16 v[176:179], a[140:143], v[116:119], v[176:179]
    s_lshl_b32 s71, s71, 1
    ds_read_b128 a[180:183], v4 offset:13312
    v_cvt_pk_bf16_f32 v196, v32, v33
    s_add_u32 s71, s71, s69
    v_exp_f32 v35, v139
    s_lshl_b32 s71, s71, 14
    buffer_load_dwordx4 v2, s[48:51], s82 offen offset:1024 sc1 lds
    s_add_u32 s71, s71, s89
    v_exp_f32 v36, v140
    s_cmp_ge_u32 s69, 34
    ds_read_b128 a[184:187], v4 offset:14336
    v_cvt_pk_bf16_f32 v197, v34, v35
    v_mfma_f32_16x16x32_bf16 v[188:191], a[144:147], v[64:67], v[60:63]
    s_cselect_b32 s99, 1073741824, s71
    v_exp_f32 v37, v141
    v_mfma_f32_16x16x32_bf16 v[188:191], a[148:151], v[80:83], v[188:191]
    s_lshl_b32 s71, s75, 13
    buffer_load_dwordx4 v2, s[48:51], s82 offen offset:2048 sc1 lds
    v_mfma_f32_16x16x32_bf16 v[188:191], a[152:155], v[96:99], v[188:191]
    s_add_u32 s71, s71, s92
    v_exp_f32 v38, v142
    v_mfma_f32_16x16x32_bf16 v[188:191], a[156:159], v[112:115], v[188:191]
    s_cmp_ge_u32 s75, 31
    ds_read_b128 a[188:191], v4 offset:15360
    v_cvt_pk_bf16_f32 v198, v36, v37
    v_mfma_f32_16x16x32_bf16 v[184:187], a[140:143], v[112:115], v[60:63]
    s_cselect_b32 s81, s71, s99
    v_exp_f32 v39, v143
    v_mfma_f32_16x16x32_bf16 v[184:187], a[136:139], v[96:99], v[184:187]
    v_mfma_f32_16x16x32_bf16 v[184:187], a[132:135], v[80:83], v[184:187]
    buffer_load_dwordx4 v2, s[48:51], s82 offen offset:3072 sc1 lds
    v_mfma_f32_16x16x32_bf16 v[184:187], a[128:131], v[64:67], v[184:187]
    s_waitcnt lgkmcnt(0)
    v_cvt_pk_bf16_f32 v199, v38, v39
    v_add_f32 v46, v46, v42
    v_mfma_f32_16x16x32_bf16 a[64:67], a[192:195], v[216:219], a[64:67]
    s_waitcnt vmcnt(18)
    s_barrier
    v_mfma_f32_16x16x32_bf16 a[64:67], a[160:163], v[200:203], a[64:67]
    s_xor_b32 m0, s80, 65536
    v_add_f32 v47, v47, v252
    v_mfma_f32_16x16x32_bf16 a[68:71], a[164:167], v[200:203], a[68:71]
    s_add_u32 s75, s75, 1
    v_mov_b32 v160, v5
    v_mov_b32 v161, v5
    v_mfma_f32_16x16x32_bf16 a[68:71], a[196:199], v[216:219], a[68:71]
    s_cmp_eq_u32 s3, 0
    v_mov_b32 v162, v5
    v_mfma_f32_16x16x32_bf16 a[72:75], a[200:203], v[216:219], a[72:75]
    s_cselect_b32 s71, s98, 4294934528
    v_mov_b32 v163, v5
    v_mfma_f32_16x16x32_bf16 a[72:75], a[168:171], v[200:203], a[72:75]
    s_add_u32 s71, s71, s99
    v_mov_b32 v164, v5
    v_mov_b32 v165, v5
    v_mfma_f32_16x16x32_bf16 a[76:79], a[172:175], v[200:203], a[76:79]
    s_cmp_lt_i32 s3, 0
    v_mov_b32 v166, v5
    v_mfma_f32_16x16x32_bf16 a[76:79], a[204:207], v[216:219], a[76:79]
    s_cselect_b32 s82, 1073741824, s71
    v_mov_b32 v167, v5
    v_mfma_f32_16x16x32_bf16 a[80:83], a[208:211], v[216:219], a[80:83]
    v_mov_b32 v168, v5
    v_mov_b32 v169, v5
    v_mfma_f32_16x16x32_bf16 a[80:83], a[176:179], v[200:203], a[80:83]
    v_mov_b32 v170, v5
    v_mfma_f32_16x16x32_bf16 a[84:87], a[180:183], v[200:203], a[84:87]
    v_mov_b32 v171, v5
    v_mfma_f32_16x16x32_bf16 a[84:87], a[212:215], v[216:219], a[84:87]
    v_mov_b32 v172, v5
    v_mov_b32 v173, v5
    v_mfma_f32_16x16x32_bf16 a[88:91], a[216:219], v[216:219], a[88:91]
    buffer_load_dword v30, v8, s[36:39], s94 offen
    v_mfma_f32_16x16x32_bf16 a[88:91], a[184:187], v[200:203], a[88:91]
    v_mov_b32 v174, v5
    v_mov_b32 v175, v5
    v_mfma_f32_16x16x32_bf16 a[92:95], a[188:191], v[200:203], a[92:95]
    v_mov_b32 v180, v5
    v_mov_b32 v181, v5
    v_mfma_f32_16x16x32_bf16 a[92:95], a[220:223], v[216:219], a[92:95]
    v_mov_b32 v182, v5
    v_mfma_f32_16x16x32_bf16 a[124:127], a[220:223], v[220:223], a[124:127]
    v_mov_b32 v183, v5
    v_mfma_f32_16x16x32_bf16 a[124:127], a[188:191], v[204:207], a[124:127]
    v_cndmask_b32 v176, v5, v176, s[4:5]
    v_mfma_f32_16x16x32_bf16 a[120:123], a[184:187], v[204:207], a[120:123]
    v_cndmask_b32 v177, v5, v177, s[6:7]
    v_cndmask_b32 v178, v5, v178, s[56:57]
    v_mfma_f32_16x16x32_bf16 a[120:123], a[216:219], v[220:223], a[120:123]
    buffer_load_dwordx4 v2, s[48:51], s81 offen offset:0 sc1 lds
    v_mfma_f32_16x16x32_bf16 a[116:119], a[212:215], v[220:223], a[116:119]
    v_cndmask_b32 v179, v5, v179, s[58:59]
    v_cndmask_b32 v188, v5, v188, s[4:5]
    v_mfma_f32_16x16x32_bf16 a[116:119], a[180:183], v[204:207], a[116:119]
    v_cndmask_b32 v189, v5, v189, s[6:7]
    v_cndmask_b32 v190, v5, v190, s[56:57]
    v_mfma_f32_16x16x32_bf16 a[112:115], a[176:179], v[204:207], a[112:115]
    v_cndmask_b32 v191, v5, v191, s[58:59]
    v_mfma_f32_16x16x32_bf16 a[112:115], a[208:211], v[220:223], a[112:115]
    buffer_load_dwordx4 v2, s[48:51], s81 offen offset:1024 sc1 lds
    v_mfma_f32_16x16x32_bf16 a[108:111], a[204:207], v[220:223], a[108:111]
    v_mov_b32 v208, 0
    v_mov_b32 v209, 0
    v_mfma_f32_16x16x32_bf16 a[108:111], a[172:175], v[204:207], a[108:111]
    v_mov_b32 v210, 0
    v_mov_b32 v211, 0
    v_mfma_f32_16x16x32_bf16 a[104:107], a[168:171], v[204:207], a[104:107]
    v_mov_b32 v212, 0
    v_mfma_f32_16x16x32_bf16 a[104:107], a[200:203], v[220:223], a[104:107]
    buffer_load_dwordx4 v2, s[48:51], s81 offen offset:2048 sc1 lds
    v_mfma_f32_16x16x32_bf16 a[100:103], a[196:199], v[220:223], a[100:103]
    v_mov_b32 v213, 0
    v_mov_b32 v214, 0
    v_mfma_f32_16x16x32_bf16 a[100:103], a[164:167], v[204:207], a[100:103]
    s_add_u32 s94, s94, 256
    v_mov_b32 v215, 0
    v_mov_b32 v38, 0
    v_mfma_f32_16x16x32_bf16 a[96:99], a[160:163], v[204:207], a[96:99]
    v_mov_b32 v39, 0
    v_mfma_f32_16x16x32_bf16 a[96:99], a[192:195], v[220:223], a[96:99]
    s_waitcnt lgkmcnt(1)
    buffer_load_dwordx4 v2, s[48:51], s81 offen offset:3072 sc1 lds
L_endd:
    s_cmp_eq_u32 s75, 34
    s_cbranch_scc1 L_end34
    v_cvt_pk_bf16_f32 v215, v38, v39
    ds_read_b128 a[192:195], v4 offset:24576
    v_mfma_f32_16x16x32_bf16 v[252:255], a[224:227], v[196:199], 0
    v_mfma_f32_16x16x32_bf16 v[252:255], a[224:227], v[212:215], v[252:255]
    ds_read_b128 a[196:199], v4 offset:25600
    ds_read_b128 a[200:203], v4 offset:26624
    ds_read_b128 a[204:207], v4 offset:27648
    ds_read_b128 a[208:211], v4 offset:28672
    ds_read_b128 a[212:215], v4 offset:29696
    ds_read_b128 a[216:219], v4 offset:30720
    ds_read_b128 a[220:223], v4 offset:31744
    s_nop 0
    v_max_f32 v224, v40, v252
    v_cmp_lt_f32 vcc, v6, v224
    s_cbranch_vccnz L_e1x_s
L_e1x_sr:
    v_add_f32 v44, v44, v40
    v_add_f32 v45, v45, v252
    v_mfma_f32_16x16x32_bf16 a[0:3], a[160:163], v[192:195], a[0:3]
    s_xor_b32 m0, s80, 0
    v_exp_f32 v32, v176
    v_mfma_f32_16x16x32_bf16 a[4:7], a[164:167], v[192:195], a[4:7]
    s_add_u32 s69, s75, s95
    v_exp_f32 v33, v177
    v_mfma_f32_16x16x32_bf16 a[8:11], a[168:171], v[192:195], a[8:11]
    s_lshr_b32 s3, s69, 1
    v_exp_f32 v34, v178
    v_mfma_f32_16x16x32_bf16 a[12:15], a[172:175], v[192:195], a[12:15]
    s_sub_i32 s3, s3, s83
    buffer_load_dwordx4 v2, s[48:51], s82 offen offset:0 sc1 lds
    v_exp_f32 v35, v179
    v_add_f32 v42, v32, v33
    v_cvt_pk_bf16_f32 v216, v32, v33
    v_mfma_f32_16x16x32_bf16 a[16:19], a[176:179], v[192:195], a[16:19]
    s_max_i32 s71, s3, 0
    v_exp_f32 v36, v180
    v_add_f32 v42, v42, v34
    v_mfma_f32_16x16x32_bf16 a[20:23], a[180:183], v[192:195], a[20:23]
    s_lshl_b32 s71, s71, 1
    v_exp_f32 v37, v181
    v_add_f32 v42, v42, v35
    v_cvt_pk_bf16_f32 v217, v34, v35
    v_mfma_f32_16x16x32_bf16 a[24:27], a[184:187], v[192:195], a[24:27]
    s_add_u32 s71, s71, s69
    v_exp_f32 v38, v182
    v_add_f32 v42, v42, v36
    v_mfma_f32_16x16x32_bf16 a[28:31], a[188:191], v[192:195], a[28:31]
    s_lshl_b32 s71, s71, 14
    buffer_load_dwordx4 v2, s[48:51], s82 offen offset:1024 sc1 lds
    v_exp_f32 v39, v183
    v_add_f32 v42, v42, v37
    v_cvt_pk_bf16_f32 v218, v36, v37
    v_mfma_f32_16x16x32_bf16 a[60:63], a[188:191], v[196:199], a[60:63]
    s_add_u32 s71, s71, s89
    v_exp_f32 v32, v184
    v_add_f32 v42, v42, v38
    v_mfma_f32_16x16x32_bf16 a[56:59], a[184:187], v[196:199], a[56:59]
    s_cmp_ge_u32 s69, 34
    v_exp_f32 v33, v185
    v_add_f32 v42, v42, v39
    v_cvt_pk_bf16_f32 v219, v38, v39
    v_mfma_f32_16x16x32_bf16 a[52:55], a[180:183], v[196:199], a[52:55]
    s_cselect_b32 s99, 1073741824, s71
    v_exp_f32 v34, v186
    v_mfma_f32_16x16x32_bf16 a[48:51], a[176:179], v[196:199], a[48:51]
    s_lshl_b32 s71, s75, 13
    buffer_load_dwordx4 v2, s[48:51], s82 offen offset:2048 sc1 lds
    v_exp_f32 v35, v187
    v_add_f32 v252, v32, v33
    v_cvt_pk_bf16_f32 v220, v32, v33
    v_mfma_f32_16x16x32_bf16 a[44:47], a[172:175], v[196:199], a[44:47]
    s_add_u32 s71, s71, s92
    v_exp_f32 v36, v188
    v_add_f32 v252, v252, v34
    v_mfma_f32_16x16x32_bf16 a[40:43], a[168:171], v[196:199], a[40:43]
    s_cmp_ge_u32 s75, 31
    v_exp_f32 v37, v189
    v_add_f32 v252, v252, v35
    v_cvt_pk_bf16_f32 v221, v34, v35
    v_mfma_f32_16x16x32_bf16 a[36:39], a[164:167], v[196:199], a[36:39]
    s_cselect_b32 s81, s71, s99
    v_exp_f32 v38, v190
    v_add_f32 v252, v252, v36
    v_mfma_f32_16x16x32_bf16 a[32:35], a[160:163], v[196:199], a[32:35]
    buffer_load_dwordx4 v2, s[48:51], s82 offen offset:3072 sc1 lds
    v_exp_f32 v39, v191
    v_add_f32 v252, v252, v37
    v_cvt_pk_bf16_f32 v222, v36, v37
    v_add_f32 v252, v252, v38
    v_add_f32 v252, v252, v39
    v_cvt_pk_bf16_f32 v223, v38, v39
    v_max_f32 v224, v42, v252
    v_cmp_lt_f32 vcc, v6, v224
    s_cbranch_vccnz L_e1y_s
L_e1y_sr:
    s_mul_i32 s67, s73, 753664
    s_lshl_b32 s69, s61, 14
    s_add_u32 s67, s67, s69
    s_add_u32 s67, s67, 33783808
    v_mov_b32 v250, v44
    v_mov_b32 v251, v45
    s_nop 1
    v_permlane16_swap_b32 v44, v250
    v_permlane16_swap_b32 v45, v251
    v_add_f32 v44, v44, v250
    v_add_f32 v45, v45, v251
    v_mov_b32 v250, v44
    v_mov_b32 v251, v45
    s_nop 1
    v_permlane32_swap_b32 v44, v250
    v_permlane32_swap_b32 v45, v251
    v_add_f32 v44, v44, v250
    v_add_f32 v45, v45, v251
    v_rcp_f32 v240, v44
    v_rcp_f32 v242, v45
    s_add_u32 s70, s67, 0
    v_accvgpr_read_b32 v128, a0
    v_accvgpr_read_b32 v129, a1
    v_accvgpr_read_b32 v130, a2
    v_accvgpr_read_b32 v131, a3
    v_accvgpr_read_b32 v132, a4
    v_accvgpr_read_b32 v133, a5
    v_accvgpr_read_b32 v134, a6
    v_accvgpr_read_b32 v135, a7
    v_pk_mul_f32 v[128:129], v[128:129], v[240:241] op_sel_hi:[1,0]
    v_pk_mul_f32 v[130:131], v[130:131], v[240:241] op_sel_hi:[1,0]
    v_pk_mul_f32 v[132:133], v[132:133], v[240:241] op_sel_hi:[1,0]
    v_pk_mul_f32 v[134:135], v[134:135], v[240:241] op_sel_hi:[1,0]
    v_cvt_pk_bf16_f32 v128, v128, v129
    v_cvt_pk_bf16_f32 v129, v130, v131
    v_cvt_pk_bf16_f32 v130, v132, v133
    v_cvt_pk_bf16_f32 v131, v134, v135
    buffer_store_dwordx4 v[128:131], v2, s[48:51], s70 offen offset:0 sc1
    s_sub_u32 s72, 1, s60
    s_lshl_b32 s72, s72, 14
    s_add_u32 s72, s72, 131072
    s_waitcnt lgkmcnt(0)
    v_mfma_f32_16x16x32_bf16 a[64:67], a[192:195], v[216:219], a[64:67]
    s_waitcnt vmcnt(17)
    s_barrier
    v_xor_b32 v4, 32768, v4
    v_add_u32 v248, s72, v2
    v_mfma_f32_16x16x32_bf16 a[68:71], a[196:199], v[216:219], a[68:71]
    s_xor_b32 s80, s80, 32768
    ds_read_b128 v[64:67], v248 offset:0
    ds_read_b128 v[68:71], v248 offset:1024
    v_add_f32 v46, v46, v42
    v_mfma_f32_16x16x32_bf16 a[72:75], a[200:203], v[216:219], a[72:75]
    s_xor_b32 m0, s80, 114688
    ds_read_b128 v[72:75], v248 offset:2048
    v_add_f32 v47, v47, v252
    v_mov_b32 v250, v46
    v_mfma_f32_16x16x32_bf16 a[76:79], a[204:207], v[216:219], a[76:79]
    s_add_u32 s75, s75, 1
    ds_read_b128 v[76:79], v248 offset:3072
    v_mov_b32 v251, v47
    v_mfma_f32_16x16x32_bf16 a[80:83], a[208:211], v[216:219], a[80:83]
    s_cmp_eq_u32 s3, 0
    ds_read_b128 v[80:83], v248 offset:4096
    v_mfma_f32_16x16x32_bf16 a[84:87], a[212:215], v[216:219], a[84:87]
    s_cselect_b32 s71, s98, 4294934528
    ds_read_b128 v[84:87], v248 offset:5120
    v_permlane16_swap_b32 v46, v250
    v_permlane16_swap_b32 v47, v251
    v_mfma_f32_16x16x32_bf16 a[88:91], a[216:219], v[216:219], a[88:91]
    s_add_u32 s71, s71, s99
    ds_read_b128 v[88:91], v248 offset:6144
    v_add_f32 v46, v46, v250
    v_add_f32 v47, v47, v251
    v_mfma_f32_16x16x32_bf16 a[92:95], a[220:223], v[216:219], a[92:95]
    s_cmp_lt_i32 s3, 0
    ds_read_b128 v[92:95], v248 offset:7168
    v_mov_b32 v250, v46
    v_mov_b32 v251, v47
    v_mfma_f32_16x16x32_bf16 a[124:127], a[220:223], v[220:223], a[124:127]
    s_cselect_b32 s82, 1073741824, s71
    ds_read_b128 v[96:99], v248 offset:8192
    ds_read_b128 v[100:103], v248 offset:9216
    v_mfma_f32_16x16x32_bf16 a[120:123], a[216:219], v[220:223], a[120:123]
    ds_read_b128 v[104:107], v248 offset:10240
    v_permlane32_swap_b32 v46, v250
    v_permlane32_swap_b32 v47, v251
    v_mfma_f32_16x16x32_bf16 a[116:119], a[212:215], v[220:223], a[116:119]
    ds_read_b128 v[108:111], v248 offset:11264
    v_add_f32 v46, v46, v250
    v_add_f32 v47, v47, v251
    v_mfma_f32_16x16x32_bf16 a[112:115], a[208:211], v[220:223], a[112:115]
    ds_read_b128 v[112:115], v248 offset:12288
    v_rcp_f32 v244, v46
    v_mfma_f32_16x16x32_bf16 a[108:111], a[204:207], v[220:223], a[108:111]
    ds_read_b128 v[116:119], v248 offset:13312
    v_rcp_f32 v246, v47
    v_mfma_f32_16x16x32_bf16 a[104:107], a[200:203], v[220:223], a[104:107]
    ds_read_b128 v[120:123], v248 offset:14336
    v_mfma_f32_16x16x32_bf16 a[100:103], a[196:199], v[220:223], a[100:103]
    ds_read_b128 v[124:127], v248 offset:15360
    v_mfma_f32_16x16x32_bf16 a[96:99], a[192:195], v[220:223], a[96:99]
    buffer_load_dwordx4 v2, s[48:51], s81 offen offset:0 sc1 lds
    s_add_u32 s70, s67, 4096
    v_accvgpr_read_b32 v136, a8
    v_accvgpr_read_b32 v137, a9
    v_accvgpr_read_b32 v138, a10
    v_accvgpr_read_b32 v139, a11
    v_accvgpr_read_b32 v140, a12
    v_accvgpr_read_b32 v141, a13
    v_accvgpr_read_b32 v142, a14
    v_accvgpr_read_b32 v143, a15
    v_pk_mul_f32 v[136:137], v[136:137], v[240:241] op_sel_hi:[1,0]
    v_pk_mul_f32 v[138:139], v[138:139], v[240:241] op_sel_hi:[1,0]
    v_pk_mul_f32 v[140:141], v[140:141], v[240:241] op_sel_hi:[1,0]
    v_pk_mul_f32 v[142:143], v[142:143], v[240:241] op_sel_hi:[1,0]
    v_cvt_pk_bf16_f32 v136, v136, v137
    v_cvt_pk_bf16_f32 v137, v138, v139
    v_cvt_pk_bf16_f32 v138, v140, v141
    v_cvt_pk_bf16_f32 v139, v142, v143
    buffer_store_dwordx4 v[136:139], v2, s[48:51], s70 offen offset:0 sc1
    buffer_load_dwordx4 v2, s[48:51], s81 offen offset:1024 sc1 lds
    s_add_u32 s70, s67, 8192
    v_accvgpr_read_b32 v144, a16
    v_accvgpr_read_b32 v145, a17
    v_accvgpr_read_b32 v146, a18
    v_accvgpr_read_b32 v147, a19
    v_accvgpr_read_b32 v148, a20
    v_accvgpr_read_b32 v149, a21
    v_accvgpr_read_b32 v150, a22
    v_accvgpr_read_b32 v151, a23
    v_pk_mul_f32 v[144:145], v[144:145], v[240:241] op_sel_hi:[1,0]
    v_pk_mul_f32 v[146:147], v[146:147], v[240:241] op_sel_hi:[1,0]
    v_pk_mul_f32 v[148:149], v[148:149], v[240:241] op_sel_hi:[1,0]
    v_pk_mul_f32 v[150:151], v[150:151], v[240:241] op_sel_hi:[1,0]
    v_cvt_pk_bf16_f32 v144, v144, v145
    v_cvt_pk_bf16_f32 v145, v146, v147
    v_cvt_pk_bf16_f32 v146, v148, v149
    v_cvt_pk_bf16_f32 v147, v150, v151
    buffer_store_dwordx4 v[144:147], v2, s[48:51], s70 offen offset:0 sc1
    buffer_load_dwordx4 v2, s[48:51], s81 offen offset:2048 sc1 lds
    s_add_u32 s70, s67, 12288
    v_accvgpr_read_b32 v152, a24
    v_accvgpr_read_b32 v153, a25
    v_accvgpr_read_b32 v154, a26
    v_accvgpr_read_b32 v155, a27
    v_accvgpr_read_b32 v156, a28
    v_accvgpr_read_b32 v157, a29
    v_accvgpr_read_b32 v158, a30
    v_accvgpr_read_b32 v159, a31
    v_pk_mul_f32 v[152:153], v[152:153], v[240:241] op_sel_hi:[1,0]
    v_pk_mul_f32 v[154:155], v[154:155], v[240:241] op_sel_hi:[1,0]
    v_pk_mul_f32 v[156:157], v[156:157], v[240:241] op_sel_hi:[1,0]
    v_pk_mul_f32 v[158:159], v[158:159], v[240:241] op_sel_hi:[1,0]
    v_cvt_pk_bf16_f32 v152, v152, v153
    v_cvt_pk_bf16_f32 v153, v154, v155
    v_cvt_pk_bf16_f32 v154, v156, v157
    v_cvt_pk_bf16_f32 v155, v158, v159
    buffer_store_dwordx4 v[152:155], v2, s[48:51], s70 offen offset:0 sc1
    buffer_load_dwordx4 v2, s[48:51], s81 offen offset:3072 sc1 lds
    s_xor_b32 m0, s80, 49152
    s_add_u32 s70, s67, 0
    v_accvgpr_read_b32 v160, a32
    v_accvgpr_read_b32 v161, a33
    v_accvgpr_read_b32 v162, a34
    v_accvgpr_read_b32 v163, a35
    v_accvgpr_read_b32 v164, a36
    v_accvgpr_read_b32 v165, a37
    v_accvgpr_read_b32 v166, a38
    v_accvgpr_read_b32 v167, a39
    v_pk_mul_f32 v[160:161], v[160:161], v[242:243] op_sel_hi:[1,0]
    v_pk_mul_f32 v[162:163], v[162:163], v[242:243] op_sel_hi:[1,0]
    v_pk_mul_f32 v[164:165], v[164:165], v[242:243] op_sel_hi:[1,0]
    v_pk_mul_f32 v[166:167], v[166:167], v[242:243] op_sel_hi:[1,0]
    v_cvt_pk_bf16_f32 v160, v160, v161
    v_cvt_pk_bf16_f32 v161, v162, v163
    v_cvt_pk_bf16_f32 v162, v164, v165
    v_cvt_pk_bf16_f32 v163, v166, v167
    buffer_store_dwordx4 v[160:163], v2, s[48:51], s70 offen offset:1024 sc1
    buffer_load_dwordx4 v2, s[48:51], s82 offen offset:0 sc1 lds
    s_add_u32 s70, s67, 4096
    v_accvgpr_read_b32 v168, a40
    v_accvgpr_read_b32 v169, a41
    v_accvgpr_read_b32 v170, a42
    v_accvgpr_read_b32 v171, a43
    v_accvgpr_read_b32 v172, a44
    v_accvgpr_read_b32 v173, a45
    v_accvgpr_read_b32 v174, a46
    v_accvgpr_read_b32 v175, a47
    v_pk_mul_f32 v[168:169], v[168:169], v[242:243] op_sel_hi:[1,0]
    v_pk_mul_f32 v[170:171], v[170:171], v[242:243] op_sel_hi:[1,0]
    v_pk_mul_f32 v[172:173], v[172:173], v[242:243] op_sel_hi:[1,0]
    v_pk_mul_f32 v[174:175], v[174:175], v[242:243] op_sel_hi:[1,0]
    v_cvt_pk_bf16_f32 v168, v168, v169
    v_cvt_pk_bf16_f32 v169, v170, v171
    v_cvt_pk_bf16_f32 v170, v172, v173
    v_cvt_pk_bf16_f32 v171, v174, v175
    buffer_store_dwordx4 v[168:171], v2, s[48:51], s70 offen offset:1024 sc1
    buffer_load_dwordx4 v2, s[48:51], s82 offen offset:1024 sc1 lds
    s_add_u32 s70, s67, 8192
    v_accvgpr_read_b32 v176, a48
    v_accvgpr_read_b32 v177, a49
    v_accvgpr_read_b32 v178, a50
    v_accvgpr_read_b32 v179, a51
    v_accvgpr_read_b32 v180, a52
    v_accvgpr_read_b32 v181, a53
    v_accvgpr_read_b32 v182, a54
    v_accvgpr_read_b32 v183, a55
    v_pk_mul_f32 v[176:177], v[176:177], v[242:243] op_sel_hi:[1,0]
    v_pk_mul_f32 v[178:179], v[178:179], v[242:243] op_sel_hi:[1,0]
    v_pk_mul_f32 v[180:181], v[180:181], v[242:243] op_sel_hi:[1,0]
    v_pk_mul_f32 v[182:183], v[182:183], v[242:243] op_sel_hi:[1,0]
    v_cvt_pk_bf16_f32 v176, v176, v177
    v_cvt_pk_bf16_f32 v177, v178, v179
    v_cvt_pk_bf16_f32 v178, v180, v181
    v_cvt_pk_bf16_f32 v179, v182, v183
    buffer_store_dwordx4 v[176:179], v2, s[48:51], s70 offen offset:1024 sc1
    buffer_load_dwordx4 v2, s[48:51], s82 offen offset:2048 sc1 lds
    s_add_u32 s70, s67, 12288
    v_accvgpr_read_b32 v184, a56
    v_accvgpr_read_b32 v185, a57
    v_accvgpr_read_b32 v186, a58
    v_accvgpr_read_b32 v187, a59
    v_accvgpr_read_b32 v188, a60
    v_accvgpr_read_b32 v189, a61
    v_accvgpr_read_b32 v190, a62
    v_accvgpr_read_b32 v191, a63
    v_pk_mul_f32 v[184:185], v[184:185], v[242:243] op_sel_hi:[1,0]
    v_pk_mul_f32 v[186:187], v[186:187], v[242:243] op_sel_hi:[1,0]
    v_pk_mul_f32 v[188:189], v[188:189], v[242:243] op_sel_hi:[1,0]
    v_pk_mul_f32 v[190:191], v[190:191], v[242:243] op_sel_hi:[1,0]
    v_cvt_pk_bf16_f32 v184, v184, v185
    v_cvt_pk_bf16_f32 v185, v186, v187
    v_cvt_pk_bf16_f32 v186, v188, v189
    v_cvt_pk_bf16_f32 v187, v190, v191
    buffer_store_dwordx4 v[184:187], v2, s[48:51], s70 offen offset:1024 sc1
    buffer_load_dwordx4 v2, s[48:51], s82 offen offset:3072 sc1 lds
    s_add_u32 s70, s67, 0
    v_accvgpr_read_b32 v128, a64
    v_accvgpr_read_b32 v129, a65
    v_accvgpr_read_b32 v130, a66
    v_accvgpr_read_b32 v131, a67
    v_accvgpr_read_b32 v132, a68
    v_accvgpr_read_b32 v133, a69
    v_accvgpr_read_b32 v134, a70
    v_accvgpr_read_b32 v135, a71
    v_pk_mul_f32 v[128:129], v[128:129], v[244:245] op_sel_hi:[1,0]
    v_pk_mul_f32 v[130:131], v[130:131], v[244:245] op_sel_hi:[1,0]
    v_pk_mul_f32 v[132:133], v[132:133], v[244:245] op_sel_hi:[1,0]
    v_pk_mul_f32 v[134:135], v[134:135], v[244:245] op_sel_hi:[1,0]
    v_cvt_pk_bf16_f32 v128, v128, v129
    v_cvt_pk_bf16_f32 v129, v130, v131
    v_cvt_pk_bf16_f32 v130, v132, v133
    v_cvt_pk_bf16_f32 v131, v134, v135
    buffer_store_dwordx4 v[128:131], v2, s[48:51], s70 offen offset:2048 sc1
    s_add_u32 s70, s67, 4096
    v_accvgpr_read_b32 v136, a72
    v_accvgpr_read_b32 v137, a73
    v_accvgpr_read_b32 v138, a74
    v_accvgpr_read_b32 v139, a75
    v_accvgpr_read_b32 v140, a76
    v_accvgpr_read_b32 v141, a77
    v_accvgpr_read_b32 v142, a78
    v_accvgpr_read_b32 v143, a79
    v_pk_mul_f32 v[136:137], v[136:137], v[244:245] op_sel_hi:[1,0]
    v_pk_mul_f32 v[138:139], v[138:139], v[244:245] op_sel_hi:[1,0]
    v_pk_mul_f32 v[140:141], v[140:141], v[244:245] op_sel_hi:[1,0]
    v_pk_mul_f32 v[142:143], v[142:143], v[244:245] op_sel_hi:[1,0]
    v_cvt_pk_bf16_f32 v136, v136, v137
    v_cvt_pk_bf16_f32 v137, v138, v139
    v_cvt_pk_bf16_f32 v138, v140, v141
    v_cvt_pk_bf16_f32 v139, v142, v143
    buffer_store_dwordx4 v[136:139], v2, s[48:51], s70 offen offset:2048 sc1
    s_add_u32 s70, s67, 8192
    v_accvgpr_read_b32 v144, a80
    v_accvgpr_read_b32 v145, a81
    v_accvgpr_read_b32 v146, a82
    v_accvgpr_read_b32 v147, a83
    v_accvgpr_read_b32 v148, a84
    v_accvgpr_read_b32 v149, a85
    v_accvgpr_read_b32 v150, a86
    v_accvgpr_read_b32 v151, a87
    v_pk_mul_f32 v[144:145], v[144:145], v[244:245] op_sel_hi:[1,0]
    v_pk_mul_f32 v[146:147], v[146:147], v[244:245] op_sel_hi:[1,0]
    v_pk_mul_f32 v[148:149], v[148:149], v[244:245] op_sel_hi:[1,0]
    v_pk_mul_f32 v[150:151], v[150:151], v[244:245] op_sel_hi:[1,0]
    v_cvt_pk_bf16_f32 v144, v144, v145
    v_cvt_pk_bf16_f32 v145, v146, v147
    v_cvt_pk_bf16_f32 v146, v148, v149
    v_cvt_pk_bf16_f32 v147, v150, v151
    buffer_store_dwordx4 v[144:147], v2, s[48:51], s70 offen offset:2048 sc1
    s_waitcnt vmcnt(27) lgkmcnt(0)
    s_barrier
    v_subrev_u32 v4, 65536, v4
    s_add_u32 s69, s75, s95
    s_lshr_b32 s3, s69, 1
    s_sub_i32 s3, s3, s83
    s_max_i32 s71, s3, 0
    s_lshl_b32 s71, s71, 1
    s_add_u32 s71, s71, s69
    s_lshl_b32 s71, s71, 14
    s_add_u32 s71, s71, s89
    s_cmp_ge_u32 s69, 34
    s_cselect_b32 s99, 1073741824, s71
    s_lshl_b32 s71, s75, 13
    s_add_u32 s71, s71, s92
    s_cmp_ge_u32 s75, 31
    s_cselect_b32 s81, s71, s99
    s_add_u32 s75, s75, 1
    s_cmp_eq_u32 s3, 0
    s_cselect_b32 s71, s98, 4294934528
    s_add_u32 s71, s71, s99
    s_cmp_lt_i32 s3, 0
    s_cselect_b32 s82, 1073741824, s71
    s_xor_b32 m0, s80, 65536
    ds_read_b128 a[128:131], v4 offset:16384
    ds_read_b128 a[132:135], v4 offset:17408
    ds_read_b128 a[136:139], v4 offset:18432
    ds_read_b128 a[140:143], v4 offset:19456
    ds_read_b128 a[156:159], v4 offset:23552
    ds_read_b128 a[152:155], v4 offset:22528
    ds_read_b128 a[148:151], v4 offset:21504
    ds_read_b128 a[144:147], v4 offset:20480
    s_add_u32 s70, s67, 12288
    v_accvgpr_read_b32 v152, a88
    v_accvgpr_read_b32 v153, a89
    v_accvgpr_read_b32 v154, a90
    v_accvgpr_read_b32 v155, a91
    v_accvgpr_read_b32 v156, a92
    v_accvgpr_read_b32 v157, a93
    v_accvgpr_read_b32 v158, a94
    v_accvgpr_read_b32 v159, a95
    v_pk_mul_f32 v[152:153], v[152:153], v[244:245] op_sel_hi:[1,0]
    v_pk_mul_f32 v[154:155], v[154:155], v[244:245] op_sel_hi:[1,0]
    v_pk_mul_f32 v[156:157], v[156:157], v[244:245] op_sel_hi:[1,0]
    v_pk_mul_f32 v[158:159], v[158:159], v[244:245] op_sel_hi:[1,0]
    v_cvt_pk_bf16_f32 v152, v152, v153
    v_cvt_pk_bf16_f32 v153, v154, v155
    v_cvt_pk_bf16_f32 v154, v156, v157
    v_cvt_pk_bf16_f32 v155, v158, v159
    buffer_store_dwordx4 v[152:155], v2, s[48:51], s70 offen offset:2048 sc1
    buffer_load_dwordx4 v2, s[48:51], s81 offen offset:0 sc1 lds
    s_add_u32 s70, s67, 0
    v_accvgpr_read_b32 v160, a96
    v_accvgpr_read_b32 v161, a97
    v_accvgpr_read_b32 v162, a98
    v_accvgpr_read_b32 v163, a99
    v_accvgpr_read_b32 v164, a100
    v_accvgpr_read_b32 v165, a101
    v_accvgpr_read_b32 v166, a102
    v_accvgpr_read_b32 v167, a103
    v_pk_mul_f32 v[160:161], v[160:161], v[246:247] op_sel_hi:[1,0]
    v_pk_mul_f32 v[162:163], v[162:163], v[246:247] op_sel_hi:[1,0]
    v_pk_mul_f32 v[164:165], v[164:165], v[246:247] op_sel_hi:[1,0]
    v_pk_mul_f32 v[166:167], v[166:167], v[246:247] op_sel_hi:[1,0]
    v_cvt_pk_bf16_f32 v160, v160, v161
    v_cvt_pk_bf16_f32 v161, v162, v163
    v_cvt_pk_bf16_f32 v162, v164, v165
    v_cvt_pk_bf16_f32 v163, v166, v167
    buffer_store_dwordx4 v[160:163], v2, s[48:51], s70 offen offset:3072 sc1
    buffer_load_dwordx4 v2, s[48:51], s81 offen offset:1024 sc1 lds
    s_add_u32 s70, s67, 4096
    v_accvgpr_read_b32 v168, a104
    v_accvgpr_read_b32 v169, a105
    v_accvgpr_read_b32 v170, a106
    v_accvgpr_read_b32 v171, a107
    v_accvgpr_read_b32 v172, a108
    v_accvgpr_read_b32 v173, a109
    v_accvgpr_read_b32 v174, a110
    v_accvgpr_read_b32 v175, a111
    v_pk_mul_f32 v[168:169], v[168:169], v[246:247] op_sel_hi:[1,0]
    v_pk_mul_f32 v[170:171], v[170:171], v[246:247] op_sel_hi:[1,0]
    v_pk_mul_f32 v[172:173], v[172:173], v[246:247] op_sel_hi:[1,0]
    v_pk_mul_f32 v[174:175], v[174:175], v[246:247] op_sel_hi:[1,0]
    v_cvt_pk_bf16_f32 v168, v168, v169
    v_cvt_pk_bf16_f32 v169, v170, v171
    v_cvt_pk_bf16_f32 v170, v172, v173
    v_cvt_pk_bf16_f32 v171, v174, v175
    buffer_store_dwordx4 v[168:171], v2, s[48:51], s70 offen offset:3072 sc1
    buffer_load_dwordx4 v2, s[48:51], s81 offen offset:2048 sc1 lds
    s_add_u32 s70, s67, 8192
    v_accvgpr_read_b32 v176, a112
    v_accvgpr_read_b32 v177, a113
    v_accvgpr_read_b32 v178, a114
    v_accvgpr_read_b32 v179, a115
    v_accvgpr_read_b32 v180, a116
    v_accvgpr_read_b32 v181, a117
    v_accvgpr_read_b32 v182, a118
    v_accvgpr_read_b32 v183, a119
    v_pk_mul_f32 v[176:177], v[176:177], v[246:247] op_sel_hi:[1,0]
    v_pk_mul_f32 v[178:179], v[178:179], v[246:247] op_sel_hi:[1,0]
    v_pk_mul_f32 v[180:181], v[180:181], v[246:247] op_sel_hi:[1,0]
    v_pk_mul_f32 v[182:183], v[182:183], v[246:247] op_sel_hi:[1,0]
    v_cvt_pk_bf16_f32 v176, v176, v177
    v_cvt_pk_bf16_f32 v177, v178, v179
    v_cvt_pk_bf16_f32 v178, v180, v181
    v_cvt_pk_bf16_f32 v179, v182, v183
    buffer_store_dwordx4 v[176:179], v2, s[48:51], s70 offen offset:3072 sc1
    buffer_load_dwordx4 v2, s[48:51], s81 offen offset:3072 sc1 lds
    s_add_u32 s70, s67, 12288
    v_accvgpr_read_b32 v184, a120
    v_accvgpr_read_b32 v185, a121
    v_accvgpr_read_b32 v186, a122
    v_accvgpr_read_b32 v187, a123
    v_accvgpr_read_b32 v188, a124
    v_accvgpr_read_b32 v189, a125
    v_accvgpr_read_b32 v190, a126
    v_accvgpr_read_b32 v191, a127
    v_pk_mul_f32 v[184:185], v[184:185], v[246:247] op_sel_hi:[1,0]
    v_pk_mul_f32 v[186:187], v[186:187], v[246:247] op_sel_hi:[1,0]
    v_pk_mul_f32 v[188:189], v[188:189], v[246:247] op_sel_hi:[1,0]
    v_pk_mul_f32 v[190:191], v[190:191], v[246:247] op_sel_hi:[1,0]
    v_cvt_pk_bf16_f32 v184, v184, v185
    v_cvt_pk_bf16_f32 v185, v186, v187
    v_cvt_pk_bf16_f32 v186, v188, v189
    v_cvt_pk_bf16_f32 v187, v190, v191
    buffer_store_dwordx4 v[184:187], v2, s[48:51], s70 offen offset:3072 sc1
    s_waitcnt lgkmcnt(0)
    s_sub_u32 s73, 31, s73
    s_mov_b32 s76, 34
    s_mov_b32 s43, 34
    s_cmp_eq_u32 s60, 0
    s_cselect_b32 s77, s75, 98
    s_add_u32 s78, s77, 1
    s_cmp_lt_u32 s75, 34
    s_cbranch_scc1 L_start
    s_add_u32 m0, s66, 131072
    s_nop 0
    buffer_load_dwordx4 v10, s[36:39], s64 offen offset:0 lds
    buffer_load_dwordx4 v11, s[36:39], s64 offen offset:1024 lds
    buffer_load_dwordx4 v12, s[36:39], s64 offen offset:2048 lds
    buffer_load_dwordx4 v13, s[36:39], s64 offen offset:3072 lds
    s_add_u32 s64, s64, 65536
    s_add_u32 m0, s66, 147456
    s_nop 0
    buffer_load_dwordx4 v10, s[36:39], s64 offen offset:0 lds
    buffer_load_dwordx4 v11, s[36:39], s64 offen offset:1024 lds
    buffer_load_dwordx4 v12, s[36:39], s64 offen offset:2048 lds
    buffer_load_dwordx4 v13, s[36:39], s64 offen offset:3072 lds
    s_add_u32 s64, s64, 65536
    s_lshr_b32 s69, s61, 2
    s_lshl_b32 s70, s62, 3
    s_add_u32 s69, s69, s70
    s_lshl_b32 s69, s69, 7
    s_add_u32 s69, s69, 58818560
    v_mov_b32 v250, 1073741824
    v_mov_b32 v251, s69
    v_cmp_eq_u32 vcc, 0, v0
    s_nop 1
    v_cndmask_b32 v14, v250, v251, vcc
    v_mov_b32 v48, 0x7f800000
    v_mov_b32 v44, 0
    v_mov_b32 v40, 0
    v_mov_b32 v52, 0x7f800000
    v_mov_b32 v45, 0
    v_mov_b32 v252, 0
    v_mov_b32 v56, 0x7f800000
    v_mov_b32 v46, 0
    v_mov_b32 v42, 0
    v_mov_b32 v60, 0x7f800000
    v_mov_b32 v47, 0
    v_mov_b32 v252, 0
    v_mov_b32 v216, 0
    v_mov_b32 v217, 0
    v_mov_b32 v218, 0
    v_mov_b32 v219, 0
    v_mov_b32 v220, 0
    v_mov_b32 v221, 0
    v_mov_b32 v222, 0
    v_mov_b32 v223, 0
    v_accvgpr_write_b32 a0, 0
    v_accvgpr_write_b32 a1, 0
    v_accvgpr_write_b32 a2, 0
    v_accvgpr_write_b32 a3, 0
    v_accvgpr_write_b32 a4, 0
    v_accvgpr_write_b32 a5, 0
    v_accvgpr_write_b32 a6, 0
    v_accvgpr_write_b32 a7, 0
    v_accvgpr_write_b32 a8, 0
    v_accvgpr_write_b32 a9, 0
    v_accvgpr_write_b32 a10, 0
    v_accvgpr_write_b32 a11, 0
    v_accvgpr_write_b32 a12, 0
    v_accvgpr_write_b32 a13, 0
    v_accvgpr_write_b32 a14, 0
    v_accvgpr_write_b32 a15, 0
    v_accvgpr_write_b32 a16, 0
    v_accvgpr_write_b32 a17, 0
    v_accvgpr_write_b32 a18, 0
    v_accvgpr_write_b32 a19, 0
    v_accvgpr_write_b32 a20, 0
    v_accvgpr_write_b32 a21, 0
    v_accvgpr_write_b32 a22, 0
    v_accvgpr_write_b32 a23, 0
    v_accvgpr_write_b32 a24, 0
    v_accvgpr_write_b32 a25, 0
    v_accvgpr_write_b32 a26, 0
    v_accvgpr_write_b32 a27, 0
    v_accvgpr_write_b32 a28, 0
    v_accvgpr_write_b32 a29, 0
    v_accvgpr_write_b32 a30, 0
    v_accvgpr_write_b32 a31, 0
    v_accvgpr_write_b32 a32, 0
    v_accvgpr_write_b32 a33, 0
    v_accvgpr_write_b32 a34, 0
    v_accvgpr_write_b32 a35, 0
    v_accvgpr_write_b32 a36, 0
    v_accvgpr_write_b32 a37, 0
    v_accvgpr_write_b32 a38, 0
    v_accvgpr_write_b32 a39, 0
    v_accvgpr_write_b32 a40, 0
    v_accvgpr_write_b32 a41, 0
    v_accvgpr_write_b32 a42, 0
    v_accvgpr_write_b32 a43, 0
    v_accvgpr_write_b32 a44, 0
    v_accvgpr_write_b32 a45, 0
    v_accvgpr_write_b32 a46, 0
    v_accvgpr_write_b32 a47, 0
    v_accvgpr_write_b32 a48, 0
    v_accvgpr_write_b32 a49, 0
    v_accvgpr_write_b32 a50, 0
    v_accvgpr_write_b32 a51, 0
    v_accvgpr_write_b32 a52, 0
    v_accvgpr_write_b32 a53, 0
    v_accvgpr_write_b32 a54, 0
    v_accvgpr_write_b32 a55, 0
    v_accvgpr_write_b32 a56, 0
    v_accvgpr_write_b32 a57, 0
    v_accvgpr_write_b32 a58, 0
    v_accvgpr_write_b32 a59, 0
    v_accvgpr_write_b32 a60, 0
    v_accvgpr_write_b32 a61, 0
    v_accvgpr_write_b32 a62, 0
    v_accvgpr_write_b32 a63, 0
    v_accvgpr_write_b32 a64, 0
    v_accvgpr_write_b32 a65, 0
    v_accvgpr_write_b32 a66, 0
    v_accvgpr_write_b32 a67, 0
    v_accvgpr_write_b32 a68, 0
    v_accvgpr_write_b32 a69, 0
    v_accvgpr_write_b32 a70, 0
    v_accvgpr_write_b32 a71, 0
    v_accvgpr_write_b32 a72, 0
    v_accvgpr_write_b32 a73, 0
    v_accvgpr_write_b32 a74, 0
    v_accvgpr_write_b32 a75, 0
    v_accvgpr_write_b32 a76, 0
    v_accvgpr_write_b32 a77, 0
    v_accvgpr_write_b32 a78, 0
    v_accvgpr_write_b32 a79, 0
    v_accvgpr_write_b32 a80, 0
    v_accvgpr_write_b32 a81, 0
    v_accvgpr_write_b32 a82, 0
    v_accvgpr_write_b32 a83, 0
    v_accvgpr_write_b32 a84, 0
    v_accvgpr_write_b32 a85, 0
    v_accvgpr_write_b32 a86, 0
    v_accvgpr_write_b32 a87, 0
    v_accvgpr_write_b32 a88, 0
    v_accvgpr_write_b32 a89, 0
    v_accvgpr_write_b32 a90, 0
    v_accvgpr_write_b32 a91, 0
    v_accvgpr_write_b32 a92, 0
    v_accvgpr_write_b32 a93, 0
    v_accvgpr_write_b32 a94, 0
    v_accvgpr_write_b32 a95, 0
    v_accvgpr_write_b32 a96, 0
    v_accvgpr_write_b32 a97, 0
    v_accvgpr_write_b32 a98, 0
    v_accvgpr_write_b32 a99, 0
    v_accvgpr_write_b32 a100, 0
    v_accvgpr_write_b32 a101, 0
    v_accvgpr_write_b32 a102, 0
    v_accvgpr_write_b32 a103, 0
    v_accvgpr_write_b32 a104, 0
    v_accvgpr_write_b32 a105, 0
    v_accvgpr_write_b32 a106, 0
    v_accvgpr_write_b32 a107, 0
    v_accvgpr_write_b32 a108, 0
    v_accvgpr_write_b32 a109, 0
    v_accvgpr_write_b32 a110, 0
    v_accvgpr_write_b32 a111, 0
    v_accvgpr_write_b32 a112, 0
    v_accvgpr_write_b32 a113, 0
    v_accvgpr_write_b32 a114, 0
    v_accvgpr_write_b32 a115, 0
    v_accvgpr_write_b32 a116, 0
    v_accvgpr_write_b32 a117, 0
    v_accvgpr_write_b32 a118, 0
    v_accvgpr_write_b32 a119, 0
    v_accvgpr_write_b32 a120, 0
    v_accvgpr_write_b32 a121, 0
    v_accvgpr_write_b32 a122, 0
    v_accvgpr_write_b32 a123, 0
    v_accvgpr_write_b32 a124, 0
    v_accvgpr_write_b32 a125, 0
    v_accvgpr_write_b32 a126, 0
    v_accvgpr_write_b32 a127, 0
    v_add_f32 v46, v46, v42
    v_add_f32 v47, v47, v252
    v_mov_b32 v224, v48
    v_mov_b32 v225, v52
    v_mov_b32 v226, v56
    v_mov_b32 v227, v60
    s_sub_u32 s69, 3, s60
    s_lshl_b32 s70, s69, 14
    s_lshl_b32 s71, s60, 12
    s_add_u32 s71, s71, s70
    v_add_u32 v240, s71, v2
    v_add_u32 v242, s70, v2
    s_lshl_b32 s70, s60, 14
    v_add_u32 v241, s70, v2
    s_lshl_b32 s69, s69, 12
    v_add_u32 v243, s69, v241
    s_waitcnt vmcnt(8)
    v_cmp_le_u32 vcc, 32, v31
    s_cmp_eq_u64 vcc, exec
    s_cbranch_scc0 L_s2b
L_s2br:
    ds_write_b128 v240, v[224:227]
    ds_write_b128 v240, v[44:47] offset:1024
    s_waitcnt lgkmcnt(0)
    s_barrier
    s_branch L_final
L_end34:
    v_cvt_pk_bf16_f32 v215, v38, v39
    ds_read_b128 a[192:195], v4 offset:24576
    ds_read_b128 a[196:199], v4 offset:25600
    v_mfma_f32_16x16x32_bf16 v[252:255], a[224:227], v[196:199], 0
    v_mfma_f32_16x16x32_bf16 v[252:255], a[224:227], v[212:215], v[252:255]
    ds_read_b128 a[200:203], v4 offset:26624
    ds_read_b128 a[204:207], v4 offset:27648
    ds_read_b128 a[208:211], v4 offset:28672
    ds_read_b128 a[212:215], v4 offset:29696
    ds_read_b128 a[216:219], v4 offset:30720
    ds_read_b128 a[220:223], v4 offset:31744
    s_nop 1
    v_max_f32 v224, v40, v252
    v_cmp_lt_f32 vcc, v6, v224
    s_cbranch_vccnz L_e2x_s
L_e2x_sr:
    v_add_f32 v44, v44, v40
    v_add_f32 v45, v45, v252
    v_mfma_f32_16x16x32_bf16 a[0:3], a[160:163], v[192:195], a[0:3]
    s_waitcnt lgkmcnt(6)
    v_exp_f32 v32, v176
    v_mfma_f32_16x16x32_bf16 a[0:3], a[192:195], v[208:211], a[0:3]
    v_mfma_f32_16x16x32_bf16 a[4:7], a[196:199], v[208:211], a[4:7]
    s_add_u32 m0, s66, 131072
    v_exp_f32 v33, v177
    v_mfma_f32_16x16x32_bf16 a[4:7], a[164:167], v[192:195], a[4:7]
    s_waitcnt lgkmcnt(0)
    buffer_load_dwordx4 v10, s[36:39], s64 offen offset:0 lds
    v_mfma_f32_16x16x32_bf16 a[8:11], a[168:171], v[192:195], a[8:11]
    s_lshr_b32 s69, s61, 2
    v_exp_f32 v34, v178
    v_mfma_f32_16x16x32_bf16 a[8:11], a[200:203], v[208:211], a[8:11]
    s_lshl_b32 s70, s62, 3
    v_add_f32 v42, v32, v33
    v_cvt_pk_bf16_f32 v216, v32, v33
    v_mfma_f32_16x16x32_bf16 a[12:15], a[204:207], v[208:211], a[12:15]
    s_add_u32 s69, s69, s70
    v_exp_f32 v35, v179
    v_mfma_f32_16x16x32_bf16 a[12:15], a[172:175], v[192:195], a[12:15]
    s_lshl_b32 s69, s69, 7
    buffer_load_dwordx4 v11, s[36:39], s64 offen offset:1024 lds
    v_add_f32 v42, v42, v34
    v_mfma_f32_16x16x32_bf16 a[16:19], a[176:179], v[192:195], a[16:19]
    s_add_u32 s69, s69, 58818560
    v_exp_f32 v36, v180
    v_mov_b32 v250, 1073741824
    v_mov_b32 v251, s69
    v_mfma_f32_16x16x32_bf16 a[16:19], a[208:211], v[208:211], a[16:19]
    v_add_f32 v42, v42, v35
    v_cvt_pk_bf16_f32 v217, v34, v35
    v_cmp_eq_u32 vcc, 0, v0
    v_mfma_f32_16x16x32_bf16 a[20:23], a[212:215], v[208:211], a[20:23]
    v_exp_f32 v37, v181
    v_mfma_f32_16x16x32_bf16 a[20:23], a[180:183], v[192:195], a[20:23]
    buffer_load_dwordx4 v12, s[36:39], s64 offen offset:2048 lds
    v_add_f32 v42, v42, v36
    v_cndmask_b32 v14, v250, v251, vcc
    v_mfma_f32_16x16x32_bf16 a[24:27], a[184:187], v[192:195], a[24:27]
    v_exp_f32 v38, v182
    v_mfma_f32_16x16x32_bf16 a[24:27], a[216:219], v[208:211], a[24:27]
    v_add_f32 v42, v42, v37
    v_cvt_pk_bf16_f32 v218, v36, v37
    v_mfma_f32_16x16x32_bf16 a[28:31], a[220:223], v[208:211], a[28:31]
    v_exp_f32 v39, v183
    v_mfma_f32_16x16x32_bf16 a[28:31], a[188:191], v[192:195], a[28:31]
    buffer_load_dwordx4 v13, s[36:39], s64 offen offset:3072 lds
    v_add_f32 v42, v42, v38
    v_mfma_f32_16x16x32_bf16 a[60:63], a[188:191], v[196:199], a[60:63]
    s_add_u32 s64, s64, 65536
    v_exp_f32 v32, v184
    v_mfma_f32_16x16x32_bf16 a[60:63], a[220:223], v[212:215], a[60:63]
    v_add_f32 v42, v42, v39
    v_cvt_pk_bf16_f32 v219, v38, v39
    v_mfma_f32_16x16x32_bf16 a[56:59], a[216:219], v[212:215], a[56:59]
    s_add_u32 m0, s66, 147456
    v_exp_f32 v33, v185
    v_mfma_f32_16x16x32_bf16 a[56:59], a[184:187], v[196:199], a[56:59]
    buffer_load_dwordx4 v10, s[36:39], s64 offen offset:0 lds
    v_mfma_f32_16x16x32_bf16 a[52:55], a[180:183], v[196:199], a[52:55]
    v_exp_f32 v34, v186
    v_mfma_f32_16x16x32_bf16 a[52:55], a[212:215], v[212:215], a[52:55]
    v_add_f32 v252, v32, v33
    v_cvt_pk_bf16_f32 v220, v32, v33
    v_mfma_f32_16x16x32_bf16 a[48:51], a[208:211], v[212:215], a[48:51]
    v_exp_f32 v35, v187
    v_mfma_f32_16x16x32_bf16 a[48:51], a[176:179], v[196:199], a[48:51]
    buffer_load_dwordx4 v11, s[36:39], s64 offen offset:1024 lds
    v_add_f32 v252, v252, v34
    v_mfma_f32_16x16x32_bf16 a[44:47], a[172:175], v[196:199], a[44:47]
    v_exp_f32 v36, v188
    v_mfma_f32_16x16x32_bf16 a[44:47], a[204:207], v[212:215], a[44:47]
    v_add_f32 v252, v252, v35
    v_cvt_pk_bf16_f32 v221, v34, v35
    v_mfma_f32_16x16x32_bf16 a[40:43], a[200:203], v[212:215], a[40:43]
    v_exp_f32 v37, v189
    v_mfma_f32_16x16x32_bf16 a[40:43], a[168:171], v[196:199], a[40:43]
    buffer_load_dwordx4 v12, s[36:39], s64 offen offset:2048 lds
    v_add_f32 v252, v252, v36
    v_mfma_f32_16x16x32_bf16 a[36:39], a[164:167], v[196:199], a[36:39]
    v_exp_f32 v38, v190
    v_mfma_f32_16x16x32_bf16 a[36:39], a[196:199], v[212:215], a[36:39]
    buffer_load_dwordx4 v13, s[36:39], s64 offen offset:3072 lds
    v_add_f32 v252, v252, v37
    v_cvt_pk_bf16_f32 v222, v36, v37
    v_mfma_f32_16x16x32_bf16 a[32:35], a[192:195], v[212:215], a[32:35]
    s_add_u32 s64, s64, 65536
    v_exp_f32 v39, v191
    v_mfma_f32_16x16x32_bf16 a[32:35], a[160:163], v[196:199], a[32:35]
    v_add_f32 v252, v252, v38
    v_add_f32 v252, v252, v39
    v_cvt_pk_bf16_f32 v223, v38, v39
    v_max_f32 v224, v42, v252
    v_cmp_lt_f32 vcc, v6, v224
    s_cbranch_vccnz L_e2y_s
L_e2y_sr:
    v_add_f32 v46, v46, v42
    v_add_f32 v47, v47, v252
    v_mov_b32 v224, v48
    v_mov_b32 v225, v52
    v_mov_b32 v226, v56
    v_mov_b32 v227, v60
    s_sub_u32 s69, 3, s60
    s_lshl_b32 s70, s69, 14
    s_lshl_b32 s71, s60, 12
    s_add_u32 s71, s71, s70
    v_add_u32 v240, s71, v2
    v_add_u32 v242, s70, v2
    s_lshl_b32 s70, s60, 14
    v_add_u32 v241, s70, v2
    s_lshl_b32 s69, s69, 12
    v_add_u32 v243, s69, v241
    s_waitcnt vmcnt(8)
    v_cmp_le_u32 vcc, 32, v31
    s_cmp_eq_u64 vcc, exec
    s_cbranch_scc0 L_s2a
L_s2ar:
    ds_write_b128 v240, v[224:227]
    ds_write_b128 v240, v[44:47] offset:1024
    s_waitcnt lgkmcnt(0)
    s_barrier
L_final:
    ds_read_b128 v[224:227], v243
    ds_read_b128 v[228:231], v243 offset:1024
    buffer_atomic_add v9, v14, s[48:51], 0 offen sc1
    s_mul_i32 s67, s73, 753664
    s_lshl_b32 s69, s61, 14
    s_add_u32 s67, s67, s69
    s_add_u32 s67, s67, 33783808
    s_cmp_lt_u32 s60, 2
    s_cbranch_scc1 L_finA
    v_mfma_f32_16x16x32_bf16 a[64:67], a[192:195], v[216:219], a[64:67]
    v_accvgpr_read_b32 v64, a0
    v_accvgpr_read_b32 v65, a1
    v_mfma_f32_16x16x32_bf16 a[68:71], a[196:199], v[216:219], a[68:71]
    s_waitcnt lgkmcnt(0)
    v_accvgpr_read_b32 v66, a2
    v_accvgpr_read_b32 v67, a3
    v_mfma_f32_16x16x32_bf16 a[72:75], a[200:203], v[216:219], a[72:75]
    v_accvgpr_read_b32 v68, a4
    v_accvgpr_read_b32 v69, a5
    v_mfma_f32_16x16x32_bf16 a[76:79], a[204:207], v[216:219], a[76:79]
    v_accvgpr_read_b32 v70, a6
    v_accvgpr_read_b32 v71, a7
    v_mfma_f32_16x16x32_bf16 a[80:83], a[208:211], v[216:219], a[80:83]
    v_accvgpr_read_b32 v72, a8
    v_accvgpr_read_b32 v73, a9
    v_mfma_f32_16x16x32_bf16 a[84:87], a[212:215], v[216:219], a[84:87]
    v_accvgpr_read_b32 v74, a10
    v_accvgpr_read_b32 v75, a11
    v_mfma_f32_16x16x32_bf16 a[88:91], a[216:219], v[216:219], a[88:91]
    v_accvgpr_read_b32 v76, a12
    v_accvgpr_read_b32 v77, a13
    v_mfma_f32_16x16x32_bf16 a[92:95], a[220:223], v[216:219], a[92:95]
    v_accvgpr_read_b32 v78, a14
    v_accvgpr_read_b32 v79, a15
    v_mfma_f32_16x16x32_bf16 a[124:127], a[220:223], v[220:223], a[124:127]
    v_accvgpr_read_b32 v80, a16
    v_accvgpr_read_b32 v81, a17
    v_mfma_f32_16x16x32_bf16 a[120:123], a[216:219], v[220:223], a[120:123]
    ds_write_b128 v241, a[64:67] offset:0
    v_accvgpr_read_b32 v82, a18
    v_accvgpr_read_b32 v83, a19
    v_accvgpr_read_b32 v84, a20
    v_mfma_f32_16x16x32_bf16 a[116:119], a[212:215], v[220:223], a[116:119]
    ds_write_b128 v241, a[68:71] offset:1024
    v_accvgpr_read_b32 v85, a21
    v_accvgpr_read_b32 v86, a22
    v_accvgpr_read_b32 v87, a23
    v_mfma_f32_16x16x32_bf16 a[112:115], a[208:211], v[220:223], a[112:115]
    ds_write_b128 v241, a[72:75] offset:2048
    v_accvgpr_read_b32 v88, a24
    v_accvgpr_read_b32 v89, a25
    v_accvgpr_read_b32 v90, a26
    v_mfma_f32_16x16x32_bf16 a[108:111], a[204:207], v[220:223], a[108:111]
    ds_write_b128 v241, a[76:79] offset:3072
    v_accvgpr_read_b32 v91, a27
    v_accvgpr_read_b32 v92, a28
    v_accvgpr_read_b32 v93, a29
    v_mfma_f32_16x16x32_bf16 a[104:107], a[200:203], v[220:223], a[104:107]
    ds_write_b128 v241, a[80:83] offset:4096
    v_accvgpr_read_b32 v94, a30
    v_accvgpr_read_b32 v95, a31
    v_accvgpr_read_b32 v96, a32
    v_mfma_f32_16x16x32_bf16 a[100:103], a[196:199], v[220:223], a[100:103]
    ds_write_b128 v241, a[84:87] offset:5120
    v_accvgpr_read_b32 v97, a33
    v_accvgpr_read_b32 v98, a34
    v_accvgpr_read_b32 v99, a35
    v_mfma_f32_16x16x32_bf16 a[96:99], a[192:195], v[220:223], a[96:99]
    ds_write_b128 v241, a[88:91] offset:6144
    v_accvgpr_read_b32 v100, a36
    v_accvgpr_read_b32 v101, a37
    v_accvgpr_read_b32 v102, a38
    ds_write_b128 v241, a[92:95] offset:7168
    v_accvgpr_read_b32 v103, a39
    v_accvgpr_read_b32 v104, a40
    v_accvgpr_read_b32 v105, a41
    v_accvgpr_read_b32 v106, a42
    v_accvgpr_read_b32 v107, a43
    v_accvgpr_read_b32 v108, a44
    v_accvgpr_read_b32 v109, a45
    v_accvgpr_read_b32 v110, a46
    ds_write_b128 v241, a[124:127] offset:15360
    v_accvgpr_read_b32 v111, a47
    v_accvgpr_read_b32 v112, a48
    v_accvgpr_read_b32 v113, a49
    v_accvgpr_read_b32 v114, a50
    v_accvgpr_read_b32 v115, a51
    v_accvgpr_read_b32 v116, a52
    v_accvgpr_read_b32 v117, a53
    v_accvgpr_read_b32 v118, a54
    ds_write_b128 v241, a[120:123] offset:14336
    v_accvgpr_read_b32 v119, a55
    v_accvgpr_read_b32 v120, a56
    v_accvgpr_read_b32 v121, a57
    v_accvgpr_read_b32 v122, a58
    v_accvgpr_read_b32 v123, a59
    v_accvgpr_read_b32 v124, a60
    v_accvgpr_read_b32 v125, a61
    v_accvgpr_read_b32 v126, a62
    ds_write_b128 v241, a[116:119] offset:13312
    v_accvgpr_read_b32 v127, a63
    v_min_f32 v32, v224, v48
    v_min_f32 v33, v225, v52
    v_sub_f32 v232, v32, v48
    v_sub_f32 v236, v32, v224
    v_sub_f32 v234, v33, v52
    v_sub_f32 v238, v33, v225
    v_exp_f32 v232, v232
    ds_write_b128 v241, a[112:115] offset:12288
    v_exp_f32 v236, v236
    v_exp_f32 v234, v234
    v_exp_f32 v238, v238
    s_nop 0
    v_mul_f32 v32, v44, v232
    v_mul_f32 v33, v45, v234
    v_fma_f32 v32, v228, v236, v32
    v_fma_f32 v33, v229, v238, v33
    ds_write_b128 v241, a[108:111] offset:11264
    v_mov_b32 v34, v32
    v_mov_b32 v35, v33
    s_nop 1
    v_permlane16_swap_b32 v32, v34
    v_permlane16_swap_b32 v33, v35
    v_add_f32 v32, v32, v34
    v_add_f32 v33, v33, v35
    v_mov_b32 v34, v32
    ds_write_b128 v241, a[104:107] offset:10240
    v_mov_b32 v35, v33
    s_nop 1
    v_permlane32_swap_b32 v32, v34
    v_permlane32_swap_b32 v33, v35
    v_add_f32 v32, v32, v34
    v_add_f32 v33, v33, v35
    v_rcp_f32 v32, v32
    v_rcp_f32 v33, v33
    ds_write_b128 v241, a[100:103] offset:9216
    s_nop 0
    v_mul_f32 v232, v232, v32
    v_mul_f32 v236, v236, v32
    v_mul_f32 v234, v234, v33
    v_mul_f32 v238, v238, v33
    s_add_u32 s69, s84, 1
    s_and_b32 s69, s69, 3
    s_lshl_b32 s4, s69, 10
    ds_write_b128 v241, a[96:99] offset:8192
    v_add_u32 v40, s4, v24
    s_add_u32 s69, s84, 2
    s_and_b32 s69, s69, 3
    s_lshl_b32 s5, s69, 10
    v_add_u32 v41, s5, v24
    s_add_u32 s69, s84, 3
    s_and_b32 s69, s69, 3
    s_lshl_b32 s6, s69, 10
    v_add_u32 v42, s6, v24
    s_add_u32 s69, s84, 4
    s_and_b32 s69, s69, 3
    s_lshl_b32 s7, s69, 10
    v_add_u32 v43, s7, v24
    s_add_u32 m0, s66, 114688
    s_nop 0
    buffer_load_dwordx4 v2, s[48:51], s65 offen offset:0 sc1 lds
    buffer_load_dwordx4 v2, s[48:51], s65 offen offset:1024 sc1 lds
    buffer_load_dwordx4 v2, s[48:51], s65 offen offset:2048 sc1 lds
    buffer_load_dwordx4 v2, s[48:51], s65 offen offset:3072 sc1 lds
    s_add_u32 s65, s65, 8192
    s_waitcnt lgkmcnt(0)
    s_barrier
    ds_read_b128 v[128:131], v242 offset:0
    ds_read_b128 v[132:135], v242 offset:1024
    ds_read_b128 v[160:163], v242 offset:8192
    ds_read_b128 v[164:167], v242 offset:9216
    ds_read_b128 v[136:139], v242 offset:2048
    ds_read_b128 v[140:143], v242 offset:3072
    ds_read_b128 v[168:171], v242 offset:10240
    ds_read_b128 v[172:175], v242 offset:11264
    ds_read_b128 v[144:147], v242 offset:4096
    ds_read_b128 v[148:151], v242 offset:5120
    ds_read_b128 v[176:179], v242 offset:12288
    ds_read_b128 v[180:183], v242 offset:13312
    ds_read_b128 v[152:155], v242 offset:6144
    ds_read_b128 v[156:159], v242 offset:7168
    ds_read_b128 v[184:187], v242 offset:14336
    ds_read_b128 v[188:191], v242 offset:15360
    v_pk_mul_f32 v[64:65], v[64:65], v[232:233] op_sel_hi:[1,0]
    v_pk_mul_f32 v[66:67], v[66:67], v[232:233] op_sel_hi:[1,0]
    v_pk_mul_f32 v[68:69], v[68:69], v[232:233] op_sel_hi:[1,0]
    v_pk_mul_f32 v[70:71], v[70:71], v[232:233] op_sel_hi:[1,0]
    s_waitcnt lgkmcnt(14)
    v_pk_fma_f32 v[64:65], v[128:129], v[236:237], v[64:65] op_sel_hi:[1,0,1]
    v_pk_fma_f32 v[66:67], v[130:131], v[236:237], v[66:67] op_sel_hi:[1,0,1]
    v_pk_fma_f32 v[68:69], v[132:133], v[236:237], v[68:69] op_sel_hi:[1,0,1]
    v_pk_fma_f32 v[70:71], v[134:135], v[236:237], v[70:71] op_sel_hi:[1,0,1]
    v_cvt_pk_bf16_f32 v64, v64, v65
    v_cvt_pk_bf16_f32 v65, v66, v67
    v_cvt_pk_bf16_f32 v66, v68, v69
    v_cvt_pk_bf16_f32 v67, v70, v71
    buffer_store_dwordx4 v[64:67], v2, s[48:51], s67 offen offset:0 sc1
    v_pk_mul_f32 v[96:97], v[96:97], v[234:235] op_sel_hi:[1,0]
    v_pk_mul_f32 v[98:99], v[98:99], v[234:235] op_sel_hi:[1,0]
    v_pk_mul_f32 v[100:101], v[100:101], v[234:235] op_sel_hi:[1,0]
    v_pk_mul_f32 v[102:103], v[102:103], v[234:235] op_sel_hi:[1,0]
    s_waitcnt lgkmcnt(12)
    v_pk_fma_f32 v[96:97], v[160:161], v[238:239], v[96:97] op_sel_hi:[1,0,1]
    v_pk_fma_f32 v[98:99], v[162:163], v[238:239], v[98:99] op_sel_hi:[1,0,1]
    v_pk_fma_f32 v[100:101], v[164:165], v[238:239], v[100:101] op_sel_hi:[1,0,1]
    v_pk_fma_f32 v[102:103], v[166:167], v[238:239], v[102:103] op_sel_hi:[1,0,1]
    v_cvt_pk_bf16_f32 v96, v96, v97
    v_cvt_pk_bf16_f32 v97, v98, v99
    v_cvt_pk_bf16_f32 v98, v100, v101
    v_cvt_pk_bf16_f32 v99, v102, v103
    buffer_store_dwordx4 v[96:99], v2, s[48:51], s67 offen offset:1024 sc1
    s_add_u32 s67, s67, 4096
    s_waitcnt vmcnt(7) lgkmcnt(0)
    s_barrier
    s_add_u32 m0, s66, 0
    s_nop 0
    buffer_load_dwordx4 v10, s[36:39], s64 offen offset:0 lds
    ds_read_b128 a[32:35], v40 offset:0
    ds_read_b64_tr_b16 a[0:1], v20 offset:0
    ds_read_b64_tr_b16 a[2:3], v20 offset:4096
    buffer_load_dwordx4 v11, s[36:39], s64 offen offset:1024 lds
    ds_read_b128 a[36:39], v40 offset:8192
    ds_read_b64_tr_b16 a[4:5], v20 offset:8192
    ds_read_b64_tr_b16 a[6:7], v20 offset:12288
    v_pk_mul_f32 v[72:73], v[72:73], v[232:233] op_sel_hi:[1,0]
    v_pk_mul_f32 v[74:75], v[74:75], v[232:233] op_sel_hi:[1,0]
    v_pk_mul_f32 v[76:77], v[76:77], v[232:233] op_sel_hi:[1,0]
    v_pk_mul_f32 v[78:79], v[78:79], v[232:233] op_sel_hi:[1,0]
    v_pk_fma_f32 v[72:73], v[136:137], v[236:237], v[72:73] op_sel_hi:[1,0,1]
    v_pk_fma_f32 v[74:75], v[138:139], v[236:237], v[74:75] op_sel_hi:[1,0,1]
    v_pk_fma_f32 v[76:77], v[140:141], v[236:237], v[76:77] op_sel_hi:[1,0,1]
    v_pk_fma_f32 v[78:79], v[142:143], v[236:237], v[78:79] op_sel_hi:[1,0,1]
    v_cvt_pk_bf16_f32 v72, v72, v73
    v_cvt_pk_bf16_f32 v73, v74, v75
    v_cvt_pk_bf16_f32 v74, v76, v77
    v_cvt_pk_bf16_f32 v75, v78, v79
    buffer_store_dwordx4 v[72:75], v2, s[48:51], s67 offen offset:0 sc1
    buffer_load_dwordx4 v12, s[36:39], s64 offen offset:2048 lds
    ds_read_b128 a[40:43], v41 offset:0
    ds_read_b64_tr_b16 a[8:9], v21 offset:0
    ds_read_b64_tr_b16 a[10:11], v21 offset:4096
    buffer_load_dwordx4 v13, s[36:39], s64 offen offset:3072 lds
    s_add_u32 s64, s64, 65536
    ds_read_b128 a[44:47], v41 offset:8192
    ds_read_b64_tr_b16 a[12:13], v21 offset:8192
    ds_read_b64_tr_b16 a[14:15], v21 offset:12288
    v_pk_mul_f32 v[104:105], v[104:105], v[234:235] op_sel_hi:[1,0]
    v_pk_mul_f32 v[106:107], v[106:107], v[234:235] op_sel_hi:[1,0]
    v_pk_mul_f32 v[108:109], v[108:109], v[234:235] op_sel_hi:[1,0]
    v_pk_mul_f32 v[110:111], v[110:111], v[234:235] op_sel_hi:[1,0]
    v_pk_fma_f32 v[104:105], v[168:169], v[238:239], v[104:105] op_sel_hi:[1,0,1]
    v_pk_fma_f32 v[106:107], v[170:171], v[238:239], v[106:107] op_sel_hi:[1,0,1]
    v_pk_fma_f32 v[108:109], v[172:173], v[238:239], v[108:109] op_sel_hi:[1,0,1]
    v_pk_fma_f32 v[110:111], v[174:175], v[238:239], v[110:111] op_sel_hi:[1,0,1]
    v_cvt_pk_bf16_f32 v104, v104, v105
    v_cvt_pk_bf16_f32 v105, v106, v107
    v_cvt_pk_bf16_f32 v106, v108, v109
    v_cvt_pk_bf16_f32 v107, v110, v111
    buffer_store_dwordx4 v[104:107], v2, s[48:51], s67 offen offset:1024 sc1
    s_add_u32 s67, s67, 4096
    s_add_u32 m0, s66, 16384
    s_nop 0
    buffer_load_dwordx4 v10, s[36:39], s64 offen offset:0 lds
    ds_read_b128 a[48:51], v42 offset:0
    ds_read_b64_tr_b16 a[16:17], v22 offset:0
    ds_read_b64_tr_b16 a[18:19], v22 offset:4096
    v_pk_mul_f32 v[80:81], v[80:81], v[232:233] op_sel_hi:[1,0]
    v_pk_mul_f32 v[82:83], v[82:83], v[232:233] op_sel_hi:[1,0]
    v_pk_mul_f32 v[84:85], v[84:85], v[232:233] op_sel_hi:[1,0]
    v_pk_mul_f32 v[86:87], v[86:87], v[232:233] op_sel_hi:[1,0]
    v_pk_fma_f32 v[80:81], v[144:145], v[236:237], v[80:81] op_sel_hi:[1,0,1]
    v_pk_fma_f32 v[82:83], v[146:147], v[236:237], v[82:83] op_sel_hi:[1,0,1]
    v_pk_fma_f32 v[84:85], v[148:149], v[236:237], v[84:85] op_sel_hi:[1,0,1]
    v_pk_fma_f32 v[86:87], v[150:151], v[236:237], v[86:87] op_sel_hi:[1,0,1]
    v_cvt_pk_bf16_f32 v80, v80, v81
    v_cvt_pk_bf16_f32 v81, v82, v83
    v_cvt_pk_bf16_f32 v82, v84, v85
    v_cvt_pk_bf16_f32 v83, v86, v87
    buffer_store_dwordx4 v[80:83], v2, s[48:51], s67 offen offset:0 sc1
    buffer_load_dwordx4 v11, s[36:39], s64 offen offset:1024 lds
    ds_read_b128 a[52:55], v42 offset:8192
    ds_read_b64_tr_b16 a[20:21], v22 offset:8192
    ds_read_b64_tr_b16 a[22:23], v22 offset:12288
    buffer_load_dwordx4 v12, s[36:39], s64 offen offset:2048 lds
    ds_read_b128 a[56:59], v43 offset:0
    ds_read_b64_tr_b16 a[24:25], v23 offset:0
    ds_read_b64_tr_b16 a[26:27], v23 offset:4096
    v_pk_mul_f32 v[112:113], v[112:113], v[234:235] op_sel_hi:[1,0]
    v_pk_mul_f32 v[114:115], v[114:115], v[234:235] op_sel_hi:[1,0]
    v_pk_mul_f32 v[116:117], v[116:117], v[234:235] op_sel_hi:[1,0]
    v_pk_mul_f32 v[118:119], v[118:119], v[234:235] op_sel_hi:[1,0]
    v_pk_fma_f32 v[112:113], v[176:177], v[238:239], v[112:113] op_sel_hi:[1,0,1]
    v_pk_fma_f32 v[114:115], v[178:179], v[238:239], v[114:115] op_sel_hi:[1,0,1]
    v_pk_fma_f32 v[116:117], v[180:181], v[238:239], v[116:117] op_sel_hi:[1,0,1]
    v_pk_fma_f32 v[118:119], v[182:183], v[238:239], v[118:119] op_sel_hi:[1,0,1]
    v_cvt_pk_bf16_f32 v112, v112, v113
    v_cvt_pk_bf16_f32 v113, v114, v115
    v_cvt_pk_bf16_f32 v114, v116, v117
    v_cvt_pk_bf16_f32 v115, v118, v119
    buffer_store_dwordx4 v[112:115], v2, s[48:51], s67 offen offset:1024 sc1
    s_add_u32 s67, s67, 4096
    buffer_load_dwordx4 v13, s[36:39], s64 offen offset:3072 lds
    s_add_u32 s64, s64, 65536
    ds_read_b128 a[60:63], v43 offset:8192
    ds_read_b64_tr_b16 a[28:29], v23 offset:8192
    ds_read_b64_tr_b16 a[30:31], v23 offset:12288
    v_pk_mul_f32 v[88:89], v[88:89], v[232:233] op_sel_hi:[1,0]
    v_pk_mul_f32 v[90:91], v[90:91], v[232:233] op_sel_hi:[1,0]
    v_pk_mul_f32 v[92:93], v[92:93], v[232:233] op_sel_hi:[1,0]
    v_pk_mul_f32 v[94:95], v[94:95], v[232:233] op_sel_hi:[1,0]
    v_pk_fma_f32 v[88:89], v[152:153], v[236:237], v[88:89] op_sel_hi:[1,0,1]
    v_pk_fma_f32 v[90:91], v[154:155], v[236:237], v[90:91] op_sel_hi:[1,0,1]
    v_pk_fma_f32 v[92:93], v[156:157], v[236:237], v[92:93] op_sel_hi:[1,0,1]
    v_pk_fma_f32 v[94:95], v[158:159], v[236:237], v[94:95] op_sel_hi:[1,0,1]
    v_cvt_pk_bf16_f32 v88, v88, v89
    v_cvt_pk_bf16_f32 v89, v90, v91
    v_cvt_pk_bf16_f32 v90, v92, v93
    v_cvt_pk_bf16_f32 v91, v94, v95
    buffer_store_dwordx4 v[88:91], v2, s[48:51], s67 offen offset:0 sc1
    v_pk_mul_f32 v[120:121], v[120:121], v[234:235] op_sel_hi:[1,0]
    v_pk_mul_f32 v[122:123], v[122:123], v[234:235] op_sel_hi:[1,0]
    v_pk_mul_f32 v[124:125], v[124:125], v[234:235] op_sel_hi:[1,0]
    v_pk_mul_f32 v[126:127], v[126:127], v[234:235] op_sel_hi:[1,0]
    v_pk_fma_f32 v[120:121], v[184:185], v[238:239], v[120:121] op_sel_hi:[1,0,1]
    v_pk_fma_f32 v[122:123], v[186:187], v[238:239], v[122:123] op_sel_hi:[1,0,1]
    v_pk_fma_f32 v[124:125], v[188:189], v[238:239], v[124:125] op_sel_hi:[1,0,1]
    v_pk_fma_f32 v[126:127], v[190:191], v[238:239], v[126:127] op_sel_hi:[1,0,1]
    v_cvt_pk_bf16_f32 v120, v120, v121
    v_cvt_pk_bf16_f32 v121, v122, v123
    v_cvt_pk_bf16_f32 v122, v124, v125
    v_cvt_pk_bf16_f32 v123, v126, v127
    buffer_store_dwordx4 v[120:123], v2, s[48:51], s67 offen offset:1024 sc1
    s_branch L_findone
L_finA:
    v_mfma_f32_16x16x32_bf16 a[64:67], a[192:195], v[216:219], a[64:67]
    v_mfma_f32_16x16x32_bf16 a[68:71], a[196:199], v[216:219], a[68:71]
    s_waitcnt lgkmcnt(0)
    v_mfma_f32_16x16x32_bf16 a[72:75], a[200:203], v[216:219], a[72:75]
    ds_write_b128 v241, a[0:3] offset:0
    v_min_f32 v32, v226, v56
    v_min_f32 v33, v227, v60
    v_sub_f32 v232, v32, v56
    v_sub_f32 v236, v32, v226
    v_mfma_f32_16x16x32_bf16 a[76:79], a[204:207], v[216:219], a[76:79]
    ds_write_b128 v241, a[4:7] offset:1024
    v_sub_f32 v234, v33, v60
    v_sub_f32 v238, v33, v227
    v_exp_f32 v232, v232
    v_exp_f32 v236, v236
    v_mfma_f32_16x16x32_bf16 a[80:83], a[208:211], v[216:219], a[80:83]
    ds_write_b128 v241, a[8:11] offset:2048
    v_exp_f32 v234, v234
    v_exp_f32 v238, v238
    s_nop 0
    v_mul_f32 v32, v46, v232
    v_mfma_f32_16x16x32_bf16 a[84:87], a[212:215], v[216:219], a[84:87]
    ds_write_b128 v241, a[12:15] offset:3072
    v_mul_f32 v33, v47, v234
    v_fma_f32 v32, v230, v236, v32
    v_fma_f32 v33, v231, v238, v33
    v_mov_b32 v34, v32
    v_mfma_f32_16x16x32_bf16 a[88:91], a[216:219], v[216:219], a[88:91]
    ds_write_b128 v241, a[16:19] offset:4096
    v_mov_b32 v35, v33
    s_nop 1
    v_permlane16_swap_b32 v32, v34
    v_permlane16_swap_b32 v33, v35
    v_mfma_f32_16x16x32_bf16 a[92:95], a[220:223], v[216:219], a[92:95]
    ds_write_b128 v241, a[20:23] offset:5120
    v_add_f32 v32, v32, v34
    v_add_f32 v33, v33, v35
    v_mov_b32 v34, v32
    v_mov_b32 v35, v33
    v_mfma_f32_16x16x32_bf16 a[124:127], a[220:223], v[220:223], a[124:127]
    ds_write_b128 v241, a[24:27] offset:6144
    s_nop 1
    v_permlane32_swap_b32 v32, v34
    v_permlane32_swap_b32 v33, v35
    v_add_f32 v32, v32, v34
    v_mfma_f32_16x16x32_bf16 a[120:123], a[216:219], v[220:223], a[120:123]
    ds_write_b128 v241, a[28:31] offset:7168
    v_add_f32 v33, v33, v35
    v_rcp_f32 v32, v32
    v_rcp_f32 v33, v33
    s_nop 0
    v_mfma_f32_16x16x32_bf16 a[116:119], a[212:215], v[220:223], a[116:119]
    ds_write_b128 v241, a[32:35] offset:8192
    v_mul_f32 v232, v232, v32
    v_mul_f32 v236, v236, v32
    v_mul_f32 v234, v234, v33
    v_mul_f32 v238, v238, v33
    v_mfma_f32_16x16x32_bf16 a[112:115], a[208:211], v[220:223], a[112:115]
    ds_write_b128 v241, a[36:39] offset:9216
    s_add_u32 s69, s84, 1
    s_and_b32 s69, s69, 3
    s_lshl_b32 s4, s69, 10
    v_add_u32 v40, s4, v24
    v_mfma_f32_16x16x32_bf16 a[108:111], a[204:207], v[220:223], a[108:111]
    ds_write_b128 v241, a[40:43] offset:10240
    s_add_u32 s69, s84, 2
    s_and_b32 s69, s69, 3
    s_lshl_b32 s5, s69, 10
    v_add_u32 v41, s5, v24
    v_mfma_f32_16x16x32_bf16 a[104:107], a[200:203], v[220:223], a[104:107]
    ds_write_b128 v241, a[44:47] offset:11264
    s_add_u32 s69, s84, 3
    s_and_b32 s69, s69, 3
    s_lshl_b32 s6, s69, 10
    v_add_u32 v42, s6, v24
    v_mfma_f32_16x16x32_bf16 a[100:103], a[196:199], v[220:223], a[100:103]
    ds_write_b128 v241, a[48:51] offset:12288
    s_add_u32 s69, s84, 4
    s_and_b32 s69, s69, 3
    s_lshl_b32 s7, s69, 10
    v_add_u32 v43, s7, v24
    v_mfma_f32_16x16x32_bf16 a[96:99], a[192:195], v[220:223], a[96:99]
    ds_write_b128 v241, a[52:55] offset:13312
    ds_write_b128 v241, a[56:59] offset:14336
    v_accvgpr_read_b32 v64, a64
    v_accvgpr_read_b32 v65, a65
    v_accvgpr_read_b32 v66, a66
    v_accvgpr_read_b32 v67, a67
    v_accvgpr_read_b32 v68, a68
    v_accvgpr_read_b32 v69, a69
    v_accvgpr_read_b32 v70, a70
    v_accvgpr_read_b32 v71, a71
    ds_write_b128 v241, a[60:63] offset:15360
    s_add_u32 m0, s66, 114688
    s_nop 0
    buffer_load_dwordx4 v2, s[48:51], s65 offen offset:0 sc1 lds
    v_accvgpr_read_b32 v72, a72
    v_accvgpr_read_b32 v73, a73
    v_accvgpr_read_b32 v74, a74
    v_accvgpr_read_b32 v75, a75
    v_accvgpr_read_b32 v76, a76
    v_accvgpr_read_b32 v77, a77
    v_accvgpr_read_b32 v78, a78
    v_accvgpr_read_b32 v79, a79
    v_accvgpr_read_b32 v80, a80
    v_accvgpr_read_b32 v81, a81
    v_accvgpr_read_b32 v82, a82
    v_accvgpr_read_b32 v83, a83
    v_accvgpr_read_b32 v84, a84
    v_accvgpr_read_b32 v85, a85
    buffer_load_dwordx4 v2, s[48:51], s65 offen offset:1024 sc1 lds
    v_accvgpr_read_b32 v86, a86
    v_accvgpr_read_b32 v87, a87
    v_accvgpr_read_b32 v88, a88
    v_accvgpr_read_b32 v89, a89
    v_accvgpr_read_b32 v90, a90
    v_accvgpr_read_b32 v91, a91
    v_accvgpr_read_b32 v92, a92
    v_accvgpr_read_b32 v93, a93
    v_accvgpr_read_b32 v94, a94
    v_accvgpr_read_b32 v95, a95
    v_accvgpr_read_b32 v124, a124
    v_accvgpr_read_b32 v125, a125
    v_accvgpr_read_b32 v126, a126
    v_accvgpr_read_b32 v127, a127
    buffer_load_dwordx4 v2, s[48:51], s65 offen offset:2048 sc1 lds
    v_accvgpr_read_b32 v120, a120
    v_accvgpr_read_b32 v121, a121
    v_accvgpr_read_b32 v122, a122
    v_accvgpr_read_b32 v123, a123
    v_accvgpr_read_b32 v116, a116
    v_accvgpr_read_b32 v117, a117
    v_accvgpr_read_b32 v118, a118
    v_accvgpr_read_b32 v119, a119
    v_accvgpr_read_b32 v112, a112
    v_accvgpr_read_b32 v113, a113
    v_accvgpr_read_b32 v114, a114
    v_accvgpr_read_b32 v115, a115
    v_accvgpr_read_b32 v108, a108
    v_accvgpr_read_b32 v109, a109
    buffer_load_dwordx4 v2, s[48:51], s65 offen offset:3072 sc1 lds
    s_add_u32 s65, s65, 8192
    v_accvgpr_read_b32 v110, a110
    v_accvgpr_read_b32 v111, a111
    v_accvgpr_read_b32 v104, a104
    v_accvgpr_read_b32 v105, a105
    v_accvgpr_read_b32 v106, a106
    v_accvgpr_read_b32 v107, a107
    v_accvgpr_read_b32 v100, a100
    v_accvgpr_read_b32 v101, a101
    v_accvgpr_read_b32 v102, a102
    v_accvgpr_read_b32 v103, a103
    v_accvgpr_read_b32 v96, a96
    v_accvgpr_read_b32 v97, a97
    v_accvgpr_read_b32 v98, a98
    v_accvgpr_read_b32 v99, a99
    s_waitcnt lgkmcnt(0)
    s_barrier
    ds_read_b128 v[128:131], v242 offset:0
    ds_read_b128 v[132:135], v242 offset:1024
    ds_read_b128 v[160:163], v242 offset:8192
    ds_read_b128 v[164:167], v242 offset:9216
    ds_read_b128 v[136:139], v242 offset:2048
    ds_read_b128 v[140:143], v242 offset:3072
    ds_read_b128 v[168:171], v242 offset:10240
    ds_read_b128 v[172:175], v242 offset:11264
    ds_read_b128 v[144:147], v242 offset:4096
    ds_read_b128 v[148:151], v242 offset:5120
    ds_read_b128 v[176:179], v242 offset:12288
    ds_read_b128 v[180:183], v242 offset:13312
    ds_read_b128 v[152:155], v242 offset:6144
    ds_read_b128 v[156:159], v242 offset:7168
    ds_read_b128 v[184:187], v242 offset:14336
    ds_read_b128 v[188:191], v242 offset:15360
    v_pk_mul_f32 v[64:65], v[64:65], v[232:233] op_sel_hi:[1,0]
    v_pk_mul_f32 v[66:67], v[66:67], v[232:233] op_sel_hi:[1,0]
    v_pk_mul_f32 v[68:69], v[68:69], v[232:233] op_sel_hi:[1,0]
    v_pk_mul_f32 v[70:71], v[70:71], v[232:233] op_sel_hi:[1,0]
    s_waitcnt lgkmcnt(14)
    v_pk_fma_f32 v[64:65], v[128:129], v[236:237], v[64:65] op_sel_hi:[1,0,1]
    v_pk_fma_f32 v[66:67], v[130:131], v[236:237], v[66:67] op_sel_hi:[1,0,1]
    v_pk_fma_f32 v[68:69], v[132:133], v[236:237], v[68:69] op_sel_hi:[1,0,1]
    v_pk_fma_f32 v[70:71], v[134:135], v[236:237], v[70:71] op_sel_hi:[1,0,1]
    v_cvt_pk_bf16_f32 v64, v64, v65
    v_cvt_pk_bf16_f32 v65, v66, v67
    v_cvt_pk_bf16_f32 v66, v68, v69
    v_cvt_pk_bf16_f32 v67, v70, v71
    buffer_store_dwordx4 v[64:67], v2, s[48:51], s67 offen offset:2048 sc1
    v_pk_mul_f32 v[96:97], v[96:97], v[234:235] op_sel_hi:[1,0]
    v_pk_mul_f32 v[98:99], v[98:99], v[234:235] op_sel_hi:[1,0]
    v_pk_mul_f32 v[100:101], v[100:101], v[234:235] op_sel_hi:[1,0]
    v_pk_mul_f32 v[102:103], v[102:103], v[234:235] op_sel_hi:[1,0]
    s_waitcnt lgkmcnt(12)
    v_pk_fma_f32 v[96:97], v[160:161], v[238:239], v[96:97] op_sel_hi:[1,0,1]
    v_pk_fma_f32 v[98:99], v[162:163], v[238:239], v[98:99] op_sel_hi:[1,0,1]
    v_pk_fma_f32 v[100:101], v[164:165], v[238:239], v[100:101] op_sel_hi:[1,0,1]
    v_pk_fma_f32 v[102:103], v[166:167], v[238:239], v[102:103] op_sel_hi:[1,0,1]
    v_cvt_pk_bf16_f32 v96, v96, v97
    v_cvt_pk_bf16_f32 v97, v98, v99
    v_cvt_pk_bf16_f32 v98, v100, v101
    v_cvt_pk_bf16_f32 v99, v102, v103
    buffer_store_dwordx4 v[96:99], v2, s[48:51], s67 offen offset:3072 sc1
    s_add_u32 s67, s67, 4096
    s_waitcnt vmcnt(7) lgkmcnt(0)
    s_barrier
    s_add_u32 m0, s66, 0
    s_nop 0
    buffer_load_dwordx4 v10, s[36:39], s64 offen offset:0 lds
    ds_read_b128 a[32:35], v40 offset:0
    ds_read_b64_tr_b16 a[0:1], v20 offset:0
    ds_read_b64_tr_b16 a[2:3], v20 offset:4096
    buffer_load_dwordx4 v11, s[36:39], s64 offen offset:1024 lds
    ds_read_b128 a[36:39], v40 offset:8192
    ds_read_b64_tr_b16 a[4:5], v20 offset:8192
    ds_read_b64_tr_b16 a[6:7], v20 offset:12288
    v_pk_mul_f32 v[72:73], v[72:73], v[232:233] op_sel_hi:[1,0]
    v_pk_mul_f32 v[74:75], v[74:75], v[232:233] op_sel_hi:[1,0]
    v_pk_mul_f32 v[76:77], v[76:77], v[232:233] op_sel_hi:[1,0]
    v_pk_mul_f32 v[78:79], v[78:79], v[232:233] op_sel_hi:[1,0]
    v_pk_fma_f32 v[72:73], v[136:137], v[236:237], v[72:73] op_sel_hi:[1,0,1]
    v_pk_fma_f32 v[74:75], v[138:139], v[236:237], v[74:75] op_sel_hi:[1,0,1]
    v_pk_fma_f32 v[76:77], v[140:141], v[236:237], v[76:77] op_sel_hi:[1,0,1]
    v_pk_fma_f32 v[78:79], v[142:143], v[236:237], v[78:79] op_sel_hi:[1,0,1]
    v_cvt_pk_bf16_f32 v72, v72, v73
    v_cvt_pk_bf16_f32 v73, v74, v75
    v_cvt_pk_bf16_f32 v74, v76, v77
    v_cvt_pk_bf16_f32 v75, v78, v79
    buffer_store_dwordx4 v[72:75], v2, s[48:51], s67 offen offset:2048 sc1
    buffer_load_dwordx4 v12, s[36:39], s64 offen offset:2048 lds
    ds_read_b128 a[40:43], v41 offset:0
    ds_read_b64_tr_b16 a[8:9], v21 offset:0
    ds_read_b64_tr_b16 a[10:11], v21 offset:4096
    buffer_load_dwordx4 v13, s[36:39], s64 offen offset:3072 lds
    s_add_u32 s64, s64, 65536
    ds_read_b128 a[44:47], v41 offset:8192
    ds_read_b64_tr_b16 a[12:13], v21 offset:8192
    ds_read_b64_tr_b16 a[14:15], v21 offset:12288
    v_pk_mul_f32 v[104:105], v[104:105], v[234:235] op_sel_hi:[1,0]
    v_pk_mul_f32 v[106:107], v[106:107], v[234:235] op_sel_hi:[1,0]
    v_pk_mul_f32 v[108:109], v[108:109], v[234:235] op_sel_hi:[1,0]
    v_pk_mul_f32 v[110:111], v[110:111], v[234:235] op_sel_hi:[1,0]
    v_pk_fma_f32 v[104:105], v[168:169], v[238:239], v[104:105] op_sel_hi:[1,0,1]
    v_pk_fma_f32 v[106:107], v[170:171], v[238:239], v[106:107] op_sel_hi:[1,0,1]
    v_pk_fma_f32 v[108:109], v[172:173], v[238:239], v[108:109] op_sel_hi:[1,0,1]
    v_pk_fma_f32 v[110:111], v[174:175], v[238:239], v[110:111] op_sel_hi:[1,0,1]
    v_cvt_pk_bf16_f32 v104, v104, v105
    v_cvt_pk_bf16_f32 v105, v106, v107
    v_cvt_pk_bf16_f32 v106, v108, v109
    v_cvt_pk_bf16_f32 v107, v110, v111
    buffer_store_dwordx4 v[104:107], v2, s[48:51], s67 offen offset:3072 sc1
    s_add_u32 s67, s67, 4096
    s_add_u32 m0, s66, 16384
    s_nop 0
    buffer_load_dwordx4 v10, s[36:39], s64 offen offset:0 lds
    ds_read_b128 a[48:51], v42 offset:0
    ds_read_b64_tr_b16 a[16:17], v22 offset:0
    ds_read_b64_tr_b16 a[18:19], v22 offset:4096
    v_pk_mul_f32 v[80:81], v[80:81], v[232:233] op_sel_hi:[1,0]
    v_pk_mul_f32 v[82:83], v[82:83], v[232:233] op_sel_hi:[1,0]
    v_pk_mul_f32 v[84:85], v[84:85], v[232:233] op_sel_hi:[1,0]
    v_pk_mul_f32 v[86:87], v[86:87], v[232:233] op_sel_hi:[1,0]
    v_pk_fma_f32 v[80:81], v[144:145], v[236:237], v[80:81] op_sel_hi:[1,0,1]
    v_pk_fma_f32 v[82:83], v[146:147], v[236:237], v[82:83] op_sel_hi:[1,0,1]
    v_pk_fma_f32 v[84:85], v[148:149], v[236:237], v[84:85] op_sel_hi:[1,0,1]
    v_pk_fma_f32 v[86:87], v[150:151], v[236:237], v[86:87] op_sel_hi:[1,0,1]
    v_cvt_pk_bf16_f32 v80, v80, v81
    v_cvt_pk_bf16_f32 v81, v82, v83
    v_cvt_pk_bf16_f32 v82, v84, v85
    v_cvt_pk_bf16_f32 v83, v86, v87
    buffer_store_dwordx4 v[80:83], v2, s[48:51], s67 offen offset:2048 sc1
    buffer_load_dwordx4 v11, s[36:39], s64 offen offset:1024 lds
    ds_read_b128 a[52:55], v42 offset:8192
    ds_read_b64_tr_b16 a[20:21], v22 offset:8192
    ds_read_b64_tr_b16 a[22:23], v22 offset:12288
    buffer_load_dwordx4 v12, s[36:39], s64 offen offset:2048 lds
    ds_read_b128 a[56:59], v43 offset:0
    ds_read_b64_tr_b16 a[24:25], v23 offset:0
    ds_read_b64_tr_b16 a[26:27], v23 offset:4096
    v_pk_mul_f32 v[112:113], v[112:113], v[234:235] op_sel_hi:[1,0]
    v_pk_mul_f32 v[114:115], v[114:115], v[234:235] op_sel_hi:[1,0]
    v_pk_mul_f32 v[116:117], v[116:117], v[234:235] op_sel_hi:[1,0]
    v_pk_mul_f32 v[118:119], v[118:119], v[234:235] op_sel_hi:[1,0]
    v_pk_fma_f32 v[112:113], v[176:177], v[238:239], v[112:113] op_sel_hi:[1,0,1]
    v_pk_fma_f32 v[114:115], v[178:179], v[238:239], v[114:115] op_sel_hi:[1,0,1]
    v_pk_fma_f32 v[116:117], v[180:181], v[238:239], v[116:117] op_sel_hi:[1,0,1]
    v_pk_fma_f32 v[118:119], v[182:183], v[238:239], v[118:119] op_sel_hi:[1,0,1]
    v_cvt_pk_bf16_f32 v112, v112, v113
    v_cvt_pk_bf16_f32 v113, v114, v115
    v_cvt_pk_bf16_f32 v114, v116, v117
    v_cvt_pk_bf16_f32 v115, v118, v119
    buffer_store_dwordx4 v[112:115], v2, s[48:51], s67 offen offset:3072 sc1
    s_add_u32 s67, s67, 4096
    buffer_load_dwordx4 v13, s[36:39], s64 offen offset:3072 lds
    s_add_u32 s64, s64, 65536
    ds_read_b128 a[60:63], v43 offset:8192
    ds_read_b64_tr_b16 a[28:29], v23 offset:8192
    ds_read_b64_tr_b16 a[30:31], v23 offset:12288
    v_pk_mul_f32 v[88:89], v[88:89], v[232:233] op_sel_hi:[1,0]
    v_pk_mul_f32 v[90:91], v[90:91], v[232:233] op_sel_hi:[1,0]
    v_pk_mul_f32 v[92:93], v[92:93], v[232:233] op_sel_hi:[1,0]
    v_pk_mul_f32 v[94:95], v[94:95], v[232:233] op_sel_hi:[1,0]
    v_pk_fma_f32 v[88:89], v[152:153], v[236:237], v[88:89] op_sel_hi:[1,0,1]
    v_pk_fma_f32 v[90:91], v[154:155], v[236:237], v[90:91] op_sel_hi:[1,0,1]
    v_pk_fma_f32 v[92:93], v[156:157], v[236:237], v[92:93] op_sel_hi:[1,0,1]
    v_pk_fma_f32 v[94:95], v[158:159], v[236:237], v[94:95] op_sel_hi:[1,0,1]
    v_cvt_pk_bf16_f32 v88, v88, v89
    v_cvt_pk_bf16_f32 v89, v90, v91
    v_cvt_pk_bf16_f32 v90, v92, v93
    v_cvt_pk_bf16_f32 v91, v94, v95
    buffer_store_dwordx4 v[88:91], v2, s[48:51], s67 offen offset:2048 sc1
    v_pk_mul_f32 v[120:121], v[120:121], v[234:235] op_sel_hi:[1,0]
    v_pk_mul_f32 v[122:123], v[122:123], v[234:235] op_sel_hi:[1,0]
    v_pk_mul_f32 v[124:125], v[124:125], v[234:235] op_sel_hi:[1,0]
    v_pk_mul_f32 v[126:127], v[126:127], v[234:235] op_sel_hi:[1,0]
    v_pk_fma_f32 v[120:121], v[184:185], v[238:239], v[120:121] op_sel_hi:[1,0,1]
    v_pk_fma_f32 v[122:123], v[186:187], v[238:239], v[122:123] op_sel_hi:[1,0,1]
    v_pk_fma_f32 v[124:125], v[188:189], v[238:239], v[124:125] op_sel_hi:[1,0,1]
    v_pk_fma_f32 v[126:127], v[190:191], v[238:239], v[126:127] op_sel_hi:[1,0,1]
    v_cvt_pk_bf16_f32 v120, v120, v121
    v_cvt_pk_bf16_f32 v121, v122, v123
    v_cvt_pk_bf16_f32 v122, v124, v125
    v_cvt_pk_bf16_f32 v123, v126, v127
    buffer_store_dwordx4 v[120:123], v2, s[48:51], s67 offen offset:3072 sc1
L_findone:
    s_waitcnt lgkmcnt(0)
    v_mfma_f32_16x16x32_bf16 v[128:131], a[0:3], a[32:35], 0
    s_barrier
    ds_read_b128 a[96:99], v40 offset:16384
    ds_read_b64_tr_b16 a[64:65], v20 offset:16384
    v_mfma_f32_16x16x32_bf16 v[128:131], a[4:7], a[36:39], v[128:131]
    ds_read_b64_tr_b16 a[66:67], v20 offset:20480
    v_add_u32 v14, 8192, v14
    v_mfma_f32_16x16x32_bf16 v[132:135], a[12:15], a[36:39], 0
    s_add_u32 m0, s66, 131072
    ds_read_b128 a[100:103], v40 offset:24576
    ds_read_b64_tr_b16 a[68:69], v20 offset:24576
    v_mfma_f32_16x16x32_bf16 v[132:135], a[8:11], a[32:35], v[132:135]
    s_sub_u32 s69, 15, s85
    buffer_load_dwordx4 v10, s[36:39], s64 offen offset:0 lds
    v_mfma_f32_16x16x32_bf16 v[136:139], a[16:19], a[32:35], 0
    s_min_u32 s69, s69, s85
    ds_read_b64_tr_b16 a[70:71], v20 offset:28672
    ds_read_b128 a[104:107], v41 offset:16384
    v_mfma_f32_16x16x32_bf16 v[136:139], a[20:23], a[36:39], v[136:139]
    s_lshl_b32 s69, s69, 3
    ds_read_b64_tr_b16 a[72:73], v21 offset:16384
    v_mfma_f32_16x16x32_bf16 v[140:143], a[28:31], a[36:39], 0
    s_and_b32 s70, s2, 7
    ds_read_b64_tr_b16 a[74:75], v21 offset:20480
    ds_read_b128 a[108:111], v41 offset:24576
    v_mfma_f32_16x16x32_bf16 v[140:143], a[24:27], a[32:35], v[140:143]
    s_add_u32 s69, s69, s70
    buffer_load_dwordx4 v11, s[36:39], s64 offen offset:1024 lds
    v_mfma_f32_16x16x32_bf16 v[156:159], a[24:27], a[40:43], 0
    s_and_b32 s70, s2, 4
    ds_read_b64_tr_b16 a[76:77], v21 offset:24576
    v_mfma_f32_16x16x32_bf16 v[156:159], a[28:31], a[44:47], v[156:159]
    s_lshl_b32 s70, s70, 4
    ds_read_b64_tr_b16 a[78:79], v21 offset:28672
    v_mfma_f32_16x16x32_bf16 v[152:155], a[20:23], a[44:47], 0
    s_add_u32 s69, s69, s70
    ds_read_b128 a[112:115], v42 offset:16384
    v_mfma_f32_16x16x32_bf16 v[152:155], a[16:19], a[40:43], v[152:155]
    s_lshl_b32 s69, s69, 7
    buffer_load_dwordx4 v12, s[36:39], s64 offen offset:2048 lds
    v_mfma_f32_16x16x32_bf16 v[148:151], a[8:11], a[40:43], 0
    s_add_u32 s69, s69, 58818560
    ds_read_b64_tr_b16 a[80:81], v22 offset:16384
    v_mov_b32 v15, s69
    v_mfma_f32_16x16x32_bf16 v[148:151], a[12:15], a[44:47], v[148:151]
    ds_read_b64_tr_b16 a[82:83], v22 offset:20480
    v_mfma_f32_16x16x32_bf16 v[144:147], a[4:7], a[44:47], 0
    ds_read_b128 a[116:119], v42 offset:24576
    v_mfma_f32_16x16x32_bf16 v[144:147], a[0:3], a[40:43], v[144:147]
    buffer_load_dwordx4 v13, s[36:39], s64 offen offset:3072 lds
    v_mfma_f32_16x16x32_bf16 v[160:163], a[0:3], a[48:51], 0
    s_add_u32 s64, s64, 65536
    ds_read_b64_tr_b16 a[84:85], v22 offset:24576
    v_mfma_f32_16x16x32_bf16 v[160:163], a[4:7], a[52:55], v[160:163]
    ds_read_b64_tr_b16 a[86:87], v22 offset:28672
    v_mfma_f32_16x16x32_bf16 v[164:167], a[12:15], a[52:55], 0
    s_add_u32 m0, s66, 65536
    ds_read_b128 a[120:123], v43 offset:16384
    v_mfma_f32_16x16x32_bf16 v[164:167], a[8:11], a[48:51], v[164:167]
    buffer_load_dwordx4 v2, s[48:51], s65 offen offset:0 sc1 lds
    v_mfma_f32_16x16x32_bf16 v[168:171], a[16:19], a[48:51], 0
    ds_read_b64_tr_b16 a[88:89], v23 offset:16384
    v_mfma_f32_16x16x32_bf16 v[168:171], a[20:23], a[52:55], v[168:171]
    ds_read_b64_tr_b16 a[90:91], v23 offset:20480
    v_mfma_f32_16x16x32_bf16 v[172:175], a[28:31], a[52:55], 0
    ds_read_b128 a[124:127], v43 offset:24576
    v_mfma_f32_16x16x32_bf16 v[172:175], a[24:27], a[48:51], v[172:175]
    buffer_load_dwordx4 v2, s[48:51], s65 offen offset:1024 sc1 lds
    v_mfma_f32_16x16x32_bf16 v[188:191], a[24:27], a[56:59], 0
    ds_read_b64_tr_b16 a[92:93], v23 offset:24576
    v_mfma_f32_16x16x32_bf16 v[188:191], a[28:31], a[60:63], v[188:191]
    ds_read_b64_tr_b16 a[94:95], v23 offset:28672
    v_mfma_f32_16x16x32_bf16 v[184:187], a[20:23], a[60:63], 0
    v_mfma_f32_16x16x32_bf16 v[184:187], a[16:19], a[56:59], v[184:187]
    buffer_load_dwordx4 v2, s[48:51], s65 offen offset:2048 sc1 lds
    v_mfma_f32_16x16x32_bf16 v[180:183], a[8:11], a[56:59], 0
    v_mfma_f32_16x16x32_bf16 v[180:183], a[12:15], a[60:63], v[180:183]
    v_mfma_f32_16x16x32_bf16 v[176:179], a[4:7], a[60:63], 0
    v_mfma_f32_16x16x32_bf16 v[176:179], a[0:3], a[56:59], v[176:179]
    s_waitcnt vmcnt(7) lgkmcnt(0)
    buffer_load_dwordx4 v2, s[48:51], s65 offen offset:3072 sc1 lds
    s_add_u32 s65, s65, 8192
    v_mfma_f32_16x16x32_bf16 v[128:131], a[64:67], a[96:99], v[128:131]
    s_barrier
    ds_read_b128 a[160:163], v40 offset:32768
    ds_read_b64_tr_b16 a[128:129], v16 offset:0
    v_mfma_f32_16x16x32_bf16 v[128:131], a[68:71], a[100:103], v[128:131]
    ds_read_b64_tr_b16 a[130:131], v16 offset:4096
    buffer_atomic_add v9, v14, s[48:51], 0 offen sc1
    v_mfma_f32_16x16x32_bf16 v[132:135], a[76:79], a[100:103], v[132:135]
    s_add_u32 m0, s66, 147456
    ds_read_b128 a[164:167], v40 offset:40960
    ds_read_b64_tr_b16 a[132:133], v16 offset:8192
    v_mfma_f32_16x16x32_bf16 v[132:135], a[72:75], a[96:99], v[132:135]
    buffer_load_dwordx4 v10, s[36:39], s64 offen offset:0 lds
    v_mfma_f32_16x16x32_bf16 v[136:139], a[80:83], a[96:99], v[136:139]
    ds_read_b64_tr_b16 a[134:135], v16 offset:12288
    ds_read_b128 a[168:171], v41 offset:32768
    v_mfma_f32_16x16x32_bf16 v[136:139], a[84:87], a[100:103], v[136:139]
    ds_read_b64_tr_b16 a[136:137], v17 offset:0
    v_and_b32 v32, 15, v1
    v_mfma_f32_16x16x32_bf16 v[140:143], a[92:95], a[100:103], v[140:143]
    ds_read_b64_tr_b16 a[138:139], v17 offset:4096
    ds_read_b128 a[172:175], v41 offset:40960
    v_mfma_f32_16x16x32_bf16 v[140:143], a[88:91], a[96:99], v[140:143]
    buffer_load_dwordx4 v11, s[36:39], s64 offen offset:1024 lds
    v_mfma_f32_16x16x32_bf16 v[156:159], a[88:91], a[104:107], v[156:159]
    ds_read_b64_tr_b16 a[140:141], v17 offset:8192
    v_lshlrev_b32 v32, 2, v32
    v_mfma_f32_16x16x32_bf16 v[156:159], a[92:95], a[108:111], v[156:159]
    s_lshl_b32 s69, s85, 9
    ds_read_b64_tr_b16 a[142:143], v17 offset:12288
    v_mfma_f32_16x16x32_bf16 v[152:155], a[84:87], a[108:111], v[152:155]
    s_and_b32 s70, s60, 1
    ds_read_b128 a[176:179], v42 offset:32768
    v_mfma_f32_16x16x32_bf16 v[152:155], a[80:83], a[104:107], v[152:155]
    s_lshl_b32 s70, s70, 8
    buffer_load_dwordx4 v12, s[36:39], s64 offen offset:2048 lds
    v_mfma_f32_16x16x32_bf16 v[148:151], a[72:75], a[104:107], v[148:151]
    s_add_u32 s69, s69, s70
    ds_read_b64_tr_b16 a[144:145], v18 offset:0
    v_mfma_f32_16x16x32_bf16 v[148:151], a[76:79], a[108:111], v[148:151]
    s_add_u32 s69, s69, 58720256
    ds_read_b64_tr_b16 a[146:147], v18 offset:4096
    v_add_u32 v32, s69, v32
    v_mfma_f32_16x16x32_bf16 v[144:147], a[68:71], a[108:111], v[144:147]
    s_lshr_b32 s56, s4, 4
    ds_read_b128 a[180:183], v42 offset:40960
    v_mfma_f32_16x16x32_bf16 v[144:147], a[64:67], a[104:107], v[144:147]
    s_lshr_b32 s57, s5, 4
    buffer_load_dwordx4 v13, s[36:39], s64 offen offset:3072 lds
    v_mfma_f32_16x16x32_bf16 v[160:163], a[64:67], a[112:115], v[160:163]
    s_add_u32 s64, s64, 65536
    ds_read_b64_tr_b16 a[148:149], v18 offset:8192
    v_mfma_f32_16x16x32_bf16 v[160:163], a[68:71], a[116:119], v[160:163]
    s_lshr_b32 s58, s6, 4
    ds_read_b64_tr_b16 a[150:151], v18 offset:12288
    v_mfma_f32_16x16x32_bf16 v[164:167], a[76:79], a[116:119], v[164:167]
    s_add_u32 m0, s66, 81920
    ds_read_b128 a[184:187], v43 offset:32768
    v_mfma_f32_16x16x32_bf16 v[164:167], a[72:75], a[112:115], v[164:167]
    s_lshr_b32 s59, s7, 4
    buffer_load_dwordx4 v2, s[48:51], s65 offen offset:0 sc1 lds
    v_mfma_f32_16x16x32_bf16 v[168:171], a[80:83], a[112:115], v[168:171]
    ds_read_b64_tr_b16 a[152:153], v19 offset:0
    v_mfma_f32_16x16x32_bf16 v[168:171], a[84:87], a[116:119], v[168:171]
    ds_read_b64_tr_b16 a[154:155], v19 offset:4096
    v_mfma_f32_16x16x32_bf16 v[172:175], a[92:95], a[116:119], v[172:175]
    ds_read_b128 a[188:191], v43 offset:40960
    v_mfma_f32_16x16x32_bf16 v[172:175], a[88:91], a[112:115], v[172:175]
    buffer_load_dwordx4 v2, s[48:51], s65 offen offset:1024 sc1 lds
    v_mfma_f32_16x16x32_bf16 v[188:191], a[88:91], a[120:123], v[188:191]
    ds_read_b64_tr_b16 a[156:157], v19 offset:8192
    v_mfma_f32_16x16x32_bf16 v[188:191], a[92:95], a[124:127], v[188:191]
    ds_read_b64_tr_b16 a[158:159], v19 offset:12288
    v_mfma_f32_16x16x32_bf16 v[184:187], a[84:87], a[124:127], v[184:187]
    buffer_load_dword v26, v32, s[48:51], s56 offen sc1
    v_mfma_f32_16x16x32_bf16 v[184:187], a[80:83], a[120:123], v[184:187]
    buffer_load_dwordx4 v2, s[48:51], s65 offen offset:2048 sc1 lds
    v_mfma_f32_16x16x32_bf16 v[180:183], a[72:75], a[120:123], v[180:183]
    buffer_load_dword v27, v32, s[48:51], s57 offen sc1
    v_mfma_f32_16x16x32_bf16 v[180:183], a[76:79], a[124:127], v[180:183]
    buffer_load_dword v28, v32, s[48:51], s58 offen sc1
    v_mfma_f32_16x16x32_bf16 v[176:179], a[68:71], a[124:127], v[176:179]
    buffer_load_dword v29, v32, s[48:51], s59 offen sc1
    v_mfma_f32_16x16x32_bf16 v[176:179], a[64:67], a[120:123], v[176:179]
    s_waitcnt vmcnt(22) lgkmcnt(0)
    buffer_load_dwordx4 v2, s[48:51], s65 offen offset:3072 sc1 lds
    s_add_u32 s65, s65, 8192
    v_mfma_f32_16x16x32_bf16 v[128:131], a[128:131], a[160:163], v[128:131]
    s_barrier
    ds_read_b128 a[224:227], v40 offset:49152
    ds_read_b64_tr_b16 a[192:193], v16 offset:16384
    v_mfma_f32_16x16x32_bf16 v[128:131], a[132:135], a[164:167], v[128:131]
    ds_read_b64_tr_b16 a[194:195], v16 offset:20480
    v_mfma_f32_16x16x32_bf16 v[132:135], a[140:143], a[164:167], v[132:135]
    s_add_u32 m0, s66, 0
    ds_read_b128 a[228:231], v40 offset:57344
    ds_read_b64_tr_b16 a[196:197], v16 offset:24576
    v_mfma_f32_16x16x32_bf16 v[132:135], a[136:139], a[160:163], v[132:135]
    buffer_load_dwordx4 v10, s[36:39], s64 offen offset:0 lds
    v_mfma_f32_16x16x32_bf16 v[136:139], a[144:147], a[160:163], v[136:139]
    ds_read_b64_tr_b16 a[198:199], v16 offset:28672
    ds_read_b128 a[232:235], v41 offset:49152
    v_mfma_f32_16x16x32_bf16 v[136:139], a[148:151], a[164:167], v[136:139]
    ds_read_b64_tr_b16 a[200:201], v17 offset:16384
    v_mfma_f32_16x16x32_bf16 v[140:143], a[156:159], a[164:167], v[140:143]
    ds_read_b64_tr_b16 a[202:203], v17 offset:20480
    ds_read_b128 a[236:239], v41 offset:57344
    v_mfma_f32_16x16x32_bf16 v[140:143], a[152:155], a[160:163], v[140:143]
    buffer_load_dwordx4 v11, s[36:39], s64 offen offset:1024 lds
    v_mfma_f32_16x16x32_bf16 v[156:159], a[152:155], a[168:171], v[156:159]
    ds_read_b64_tr_b16 a[204:205], v17 offset:24576
    v_mfma_f32_16x16x32_bf16 v[156:159], a[156:159], a[172:175], v[156:159]
    ds_read_b64_tr_b16 a[206:207], v17 offset:28672
    v_mfma_f32_16x16x32_bf16 v[152:155], a[148:151], a[172:175], v[152:155]
    ds_read_b128 a[240:243], v42 offset:49152
    v_mfma_f32_16x16x32_bf16 v[152:155], a[144:147], a[168:171], v[152:155]
    buffer_load_dwordx4 v12, s[36:39], s64 offen offset:2048 lds
    v_mfma_f32_16x16x32_bf16 v[148:151], a[136:139], a[168:171], v[148:151]
    ds_read_b64_tr_b16 a[208:209], v18 offset:16384
    v_mfma_f32_16x16x32_bf16 v[148:151], a[140:143], a[172:175], v[148:151]
    ds_read_b64_tr_b16 a[210:211], v18 offset:20480
    v_mfma_f32_16x16x32_bf16 v[144:147], a[132:135], a[172:175], v[144:147]
    ds_read_b128 a[244:247], v42 offset:57344
    v_mfma_f32_16x16x32_bf16 v[144:147], a[128:131], a[168:171], v[144:147]
    buffer_load_dwordx4 v13, s[36:39], s64 offen offset:3072 lds
    v_mfma_f32_16x16x32_bf16 v[160:163], a[128:131], a[176:179], v[160:163]
    s_add_u32 s64, s64, 65536
    ds_read_b64_tr_b16 a[212:213], v18 offset:24576
    v_mfma_f32_16x16x32_bf16 v[160:163], a[132:135], a[180:183], v[160:163]
    ds_read_b64_tr_b16 a[214:215], v18 offset:28672
    v_mfma_f32_16x16x32_bf16 v[164:167], a[140:143], a[180:183], v[164:167]
    s_add_u32 m0, s66, 98304
    ds_read_b128 a[248:251], v43 offset:49152
    v_mfma_f32_16x16x32_bf16 v[164:167], a[136:139], a[176:179], v[164:167]
    buffer_load_dwordx4 v2, s[48:51], s65 offen offset:0 sc1 lds
    v_mfma_f32_16x16x32_bf16 v[168:171], a[144:147], a[176:179], v[168:171]
    ds_read_b64_tr_b16 a[216:217], v19 offset:16384
    v_mfma_f32_16x16x32_bf16 v[168:171], a[148:151], a[180:183], v[168:171]
    ds_read_b64_tr_b16 a[218:219], v19 offset:20480
    v_mfma_f32_16x16x32_bf16 v[172:175], a[156:159], a[180:183], v[172:175]
    ds_read_b128 a[252:255], v43 offset:57344
    v_mfma_f32_16x16x32_bf16 v[172:175], a[152:155], a[176:179], v[172:175]
    buffer_load_dwordx4 v2, s[48:51], s65 offen offset:1024 sc1 lds
    v_mfma_f32_16x16x32_bf16 v[188:191], a[152:155], a[184:187], v[188:191]
    ds_read_b64_tr_b16 a[220:221], v19 offset:24576
    v_mfma_f32_16x16x32_bf16 v[188:191], a[156:159], a[188:191], v[188:191]
    ds_read_b64_tr_b16 a[222:223], v19 offset:28672
    v_mfma_f32_16x16x32_bf16 v[184:187], a[148:151], a[188:191], v[184:187]
    v_mfma_f32_16x16x32_bf16 v[184:187], a[144:147], a[184:187], v[184:187]
    buffer_load_dwordx4 v2, s[48:51], s65 offen offset:2048 sc1 lds
    v_mfma_f32_16x16x32_bf16 v[180:183], a[136:139], a[184:187], v[180:183]
    v_mfma_f32_16x16x32_bf16 v[180:183], a[140:143], a[188:191], v[180:183]
    v_mfma_f32_16x16x32_bf16 v[176:179], a[132:135], a[188:191], v[176:179]
    v_mfma_f32_16x16x32_bf16 v[176:179], a[128:131], a[184:187], v[176:179]
    s_waitcnt vmcnt(20) lgkmcnt(0)
    buffer_load_dwordx4 v2, s[48:51], s65 offen offset:3072 sc1 lds
    s_add_u32 s65, s65, 8192
    v_mfma_f32_16x16x32_bf16 v[128:131], a[192:195], a[224:227], v[128:131]
    s_barrier
    ds_read_b128 a[32:35], v40 offset:0
    ds_read_b64_tr_b16 a[0:1], v20 offset:0
    v_mfma_f32_16x16x32_bf16 v[128:131], a[196:199], a[228:231], v[128:131]
    ds_read_b64_tr_b16 a[2:3], v20 offset:4096
    buffer_load_dword v31, v15, s[48:51], 0 offen sc1
    v_mfma_f32_16x16x32_bf16 v[132:135], a[204:207], a[228:231], v[132:135]
    s_and_b32 s64, s2, 7
    s_lshl_b32 s64, s64, 19
    s_lshl_b32 s69, s60, 14
    s_add_u32 s64, s64, s69
    s_lshl_b32 s69, s86, 8
    s_add_u32 s64, s64, s69
    s_add_u32 m0, s66, 16384
    ds_read_b128 a[36:39], v40 offset:8192
    ds_read_b64_tr_b16 a[4:5], v20 offset:8192
    v_mfma_f32_16x16x32_bf16 v[132:135], a[200:203], a[224:227], v[132:135]
    buffer_load_dwordx4 v10, s[24:27], s64 offen offset:0 lds
    v_mfma_f32_16x16x32_bf16 v[136:139], a[208:211], a[224:227], v[136:139]
    ds_read_b64_tr_b16 a[6:7], v20 offset:12288
    ds_read_b128 a[40:43], v41 offset:0
    v_mfma_f32_16x16x32_bf16 v[136:139], a[212:215], a[228:231], v[136:139]
    ds_read_b64_tr_b16 a[8:9], v21 offset:0
    v_mfma_f32_16x16x32_bf16 v[140:143], a[220:223], a[228:231], v[140:143]
    ds_read_b64_tr_b16 a[10:11], v21 offset:4096
    ds_read_b128 a[44:47], v41 offset:8192
    v_mfma_f32_16x16x32_bf16 v[140:143], a[216:219], a[224:227], v[140:143]
    buffer_load_dwordx4 v11, s[24:27], s64 offen offset:1024 lds
    v_mfma_f32_16x16x32_bf16 v[156:159], a[216:219], a[232:235], v[156:159]
    ds_read_b64_tr_b16 a[12:13], v21 offset:8192
    v_mfma_f32_16x16x32_bf16 v[156:159], a[220:223], a[236:239], v[156:159]
    ds_read_b64_tr_b16 a[14:15], v21 offset:12288
    v_mfma_f32_16x16x32_bf16 v[152:155], a[212:215], a[236:239], v[152:155]
    ds_read_b128 a[48:51], v42 offset:0
    v_mfma_f32_16x16x32_bf16 v[152:155], a[208:211], a[232:235], v[152:155]
    buffer_load_dwordx4 v12, s[24:27], s64 offen offset:2048 lds
    v_mfma_f32_16x16x32_bf16 v[148:151], a[200:203], a[232:235], v[148:151]
    ds_read_b64_tr_b16 a[16:17], v22 offset:0
    v_mfma_f32_16x16x32_bf16 v[148:151], a[204:207], a[236:239], v[148:151]
    ds_read_b64_tr_b16 a[18:19], v22 offset:4096
    v_mfma_f32_16x16x32_bf16 v[144:147], a[196:199], a[236:239], v[144:147]
    ds_read_b128 a[52:55], v42 offset:8192
    v_mfma_f32_16x16x32_bf16 v[144:147], a[192:195], a[232:235], v[144:147]
    buffer_load_dwordx4 v13, s[24:27], s64 offen offset:3072 lds
    v_mfma_f32_16x16x32_bf16 v[160:163], a[192:195], a[240:243], v[160:163]
    s_add_u32 s64, s64, 65536
    ds_read_b64_tr_b16 a[20:21], v22 offset:8192
    v_mfma_f32_16x16x32_bf16 v[160:163], a[196:199], a[244:247], v[160:163]
    ds_read_b64_tr_b16 a[22:23], v22 offset:12288
    v_mfma_f32_16x16x32_bf16 v[164:167], a[204:207], a[244:247], v[164:167]
    ds_read_b128 a[56:59], v43 offset:0
    v_mfma_f32_16x16x32_bf16 v[164:167], a[200:203], a[240:243], v[164:167]
    v_mfma_f32_16x16x32_bf16 v[168:171], a[208:211], a[240:243], v[168:171]
    ds_read_b64_tr_b16 a[24:25], v23 offset:0
    v_mfma_f32_16x16x32_bf16 v[168:171], a[212:215], a[244:247], v[168:171]
    ds_read_b64_tr_b16 a[26:27], v23 offset:4096
    v_mfma_f32_16x16x32_bf16 v[172:175], a[220:223], a[244:247], v[172:175]
    ds_read_b128 a[60:63], v43 offset:8192
    v_mfma_f32_16x16x32_bf16 v[172:175], a[216:219], a[240:243], v[172:175]
    v_mfma_f32_16x16x32_bf16 v[188:191], a[216:219], a[248:251], v[188:191]
    ds_read_b64_tr_b16 a[28:29], v23 offset:8192
    v_mfma_f32_16x16x32_bf16 v[188:191], a[220:223], a[252:255], v[188:191]
    ds_read_b64_tr_b16 a[30:31], v23 offset:12288
    v_mfma_f32_16x16x32_bf16 v[184:187], a[212:215], a[252:255], v[184:187]
    v_mfma_f32_16x16x32_bf16 v[184:187], a[208:211], a[248:251], v[184:187]
    v_mfma_f32_16x16x32_bf16 v[180:183], a[200:203], a[248:251], v[180:183]
    v_mfma_f32_16x16x32_bf16 v[180:183], a[204:207], a[252:255], v[180:183]
    v_mfma_f32_16x16x32_bf16 v[176:179], a[196:199], a[252:255], v[176:179]
    v_mfma_f32_16x16x32_bf16 v[176:179], a[192:195], a[248:251], v[176:179]
    s_waitcnt vmcnt(4) lgkmcnt(0)
    s_mov_b32 s88, 65536
L_s3_t:
    v_readfirstlane_b32 s69, v31
    s_cmp_ge_u32 s69, 4
    s_cbranch_scc1 L_s3_ok
    s_sub_u32 s88, s88, 1
    s_cmp_eq_u32 s88, 0
    s_cbranch_scc1 L_s3_ok
    s_sleep 1
    buffer_load_dword v31, v15, s[48:51], 0 offen sc1
    s_waitcnt vmcnt(0)
    s_branch L_s3_t
L_s3_ok:
    v_mfma_f32_16x16x32_bf16 v[128:131], a[0:3], a[32:35], v[128:131]
    s_barrier
    ds_read_b128 a[96:99], v40 offset:16384
    ds_read_b64_tr_b16 a[64:65], v20 offset:16384
    v_mfma_f32_16x16x32_bf16 v[128:131], a[4:7], a[36:39], v[128:131]
    s_and_b32 s69, s60, 1
    s_lshl_b32 s65, s85, 1
    s_add_u32 s65, s65, s69
    s_mul_i32 s65, s65, 753664
    s_and_b32 s69, s2, 7
    s_lshl_b32 s69, s69, 16
    s_add_u32 s65, s65, s69
    s_and_b32 s69, s60, 2
    s_lshl_b32 s69, s69, 11
    s_add_u32 s65, s65, s69
    s_add_u32 s65, s65, 33783808
    s_add_u32 m0, s66, 114688
    ds_read_b64_tr_b16 a[66:67], v20 offset:20480
    v_mfma_f32_16x16x32_bf16 v[132:135], a[12:15], a[36:39], v[132:135]
    ds_read_b128 a[100:103], v40 offset:24576
    ds_read_b64_tr_b16 a[68:69], v20 offset:24576
    buffer_load_dwordx4 v2, s[48:51], s65 offen offset:0 sc1 lds
    v_mfma_f32_16x16x32_bf16 v[132:135], a[8:11], a[32:35], v[132:135]
    v_mfma_f32_16x16x32_bf16 v[136:139], a[16:19], a[32:35], v[136:139]
    ds_read_b64_tr_b16 a[70:71], v20 offset:28672
    ds_read_b128 a[104:107], v41 offset:16384
    buffer_load_dwordx4 v2, s[48:51], s65 offen offset:1024 sc1 lds
    v_mfma_f32_16x16x32_bf16 v[136:139], a[20:23], a[36:39], v[136:139]
    ds_read_b64_tr_b16 a[72:73], v21 offset:16384
    v_xor_b32 v15, 512, v15
    v_mfma_f32_16x16x32_bf16 v[140:143], a[28:31], a[36:39], v[140:143]
    ds_read_b64_tr_b16 a[74:75], v21 offset:20480
    ds_read_b128 a[108:111], v41 offset:24576
    buffer_load_dwordx4 v2, s[48:51], s65 offen offset:2048 sc1 lds
    v_mfma_f32_16x16x32_bf16 v[140:143], a[24:27], a[32:35], v[140:143]
    v_mfma_f32_16x16x32_bf16 v[156:159], a[24:27], a[40:43], v[156:159]
    ds_read_b64_tr_b16 a[76:77], v21 offset:24576
    v_mfma_f32_16x16x32_bf16 v[156:159], a[28:31], a[44:47], v[156:159]
    ds_read_b64_tr_b16 a[78:79], v21 offset:28672
    buffer_load_dwordx4 v2, s[48:51], s65 offen offset:3072 sc1 lds
    v_mfma_f32_16x16x32_bf16 v[152:155], a[20:23], a[44:47], v[152:155]
    s_add_u32 s65, s65, 8192
    s_add_u32 m0, s66, 131072
    ds_read_b128 a[112:115], v42 offset:16384
    v_mfma_f32_16x16x32_bf16 v[152:155], a[16:19], a[40:43], v[152:155]
    buffer_load_dwordx4 v10, s[24:27], s64 offen offset:0 lds
    v_mfma_f32_16x16x32_bf16 v[148:151], a[8:11], a[40:43], v[148:151]
    ds_read_b64_tr_b16 a[80:81], v22 offset:16384
    v_mfma_f32_16x16x32_bf16 v[148:151], a[12:15], a[44:47], v[148:151]
    ds_read_b64_tr_b16 a[82:83], v22 offset:20480
    v_mfma_f32_16x16x32_bf16 v[144:147], a[4:7], a[44:47], v[144:147]
    ds_read_b128 a[116:119], v42 offset:24576
    buffer_load_dwordx4 v11, s[24:27], s64 offen offset:1024 lds
    v_mfma_f32_16x16x32_bf16 v[144:147], a[0:3], a[40:43], v[144:147]
    v_mfma_f32_16x16x32_bf16 v[160:163], a[0:3], a[48:51], v[160:163]
    ds_read_b64_tr_b16 a[84:85], v22 offset:24576
    buffer_load_dwordx4 v12, s[24:27], s64 offen offset:2048 lds
    v_mfma_f32_16x16x32_bf16 v[160:163], a[4:7], a[52:55], v[160:163]
    ds_read_b64_tr_b16 a[86:87], v22 offset:28672
    v_mfma_f32_16x16x32_bf16 v[164:167], a[12:15], a[52:55], v[164:167]
    ds_read_b128 a[120:123], v43 offset:16384
    buffer_load_dwordx4 v13, s[24:27], s64 offen offset:3072 lds
    v_mfma_f32_16x16x32_bf16 v[164:167], a[8:11], a[48:51], v[164:167]
    s_add_u32 s64, s64, 65536
    v_mfma_f32_16x16x32_bf16 v[168:171], a[16:19], a[48:51], v[168:171]
    s_add_u32 m0, s66, 65536
    ds_read_b64_tr_b16 a[88:89], v23 offset:16384
    v_mfma_f32_16x16x32_bf16 v[168:171], a[20:23], a[52:55], v[168:171]
    ds_read_b64_tr_b16 a[90:91], v23 offset:20480
    buffer_load_dwordx4 v2, s[48:51], s65 offen offset:0 sc1 lds
    v_mfma_f32_16x16x32_bf16 v[172:175], a[28:31], a[52:55], v[172:175]
    ds_read_b128 a[124:127], v43 offset:24576
    v_mfma_f32_16x16x32_bf16 v[172:175], a[24:27], a[48:51], v[172:175]
    buffer_load_dwordx4 v2, s[48:51], s65 offen offset:1024 sc1 lds
    v_mfma_f32_16x16x32_bf16 v[188:191], a[24:27], a[56:59], v[188:191]
    ds_read_b64_tr_b16 a[92:93], v23 offset:24576
    v_mfma_f32_16x16x32_bf16 v[188:191], a[28:31], a[60:63], v[188:191]
    ds_read_b64_tr_b16 a[94:95], v23 offset:28672
    v_mfma_f32_16x16x32_bf16 v[184:187], a[20:23], a[60:63], v[184:187]
    buffer_load_dwordx4 v2, s[48:51], s65 offen offset:2048 sc1 lds
    v_mfma_f32_16x16x32_bf16 v[184:187], a[16:19], a[56:59], v[184:187]
    v_mfma_f32_16x16x32_bf16 v[180:183], a[8:11], a[56:59], v[180:183]
    buffer_load_dwordx4 v2, s[48:51], s65 offen offset:3072 sc1 lds
    v_mfma_f32_16x16x32_bf16 v[180:183], a[12:15], a[60:63], v[180:183]
    s_add_u32 s65, s65, 8192
    v_mfma_f32_16x16x32_bf16 v[176:179], a[4:7], a[60:63], v[176:179]
    v_mfma_f32_16x16x32_bf16 v[176:179], a[0:3], a[56:59], v[176:179]
    s_waitcnt vmcnt(17) lgkmcnt(0)
    v_mfma_f32_16x16x32_bf16 v[128:131], a[64:67], a[96:99], v[128:131]
    s_barrier
    ds_read_b128 a[160:163], v40 offset:32768
    ds_read_b64_tr_b16 a[128:129], v16 offset:0
    v_mfma_f32_16x16x32_bf16 v[128:131], a[68:71], a[100:103], v[128:131]
    ds_read_b64_tr_b16 a[130:131], v16 offset:4096
    v_mfma_f32_16x16x32_bf16 v[132:135], a[76:79], a[100:103], v[132:135]
    s_add_u32 m0, s66, 147456
    ds_read_b128 a[164:167], v40 offset:40960
    ds_read_b64_tr_b16 a[132:133], v16 offset:8192
    v_mfma_f32_16x16x32_bf16 v[132:135], a[72:75], a[96:99], v[132:135]
    buffer_load_dwordx4 v10, s[24:27], s64 offen offset:0 lds
    v_mfma_f32_16x16x32_bf16 v[136:139], a[80:83], a[96:99], v[136:139]
    ds_read_b64_tr_b16 a[134:135], v16 offset:12288
    ds_read_b128 a[168:171], v41 offset:32768
    v_mfma_f32_16x16x32_bf16 v[136:139], a[84:87], a[100:103], v[136:139]
    ds_read_b64_tr_b16 a[136:137], v17 offset:0
    v_mfma_f32_16x16x32_bf16 v[140:143], a[92:95], a[100:103], v[140:143]
    ds_read_b64_tr_b16 a[138:139], v17 offset:4096
    ds_read_b128 a[172:175], v41 offset:40960
    v_mfma_f32_16x16x32_bf16 v[140:143], a[88:91], a[96:99], v[140:143]
    buffer_load_dwordx4 v11, s[24:27], s64 offen offset:1024 lds
    v_mfma_f32_16x16x32_bf16 v[156:159], a[88:91], a[104:107], v[156:159]
    ds_read_b64_tr_b16 a[140:141], v17 offset:8192
    v_mfma_f32_16x16x32_bf16 v[156:159], a[92:95], a[108:111], v[156:159]
    ds_read_b64_tr_b16 a[142:143], v17 offset:12288
    v_mfma_f32_16x16x32_bf16 v[152:155], a[84:87], a[108:111], v[152:155]
    ds_read_b128 a[176:179], v42 offset:32768
    v_mfma_f32_16x16x32_bf16 v[152:155], a[80:83], a[104:107], v[152:155]
    buffer_load_dwordx4 v12, s[24:27], s64 offen offset:2048 lds
    v_mfma_f32_16x16x32_bf16 v[148:151], a[72:75], a[104:107], v[148:151]
    ds_read_b64_tr_b16 a[144:145], v18 offset:0
    v_mfma_f32_16x16x32_bf16 v[148:151], a[76:79], a[108:111], v[148:151]
    ds_read_b64_tr_b16 a[146:147], v18 offset:4096
    v_mfma_f32_16x16x32_bf16 v[144:147], a[68:71], a[108:111], v[144:147]
    ds_read_b128 a[180:183], v42 offset:40960
    v_mfma_f32_16x16x32_bf16 v[144:147], a[64:67], a[104:107], v[144:147]
    buffer_load_dwordx4 v13, s[24:27], s64 offen offset:3072 lds
    v_mfma_f32_16x16x32_bf16 v[160:163], a[64:67], a[112:115], v[160:163]
    s_add_u32 s64, s64, 65536
    ds_read_b64_tr_b16 a[148:149], v18 offset:8192
    v_mfma_f32_16x16x32_bf16 v[160:163], a[68:71], a[116:119], v[160:163]
    ds_read_b64_tr_b16 a[150:151], v18 offset:12288
    v_mfma_f32_16x16x32_bf16 v[164:167], a[76:79], a[116:119], v[164:167]
    s_add_u32 m0, s66, 81920
    ds_read_b128 a[184:187], v43 offset:32768
    v_mfma_f32_16x16x32_bf16 v[164:167], a[72:75], a[112:115], v[164:167]
    buffer_load_dwordx4 v2, s[48:51], s65 offen offset:0 sc1 lds
    v_mfma_f32_16x16x32_bf16 v[168:171], a[80:83], a[112:115], v[168:171]
    ds_read_b64_tr_b16 a[152:153], v19 offset:0
    v_mfma_f32_16x16x32_bf16 v[168:171], a[84:87], a[116:119], v[168:171]
    ds_read_b64_tr_b16 a[154:155], v19 offset:4096
    v_mfma_f32_16x16x32_bf16 v[172:175], a[92:95], a[116:119], v[172:175]
    ds_read_b128 a[188:191], v43 offset:40960
    v_mfma_f32_16x16x32_bf16 v[172:175], a[88:91], a[112:115], v[172:175]
    buffer_load_dwordx4 v2, s[48:51], s65 offen offset:1024 sc1 lds
    v_mfma_f32_16x16x32_bf16 v[188:191], a[88:91], a[120:123], v[188:191]
    ds_read_b64_tr_b16 a[156:157], v19 offset:8192
    v_mfma_f32_16x16x32_bf16 v[188:191], a[92:95], a[124:127], v[188:191]
    ds_read_b64_tr_b16 a[158:159], v19 offset:12288
    v_mfma_f32_16x16x32_bf16 v[184:187], a[84:87], a[124:127], v[184:187]
    v_mfma_f32_16x16x32_bf16 v[184:187], a[80:83], a[120:123], v[184:187]
    buffer_load_dwordx4 v2, s[48:51], s65 offen offset:2048 sc1 lds
    v_mfma_f32_16x16x32_bf16 v[180:183], a[72:75], a[120:123], v[180:183]
    v_mfma_f32_16x16x32_bf16 v[180:183], a[76:79], a[124:127], v[180:183]
    v_mfma_f32_16x16x32_bf16 v[176:179], a[68:71], a[124:127], v[176:179]
    v_mfma_f32_16x16x32_bf16 v[176:179], a[64:67], a[120:123], v[176:179]
    s_waitcnt vmcnt(15) lgkmcnt(0)
    buffer_load_dwordx4 v2, s[48:51], s65 offen offset:3072 sc1 lds
    s_add_u32 s65, s65, 8192
    v_mfma_f32_16x16x32_bf16 v[128:131], a[128:131], a[160:163], v[128:131]
    s_barrier
    ds_read_b128 a[224:227], v40 offset:49152
    ds_read_b64_tr_b16 a[192:193], v16 offset:16384
    v_mfma_f32_16x16x32_bf16 v[128:131], a[132:135], a[164:167], v[128:131]
    ds_read_b64_tr_b16 a[194:195], v16 offset:20480
    v_mfma_f32_16x16x32_bf16 v[132:135], a[140:143], a[164:167], v[132:135]
    s_add_u32 m0, s66, 0
    ds_read_b128 a[228:231], v40 offset:57344
    ds_read_b64_tr_b16 a[196:197], v16 offset:24576
    v_mfma_f32_16x16x32_bf16 v[132:135], a[136:139], a[160:163], v[132:135]
    buffer_load_dwordx4 v10, s[24:27], s64 offen offset:0 lds
    v_mfma_f32_16x16x32_bf16 v[136:139], a[144:147], a[160:163], v[136:139]
    ds_read_b64_tr_b16 a[198:199], v16 offset:28672
    ds_read_b128 a[232:235], v41 offset:49152
    v_mfma_f32_16x16x32_bf16 v[136:139], a[148:151], a[164:167], v[136:139]
    ds_read_b64_tr_b16 a[200:201], v17 offset:16384
    v_mfma_f32_16x16x32_bf16 v[140:143], a[156:159], a[164:167], v[140:143]
    ds_read_b64_tr_b16 a[202:203], v17 offset:20480
    ds_read_b128 a[236:239], v41 offset:57344
    v_mfma_f32_16x16x32_bf16 v[140:143], a[152:155], a[160:163], v[140:143]
    buffer_load_dwordx4 v11, s[24:27], s64 offen offset:1024 lds
    v_mfma_f32_16x16x32_bf16 v[156:159], a[152:155], a[168:171], v[156:159]
    ds_read_b64_tr_b16 a[204:205], v17 offset:24576
    v_mfma_f32_16x16x32_bf16 v[156:159], a[156:159], a[172:175], v[156:159]
    ds_read_b64_tr_b16 a[206:207], v17 offset:28672
    v_mfma_f32_16x16x32_bf16 v[152:155], a[148:151], a[172:175], v[152:155]
    ds_read_b128 a[240:243], v42 offset:49152
    v_mfma_f32_16x16x32_bf16 v[152:155], a[144:147], a[168:171], v[152:155]
    buffer_load_dwordx4 v12, s[24:27], s64 offen offset:2048 lds
    v_mfma_f32_16x16x32_bf16 v[148:151], a[136:139], a[168:171], v[148:151]
    ds_read_b64_tr_b16 a[208:209], v18 offset:16384
    v_mfma_f32_16x16x32_bf16 v[148:151], a[140:143], a[172:175], v[148:151]
    ds_read_b64_tr_b16 a[210:211], v18 offset:20480
    v_mfma_f32_16x16x32_bf16 v[144:147], a[132:135], a[172:175], v[144:147]
    ds_read_b128 a[244:247], v42 offset:57344
    v_mfma_f32_16x16x32_bf16 v[144:147], a[128:131], a[168:171], v[144:147]
    buffer_load_dwordx4 v13, s[24:27], s64 offen offset:3072 lds
    v_mfma_f32_16x16x32_bf16 v[160:163], a[128:131], a[176:179], v[160:163]
    s_add_u32 s64, s64, 65536
    ds_read_b64_tr_b16 a[212:213], v18 offset:24576
    v_mfma_f32_16x16x32_bf16 v[160:163], a[132:135], a[180:183], v[160:163]
    ds_read_b64_tr_b16 a[214:215], v18 offset:28672
    v_mfma_f32_16x16x32_bf16 v[164:167], a[140:143], a[180:183], v[164:167]
    s_add_u32 m0, s66, 98304
    ds_read_b128 a[248:251], v43 offset:49152
    v_mfma_f32_16x16x32_bf16 v[164:167], a[136:139], a[176:179], v[164:167]
    buffer_load_dwordx4 v2, s[48:51], s65 offen offset:0 sc1 lds
    v_mfma_f32_16x16x32_bf16 v[168:171], a[144:147], a[176:179], v[168:171]
    ds_read_b64_tr_b16 a[216:217], v19 offset:16384
    v_mfma_f32_16x16x32_bf16 v[168:171], a[148:151], a[180:183], v[168:171]
    ds_read_b64_tr_b16 a[218:219], v19 offset:20480
    v_mfma_f32_16x16x32_bf16 v[172:175], a[156:159], a[180:183], v[172:175]
    ds_read_b128 a[252:255], v43 offset:57344
    v_mfma_f32_16x16x32_bf16 v[172:175], a[152:155], a[176:179], v[172:175]
    buffer_load_dwordx4 v2, s[48:51], s65 offen offset:1024 sc1 lds
    v_mfma_f32_16x16x32_bf16 v[188:191], a[152:155], a[184:187], v[188:191]
    ds_read_b64_tr_b16 a[220:221], v19 offset:24576
    v_mfma_f32_16x16x32_bf16 v[188:191], a[156:159], a[188:191], v[188:191]
    ds_read_b64_tr_b16 a[222:223], v19 offset:28672
    v_mfma_f32_16x16x32_bf16 v[184:187], a[148:151], a[188:191], v[184:187]
    v_mfma_f32_16x16x32_bf16 v[184:187], a[144:147], a[184:187], v[184:187]
    buffer_load_dwordx4 v2, s[48:51], s65 offen offset:2048 sc1 lds
    v_mfma_f32_16x16x32_bf16 v[180:183], a[136:139], a[184:187], v[180:183]
    v_mfma_f32_16x16x32_bf16 v[180:183], a[140:143], a[188:191], v[180:183]
    v_mfma_f32_16x16x32_bf16 v[176:179], a[132:135], a[188:191], v[176:179]
    v_mfma_f32_16x16x32_bf16 v[176:179], a[128:131], a[184:187], v[176:179]
    s_waitcnt vmcnt(15) lgkmcnt(0)
    buffer_load_dwordx4 v2, s[48:51], s65 offen offset:3072 sc1 lds
    s_add_u32 s65, s65, 8192
    v_mfma_f32_16x16x32_bf16 v[192:195], a[192:195], a[224:227], 0
    s_barrier
    ds_read_b128 a[32:35], v40 offset:0
    ds_read_b64_tr_b16 a[0:1], v20 offset:0
    v_mfma_f32_16x16x32_bf16 v[192:195], a[196:199], a[228:231], v[192:195]
    ds_read_b64_tr_b16 a[2:3], v20 offset:4096
    v_mfma_f32_16x16x32_bf16 v[196:199], a[204:207], a[228:231], 0
    s_add_u32 m0, s66, 16384
    ds_read_b128 a[36:39], v40 offset:8192
    ds_read_b64_tr_b16 a[4:5], v20 offset:8192
    v_mfma_f32_16x16x32_bf16 v[196:199], a[200:203], a[224:227], v[196:199]
    buffer_load_dwordx4 v10, s[24:27], s64 offen offset:0 lds
    v_mfma_f32_16x16x32_bf16 v[200:203], a[208:211], a[224:227], 0
    ds_read_b64_tr_b16 a[6:7], v20 offset:12288
    ds_read_b128 a[40:43], v41 offset:0
    v_mfma_f32_16x16x32_bf16 v[200:203], a[212:215], a[228:231], v[200:203]
    ds_read_b64_tr_b16 a[8:9], v21 offset:0
    v_mfma_f32_16x16x32_bf16 v[204:207], a[220:223], a[228:231], 0
    ds_read_b64_tr_b16 a[10:11], v21 offset:4096
    ds_read_b128 a[44:47], v41 offset:8192
    v_mfma_f32_16x16x32_bf16 v[204:207], a[216:219], a[224:227], v[204:207]
    buffer_load_dwordx4 v11, s[24:27], s64 offen offset:1024 lds
    v_mfma_f32_16x16x32_bf16 v[220:223], a[216:219], a[232:235], 0
    ds_read_b64_tr_b16 a[12:13], v21 offset:8192
    v_mfma_f32_16x16x32_bf16 v[220:223], a[220:223], a[236:239], v[220:223]
    ds_read_b64_tr_b16 a[14:15], v21 offset:12288
    v_mfma_f32_16x16x32_bf16 v[216:219], a[212:215], a[236:239], 0
    ds_read_b128 a[48:51], v42 offset:0
    v_mfma_f32_16x16x32_bf16 v[216:219], a[208:211], a[232:235], v[216:219]
    buffer_load_dwordx4 v12, s[24:27], s64 offen offset:2048 lds
    v_mfma_f32_16x16x32_bf16 v[212:215], a[200:203], a[232:235], 0
    ds_read_b64_tr_b16 a[16:17], v22 offset:0
    v_mfma_f32_16x16x32_bf16 v[212:215], a[204:207], a[236:239], v[212:215]
    ds_read_b64_tr_b16 a[18:19], v22 offset:4096
    v_mfma_f32_16x16x32_bf16 v[208:211], a[196:199], a[236:239], 0
    ds_read_b128 a[52:55], v42 offset:8192
    v_mfma_f32_16x16x32_bf16 v[208:211], a[192:195], a[232:235], v[208:211]
    buffer_load_dwordx4 v13, s[24:27], s64 offen offset:3072 lds
    v_mfma_f32_16x16x32_bf16 v[224:227], a[192:195], a[240:243], 0
    s_add_u32 s64, s64, 65536
    ds_read_b64_tr_b16 a[20:21], v22 offset:8192
    v_mfma_f32_16x16x32_bf16 v[224:227], a[196:199], a[244:247], v[224:227]
    ds_read_b64_tr_b16 a[22:23], v22 offset:12288
    v_mfma_f32_16x16x32_bf16 v[228:231], a[204:207], a[244:247], 0
    s_add_u32 m0, s66, 114688
    ds_read_b128 a[56:59], v43 offset:0
    v_mfma_f32_16x16x32_bf16 v[228:231], a[200:203], a[240:243], v[228:231]
    buffer_load_dwordx4 v2, s[48:51], s65 offen offset:0 sc1 lds
    v_mfma_f32_16x16x32_bf16 v[232:235], a[208:211], a[240:243], 0
    ds_read_b64_tr_b16 a[24:25], v23 offset:0
    v_mfma_f32_16x16x32_bf16 v[232:235], a[212:215], a[244:247], v[232:235]
    ds_read_b64_tr_b16 a[26:27], v23 offset:4096
    v_mfma_f32_16x16x32_bf16 v[236:239], a[220:223], a[244:247], 0
    ds_read_b128 a[60:63], v43 offset:8192
    v_mfma_f32_16x16x32_bf16 v[236:239], a[216:219], a[240:243], v[236:239]
    buffer_load_dwordx4 v2, s[48:51], s65 offen offset:1024 sc1 lds
    v_mfma_f32_16x16x32_bf16 v[252:255], a[216:219], a[248:251], 0
    ds_read_b64_tr_b16 a[28:29], v23 offset:8192
    v_mfma_f32_16x16x32_bf16 v[252:255], a[220:223], a[252:255], v[252:255]
    ds_read_b64_tr_b16 a[30:31], v23 offset:12288
    v_mfma_f32_16x16x32_bf16 v[248:251], a[212:215], a[252:255], 0
    v_mfma_f32_16x16x32_bf16 v[248:251], a[208:211], a[248:251], v[248:251]
    buffer_load_dwordx4 v2, s[48:51], s65 offen offset:2048 sc1 lds
    v_mfma_f32_16x16x32_bf16 v[244:247], a[200:203], a[248:251], 0
    v_mfma_f32_16x16x32_bf16 v[244:247], a[204:207], a[252:255], v[244:247]
    v_mfma_f32_16x16x32_bf16 v[240:243], a[196:199], a[252:255], 0
    v_mfma_f32_16x16x32_bf16 v[240:243], a[192:195], a[248:251], v[240:243]
    s_waitcnt vmcnt(15) lgkmcnt(0)
    buffer_load_dwordx4 v2, s[48:51], s65 offen offset:3072 sc1 lds
    s_add_u32 s65, s65, 8192
    v_mfma_f32_16x16x32_bf16 v[192:195], a[0:3], a[32:35], v[192:195]
    s_barrier
    ds_read_b128 a[96:99], v40 offset:16384
    ds_read_b64_tr_b16 a[64:65], v20 offset:16384
    v_mfma_f32_16x16x32_bf16 v[192:195], a[4:7], a[36:39], v[192:195]
    ds_read_b64_tr_b16 a[66:67], v20 offset:20480
    v_sub_f32 v34, 1.0, v26
    v_mfma_f32_16x16x32_bf16 v[196:199], a[12:15], a[36:39], v[196:199]
    s_add_u32 m0, s66, 131072
    ds_read_b128 a[100:103], v40 offset:24576
    ds_read_b64_tr_b16 a[68:69], v20 offset:24576
    v_mfma_f32_16x16x32_bf16 v[196:199], a[8:11], a[32:35], v[196:199]
    buffer_load_dwordx4 v10, s[24:27], s64 offen offset:0 lds
    v_mfma_f32_16x16x32_bf16 v[200:203], a[16:19], a[32:35], v[200:203]
    ds_read_b64_tr_b16 a[70:71], v20 offset:28672
    ds_read_b128 a[104:107], v41 offset:16384
    v_mfma_f32_16x16x32_bf16 v[200:203], a[20:23], a[36:39], v[200:203]
    ds_read_b64_tr_b16 a[72:73], v21 offset:16384
    v_sub_f32 v35, 1.0, v27
    v_sub_f32 v36, 1.0, v28
    v_mfma_f32_16x16x32_bf16 v[204:207], a[28:31], a[36:39], v[204:207]
    ds_read_b64_tr_b16 a[74:75], v21 offset:20480
    ds_read_b128 a[108:111], v41 offset:24576
    v_mfma_f32_16x16x32_bf16 v[204:207], a[24:27], a[32:35], v[204:207]
    buffer_load_dwordx4 v11, s[24:27], s64 offen offset:1024 lds
    v_mfma_f32_16x16x32_bf16 v[220:223], a[24:27], a[40:43], v[220:223]
    ds_read_b64_tr_b16 a[76:77], v21 offset:24576
    v_sub_f32 v37, 1.0, v29
    v_mfma_f32_16x16x32_bf16 v[220:223], a[28:31], a[44:47], v[220:223]
    ds_read_b64_tr_b16 a[78:79], v21 offset:28672
    v_mul_f32 v128, v34, v128
    v_mfma_f32_16x16x32_bf16 v[216:219], a[20:23], a[44:47], v[216:219]
    ds_read_b128 a[112:115], v42 offset:16384
    v_mul_f32 v129, v34, v129
    v_mfma_f32_16x16x32_bf16 v[216:219], a[16:19], a[40:43], v[216:219]
    buffer_load_dwordx4 v12, s[24:27], s64 offen offset:2048 lds
    v_mfma_f32_16x16x32_bf16 v[212:215], a[8:11], a[40:43], v[212:215]
    ds_read_b64_tr_b16 a[80:81], v22 offset:16384
    v_mul_f32 v130, v34, v130
    v_mfma_f32_16x16x32_bf16 v[212:215], a[12:15], a[44:47], v[212:215]
    ds_read_b64_tr_b16 a[82:83], v22 offset:20480
    v_mul_f32 v131, v34, v131
    v_mfma_f32_16x16x32_bf16 v[208:211], a[4:7], a[44:47], v[208:211]
    ds_read_b128 a[116:119], v42 offset:24576
    v_mfma_f32_16x16x32_bf16 v[208:211], a[0:3], a[40:43], v[208:211]
    buffer_load_dwordx4 v13, s[24:27], s64 offen offset:3072 lds
    v_mfma_f32_16x16x32_bf16 v[224:227], a[0:3], a[48:51], v[224:227]
    s_add_u32 s64, s64, 65536
    ds_read_b64_tr_b16 a[84:85], v22 offset:24576
    v_mul_f32 v132, v34, v132
    v_mfma_f32_16x16x32_bf16 v[224:227], a[4:7], a[52:55], v[224:227]
    ds_read_b64_tr_b16 a[86:87], v22 offset:28672
    v_mul_f32 v133, v34, v133
    v_mfma_f32_16x16x32_bf16 v[228:231], a[12:15], a[52:55], v[228:231]
    s_add_u32 m0, s66, 65536
    ds_read_b128 a[120:123], v43 offset:16384
    v_mul_f32 v134, v34, v134
    v_mfma_f32_16x16x32_bf16 v[228:231], a[8:11], a[48:51], v[228:231]
    buffer_load_dwordx4 v2, s[48:51], s65 offen offset:0 sc1 lds
    v_mfma_f32_16x16x32_bf16 v[232:235], a[16:19], a[48:51], v[232:235]
    ds_read_b64_tr_b16 a[88:89], v23 offset:16384
    v_mul_f32 v135, v34, v135
    v_mfma_f32_16x16x32_bf16 v[232:235], a[20:23], a[52:55], v[232:235]
    ds_read_b64_tr_b16 a[90:91], v23 offset:20480
    v_mfma_f32_16x16x32_bf16 v[236:239], a[28:31], a[52:55], v[236:239]
    ds_read_b128 a[124:127], v43 offset:24576
    v_mul_f32 v136, v34, v136
    v_mfma_f32_16x16x32_bf16 v[236:239], a[24:27], a[48:51], v[236:239]
    buffer_load_dwordx4 v2, s[48:51], s65 offen offset:1024 sc1 lds
    v_mfma_f32_16x16x32_bf16 v[252:255], a[24:27], a[56:59], v[252:255]
    ds_read_b64_tr_b16 a[92:93], v23 offset:24576
    v_mul_f32 v137, v34, v137
    v_mfma_f32_16x16x32_bf16 v[252:255], a[28:31], a[60:63], v[252:255]
    ds_read_b64_tr_b16 a[94:95], v23 offset:28672
    v_mul_f32 v138, v34, v138
    v_mfma_f32_16x16x32_bf16 v[248:251], a[20:23], a[60:63], v[248:251]
    v_mfma_f32_16x16x32_bf16 v[248:251], a[16:19], a[56:59], v[248:251]
    buffer_load_dwordx4 v2, s[48:51], s65 offen offset:2048 sc1 lds
    v_mfma_f32_16x16x32_bf16 v[244:247], a[8:11], a[56:59], v[244:247]
    v_mul_f32 v139, v34, v139
    v_mfma_f32_16x16x32_bf16 v[244:247], a[12:15], a[60:63], v[244:247]
    v_mul_f32 v140, v34, v140
    v_mfma_f32_16x16x32_bf16 v[240:243], a[4:7], a[60:63], v[240:243]
    v_mfma_f32_16x16x32_bf16 v[240:243], a[0:3], a[56:59], v[240:243]
    s_waitcnt vmcnt(15) lgkmcnt(0)
    buffer_load_dwordx4 v2, s[48:51], s65 offen offset:3072 sc1 lds
    s_add_u32 s65, s65, 8192
    v_mfma_f32_16x16x32_bf16 v[192:195], a[64:67], a[96:99], v[192:195]
    s_barrier
    ds_read_b128 a[160:163], v40 offset:32768
    ds_read_b64_tr_b16 a[128:129], v16 offset:0
    v_mfma_f32_16x16x32_bf16 v[192:195], a[68:71], a[100:103], v[192:195]
    ds_read_b64_tr_b16 a[130:131], v16 offset:4096
    v_mul_f32 v141, v34, v141
    v_mfma_f32_16x16x32_bf16 v[196:199], a[76:79], a[100:103], v[196:199]
    s_add_u32 m0, s66, 147456
    ds_read_b128 a[164:167], v40 offset:40960
    ds_read_b64_tr_b16 a[132:133], v16 offset:8192
    v_mfma_f32_16x16x32_bf16 v[196:199], a[72:75], a[96:99], v[196:199]
    buffer_load_dwordx4 v10, s[24:27], s64 offen offset:0 lds
    v_mfma_f32_16x16x32_bf16 v[200:203], a[80:83], a[96:99], v[200:203]
    ds_read_b64_tr_b16 a[134:135], v16 offset:12288
    ds_read_b128 a[168:171], v41 offset:32768
    v_mfma_f32_16x16x32_bf16 v[200:203], a[84:87], a[100:103], v[200:203]
    ds_read_b64_tr_b16 a[136:137], v17 offset:0
    v_mul_f32 v142, v34, v142
    v_mul_f32 v143, v34, v143
    v_mfma_f32_16x16x32_bf16 v[204:207], a[92:95], a[100:103], v[204:207]
    ds_read_b64_tr_b16 a[138:139], v17 offset:4096
    ds_read_b128 a[172:175], v41 offset:40960
    v_mfma_f32_16x16x32_bf16 v[204:207], a[88:91], a[96:99], v[204:207]
    buffer_load_dwordx4 v11, s[24:27], s64 offen offset:1024 lds
    v_mfma_f32_16x16x32_bf16 v[220:223], a[88:91], a[104:107], v[220:223]
    ds_read_b64_tr_b16 a[140:141], v17 offset:8192
    v_mul_f32 v144, v35, v144
    v_mfma_f32_16x16x32_bf16 v[220:223], a[92:95], a[108:111], v[220:223]
    ds_read_b64_tr_b16 a[142:143], v17 offset:12288
    v_mul_f32 v145, v35, v145
    v_mfma_f32_16x16x32_bf16 v[216:219], a[84:87], a[108:111], v[216:219]
    ds_read_b128 a[176:179], v42 offset:32768
    v_mul_f32 v146, v35, v146
    v_mfma_f32_16x16x32_bf16 v[216:219], a[80:83], a[104:107], v[216:219]
    buffer_load_dwordx4 v12, s[24:27], s64 offen offset:2048 lds
    v_mfma_f32_16x16x32_bf16 v[212:215], a[72:75], a[104:107], v[212:215]
    ds_read_b64_tr_b16 a[144:145], v18 offset:0
    v_mul_f32 v147, v35, v147
    v_mfma_f32_16x16x32_bf16 v[212:215], a[76:79], a[108:111], v[212:215]
    ds_read_b64_tr_b16 a[146:147], v18 offset:4096
    v_mul_f32 v148, v35, v148
    v_mfma_f32_16x16x32_bf16 v[208:211], a[68:71], a[108:111], v[208:211]
    ds_read_b128 a[180:183], v42 offset:40960
    v_mfma_f32_16x16x32_bf16 v[208:211], a[64:67], a[104:107], v[208:211]
    buffer_load_dwordx4 v13, s[24:27], s64 offen offset:3072 lds
    v_mfma_f32_16x16x32_bf16 v[224:227], a[64:67], a[112:115], v[224:227]
    s_add_u32 s64, s64, 65536
    ds_read_b64_tr_b16 a[148:149], v18 offset:8192
    v_mul_f32 v149, v35, v149
    v_mfma_f32_16x16x32_bf16 v[224:227], a[68:71], a[116:119], v[224:227]
    ds_read_b64_tr_b16 a[150:151], v18 offset:12288
    v_mul_f32 v150, v35, v150
    v_mfma_f32_16x16x32_bf16 v[228:231], a[76:79], a[116:119], v[228:231]
    s_add_u32 m0, s66, 81920
    ds_read_b128 a[184:187], v43 offset:32768
    v_mul_f32 v151, v35, v151
    v_mfma_f32_16x16x32_bf16 v[228:231], a[72:75], a[112:115], v[228:231]
    buffer_load_dwordx4 v2, s[48:51], s65 offen offset:0 sc1 lds
    v_mfma_f32_16x16x32_bf16 v[232:235], a[80:83], a[112:115], v[232:235]
    ds_read_b64_tr_b16 a[152:153], v19 offset:0
    v_mul_f32 v152, v35, v152
    v_mfma_f32_16x16x32_bf16 v[232:235], a[84:87], a[116:119], v[232:235]
    ds_read_b64_tr_b16 a[154:155], v19 offset:4096
    v_mfma_f32_16x16x32_bf16 v[236:239], a[92:95], a[116:119], v[236:239]
    ds_read_b128 a[188:191], v43 offset:40960
    v_mul_f32 v153, v35, v153
    v_mfma_f32_16x16x32_bf16 v[236:239], a[88:91], a[112:115], v[236:239]
    buffer_load_dwordx4 v2, s[48:51], s65 offen offset:1024 sc1 lds
    v_mfma_f32_16x16x32_bf16 v[252:255], a[88:91], a[120:123], v[252:255]
    ds_read_b64_tr_b16 a[156:157], v19 offset:8192
    v_mul_f32 v154, v35, v154
    v_mfma_f32_16x16x32_bf16 v[252:255], a[92:95], a[124:127], v[252:255]
    ds_read_b64_tr_b16 a[158:159], v19 offset:12288
    v_mul_f32 v155, v35, v155
    v_mfma_f32_16x16x32_bf16 v[248:251], a[84:87], a[124:127], v[248:251]
    v_mfma_f32_16x16x32_bf16 v[248:251], a[80:83], a[120:123], v[248:251]
    buffer_load_dwordx4 v2, s[48:51], s65 offen offset:2048 sc1 lds
    v_mfma_f32_16x16x32_bf16 v[244:247], a[72:75], a[120:123], v[244:247]
    v_mul_f32 v156, v35, v156
    v_mfma_f32_16x16x32_bf16 v[244:247], a[76:79], a[124:127], v[244:247]
    v_mul_f32 v157, v35, v157
    v_mfma_f32_16x16x32_bf16 v[240:243], a[68:71], a[124:127], v[240:243]
    v_mfma_f32_16x16x32_bf16 v[240:243], a[64:67], a[120:123], v[240:243]
    s_waitcnt vmcnt(15) lgkmcnt(0)
    buffer_load_dwordx4 v2, s[48:51], s65 offen offset:3072 sc1 lds
    s_add_u32 s65, s65, 8192
    v_mfma_f32_16x16x32_bf16 v[192:195], a[128:131], a[160:163], v[192:195]
    s_barrier
    ds_read_b128 a[224:227], v40 offset:49152
    ds_read_b64_tr_b16 a[192:193], v16 offset:16384
    v_mfma_f32_16x16x32_bf16 v[192:195], a[132:135], a[164:167], v[192:195]
    buffer_load_dword v31, v15, s[48:51], 0 offen sc1
    ds_read_b64_tr_b16 a[194:195], v16 offset:20480
    v_mul_f32 v158, v35, v158
    v_mfma_f32_16x16x32_bf16 v[196:199], a[140:143], a[164:167], v[196:199]
    s_add_u32 m0, s66, 0
    ds_read_b128 a[228:231], v40 offset:57344
    ds_read_b64_tr_b16 a[196:197], v16 offset:24576
    v_mfma_f32_16x16x32_bf16 v[196:199], a[136:139], a[160:163], v[196:199]
    buffer_load_dwordx4 v10, s[24:27], s64 offen offset:0 lds
    v_mfma_f32_16x16x32_bf16 v[200:203], a[144:147], a[160:163], v[200:203]
    ds_read_b64_tr_b16 a[198:199], v16 offset:28672
    ds_read_b128 a[232:235], v41 offset:49152
    v_mfma_f32_16x16x32_bf16 v[200:203], a[148:151], a[164:167], v[200:203]
    ds_read_b64_tr_b16 a[200:201], v17 offset:16384
    v_mul_f32 v159, v35, v159
    v_mul_f32 v160, v36, v160
    v_mfma_f32_16x16x32_bf16 v[204:207], a[156:159], a[164:167], v[204:207]
    ds_read_b64_tr_b16 a[202:203], v17 offset:20480
    ds_read_b128 a[236:239], v41 offset:57344
    v_mfma_f32_16x16x32_bf16 v[204:207], a[152:155], a[160:163], v[204:207]
    buffer_load_dwordx4 v11, s[24:27], s64 offen offset:1024 lds
    v_mfma_f32_16x16x32_bf16 v[220:223], a[152:155], a[168:171], v[220:223]
    ds_read_b64_tr_b16 a[204:205], v17 offset:24576
    v_mul_f32 v161, v36, v161
    v_mfma_f32_16x16x32_bf16 v[220:223], a[156:159], a[172:175], v[220:223]
    ds_read_b64_tr_b16 a[206:207], v17 offset:28672
    v_mul_f32 v162, v36, v162
    v_mfma_f32_16x16x32_bf16 v[216:219], a[148:151], a[172:175], v[216:219]
    ds_read_b128 a[240:243], v42 offset:49152
    v_mul_f32 v163, v36, v163
    v_mfma_f32_16x16x32_bf16 v[216:219], a[144:147], a[168:171], v[216:219]
    buffer_load_dwordx4 v12, s[24:27], s64 offen offset:2048 lds
    v_mfma_f32_16x16x32_bf16 v[212:215], a[136:139], a[168:171], v[212:215]
    ds_read_b64_tr_b16 a[208:209], v18 offset:16384
    v_mul_f32 v164, v36, v164
    v_mfma_f32_16x16x32_bf16 v[212:215], a[140:143], a[172:175], v[212:215]
    ds_read_b64_tr_b16 a[210:211], v18 offset:20480
    v_mul_f32 v165, v36, v165
    v_mfma_f32_16x16x32_bf16 v[208:211], a[132:135], a[172:175], v[208:211]
    ds_read_b128 a[244:247], v42 offset:57344
    v_mfma_f32_16x16x32_bf16 v[208:211], a[128:131], a[168:171], v[208:211]
    buffer_load_dwordx4 v13, s[24:27], s64 offen offset:3072 lds
    v_mfma_f32_16x16x32_bf16 v[224:227], a[128:131], a[176:179], v[224:227]
    s_add_u32 s64, s64, 65536
    ds_read_b64_tr_b16 a[212:213], v18 offset:24576
    v_mul_f32 v166, v36, v166
    v_mfma_f32_16x16x32_bf16 v[224:227], a[132:135], a[180:183], v[224:227]
    ds_read_b64_tr_b16 a[214:215], v18 offset:28672
    v_mul_f32 v167, v36, v167
    v_mfma_f32_16x16x32_bf16 v[228:231], a[140:143], a[180:183], v[228:231]
    s_add_u32 m0, s66, 98304
    ds_read_b128 a[248:251], v43 offset:49152
    v_mul_f32 v168, v36, v168
    v_mfma_f32_16x16x32_bf16 v[228:231], a[136:139], a[176:179], v[228:231]
    buffer_load_dwordx4 v2, s[48:51], s65 offen offset:0 sc1 lds
    v_mfma_f32_16x16x32_bf16 v[232:235], a[144:147], a[176:179], v[232:235]
    ds_read_b64_tr_b16 a[216:217], v19 offset:16384
    v_mul_f32 v169, v36, v169
    v_mfma_f32_16x16x32_bf16 v[232:235], a[148:151], a[180:183], v[232:235]
    ds_read_b64_tr_b16 a[218:219], v19 offset:20480
    v_mfma_f32_16x16x32_bf16 v[236:239], a[156:159], a[180:183], v[236:239]
    ds_read_b128 a[252:255], v43 offset:57344
    v_mul_f32 v170, v36, v170
    v_mfma_f32_16x16x32_bf16 v[236:239], a[152:155], a[176:179], v[236:239]
    buffer_load_dwordx4 v2, s[48:51], s65 offen offset:1024 sc1 lds
    v_mfma_f32_16x16x32_bf16 v[252:255], a[152:155], a[184:187], v[252:255]
    ds_read_b64_tr_b16 a[220:221], v19 offset:24576
    v_mul_f32 v171, v36, v171
    v_mfma_f32_16x16x32_bf16 v[252:255], a[156:159], a[188:191], v[252:255]
    ds_read_b64_tr_b16 a[222:223], v19 offset:28672
    v_mul_f32 v172, v36, v172
    v_mfma_f32_16x16x32_bf16 v[248:251], a[148:151], a[188:191], v[248:251]
    v_mfma_f32_16x16x32_bf16 v[248:251], a[144:147], a[184:187], v[248:251]
    buffer_load_dwordx4 v2, s[48:51], s65 offen offset:2048 sc1 lds
    v_mfma_f32_16x16x32_bf16 v[244:247], a[136:139], a[184:187], v[244:247]
    v_mul_f32 v173, v36, v173
    v_mfma_f32_16x16x32_bf16 v[244:247], a[140:143], a[188:191], v[244:247]
    v_mul_f32 v174, v36, v174
    v_mfma_f32_16x16x32_bf16 v[240:243], a[132:135], a[188:191], v[240:243]
    v_mfma_f32_16x16x32_bf16 v[240:243], a[128:131], a[184:187], v[240:243]
    s_waitcnt vmcnt(7) lgkmcnt(0)
    buffer_load_dwordx4 v2, s[48:51], s65 offen offset:3072 sc1 lds
    s_add_u32 s65, s65, 8192
    s_mov_b32 s88, 65536
L_s3b_t:
    v_readfirstlane_b32 s69, v31
    s_cmp_ge_u32 s69, 4
    s_cbranch_scc1 L_s3b_ok
    s_sub_u32 s88, s88, 1
    s_cmp_eq_u32 s88, 0
    s_cbranch_scc1 L_s3b_ok
    s_sleep 1
    buffer_load_dword v31, v15, s[48:51], 0 offen sc1
    s_waitcnt vmcnt(0)
    s_branch L_s3b_t
L_s3b_ok:
    v_mfma_f32_16x16x32_bf16 v[192:195], a[192:195], a[224:227], v[192:195]
    s_barrier
    ds_read_b128 a[32:35], v40 offset:0
    ds_read_b64_tr_b16 a[0:1], v20 offset:0
    v_mfma_f32_16x16x32_bf16 v[192:195], a[196:199], a[228:231], v[192:195]
    ds_read_b64_tr_b16 a[2:3], v20 offset:4096
    v_mul_f32 v175, v36, v175
    v_mfma_f32_16x16x32_bf16 v[196:199], a[204:207], a[228:231], v[196:199]
    s_and_b32 s69, s2, 4
    s_cmp_eq_u32 s69, 0
    s_cselect_b32 s69, 12, -20
    s_lshl_b32 s69, s69, 17
    s_add_u32 s64, s64, s69
    s_add_u32 m0, s66, 16384
    ds_read_b128 a[36:39], v40 offset:8192
    ds_read_b64_tr_b16 a[4:5], v20 offset:8192
    v_mfma_f32_16x16x32_bf16 v[196:199], a[200:203], a[224:227], v[196:199]
    buffer_load_dwordx4 v10, s[24:27], s64 offen offset:0 lds
    v_mfma_f32_16x16x32_bf16 v[200:203], a[208:211], a[224:227], v[200:203]
    ds_read_b64_tr_b16 a[6:7], v20 offset:12288
    ds_read_b128 a[40:43], v41 offset:0
    v_mfma_f32_16x16x32_bf16 v[200:203], a[212:215], a[228:231], v[200:203]
    ds_read_b64_tr_b16 a[8:9], v21 offset:0
    v_mul_f32 v176, v37, v176
    v_mul_f32 v177, v37, v177
    v_mfma_f32_16x16x32_bf16 v[204:207], a[220:223], a[228:231], v[204:207]
    ds_read_b64_tr_b16 a[10:11], v21 offset:4096
    ds_read_b128 a[44:47], v41 offset:8192
    v_mfma_f32_16x16x32_bf16 v[204:207], a[216:219], a[224:227], v[204:207]
    buffer_load_dwordx4 v11, s[24:27], s64 offen offset:1024 lds
    v_mfma_f32_16x16x32_bf16 v[220:223], a[216:219], a[232:235], v[220:223]
    ds_read_b64_tr_b16 a[12:13], v21 offset:8192
    v_mul_f32 v178, v37, v178
    v_mfma_f32_16x16x32_bf16 v[220:223], a[220:223], a[236:239], v[220:223]
    ds_read_b64_tr_b16 a[14:15], v21 offset:12288
    v_mul_f32 v179, v37, v179
    v_mfma_f32_16x16x32_bf16 v[216:219], a[212:215], a[236:239], v[216:219]
    ds_read_b128 a[48:51], v42 offset:0
    v_mul_f32 v180, v37, v180
    v_mfma_f32_16x16x32_bf16 v[216:219], a[208:211], a[232:235], v[216:219]
    buffer_load_dwordx4 v12, s[24:27], s64 offen offset:2048 lds
    v_mfma_f32_16x16x32_bf16 v[212:215], a[200:203], a[232:235], v[212:215]
    ds_read_b64_tr_b16 a[16:17], v22 offset:0
    v_mul_f32 v181, v37, v181
    v_mfma_f32_16x16x32_bf16 v[212:215], a[204:207], a[236:239], v[212:215]
    ds_read_b64_tr_b16 a[18:19], v22 offset:4096
    v_mul_f32 v182, v37, v182
    v_mfma_f32_16x16x32_bf16 v[208:211], a[196:199], a[236:239], v[208:211]
    ds_read_b128 a[52:55], v42 offset:8192
    v_mfma_f32_16x16x32_bf16 v[208:211], a[192:195], a[232:235], v[208:211]
    buffer_load_dwordx4 v13, s[24:27], s64 offen offset:3072 lds
    v_mfma_f32_16x16x32_bf16 v[224:227], a[192:195], a[240:243], v[224:227]
    s_add_u32 s64, s64, 65536
    ds_read_b64_tr_b16 a[20:21], v22 offset:8192
    v_mul_f32 v183, v37, v183
    v_mfma_f32_16x16x32_bf16 v[224:227], a[196:199], a[244:247], v[224:227]
    ds_read_b64_tr_b16 a[22:23], v22 offset:12288
    v_mul_f32 v184, v37, v184
    v_mfma_f32_16x16x32_bf16 v[228:231], a[204:207], a[244:247], v[228:231]
    s_and_b32 s69, s2, 4
    s_cmp_eq_u32 s69, 0
    s_cselect_b32 s69, 12, -20
    s_lshl_b32 s69, s69, 14
    s_add_u32 s65, s65, s69
    s_add_u32 m0, s66, 114688
    ds_read_b128 a[56:59], v43 offset:0
    v_mul_f32 v185, v37, v185
    v_mfma_f32_16x16x32_bf16 v[228:231], a[200:203], a[240:243], v[228:231]
    buffer_load_dwordx4 v2, s[48:51], s65 offen offset:0 sc1 lds
    v_mfma_f32_16x16x32_bf16 v[232:235], a[208:211], a[240:243], v[232:235]
    ds_read_b64_tr_b16 a[24:25], v23 offset:0
    v_mul_f32 v186, v37, v186
    v_mfma_f32_16x16x32_bf16 v[232:235], a[212:215], a[244:247], v[232:235]
    ds_read_b64_tr_b16 a[26:27], v23 offset:4096
    v_mfma_f32_16x16x32_bf16 v[236:239], a[220:223], a[244:247], v[236:239]
    ds_read_b128 a[60:63], v43 offset:8192
    v_mul_f32 v187, v37, v187
    v_mfma_f32_16x16x32_bf16 v[236:239], a[216:219], a[240:243], v[236:239]
    buffer_load_dwordx4 v2, s[48:51], s65 offen offset:1024 sc1 lds
    v_mfma_f32_16x16x32_bf16 v[252:255], a[216:219], a[248:251], v[252:255]
    ds_read_b64_tr_b16 a[28:29], v23 offset:8192
    v_mul_f32 v188, v37, v188
    v_mfma_f32_16x16x32_bf16 v[252:255], a[220:223], a[252:255], v[252:255]
    ds_read_b64_tr_b16 a[30:31], v23 offset:12288
    v_mul_f32 v189, v37, v189
    v_mfma_f32_16x16x32_bf16 v[248:251], a[212:215], a[252:255], v[248:251]
    v_mfma_f32_16x16x32_bf16 v[248:251], a[208:211], a[248:251], v[248:251]
    buffer_load_dwordx4 v2, s[48:51], s65 offen offset:2048 sc1 lds
    v_mfma_f32_16x16x32_bf16 v[244:247], a[200:203], a[248:251], v[244:247]
    v_mul_f32 v190, v37, v190
    v_mfma_f32_16x16x32_bf16 v[244:247], a[204:207], a[252:255], v[244:247]
    v_mul_f32 v191, v37, v191
    v_mfma_f32_16x16x32_bf16 v[240:243], a[196:199], a[252:255], v[240:243]
    v_mfma_f32_16x16x32_bf16 v[240:243], a[192:195], a[248:251], v[240:243]
    s_waitcnt vmcnt(16) lgkmcnt(0)
    buffer_load_dwordx4 v2, s[48:51], s65 offen offset:3072 sc1 lds
    s_add_u32 s65, s65, 8192
    v_mfma_f32_16x16x32_bf16 v[192:195], a[0:3], a[32:35], v[192:195]
    s_barrier
    ds_read_b128 a[96:99], v40 offset:16384
    ds_read_b64_tr_b16 a[64:65], v20 offset:16384
    v_mfma_f32_16x16x32_bf16 v[192:195], a[4:7], a[36:39], v[192:195]
    ds_read_b64_tr_b16 a[66:67], v20 offset:20480
    v_mfma_f32_16x16x32_bf16 v[196:199], a[12:15], a[36:39], v[196:199]
    s_add_u32 m0, s66, 131072
    ds_read_b128 a[100:103], v40 offset:24576
    ds_read_b64_tr_b16 a[68:69], v20 offset:24576
    v_mfma_f32_16x16x32_bf16 v[196:199], a[8:11], a[32:35], v[196:199]
    buffer_load_dwordx4 v10, s[24:27], s64 offen offset:0 lds
    v_mfma_f32_16x16x32_bf16 v[200:203], a[16:19], a[32:35], v[200:203]
    ds_read_b64_tr_b16 a[70:71], v20 offset:28672
    ds_read_b128 a[104:107], v41 offset:16384
    v_mfma_f32_16x16x32_bf16 v[200:203], a[20:23], a[36:39], v[200:203]
    ds_read_b64_tr_b16 a[72:73], v21 offset:16384
    v_mfma_f32_16x16x32_bf16 v[204:207], a[28:31], a[36:39], v[204:207]
    ds_read_b64_tr_b16 a[74:75], v21 offset:20480
    ds_read_b128 a[108:111], v41 offset:24576
    v_mfma_f32_16x16x32_bf16 v[204:207], a[24:27], a[32:35], v[204:207]
    buffer_load_dwordx4 v11, s[24:27], s64 offen offset:1024 lds
    v_mfma_f32_16x16x32_bf16 v[220:223], a[24:27], a[40:43], v[220:223]
    ds_read_b64_tr_b16 a[76:77], v21 offset:24576
    v_mfma_f32_16x16x32_bf16 v[220:223], a[28:31], a[44:47], v[220:223]
    ds_read_b64_tr_b16 a[78:79], v21 offset:28672
    v_mfma_f32_16x16x32_bf16 v[216:219], a[20:23], a[44:47], v[216:219]
    ds_read_b128 a[112:115], v42 offset:16384
    v_mfma_f32_16x16x32_bf16 v[216:219], a[16:19], a[40:43], v[216:219]
    buffer_load_dwordx4 v12, s[24:27], s64 offen offset:2048 lds
    v_mfma_f32_16x16x32_bf16 v[212:215], a[8:11], a[40:43], v[212:215]
    ds_read_b64_tr_b16 a[80:81], v22 offset:16384
    v_mfma_f32_16x16x32_bf16 v[212:215], a[12:15], a[44:47], v[212:215]
    ds_read_b64_tr_b16 a[82:83], v22 offset:20480
    v_mfma_f32_16x16x32_bf16 v[208:211], a[4:7], a[44:47], v[208:211]
    ds_read_b128 a[116:119], v42 offset:24576
    v_mfma_f32_16x16x32_bf16 v[208:211], a[0:3], a[40:43], v[208:211]
    buffer_load_dwordx4 v13, s[24:27], s64 offen offset:3072 lds
    v_mfma_f32_16x16x32_bf16 v[224:227], a[0:3], a[48:51], v[224:227]
    s_add_u32 s64, s64, 65536
    ds_read_b64_tr_b16 a[84:85], v22 offset:24576
    v_mfma_f32_16x16x32_bf16 v[224:227], a[4:7], a[52:55], v[224:227]
    ds_read_b64_tr_b16 a[86:87], v22 offset:28672
    v_mfma_f32_16x16x32_bf16 v[228:231], a[12:15], a[52:55], v[228:231]
    s_add_u32 m0, s66, 65536
    ds_read_b128 a[120:123], v43 offset:16384
    v_mfma_f32_16x16x32_bf16 v[228:231], a[8:11], a[48:51], v[228:231]
    buffer_load_dwordx4 v2, s[48:51], s65 offen offset:0 sc1 lds
    v_mfma_f32_16x16x32_bf16 v[232:235], a[16:19], a[48:51], v[232:235]
    ds_read_b64_tr_b16 a[88:89], v23 offset:16384
    v_mfma_f32_16x16x32_bf16 v[232:235], a[20:23], a[52:55], v[232:235]
    ds_read_b64_tr_b16 a[90:91], v23 offset:20480
    v_mfma_f32_16x16x32_bf16 v[236:239], a[28:31], a[52:55], v[236:239]
    ds_read_b128 a[124:127], v43 offset:24576
    v_mfma_f32_16x16x32_bf16 v[236:239], a[24:27], a[48:51], v[236:239]
    buffer_load_dwordx4 v2, s[48:51], s65 offen offset:1024 sc1 lds
    v_mfma_f32_16x16x32_bf16 v[252:255], a[24:27], a[56:59], v[252:255]
    ds_read_b64_tr_b16 a[92:93], v23 offset:24576
    v_mfma_f32_16x16x32_bf16 v[252:255], a[28:31], a[60:63], v[252:255]
    ds_read_b64_tr_b16 a[94:95], v23 offset:28672
    v_mfma_f32_16x16x32_bf16 v[248:251], a[20:23], a[60:63], v[248:251]
    v_mfma_f32_16x16x32_bf16 v[248:251], a[16:19], a[56:59], v[248:251]
    buffer_load_dwordx4 v2, s[48:51], s65 offen offset:2048 sc1 lds
    v_mfma_f32_16x16x32_bf16 v[244:247], a[8:11], a[56:59], v[244:247]
    v_mfma_f32_16x16x32_bf16 v[244:247], a[12:15], a[60:63], v[244:247]
    v_mfma_f32_16x16x32_bf16 v[240:243], a[4:7], a[60:63], v[240:243]
    v_mfma_f32_16x16x32_bf16 v[240:243], a[0:3], a[56:59], v[240:243]
    s_waitcnt vmcnt(15) lgkmcnt(0)
    buffer_load_dwordx4 v2, s[48:51], s65 offen offset:3072 sc1 lds
    s_add_u32 s65, s65, 8192
    v_mfma_f32_16x16x32_bf16 v[192:195], a[64:67], a[96:99], v[192:195]
    s_barrier
    ds_read_b128 a[160:163], v40 offset:32768
    ds_read_b64_tr_b16 a[128:129], v16 offset:0
    v_mfma_f32_16x16x32_bf16 v[192:195], a[68:71], a[100:103], v[192:195]
    ds_read_b64_tr_b16 a[130:131], v16 offset:4096
    v_mfma_f32_16x16x32_bf16 v[196:199], a[76:79], a[100:103], v[196:199]
    s_add_u32 m0, s66, 147456
    ds_read_b128 a[164:167], v40 offset:40960
    ds_read_b64_tr_b16 a[132:133], v16 offset:8192
    v_mfma_f32_16x16x32_bf16 v[196:199], a[72:75], a[96:99], v[196:199]
    buffer_load_dwordx4 v10, s[24:27], s64 offen offset:0 lds
    v_mfma_f32_16x16x32_bf16 v[200:203], a[80:83], a[96:99], v[200:203]
    ds_read_b64_tr_b16 a[134:135], v16 offset:12288
    ds_read_b128 a[168:171], v41 offset:32768
    v_mfma_f32_16x16x32_bf16 v[200:203], a[84:87], a[100:103], v[200:203]
    ds_read_b64_tr_b16 a[136:137], v17 offset:0
    v_mfma_f32_16x16x32_bf16 v[204:207], a[92:95], a[100:103], v[204:207]
    ds_read_b64_tr_b16 a[138:139], v17 offset:4096
    ds_read_b128 a[172:175], v41 offset:40960
    v_mfma_f32_16x16x32_bf16 v[204:207], a[88:91], a[96:99], v[204:207]
    buffer_load_dwordx4 v11, s[24:27], s64 offen offset:1024 lds
    v_mfma_f32_16x16x32_bf16 v[220:223], a[88:91], a[104:107], v[220:223]
    ds_read_b64_tr_b16 a[140:141], v17 offset:8192
    v_mfma_f32_16x16x32_bf16 v[220:223], a[92:95], a[108:111], v[220:223]
    ds_read_b64_tr_b16 a[142:143], v17 offset:12288
    v_mfma_f32_16x16x32_bf16 v[216:219], a[84:87], a[108:111], v[216:219]
    ds_read_b128 a[176:179], v42 offset:32768
    v_mfma_f32_16x16x32_bf16 v[216:219], a[80:83], a[104:107], v[216:219]
    buffer_load_dwordx4 v12, s[24:27], s64 offen offset:2048 lds
    v_mfma_f32_16x16x32_bf16 v[212:215], a[72:75], a[104:107], v[212:215]
    ds_read_b64_tr_b16 a[144:145], v18 offset:0
    v_mfma_f32_16x16x32_bf16 v[212:215], a[76:79], a[108:111], v[212:215]
    ds_read_b64_tr_b16 a[146:147], v18 offset:4096
    v_mfma_f32_16x16x32_bf16 v[208:211], a[68:71], a[108:111], v[208:211]
    ds_read_b128 a[180:183], v42 offset:40960
    v_mfma_f32_16x16x32_bf16 v[208:211], a[64:67], a[104:107], v[208:211]
    buffer_load_dwordx4 v13, s[24:27], s64 offen offset:3072 lds
    v_mfma_f32_16x16x32_bf16 v[224:227], a[64:67], a[112:115], v[224:227]
    s_add_u32 s64, s64, 65536
    ds_read_b64_tr_b16 a[148:149], v18 offset:8192
    v_mfma_f32_16x16x32_bf16 v[224:227], a[68:71], a[116:119], v[224:227]
    ds_read_b64_tr_b16 a[150:151], v18 offset:12288
    v_mfma_f32_16x16x32_bf16 v[228:231], a[76:79], a[116:119], v[228:231]
    s_add_u32 m0, s66, 81920
    ds_read_b128 a[184:187], v43 offset:32768
    v_mfma_f32_16x16x32_bf16 v[228:231], a[72:75], a[112:115], v[228:231]
    buffer_load_dwordx4 v2, s[48:51], s65 offen offset:0 sc1 lds
    v_mfma_f32_16x16x32_bf16 v[232:235], a[80:83], a[112:115], v[232:235]
    ds_read_b64_tr_b16 a[152:153], v19 offset:0
    v_mfma_f32_16x16x32_bf16 v[232:235], a[84:87], a[116:119], v[232:235]
    ds_read_b64_tr_b16 a[154:155], v19 offset:4096
    v_mfma_f32_16x16x32_bf16 v[236:239], a[92:95], a[116:119], v[236:239]
    ds_read_b128 a[188:191], v43 offset:40960
    v_mfma_f32_16x16x32_bf16 v[236:239], a[88:91], a[112:115], v[236:239]
    buffer_load_dwordx4 v2, s[48:51], s65 offen offset:1024 sc1 lds
    v_mfma_f32_16x16x32_bf16 v[252:255], a[88:91], a[120:123], v[252:255]
    ds_read_b64_tr_b16 a[156:157], v19 offset:8192
    v_mfma_f32_16x16x32_bf16 v[252:255], a[92:95], a[124:127], v[252:255]
    ds_read_b64_tr_b16 a[158:159], v19 offset:12288
    v_mfma_f32_16x16x32_bf16 v[248:251], a[84:87], a[124:127], v[248:251]
    v_mfma_f32_16x16x32_bf16 v[248:251], a[80:83], a[120:123], v[248:251]
    buffer_load_dwordx4 v2, s[48:51], s65 offen offset:2048 sc1 lds
    v_mfma_f32_16x16x32_bf16 v[244:247], a[72:75], a[120:123], v[244:247]
    v_mfma_f32_16x16x32_bf16 v[244:247], a[76:79], a[124:127], v[244:247]
    v_mfma_f32_16x16x32_bf16 v[240:243], a[68:71], a[124:127], v[240:243]
    v_mfma_f32_16x16x32_bf16 v[240:243], a[64:67], a[120:123], v[240:243]
    s_waitcnt vmcnt(15) lgkmcnt(0)
    buffer_load_dwordx4 v2, s[48:51], s65 offen offset:3072 sc1 lds
    s_add_u32 s65, s65, 8192
    v_mfma_f32_16x16x32_bf16 v[192:195], a[128:131], a[160:163], v[192:195]
    s_barrier
    ds_read_b128 a[224:227], v40 offset:49152
    ds_read_b64_tr_b16 a[192:193], v16 offset:16384
    v_mfma_f32_16x16x32_bf16 v[192:195], a[132:135], a[164:167], v[192:195]
    ds_read_b64_tr_b16 a[194:195], v16 offset:20480
    v_mfma_f32_16x16x32_bf16 v[196:199], a[140:143], a[164:167], v[196:199]
    s_add_u32 m0, s66, 0
    ds_read_b128 a[228:231], v40 offset:57344
    ds_read_b64_tr_b16 a[196:197], v16 offset:24576
    v_mfma_f32_16x16x32_bf16 v[196:199], a[136:139], a[160:163], v[196:199]
    buffer_load_dwordx4 v10, s[24:27], s64 offen offset:0 lds
    v_mfma_f32_16x16x32_bf16 v[200:203], a[144:147], a[160:163], v[200:203]
    ds_read_b64_tr_b16 a[198:199], v16 offset:28672
    ds_read_b128 a[232:235], v41 offset:49152
    v_mfma_f32_16x16x32_bf16 v[200:203], a[148:151], a[164:167], v[200:203]
    ds_read_b64_tr_b16 a[200:201], v17 offset:16384
    v_mfma_f32_16x16x32_bf16 v[204:207], a[156:159], a[164:167], v[204:207]
    ds_read_b64_tr_b16 a[202:203], v17 offset:20480
    ds_read_b128 a[236:239], v41 offset:57344
    v_mfma_f32_16x16x32_bf16 v[204:207], a[152:155], a[160:163], v[204:207]
    buffer_load_dwordx4 v11, s[24:27], s64 offen offset:1024 lds
    v_mfma_f32_16x16x32_bf16 v[220:223], a[152:155], a[168:171], v[220:223]
    ds_read_b64_tr_b16 a[204:205], v17 offset:24576
    v_mfma_f32_16x16x32_bf16 v[220:223], a[156:159], a[172:175], v[220:223]
    ds_read_b64_tr_b16 a[206:207], v17 offset:28672
    v_mfma_f32_16x16x32_bf16 v[216:219], a[148:151], a[172:175], v[216:219]
    ds_read_b128 a[240:243], v42 offset:49152
    v_mfma_f32_16x16x32_bf16 v[216:219], a[144:147], a[168:171], v[216:219]
    buffer_load_dwordx4 v12, s[24:27], s64 offen offset:2048 lds
    v_mfma_f32_16x16x32_bf16 v[212:215], a[136:139], a[168:171], v[212:215]
    ds_read_b64_tr_b16 a[208:209], v18 offset:16384
    v_mfma_f32_16x16x32_bf16 v[212:215], a[140:143], a[172:175], v[212:215]
    ds_read_b64_tr_b16 a[210:211], v18 offset:20480
    v_mfma_f32_16x16x32_bf16 v[208:211], a[132:135], a[172:175], v[208:211]
    ds_read_b128 a[244:247], v42 offset:57344
    v_mfma_f32_16x16x32_bf16 v[208:211], a[128:131], a[168:171], v[208:211]
    buffer_load_dwordx4 v13, s[24:27], s64 offen offset:3072 lds
    v_mfma_f32_16x16x32_bf16 v[224:227], a[128:131], a[176:179], v[224:227]
    s_add_u32 s64, s64, 65536
    ds_read_b64_tr_b16 a[212:213], v18 offset:24576
    v_mfma_f32_16x16x32_bf16 v[224:227], a[132:135], a[180:183], v[224:227]
    ds_read_b64_tr_b16 a[214:215], v18 offset:28672
    v_mfma_f32_16x16x32_bf16 v[228:231], a[140:143], a[180:183], v[228:231]
    s_add_u32 m0, s66, 98304
    ds_read_b128 a[248:251], v43 offset:49152
    v_mfma_f32_16x16x32_bf16 v[228:231], a[136:139], a[176:179], v[228:231]
    buffer_load_dwordx4 v2, s[48:51], s65 offen offset:0 sc1 lds
    v_mfma_f32_16x16x32_bf16 v[232:235], a[144:147], a[176:179], v[232:235]
    ds_read_b64_tr_b16 a[216:217], v19 offset:16384
    v_mfma_f32_16x16x32_bf16 v[232:235], a[148:151], a[180:183], v[232:235]
    ds_read_b64_tr_b16 a[218:219], v19 offset:20480
    v_mfma_f32_16x16x32_bf16 v[236:239], a[156:159], a[180:183], v[236:239]
    ds_read_b128 a[252:255], v43 offset:57344
    v_mfma_f32_16x16x32_bf16 v[236:239], a[152:155], a[176:179], v[236:239]
    buffer_load_dwordx4 v2, s[48:51], s65 offen offset:1024 sc1 lds
    v_mfma_f32_16x16x32_bf16 v[252:255], a[152:155], a[184:187], v[252:255]
    ds_read_b64_tr_b16 a[220:221], v19 offset:24576
    v_mfma_f32_16x16x32_bf16 v[252:255], a[156:159], a[188:191], v[252:255]
    ds_read_b64_tr_b16 a[222:223], v19 offset:28672
    v_mfma_f32_16x16x32_bf16 v[248:251], a[148:151], a[188:191], v[248:251]
    v_mfma_f32_16x16x32_bf16 v[248:251], a[144:147], a[184:187], v[248:251]
    buffer_load_dwordx4 v2, s[48:51], s65 offen offset:2048 sc1 lds
    v_mfma_f32_16x16x32_bf16 v[244:247], a[136:139], a[184:187], v[244:247]
    v_mfma_f32_16x16x32_bf16 v[244:247], a[140:143], a[188:191], v[244:247]
    v_mfma_f32_16x16x32_bf16 v[240:243], a[132:135], a[188:191], v[240:243]
    v_mfma_f32_16x16x32_bf16 v[240:243], a[128:131], a[184:187], v[240:243]
    s_waitcnt vmcnt(15) lgkmcnt(0)
    buffer_load_dwordx4 v2, s[48:51], s65 offen offset:3072 sc1 lds
    s_add_u32 s65, s65, 8192
    v_mfma_f32_16x16x32_bf16 v[192:195], a[192:195], a[224:227], v[192:195]
    s_barrier
    ds_read_b128 a[32:35], v40 offset:0
    ds_read_b64_tr_b16 a[0:1], v20 offset:0
    v_mfma_f32_16x16x32_bf16 v[192:195], a[196:199], a[228:231], v[192:195]
    ds_read_b64_tr_b16 a[2:3], v20 offset:4096
    v_mfma_f32_16x16x32_bf16 v[196:199], a[204:207], a[228:231], v[196:199]
    s_add_u32 m0, s66, 16384
    ds_read_b128 a[36:39], v40 offset:8192
    ds_read_b64_tr_b16 a[4:5], v20 offset:8192
    v_mfma_f32_16x16x32_bf16 v[196:199], a[200:203], a[224:227], v[196:199]
    buffer_load_dwordx4 v10, s[24:27], s64 offen offset:0 lds
    v_mfma_f32_16x16x32_bf16 v[200:203], a[208:211], a[224:227], v[200:203]
    ds_read_b64_tr_b16 a[6:7], v20 offset:12288
    ds_read_b128 a[40:43], v41 offset:0
    v_mfma_f32_16x16x32_bf16 v[200:203], a[212:215], a[228:231], v[200:203]
    ds_read_b64_tr_b16 a[8:9], v21 offset:0
    v_mfma_f32_16x16x32_bf16 v[204:207], a[220:223], a[228:231], v[204:207]
    ds_read_b64_tr_b16 a[10:11], v21 offset:4096
    ds_read_b128 a[44:47], v41 offset:8192
    v_mfma_f32_16x16x32_bf16 v[204:207], a[216:219], a[224:227], v[204:207]
    buffer_load_dwordx4 v11, s[24:27], s64 offen offset:1024 lds
    v_mfma_f32_16x16x32_bf16 v[220:223], a[216:219], a[232:235], v[220:223]
    ds_read_b64_tr_b16 a[12:13], v21 offset:8192
    v_mfma_f32_16x16x32_bf16 v[220:223], a[220:223], a[236:239], v[220:223]
    ds_read_b64_tr_b16 a[14:15], v21 offset:12288
    v_mfma_f32_16x16x32_bf16 v[216:219], a[212:215], a[236:239], v[216:219]
    ds_read_b128 a[48:51], v42 offset:0
    v_mfma_f32_16x16x32_bf16 v[216:219], a[208:211], a[232:235], v[216:219]
    buffer_load_dwordx4 v12, s[24:27], s64 offen offset:2048 lds
    v_mfma_f32_16x16x32_bf16 v[212:215], a[200:203], a[232:235], v[212:215]
    ds_read_b64_tr_b16 a[16:17], v22 offset:0
    v_mfma_f32_16x16x32_bf16 v[212:215], a[204:207], a[236:239], v[212:215]
    ds_read_b64_tr_b16 a[18:19], v22 offset:4096
    v_mfma_f32_16x16x32_bf16 v[208:211], a[196:199], a[236:239], v[208:211]
    ds_read_b128 a[52:55], v42 offset:8192
    v_mfma_f32_16x16x32_bf16 v[208:211], a[192:195], a[232:235], v[208:211]
    buffer_load_dwordx4 v13, s[24:27], s64 offen offset:3072 lds
    v_mfma_f32_16x16x32_bf16 v[224:227], a[192:195], a[240:243], v[224:227]
    s_add_u32 s64, s64, 65536
    ds_read_b64_tr_b16 a[20:21], v22 offset:8192
    v_mfma_f32_16x16x32_bf16 v[224:227], a[196:199], a[244:247], v[224:227]
    ds_read_b64_tr_b16 a[22:23], v22 offset:12288
    v_mfma_f32_16x16x32_bf16 v[228:231], a[204:207], a[244:247], v[228:231]
    s_add_u32 m0, s66, 114688
    ds_read_b128 a[56:59], v43 offset:0
    v_mfma_f32_16x16x32_bf16 v[228:231], a[200:203], a[240:243], v[228:231]
    buffer_load_dwordx4 v2, s[48:51], s65 offen offset:0 sc1 lds
    v_mfma_f32_16x16x32_bf16 v[232:235], a[208:211], a[240:243], v[232:235]
    ds_read_b64_tr_b16 a[24:25], v23 offset:0
    v_mfma_f32_16x16x32_bf16 v[232:235], a[212:215], a[244:247], v[232:235]
    ds_read_b64_tr_b16 a[26:27], v23 offset:4096
    v_mfma_f32_16x16x32_bf16 v[236:239], a[220:223], a[244:247], v[236:239]
    ds_read_b128 a[60:63], v43 offset:8192
    v_mfma_f32_16x16x32_bf16 v[236:239], a[216:219], a[240:243], v[236:239]
    buffer_load_dwordx4 v2, s[48:51], s65 offen offset:1024 sc1 lds
    v_mfma_f32_16x16x32_bf16 v[252:255], a[216:219], a[248:251], v[252:255]
    ds_read_b64_tr_b16 a[28:29], v23 offset:8192
    v_mfma_f32_16x16x32_bf16 v[252:255], a[220:223], a[252:255], v[252:255]
    ds_read_b64_tr_b16 a[30:31], v23 offset:12288
    v_mfma_f32_16x16x32_bf16 v[248:251], a[212:215], a[252:255], v[248:251]
    v_mfma_f32_16x16x32_bf16 v[248:251], a[208:211], a[248:251], v[248:251]
    buffer_load_dwordx4 v2, s[48:51], s65 offen offset:2048 sc1 lds
    v_mfma_f32_16x16x32_bf16 v[244:247], a[200:203], a[248:251], v[244:247]
    v_mfma_f32_16x16x32_bf16 v[244:247], a[204:207], a[252:255], v[244:247]
    v_mfma_f32_16x16x32_bf16 v[240:243], a[196:199], a[252:255], v[240:243]
    v_mfma_f32_16x16x32_bf16 v[240:243], a[192:195], a[248:251], v[240:243]
    s_waitcnt vmcnt(15) lgkmcnt(0)
    buffer_load_dwordx4 v2, s[48:51], s65 offen offset:3072 sc1 lds
    s_add_u32 s65, s65, 8192
    v_mfma_f32_16x16x32_bf16 v[192:195], a[0:3], a[32:35], v[192:195]
    s_barrier
    ds_read_b128 a[96:99], v40 offset:16384
    ds_read_b64_tr_b16 a[64:65], v20 offset:16384
    v_mfma_f32_16x16x32_bf16 v[192:195], a[4:7], a[36:39], v[192:195]
    ds_read_b64_tr_b16 a[66:67], v20 offset:20480
    v_mfma_f32_16x16x32_bf16 v[196:199], a[12:15], a[36:39], v[196:199]
    s_add_u32 m0, s66, 131072
    ds_read_b128 a[100:103], v40 offset:24576
    ds_read_b64_tr_b16 a[68:69], v20 offset:24576
    v_mfma_f32_16x16x32_bf16 v[196:199], a[8:11], a[32:35], v[196:199]
    buffer_load_dwordx4 v10, s[24:27], s64 offen offset:0 lds
    v_mfma_f32_16x16x32_bf16 v[200:203], a[16:19], a[32:35], v[200:203]
    ds_read_b64_tr_b16 a[70:71], v20 offset:28672
    ds_read_b128 a[104:107], v41 offset:16384
    v_mfma_f32_16x16x32_bf16 v[200:203], a[20:23], a[36:39], v[200:203]
    ds_read_b64_tr_b16 a[72:73], v21 offset:16384
    v_mfma_f32_16x16x32_bf16 v[204:207], a[28:31], a[36:39], v[204:207]
    ds_read_b64_tr_b16 a[74:75], v21 offset:20480
    ds_read_b128 a[108:111], v41 offset:24576
    v_mfma_f32_16x16x32_bf16 v[204:207], a[24:27], a[32:35], v[204:207]
    buffer_load_dwordx4 v11, s[24:27], s64 offen offset:1024 lds
    v_mfma_f32_16x16x32_bf16 v[220:223], a[24:27], a[40:43], v[220:223]
    ds_read_b64_tr_b16 a[76:77], v21 offset:24576
    v_mfma_f32_16x16x32_bf16 v[220:223], a[28:31], a[44:47], v[220:223]
    ds_read_b64_tr_b16 a[78:79], v21 offset:28672
    v_mfma_f32_16x16x32_bf16 v[216:219], a[20:23], a[44:47], v[216:219]
    ds_read_b128 a[112:115], v42 offset:16384
    v_mfma_f32_16x16x32_bf16 v[216:219], a[16:19], a[40:43], v[216:219]
    buffer_load_dwordx4 v12, s[24:27], s64 offen offset:2048 lds
    v_mfma_f32_16x16x32_bf16 v[212:215], a[8:11], a[40:43], v[212:215]
    ds_read_b64_tr_b16 a[80:81], v22 offset:16384
    v_mfma_f32_16x16x32_bf16 v[212:215], a[12:15], a[44:47], v[212:215]
    ds_read_b64_tr_b16 a[82:83], v22 offset:20480
    v_mfma_f32_16x16x32_bf16 v[208:211], a[4:7], a[44:47], v[208:211]
    ds_read_b128 a[116:119], v42 offset:24576
    v_mfma_f32_16x16x32_bf16 v[208:211], a[0:3], a[40:43], v[208:211]
    buffer_load_dwordx4 v13, s[24:27], s64 offen offset:3072 lds
    v_mfma_f32_16x16x32_bf16 v[224:227], a[0:3], a[48:51], v[224:227]
    s_add_u32 s64, s64, 65536
    ds_read_b64_tr_b16 a[84:85], v22 offset:24576
    v_mfma_f32_16x16x32_bf16 v[224:227], a[4:7], a[52:55], v[224:227]
    ds_read_b64_tr_b16 a[86:87], v22 offset:28672
    v_mfma_f32_16x16x32_bf16 v[228:231], a[12:15], a[52:55], v[228:231]
    s_add_u32 m0, s66, 65536
    ds_read_b128 a[120:123], v43 offset:16384
    v_mfma_f32_16x16x32_bf16 v[228:231], a[8:11], a[48:51], v[228:231]
    buffer_load_dwordx4 v2, s[48:51], s65 offen offset:0 sc1 lds
    v_mfma_f32_16x16x32_bf16 v[232:235], a[16:19], a[48:51], v[232:235]
    ds_read_b64_tr_b16 a[88:89], v23 offset:16384
    v_mfma_f32_16x16x32_bf16 v[232:235], a[20:23], a[52:55], v[232:235]
    ds_read_b64_tr_b16 a[90:91], v23 offset:20480
    v_mfma_f32_16x16x32_bf16 v[236:239], a[28:31], a[52:55], v[236:239]
    ds_read_b128 a[124:127], v43 offset:24576
    v_mfma_f32_16x16x32_bf16 v[236:239], a[24:27], a[48:51], v[236:239]
    buffer_load_dwordx4 v2, s[48:51], s65 offen offset:1024 sc1 lds
    v_mfma_f32_16x16x32_bf16 v[252:255], a[24:27], a[56:59], v[252:255]
    ds_read_b64_tr_b16 a[92:93], v23 offset:24576
    v_mfma_f32_16x16x32_bf16 v[252:255], a[28:31], a[60:63], v[252:255]
    ds_read_b64_tr_b16 a[94:95], v23 offset:28672
    v_mfma_f32_16x16x32_bf16 v[248:251], a[20:23], a[60:63], v[248:251]
    v_mfma_f32_16x16x32_bf16 v[248:251], a[16:19], a[56:59], v[248:251]
    buffer_load_dwordx4 v2, s[48:51], s65 offen offset:2048 sc1 lds
    v_mfma_f32_16x16x32_bf16 v[244:247], a[8:11], a[56:59], v[244:247]
    v_mfma_f32_16x16x32_bf16 v[244:247], a[12:15], a[60:63], v[244:247]
    v_mfma_f32_16x16x32_bf16 v[240:243], a[4:7], a[60:63], v[240:243]
    v_mfma_f32_16x16x32_bf16 v[240:243], a[0:3], a[56:59], v[240:243]
    s_waitcnt vmcnt(15) lgkmcnt(0)
    buffer_load_dwordx4 v2, s[48:51], s65 offen offset:3072 sc1 lds
    s_add_u32 s65, s65, 8192
    v_mfma_f32_16x16x32_bf16 v[192:195], a[64:67], a[96:99], v[192:195]
    s_barrier
    ds_read_b128 a[160:163], v40 offset:32768
    ds_read_b64_tr_b16 a[128:129], v16 offset:0
    v_mfma_f32_16x16x32_bf16 v[192:195], a[68:71], a[100:103], v[192:195]
    ds_read_b64_tr_b16 a[130:131], v16 offset:4096
    v_mfma_f32_16x16x32_bf16 v[196:199], a[76:79], a[100:103], v[196:199]
    s_add_u32 m0, s66, 147456
    ds_read_b128 a[164:167], v40 offset:40960
    ds_read_b64_tr_b16 a[132:133], v16 offset:8192
    v_mfma_f32_16x16x32_bf16 v[196:199], a[72:75], a[96:99], v[196:199]
    buffer_load_dwordx4 v10, s[24:27], s64 offen offset:0 lds
    v_mfma_f32_16x16x32_bf16 v[200:203], a[80:83], a[96:99], v[200:203]
    ds_read_b64_tr_b16 a[134:135], v16 offset:12288
    ds_read_b128 a[168:171], v41 offset:32768
    v_mfma_f32_16x16x32_bf16 v[200:203], a[84:87], a[100:103], v[200:203]
    ds_read_b64_tr_b16 a[136:137], v17 offset:0
    v_mfma_f32_16x16x32_bf16 v[204:207], a[92:95], a[100:103], v[204:207]
    ds_read_b64_tr_b16 a[138:139], v17 offset:4096
    ds_read_b128 a[172:175], v41 offset:40960
    v_mfma_f32_16x16x32_bf16 v[204:207], a[88:91], a[96:99], v[204:207]
    buffer_load_dwordx4 v11, s[24:27], s64 offen offset:1024 lds
    v_mfma_f32_16x16x32_bf16 v[220:223], a[88:91], a[104:107], v[220:223]
    ds_read_b64_tr_b16 a[140:141], v17 offset:8192
    v_mfma_f32_16x16x32_bf16 v[220:223], a[92:95], a[108:111], v[220:223]
    ds_read_b64_tr_b16 a[142:143], v17 offset:12288
    v_mfma_f32_16x16x32_bf16 v[216:219], a[84:87], a[108:111], v[216:219]
    ds_read_b128 a[176:179], v42 offset:32768
    v_mfma_f32_16x16x32_bf16 v[216:219], a[80:83], a[104:107], v[216:219]
    buffer_load_dwordx4 v12, s[24:27], s64 offen offset:2048 lds
    v_mfma_f32_16x16x32_bf16 v[212:215], a[72:75], a[104:107], v[212:215]
    ds_read_b64_tr_b16 a[144:145], v18 offset:0
    v_mfma_f32_16x16x32_bf16 v[212:215], a[76:79], a[108:111], v[212:215]
    ds_read_b64_tr_b16 a[146:147], v18 offset:4096
    v_mfma_f32_16x16x32_bf16 v[208:211], a[68:71], a[108:111], v[208:211]
    ds_read_b128 a[180:183], v42 offset:40960
    v_mfma_f32_16x16x32_bf16 v[208:211], a[64:67], a[104:107], v[208:211]
    buffer_load_dwordx4 v13, s[24:27], s64 offen offset:3072 lds
    v_mfma_f32_16x16x32_bf16 v[224:227], a[64:67], a[112:115], v[224:227]
    s_add_u32 s64, s64, 65536
    ds_read_b64_tr_b16 a[148:149], v18 offset:8192
    v_mfma_f32_16x16x32_bf16 v[224:227], a[68:71], a[116:119], v[224:227]
    ds_read_b64_tr_b16 a[150:151], v18 offset:12288
    v_mfma_f32_16x16x32_bf16 v[228:231], a[76:79], a[116:119], v[228:231]
    s_add_u32 m0, s66, 81920
    ds_read_b128 a[184:187], v43 offset:32768
    v_mfma_f32_16x16x32_bf16 v[228:231], a[72:75], a[112:115], v[228:231]
    buffer_load_dwordx4 v2, s[48:51], s65 offen offset:0 sc1 lds
    v_mfma_f32_16x16x32_bf16 v[232:235], a[80:83], a[112:115], v[232:235]
    ds_read_b64_tr_b16 a[152:153], v19 offset:0
    v_mfma_f32_16x16x32_bf16 v[232:235], a[84:87], a[116:119], v[232:235]
    ds_read_b64_tr_b16 a[154:155], v19 offset:4096
    v_mfma_f32_16x16x32_bf16 v[236:239], a[92:95], a[116:119], v[236:239]
    ds_read_b128 a[188:191], v43 offset:40960
    v_mfma_f32_16x16x32_bf16 v[236:239], a[88:91], a[112:115], v[236:239]
    buffer_load_dwordx4 v2, s[48:51], s65 offen offset:1024 sc1 lds
    v_mfma_f32_16x16x32_bf16 v[252:255], a[88:91], a[120:123], v[252:255]
    ds_read_b64_tr_b16 a[156:157], v19 offset:8192
    v_mfma_f32_16x16x32_bf16 v[252:255], a[92:95], a[124:127], v[252:255]
    ds_read_b64_tr_b16 a[158:159], v19 offset:12288
    v_mfma_f32_16x16x32_bf16 v[248:251], a[84:87], a[124:127], v[248:251]
    v_mfma_f32_16x16x32_bf16 v[248:251], a[80:83], a[120:123], v[248:251]
    buffer_load_dwordx4 v2, s[48:51], s65 offen offset:2048 sc1 lds
    v_mfma_f32_16x16x32_bf16 v[244:247], a[72:75], a[120:123], v[244:247]
    v_mfma_f32_16x16x32_bf16 v[244:247], a[76:79], a[124:127], v[244:247]
    v_mfma_f32_16x16x32_bf16 v[240:243], a[68:71], a[124:127], v[240:243]
    v_mfma_f32_16x16x32_bf16 v[240:243], a[64:67], a[120:123], v[240:243]
    s_waitcnt vmcnt(15) lgkmcnt(0)
    buffer_load_dwordx4 v2, s[48:51], s65 offen offset:3072 sc1 lds
    s_add_u32 s65, s65, 8192
    v_mfma_f32_16x16x32_bf16 v[192:195], a[128:131], a[160:163], v[192:195]
    s_barrier
    ds_read_b128 a[224:227], v40 offset:49152
    ds_read_b64_tr_b16 a[192:193], v16 offset:16384
    v_mfma_f32_16x16x32_bf16 v[192:195], a[132:135], a[164:167], v[192:195]
    ds_read_b64_tr_b16 a[194:195], v16 offset:20480
    v_mfma_f32_16x16x32_bf16 v[196:199], a[140:143], a[164:167], v[196:199]
    s_add_u32 m0, s66, 0
    ds_read_b128 a[228:231], v40 offset:57344
    ds_read_b64_tr_b16 a[196:197], v16 offset:24576
    v_mfma_f32_16x16x32_bf16 v[196:199], a[136:139], a[160:163], v[196:199]
    buffer_load_dwordx4 v10, s[24:27], s64 offen offset:0 lds
    v_mfma_f32_16x16x32_bf16 v[200:203], a[144:147], a[160:163], v[200:203]
    ds_read_b64_tr_b16 a[198:199], v16 offset:28672
    ds_read_b128 a[232:235], v41 offset:49152
    v_mfma_f32_16x16x32_bf16 v[200:203], a[148:151], a[164:167], v[200:203]
    ds_read_b64_tr_b16 a[200:201], v17 offset:16384
    v_mfma_f32_16x16x32_bf16 v[204:207], a[156:159], a[164:167], v[204:207]
    ds_read_b64_tr_b16 a[202:203], v17 offset:20480
    ds_read_b128 a[236:239], v41 offset:57344
    v_mfma_f32_16x16x32_bf16 v[204:207], a[152:155], a[160:163], v[204:207]
    buffer_load_dwordx4 v11, s[24:27], s64 offen offset:1024 lds
    v_mfma_f32_16x16x32_bf16 v[220:223], a[152:155], a[168:171], v[220:223]
    ds_read_b64_tr_b16 a[204:205], v17 offset:24576
    v_mfma_f32_16x16x32_bf16 v[220:223], a[156:159], a[172:175], v[220:223]
    ds_read_b64_tr_b16 a[206:207], v17 offset:28672
    v_mfma_f32_16x16x32_bf16 v[216:219], a[148:151], a[172:175], v[216:219]
    ds_read_b128 a[240:243], v42 offset:49152
    v_mfma_f32_16x16x32_bf16 v[216:219], a[144:147], a[168:171], v[216:219]
    buffer_load_dwordx4 v12, s[24:27], s64 offen offset:2048 lds
    v_mfma_f32_16x16x32_bf16 v[212:215], a[136:139], a[168:171], v[212:215]
    ds_read_b64_tr_b16 a[208:209], v18 offset:16384
    v_mfma_f32_16x16x32_bf16 v[212:215], a[140:143], a[172:175], v[212:215]
    ds_read_b64_tr_b16 a[210:211], v18 offset:20480
    v_mfma_f32_16x16x32_bf16 v[208:211], a[132:135], a[172:175], v[208:211]
    ds_read_b128 a[244:247], v42 offset:57344
    v_mfma_f32_16x16x32_bf16 v[208:211], a[128:131], a[168:171], v[208:211]
    buffer_load_dwordx4 v13, s[24:27], s64 offen offset:3072 lds
    v_mfma_f32_16x16x32_bf16 v[224:227], a[128:131], a[176:179], v[224:227]
    s_add_u32 s64, s64, 65536
    ds_read_b64_tr_b16 a[212:213], v18 offset:24576
    v_mfma_f32_16x16x32_bf16 v[224:227], a[132:135], a[180:183], v[224:227]
    ds_read_b64_tr_b16 a[214:215], v18 offset:28672
    v_mfma_f32_16x16x32_bf16 v[228:231], a[140:143], a[180:183], v[228:231]
    s_add_u32 m0, s66, 98304
    ds_read_b128 a[248:251], v43 offset:49152
    v_mfma_f32_16x16x32_bf16 v[228:231], a[136:139], a[176:179], v[228:231]
    buffer_load_dwordx4 v2, s[48:51], s65 offen offset:0 sc1 lds
    v_mfma_f32_16x16x32_bf16 v[232:235], a[144:147], a[176:179], v[232:235]
    ds_read_b64_tr_b16 a[216:217], v19 offset:16384
    v_mfma_f32_16x16x32_bf16 v[232:235], a[148:151], a[180:183], v[232:235]
    ds_read_b64_tr_b16 a[218:219], v19 offset:20480
    v_mfma_f32_16x16x32_bf16 v[236:239], a[156:159], a[180:183], v[236:239]
    ds_read_b128 a[252:255], v43 offset:57344
    v_mfma_f32_16x16x32_bf16 v[236:239], a[152:155], a[176:179], v[236:239]
    buffer_load_dwordx4 v2, s[48:51], s65 offen offset:1024 sc1 lds
    v_mfma_f32_16x16x32_bf16 v[252:255], a[152:155], a[184:187], v[252:255]
    ds_read_b64_tr_b16 a[220:221], v19 offset:24576
    v_mfma_f32_16x16x32_bf16 v[252:255], a[156:159], a[188:191], v[252:255]
    ds_read_b64_tr_b16 a[222:223], v19 offset:28672
    v_mfma_f32_16x16x32_bf16 v[248:251], a[148:151], a[188:191], v[248:251]
    v_mfma_f32_16x16x32_bf16 v[248:251], a[144:147], a[184:187], v[248:251]
    buffer_load_dwordx4 v2, s[48:51], s65 offen offset:2048 sc1 lds
    v_mfma_f32_16x16x32_bf16 v[244:247], a[136:139], a[184:187], v[244:247]
    v_mfma_f32_16x16x32_bf16 v[244:247], a[140:143], a[188:191], v[244:247]
    v_mfma_f32_16x16x32_bf16 v[240:243], a[132:135], a[188:191], v[240:243]
    v_mfma_f32_16x16x32_bf16 v[240:243], a[128:131], a[184:187], v[240:243]
    s_waitcnt vmcnt(15) lgkmcnt(0)
    buffer_load_dwordx4 v2, s[48:51], s65 offen offset:3072 sc1 lds
    s_add_u32 s65, s65, 8192
    v_mfma_f32_16x16x32_bf16 v[192:195], a[192:195], a[224:227], v[192:195]
    s_barrier
    ds_read_b128 a[32:35], v40 offset:0
    ds_read_b64_tr_b16 a[0:1], v20 offset:0
    v_mfma_f32_16x16x32_bf16 v[192:195], a[196:199], a[228:231], v[192:195]
    s_lshl_b32 s67, s87, 18
    ds_read_b64_tr_b16 a[2:3], v20 offset:4096
    v_mfma_f32_16x16x32_bf16 v[196:199], a[204:207], a[228:231], v[196:199]
    s_lshl_b32 s69, s60, 12
    ds_read_b128 a[36:39], v40 offset:8192
    v_mfma_f32_16x16x32_bf16 v[196:199], a[200:203], a[224:227], v[196:199]
    s_add_u32 s67, s67, s69
    ds_read_b64_tr_b16 a[4:5], v20 offset:8192
    ds_read_b64_tr_b16 a[6:7], v20 offset:12288
    v_mfma_f32_16x16x32_bf16 v[200:203], a[208:211], a[224:227], v[200:203]
    s_add_u32 s67, s67, 67108864
    ds_read_b128 a[40:43], v41 offset:0
    v_mfma_f32_16x16x32_bf16 v[200:203], a[212:215], a[228:231], v[200:203]
    s_lshl_b32 s69, s84, 14
    ds_read_b64_tr_b16 a[8:9], v21 offset:0
    v_mfma_f32_16x16x32_bf16 v[204:207], a[220:223], a[228:231], v[204:207]
    s_add_u32 s64, s67, s69
    ds_read_b64_tr_b16 a[10:11], v21 offset:4096
    v_mfma_f32_16x16x32_bf16 v[204:207], a[216:219], a[224:227], v[204:207]
    s_lshl_b32 s69, s84, 16
    ds_read_b128 a[44:47], v41 offset:8192
    ds_read_b64_tr_b16 a[12:13], v21 offset:8192
    v_mfma_f32_16x16x32_bf16 v[220:223], a[216:219], a[232:235], v[220:223]
    s_add_u32 s67, s67, s69
    ds_read_b64_tr_b16 a[14:15], v21 offset:12288
    v_mfma_f32_16x16x32_bf16 v[220:223], a[220:223], a[236:239], v[220:223]
    s_add_u32 s69, s84, 1
    ds_read_b128 a[48:51], v42 offset:0
    v_mfma_f32_16x16x32_bf16 v[216:219], a[212:215], a[236:239], v[216:219]
    s_and_b32 s69, s69, 3
    ds_read_b64_tr_b16 a[16:17], v22 offset:0
    v_mfma_f32_16x16x32_bf16 v[216:219], a[208:211], a[232:235], v[216:219]
    s_lshl_b32 s69, s69, 14
    ds_read_b64_tr_b16 a[18:19], v22 offset:4096
    ds_read_b128 a[52:55], v42 offset:8192
    v_mfma_f32_16x16x32_bf16 v[212:215], a[200:203], a[232:235], v[212:215]
    s_add_u32 s70, s67, s69
    ds_read_b64_tr_b16 a[20:21], v22 offset:8192
    v_mfma_f32_16x16x32_bf16 v[212:215], a[204:207], a[236:239], v[212:215]
    s_add_u32 s69, s84, 2
    ds_read_b64_tr_b16 a[22:23], v22 offset:12288
    v_mfma_f32_16x16x32_bf16 v[208:211], a[196:199], a[236:239], v[208:211]
    s_and_b32 s69, s69, 3
    ds_read_b128 a[56:59], v43 offset:0
    v_mfma_f32_16x16x32_bf16 v[208:211], a[192:195], a[232:235], v[208:211]
    s_lshl_b32 s69, s69, 14
    ds_read_b64_tr_b16 a[24:25], v23 offset:0
    ds_read_b64_tr_b16 a[26:27], v23 offset:4096
    v_mfma_f32_16x16x32_bf16 v[224:227], a[192:195], a[240:243], v[224:227]
    s_add_u32 s71, s67, s69
    ds_read_b128 a[60:63], v43 offset:8192
    v_mfma_f32_16x16x32_bf16 v[224:227], a[196:199], a[244:247], v[224:227]
    s_add_u32 s69, s84, 3
    ds_read_b64_tr_b16 a[28:29], v23 offset:8192
    v_mfma_f32_16x16x32_bf16 v[228:231], a[204:207], a[244:247], v[228:231]
    s_and_b32 s69, s69, 3
    ds_read_b64_tr_b16 a[30:31], v23 offset:12288
    v_mfma_f32_16x16x32_bf16 v[228:231], a[200:203], a[240:243], v[228:231]
    s_lshl_b32 s69, s69, 14
    v_mfma_f32_16x16x32_bf16 v[232:235], a[208:211], a[240:243], v[232:235]
    s_add_u32 s72, s67, s69
    v_mfma_f32_16x16x32_bf16 v[232:235], a[212:215], a[244:247], v[232:235]
    v_mfma_f32_16x16x32_bf16 v[236:239], a[220:223], a[244:247], v[236:239]
    v_mfma_f32_16x16x32_bf16 v[236:239], a[216:219], a[240:243], v[236:239]
    s_waitcnt vmcnt(8) lgkmcnt(0)
    v_mfma_f32_16x16x32_bf16 v[192:195], a[0:3], a[32:35], v[192:195]
    s_barrier
    ds_read_b128 a[96:99], v40 offset:16384
    ds_read_b64_tr_b16 a[64:65], v20 offset:16384
    v_mfma_f32_16x16x32_bf16 v[192:195], a[4:7], a[36:39], v[192:195]
    ds_read_b64_tr_b16 a[66:67], v20 offset:20480
    v_and_b32 v32, 15, v1
    v_lshrrev_b32 v33, 4, v1
    v_mfma_f32_16x16x32_bf16 v[196:199], a[12:15], a[36:39], v[196:199]
    ds_read_b128 a[100:103], v40 offset:24576
    v_lshlrev_b32 v33, 3, v33
    v_lshl_add_u32 v38, v32, 10, v33
    v_mfma_f32_16x16x32_bf16 v[196:199], a[8:11], a[32:35], v[196:199]
    s_lshl_b32 s65, s85, 17
    ds_read_b64_tr_b16 a[68:69], v20 offset:24576
    ds_read_b64_tr_b16 a[70:71], v20 offset:28672
    v_mfma_f32_16x16x32_bf16 v[200:203], a[16:19], a[32:35], v[200:203]
    s_and_b32 s69, s60, 1
    ds_read_b128 a[104:107], v41 offset:16384
    v_mfma_f32_16x16x32_bf16 v[200:203], a[20:23], a[36:39], v[200:203]
    s_lshl_b32 s69, s69, 16
    ds_read_b64_tr_b16 a[72:73], v21 offset:16384
    v_mfma_f32_16x16x32_bf16 v[204:207], a[28:31], a[36:39], v[204:207]
    s_add_u32 s65, s65, s69
    ds_read_b64_tr_b16 a[74:75], v21 offset:20480
    v_mfma_f32_16x16x32_bf16 v[204:207], a[24:27], a[32:35], v[204:207]
    s_lshl_b32 s69, s84, 14
    ds_read_b128 a[108:111], v41 offset:24576
    ds_read_b64_tr_b16 a[76:77], v21 offset:24576
    v_mfma_f32_16x16x32_bf16 v[220:223], a[24:27], a[40:43], v[220:223]
    s_add_u32 s65, s65, s69
    ds_read_b64_tr_b16 a[78:79], v21 offset:28672
    v_mfma_f32_16x16x32_bf16 v[220:223], a[28:31], a[44:47], v[220:223]
    s_lshl_b32 s69, s86, 8
    ds_read_b128 a[112:115], v42 offset:16384
    v_mfma_f32_16x16x32_bf16 v[216:219], a[20:23], a[44:47], v[216:219]
    s_add_u32 s65, s65, s69
    ds_read_b64_tr_b16 a[80:81], v22 offset:16384
    v_mfma_f32_16x16x32_bf16 v[216:219], a[16:19], a[40:43], v[216:219]
    s_and_b32 s69, s60, 2
    ds_read_b64_tr_b16 a[82:83], v22 offset:20480
    ds_read_b128 a[116:119], v42 offset:24576
    v_mfma_f32_16x16x32_bf16 v[212:215], a[8:11], a[40:43], v[212:215]
    s_lshl_b32 s69, s69, 6
    ds_read_b64_tr_b16 a[84:85], v22 offset:24576
    v_mfma_f32_16x16x32_bf16 v[212:215], a[12:15], a[44:47], v[212:215]
    s_add_u32 s65, s65, s69
    ds_read_b64_tr_b16 a[86:87], v22 offset:28672
    v_mfma_f32_16x16x32_bf16 v[208:211], a[4:7], a[44:47], v[208:211]
    s_mov_b32 s88, 65536
    ds_read_b128 a[120:123], v43 offset:16384
    v_mfma_f32_16x16x32_bf16 v[208:211], a[0:3], a[40:43], v[208:211]
    ds_read_b64_tr_b16 a[88:89], v23 offset:16384
    ds_read_b64_tr_b16 a[90:91], v23 offset:20480
    v_mfma_f32_16x16x32_bf16 v[224:227], a[0:3], a[48:51], v[224:227]
    ds_read_b128 a[124:127], v43 offset:24576
    v_mfma_f32_16x16x32_bf16 v[224:227], a[4:7], a[52:55], v[224:227]
    ds_read_b64_tr_b16 a[92:93], v23 offset:24576
    v_mfma_f32_16x16x32_bf16 v[228:231], a[12:15], a[52:55], v[228:231]
    ds_read_b64_tr_b16 a[94:95], v23 offset:28672
    v_mfma_f32_16x16x32_bf16 v[228:231], a[8:11], a[48:51], v[228:231]
    v_mfma_f32_16x16x32_bf16 v[232:235], a[16:19], a[48:51], v[232:235]
    v_mfma_f32_16x16x32_bf16 v[232:235], a[20:23], a[52:55], v[232:235]
    v_mfma_f32_16x16x32_bf16 v[236:239], a[28:31], a[52:55], v[236:239]
    v_mfma_f32_16x16x32_bf16 v[236:239], a[24:27], a[48:51], v[236:239]
    s_waitcnt vmcnt(0) lgkmcnt(0)
    v_mfma_f32_16x16x32_bf16 v[192:195], a[64:67], a[96:99], v[192:195]
    s_barrier
    ds_read_b128 a[160:163], v40 offset:32768
    ds_read_b64_tr_b16 a[128:129], v16 offset:0
    v_mfma_f32_16x16x32_bf16 v[192:195], a[68:71], a[100:103], v[192:195]
    s_lshl_b32 s69, s4, 6
    ds_read_b64_tr_b16 a[130:131], v16 offset:4096
    v_mfma_f32_16x16x32_bf16 v[196:199], a[76:79], a[100:103], v[196:199]
    s_add_u32 s82, s69, s64
    ds_read_b128 a[164:167], v40 offset:40960
    v_mfma_f32_16x16x32_bf16 v[196:199], a[72:75], a[96:99], v[196:199]
    s_lshl_b32 s69, s5, 6
    ds_read_b64_tr_b16 a[132:133], v16 offset:8192
    ds_read_b64_tr_b16 a[134:135], v16 offset:12288
    v_mfma_f32_16x16x32_bf16 v[200:203], a[80:83], a[96:99], v[200:203]
    s_add_u32 s81, s69, s64
    ds_read_b128 a[168:171], v41 offset:32768
    v_mfma_f32_16x16x32_bf16 v[200:203], a[84:87], a[100:103], v[200:203]
    s_lshl_b32 s69, s6, 6
    ds_read_b64_tr_b16 a[136:137], v17 offset:0
    v_mfma_f32_16x16x32_bf16 v[204:207], a[92:95], a[100:103], v[204:207]
    s_add_u32 s76, s69, s64
    ds_read_b64_tr_b16 a[138:139], v17 offset:4096
    v_mfma_f32_16x16x32_bf16 v[204:207], a[88:91], a[96:99], v[204:207]
    ds_read_b128 a[172:175], v41 offset:40960
    ds_read_b64_tr_b16 a[140:141], v17 offset:8192
    v_mfma_f32_16x16x32_bf16 v[220:223], a[88:91], a[104:107], v[220:223]
    ds_read_b64_tr_b16 a[142:143], v17 offset:12288
    v_mfma_f32_16x16x32_bf16 v[220:223], a[92:95], a[108:111], v[220:223]
    ds_read_b128 a[176:179], v42 offset:32768
    v_mfma_f32_16x16x32_bf16 v[216:219], a[84:87], a[108:111], v[216:219]
    ds_read_b64_tr_b16 a[144:145], v18 offset:0
    v_mfma_f32_16x16x32_bf16 v[216:219], a[80:83], a[104:107], v[216:219]
    ds_read_b64_tr_b16 a[146:147], v18 offset:4096
    ds_read_b128 a[180:183], v42 offset:40960
    v_mfma_f32_16x16x32_bf16 v[212:215], a[72:75], a[104:107], v[212:215]
    ds_read_b64_tr_b16 a[148:149], v18 offset:8192
    v_mfma_f32_16x16x32_bf16 v[212:215], a[76:79], a[108:111], v[212:215]
    ds_read_b64_tr_b16 a[150:151], v18 offset:12288
    v_mfma_f32_16x16x32_bf16 v[208:211], a[68:71], a[108:111], v[208:211]
    ds_read_b128 a[184:187], v43 offset:32768
    v_mfma_f32_16x16x32_bf16 v[208:211], a[64:67], a[104:107], v[208:211]
    ds_read_b64_tr_b16 a[152:153], v19 offset:0
    ds_read_b64_tr_b16 a[154:155], v19 offset:4096
    v_mfma_f32_16x16x32_bf16 v[224:227], a[64:67], a[112:115], v[224:227]
    ds_read_b128 a[188:191], v43 offset:40960
    v_mfma_f32_16x16x32_bf16 v[224:227], a[68:71], a[116:119], v[224:227]
    ds_read_b64_tr_b16 a[156:157], v19 offset:8192
    v_mfma_f32_16x16x32_bf16 v[228:231], a[76:79], a[116:119], v[228:231]
    ds_read_b64_tr_b16 a[158:159], v19 offset:12288
    v_mfma_f32_16x16x32_bf16 v[228:231], a[72:75], a[112:115], v[228:231]
    v_mfma_f32_16x16x32_bf16 v[232:235], a[80:83], a[112:115], v[232:235]
    v_mfma_f32_16x16x32_bf16 v[232:235], a[84:87], a[116:119], v[232:235]
    v_mfma_f32_16x16x32_bf16 v[236:239], a[92:95], a[116:119], v[236:239]
    v_mfma_f32_16x16x32_bf16 v[236:239], a[88:91], a[112:115], v[236:239]
    s_waitcnt lgkmcnt(0)
    v_mfma_f32_16x16x32_bf16 v[192:195], a[128:131], a[160:163], v[192:195]
    v_mfma_f32_16x16x32_bf16 v[192:195], a[132:135], a[164:167], v[192:195]
    v_mfma_f32_16x16x32_bf16 v[196:199], a[140:143], a[164:167], v[196:199]
    v_mfma_f32_16x16x32_bf16 v[196:199], a[136:139], a[160:163], v[196:199]
    v_mfma_f32_16x16x32_bf16 v[200:203], a[144:147], a[160:163], v[200:203]
    v_mfma_f32_16x16x32_bf16 v[200:203], a[148:151], a[164:167], v[200:203]
    v_mfma_f32_16x16x32_bf16 v[204:207], a[156:159], a[164:167], v[204:207]
    v_mfma_f32_16x16x32_bf16 v[204:207], a[152:155], a[160:163], v[204:207]
    v_mfma_f32_16x16x32_bf16 v[220:223], a[152:155], a[168:171], v[220:223]
    v_mfma_f32_16x16x32_bf16 v[220:223], a[156:159], a[172:175], v[220:223]
    v_fmac_f32 v128, v26, v192
    v_fmac_f32 v129, v26, v193
    v_fmac_f32 v130, v26, v194
    v_mfma_f32_16x16x32_bf16 v[216:219], a[148:151], a[172:175], v[216:219]
    v_fmac_f32 v131, v26, v195
    v_fmac_f32 v132, v26, v196
    v_fmac_f32 v133, v26, v197
    v_mfma_f32_16x16x32_bf16 v[216:219], a[144:147], a[168:171], v[216:219]
    v_fmac_f32 v134, v26, v198
    v_fmac_f32 v135, v26, v199
    v_cvt_pk_bf16_f32 v128, v128, v129
    v_mfma_f32_16x16x32_bf16 v[212:215], a[136:139], a[168:171], v[212:215]
    v_cvt_pk_bf16_f32 v129, v130, v131
    v_cvt_pk_bf16_f32 v130, v132, v133
    v_cvt_pk_bf16_f32 v131, v134, v135
    v_mfma_f32_16x16x32_bf16 v[212:215], a[140:143], a[172:175], v[212:215]
    buffer_store_dwordx4 v[128:131], v2, s[48:51], s82 offen offset:0 sc1
    v_fmac_f32 v136, v26, v200
    v_fmac_f32 v137, v26, v201
    v_fmac_f32 v138, v26, v202
    v_mfma_f32_16x16x32_bf16 v[208:211], a[132:135], a[172:175], v[208:211]
    v_fmac_f32 v139, v26, v203
    v_fmac_f32 v140, v26, v204
    v_fmac_f32 v141, v26, v205
    v_mfma_f32_16x16x32_bf16 v[208:211], a[128:131], a[168:171], v[208:211]
    v_fmac_f32 v142, v26, v206
    v_fmac_f32 v143, v26, v207
    v_cvt_pk_bf16_f32 v136, v136, v137
    v_mfma_f32_16x16x32_bf16 v[224:227], a[128:131], a[176:179], v[224:227]
    v_cvt_pk_bf16_f32 v137, v138, v139
    v_cvt_pk_bf16_f32 v138, v140, v141
    v_cvt_pk_bf16_f32 v139, v142, v143
    v_mfma_f32_16x16x32_bf16 v[224:227], a[132:135], a[180:183], v[224:227]
    buffer_store_dwordx4 v[136:139], v2, s[48:51], s82 offen offset:1024 sc1
    v_fmac_f32 v152, v27, v216
    v_fmac_f32 v153, v27, v217
    v_fmac_f32 v154, v27, v218
    v_mfma_f32_16x16x32_bf16 v[228:231], a[140:143], a[180:183], v[228:231]
    v_fmac_f32 v155, v27, v219
    v_fmac_f32 v156, v27, v220
    v_fmac_f32 v157, v27, v221
    v_mfma_f32_16x16x32_bf16 v[228:231], a[136:139], a[176:179], v[228:231]
    v_fmac_f32 v158, v27, v222
    v_fmac_f32 v159, v27, v223
    v_cvt_pk_bf16_f32 v152, v152, v153
    v_mfma_f32_16x16x32_bf16 v[232:235], a[144:147], a[176:179], v[232:235]
    v_cvt_pk_bf16_f32 v153, v154, v155
    v_cvt_pk_bf16_f32 v154, v156, v157
    v_cvt_pk_bf16_f32 v155, v158, v159
    v_mfma_f32_16x16x32_bf16 v[232:235], a[148:151], a[180:183], v[232:235]
    buffer_store_dwordx4 v[152:155], v2, s[48:51], s81 offen offset:1024 sc1
    v_fmac_f32 v144, v27, v208
    v_fmac_f32 v145, v27, v209
    v_fmac_f32 v146, v27, v210
    v_mfma_f32_16x16x32_bf16 v[236:239], a[156:159], a[180:183], v[236:239]
    v_fmac_f32 v147, v27, v211
    v_fmac_f32 v148, v27, v212
    v_fmac_f32 v149, v27, v213
    v_mfma_f32_16x16x32_bf16 v[236:239], a[152:155], a[176:179], v[236:239]
    v_fmac_f32 v150, v27, v214
    v_fmac_f32 v151, v27, v215
    v_cvt_pk_bf16_f32 v144, v144, v145
    v_mfma_f32_16x16x32_bf16 v[252:255], a[156:159], a[188:191], v[252:255]
    v_cvt_pk_bf16_f32 v145, v146, v147
    v_cvt_pk_bf16_f32 v146, v148, v149
    v_cvt_pk_bf16_f32 v147, v150, v151
    v_mfma_f32_16x16x32_bf16 v[252:255], a[152:155], a[184:187], v[252:255]
    buffer_store_dwordx4 v[144:147], v2, s[48:51], s81 offen offset:0 sc1
    v_fmac_f32 v160, v28, v224
    v_fmac_f32 v161, v28, v225
    v_fmac_f32 v162, v28, v226
    v_mfma_f32_16x16x32_bf16 v[252:255], a[92:95], a[124:127], v[252:255]
    v_fmac_f32 v163, v28, v227
    v_fmac_f32 v164, v28, v228
    v_fmac_f32 v165, v28, v229
    v_mfma_f32_16x16x32_bf16 v[252:255], a[88:91], a[120:123], v[252:255]
    v_fmac_f32 v166, v28, v230
    v_fmac_f32 v167, v28, v231
    v_cvt_pk_bf16_f32 v160, v160, v161
    v_mfma_f32_16x16x32_bf16 v[252:255], a[28:31], a[60:63], v[252:255]
    v_cvt_pk_bf16_f32 v161, v162, v163
    v_cvt_pk_bf16_f32 v162, v164, v165
    v_cvt_pk_bf16_f32 v163, v166, v167
    v_mfma_f32_16x16x32_bf16 v[252:255], a[24:27], a[56:59], v[252:255]
    buffer_store_dwordx4 v[160:163], v2, s[48:51], s76 offen offset:0 sc1
    v_fmac_f32 v168, v28, v232
    v_fmac_f32 v169, v28, v233
    v_fmac_f32 v170, v28, v234
    v_mfma_f32_16x16x32_bf16 v[252:255], a[220:223], a[252:255], v[252:255]
    v_fmac_f32 v171, v28, v235
    v_fmac_f32 v172, v28, v236
    v_fmac_f32 v173, v28, v237
    v_mfma_f32_16x16x32_bf16 v[252:255], a[216:219], a[248:251], v[252:255]
    v_fmac_f32 v174, v28, v238
    v_fmac_f32 v175, v28, v239
    v_cvt_pk_bf16_f32 v168, v168, v169
    v_mfma_f32_16x16x32_bf16 v[248:251], a[208:211], a[248:251], v[248:251]
    v_cvt_pk_bf16_f32 v169, v170, v171
    v_cvt_pk_bf16_f32 v170, v172, v173
    v_cvt_pk_bf16_f32 v171, v174, v175
    v_mfma_f32_16x16x32_bf16 v[248:251], a[212:215], a[252:255], v[248:251]
    buffer_store_dwordx4 v[168:171], v2, s[48:51], s76 offen offset:1024 sc1
    v_mfma_f32_16x16x32_bf16 v[248:251], a[16:19], a[56:59], v[248:251]
    v_mfma_f32_16x16x32_bf16 v[248:251], a[20:23], a[60:63], v[248:251]
    v_mfma_f32_16x16x32_bf16 v[248:251], a[80:83], a[120:123], v[248:251]
    v_mfma_f32_16x16x32_bf16 v[248:251], a[84:87], a[124:127], v[248:251]
    v_mfma_f32_16x16x32_bf16 v[248:251], a[144:147], a[184:187], v[248:251]
    v_mfma_f32_16x16x32_bf16 v[248:251], a[148:151], a[188:191], v[248:251]
    v_mfma_f32_16x16x32_bf16 v[244:247], a[140:143], a[188:191], v[244:247]
    v_mfma_f32_16x16x32_bf16 v[244:247], a[136:139], a[184:187], v[244:247]
    v_mfma_f32_16x16x32_bf16 v[244:247], a[76:79], a[124:127], v[244:247]
    v_mfma_f32_16x16x32_bf16 v[244:247], a[72:75], a[120:123], v[244:247]
    v_mfma_f32_16x16x32_bf16 v[244:247], a[12:15], a[60:63], v[244:247]
    v_mfma_f32_16x16x32_bf16 v[244:247], a[8:11], a[56:59], v[244:247]
    v_mfma_f32_16x16x32_bf16 v[244:247], a[204:207], a[252:255], v[244:247]
    v_mfma_f32_16x16x32_bf16 v[244:247], a[200:203], a[248:251], v[244:247]
    v_mfma_f32_16x16x32_bf16 v[240:243], a[192:195], a[248:251], v[240:243]
    v_mfma_f32_16x16x32_bf16 v[240:243], a[196:199], a[252:255], v[240:243]
    v_mfma_f32_16x16x32_bf16 v[240:243], a[0:3], a[56:59], v[240:243]
    buffer_load_dwordx4 v[64:67], v2, s[48:51], s70 offen offset:0 sc1
    v_mfma_f32_16x16x32_bf16 v[240:243], a[4:7], a[60:63], v[240:243]
    buffer_load_dwordx4 v[68:71], v2, s[48:51], s70 offen offset:1024 sc1
    v_mfma_f32_16x16x32_bf16 v[240:243], a[64:67], a[120:123], v[240:243]
    buffer_load_dwordx4 v[80:83], v2, s[48:51], s71 offen offset:0 sc1
    v_mfma_f32_16x16x32_bf16 v[240:243], a[68:71], a[124:127], v[240:243]
    buffer_load_dwordx4 v[84:87], v2, s[48:51], s71 offen offset:1024 sc1
    v_mfma_f32_16x16x32_bf16 v[240:243], a[128:131], a[184:187], v[240:243]
    buffer_load_dwordx4 v[96:99], v2, s[48:51], s72 offen offset:0 sc1
    v_mfma_f32_16x16x32_bf16 v[240:243], a[132:135], a[188:191], v[240:243]
    buffer_load_dwordx4 v[100:103], v2, s[48:51], s72 offen offset:1024 sc1
    v_fma_f32 v124, v29, v252, v188
    v_fma_f32 v125, v29, v253, v189
    v_fma_f32 v126, v29, v254, v190
    v_fma_f32 v127, v29, v255, v191
    v_fma_f32 v120, v29, v248, v184
    v_fma_f32 v121, v29, v249, v185
    v_fma_f32 v122, v29, v250, v186
    v_fma_f32 v123, v29, v251, v187
    v_fma_f32 v116, v29, v244, v180
    v_fma_f32 v117, v29, v245, v181
    v_fma_f32 v118, v29, v246, v182
    v_fma_f32 v119, v29, v247, v183
    v_fma_f32 v112, v29, v240, v176
    v_fma_f32 v113, v29, v241, v177
    v_fma_f32 v114, v29, v242, v178
    v_fma_f32 v115, v29, v243, v179
L_xdone:
    s_waitcnt vmcnt(0)
L_s4_0:
    v_max3_u32 v34, v64, v65, v66
    v_max3_u32 v35, v67, v68, v69
    v_max3_u32 v34, v34, v70, v71
    v_max_u32 v34, v34, v35
    v_cmp_eq_u32 vcc, -1, v34
    s_cbranch_vccnz L_s4r_0
L_s4ok_0:
    v_and_b32 v79, 0xffff0000, v71
    v_lshlrev_b32 v78, 16, v71
    v_and_b32 v77, 0xffff0000, v70
    v_lshlrev_b32 v76, 16, v70
    v_and_b32 v75, 0xffff0000, v69
    v_lshlrev_b32 v74, 16, v69
    v_and_b32 v73, 0xffff0000, v68
    v_lshlrev_b32 v72, 16, v68
    v_and_b32 v71, 0xffff0000, v67
    v_lshlrev_b32 v70, 16, v67
    v_and_b32 v69, 0xffff0000, v66
    v_lshlrev_b32 v68, 16, v66
    v_and_b32 v67, 0xffff0000, v65
    v_lshlrev_b32 v66, 16, v65
    v_and_b32 v65, 0xffff0000, v64
    v_lshlrev_b32 v64, 16, v64
    v_pk_add_f32 v[112:113], v[112:113], v[64:65]
    v_pk_add_f32 v[114:115], v[114:115], v[66:67]
    v_pk_add_f32 v[116:117], v[116:117], v[68:69]
    v_pk_add_f32 v[118:119], v[118:119], v[70:71]
    v_pk_add_f32 v[120:121], v[120:121], v[72:73]
    v_pk_add_f32 v[122:123], v[122:123], v[74:75]
    v_pk_add_f32 v[124:125], v[124:125], v[76:77]
    v_pk_add_f32 v[126:127], v[126:127], v[78:79]
L_s4_1:
    v_max3_u32 v34, v80, v81, v82
    v_max3_u32 v35, v83, v84, v85
    v_max3_u32 v34, v34, v86, v87
    v_max_u32 v34, v34, v35
    v_cmp_eq_u32 vcc, -1, v34
    s_cbranch_vccnz L_s4r_1
L_s4ok_1:
    v_and_b32 v95, 0xffff0000, v87
    v_lshlrev_b32 v94, 16, v87
    v_and_b32 v93, 0xffff0000, v86
    v_lshlrev_b32 v92, 16, v86
    v_and_b32 v91, 0xffff0000, v85
    v_lshlrev_b32 v90, 16, v85
    v_and_b32 v89, 0xffff0000, v84
    v_lshlrev_b32 v88, 16, v84
    v_and_b32 v87, 0xffff0000, v83
    v_lshlrev_b32 v86, 16, v83
    v_and_b32 v85, 0xffff0000, v82
    v_lshlrev_b32 v84, 16, v82
    v_and_b32 v83, 0xffff0000, v81
    v_lshlrev_b32 v82, 16, v81
    v_and_b32 v81, 0xffff0000, v80
    v_lshlrev_b32 v80, 16, v80
    v_pk_add_f32 v[112:113], v[112:113], v[80:81]
    v_pk_add_f32 v[114:115], v[114:115], v[82:83]
    v_pk_add_f32 v[116:117], v[116:117], v[84:85]
    v_pk_add_f32 v[118:119], v[118:119], v[86:87]
    v_pk_add_f32 v[120:121], v[120:121], v[88:89]
    v_pk_add_f32 v[122:123], v[122:123], v[90:91]
    v_pk_add_f32 v[124:125], v[124:125], v[92:93]
    v_pk_add_f32 v[126:127], v[126:127], v[94:95]
L_s4_2:
    v_max3_u32 v34, v96, v97, v98
    v_max3_u32 v35, v99, v100, v101
    v_max3_u32 v34, v34, v102, v103
    v_max_u32 v34, v34, v35
    v_cmp_eq_u32 vcc, -1, v34
    s_cbranch_vccnz L_s4r_2
L_s4ok_2:
    v_and_b32 v111, 0xffff0000, v103
    v_lshlrev_b32 v110, 16, v103
    v_and_b32 v109, 0xffff0000, v102
    v_lshlrev_b32 v108, 16, v102
    v_and_b32 v107, 0xffff0000, v101
    v_lshlrev_b32 v106, 16, v101
    v_and_b32 v105, 0xffff0000, v100
    v_lshlrev_b32 v104, 16, v100
    v_and_b32 v103, 0xffff0000, v99
    v_lshlrev_b32 v102, 16, v99
    v_and_b32 v101, 0xffff0000, v98
    v_lshlrev_b32 v100, 16, v98
    v_and_b32 v99, 0xffff0000, v97
    v_lshlrev_b32 v98, 16, v97
    v_and_b32 v97, 0xffff0000, v96
    v_lshlrev_b32 v96, 16, v96
    v_pk_add_f32 v[112:113], v[112:113], v[96:97]
    v_pk_add_f32 v[114:115], v[114:115], v[98:99]
    v_pk_add_f32 v[116:117], v[116:117], v[100:101]
    v_pk_add_f32 v[118:119], v[118:119], v[102:103]
    v_pk_add_f32 v[120:121], v[120:121], v[104:105]
    v_pk_add_f32 v[122:123], v[122:123], v[106:107]
    v_pk_add_f32 v[124:125], v[124:125], v[108:109]
    v_pk_add_f32 v[126:127], v[126:127], v[110:111]
    v_cvt_pk_bf16_f32 v112, v112, v113
    v_cvt_pk_bf16_f32 v113, v114, v115
    buffer_store_dwordx2 v[112:113], v38, s[44:47], s65 offen offset:0
    v_cvt_pk_bf16_f32 v116, v116, v117
    v_cvt_pk_bf16_f32 v117, v118, v119
    buffer_store_dwordx2 v[116:117], v38, s[44:47], s65 offen offset:32
    v_cvt_pk_bf16_f32 v120, v120, v121
    v_cvt_pk_bf16_f32 v121, v122, v123
    buffer_store_dwordx2 v[120:121], v38, s[44:47], s65 offen offset:64
    v_cvt_pk_bf16_f32 v124, v124, v125
    v_cvt_pk_bf16_f32 v125, v126, v127
    buffer_store_dwordx2 v[124:125], v38, s[44:47], s65 offen offset:96
    s_endpgm
L_s4r_0:
    s_sub_u32 s88, s88, 1
    s_cmp_le_i32 s88, 0
    s_cbranch_scc1 L_s4ok_0
    s_sleep 1
    buffer_load_dwordx4 v[64:67], v2, s[48:51], s70 offen offset:0 sc1
    buffer_load_dwordx4 v[68:71], v2, s[48:51], s70 offen offset:1024 sc1
    buffer_load_dwordx4 v[80:83], v2, s[48:51], s71 offen offset:0 sc1
    buffer_load_dwordx4 v[84:87], v2, s[48:51], s71 offen offset:1024 sc1
    buffer_load_dwordx4 v[96:99], v2, s[48:51], s72 offen offset:0 sc1
    buffer_load_dwordx4 v[100:103], v2, s[48:51], s72 offen offset:1024 sc1
    s_waitcnt vmcnt(0)
    s_branch L_s4_0
L_s4r_1:
    s_sub_u32 s88, s88, 1
    s_cmp_le_i32 s88, 0
    s_cbranch_scc1 L_s4ok_1
    s_sleep 1
    buffer_load_dwordx4 v[80:83], v2, s[48:51], s71 offen offset:0 sc1
    buffer_load_dwordx4 v[84:87], v2, s[48:51], s71 offen offset:1024 sc1
    buffer_load_dwordx4 v[96:99], v2, s[48:51], s72 offen offset:0 sc1
    buffer_load_dwordx4 v[100:103], v2, s[48:51], s72 offen offset:1024 sc1
    s_waitcnt vmcnt(0)
    s_branch L_s4_1
L_s4r_2:
    s_sub_u32 s88, s88, 1
    s_cmp_le_i32 s88, 0
    s_cbranch_scc1 L_s4ok_2
    s_sleep 1
    buffer_load_dwordx4 v[96:99], v2, s[48:51], s72 offen offset:0 sc1
    buffer_load_dwordx4 v[100:103], v2, s[48:51], s72 offen offset:1024 sc1
    s_waitcnt vmcnt(0)
    s_branch L_s4_2
L_st_m:
    s_nop 7
    v_mov_b32 v132, v5
    v_mov_b32 v133, v5
    v_mov_b32 v134, v5
    v_mov_b32 v135, v5
    v_cndmask_b32 v128, v5, v128, s[4:5]
    v_cndmask_b32 v129, v5, v129, s[6:7]
    v_cndmask_b32 v130, v5, v130, s[56:57]
    v_cndmask_b32 v131, v5, v131, s[58:59]
    v_cndmask_b32 v140, v5, v140, s[4:5]
    v_cndmask_b32 v141, v5, v141, s[6:7]
    v_cndmask_b32 v142, v5, v142, s[56:57]
    v_cndmask_b32 v143, v5, v143, s[58:59]
    s_branch L_st_mr
L_ff_m:
    v_mov_b32 v180, v5
    v_mov_b32 v181, v5
    v_mov_b32 v182, v5
    v_mov_b32 v183, v5
    v_cndmask_b32 v176, v5, v176, s[4:5]
    v_cndmask_b32 v177, v5, v177, s[6:7]
    v_cndmask_b32 v178, v5, v178, s[56:57]
    v_cndmask_b32 v179, v5, v179, s[58:59]
    v_cndmask_b32 v188, v5, v188, s[4:5]
    v_cndmask_b32 v189, v5, v189, s[6:7]
    v_cndmask_b32 v190, v5, v190, s[56:57]
    v_cndmask_b32 v191, v5, v191, s[58:59]
    s_branch L_ff_mr
L_ffy_m:
    v_mov_b32 v160, v5
    v_mov_b32 v161, v5
    v_mov_b32 v162, v5
    v_mov_b32 v163, v5
    v_mov_b32 v164, v5
    v_mov_b32 v165, v5
    v_mov_b32 v166, v5
    v_mov_b32 v167, v5
    v_mov_b32 v168, v5
    v_mov_b32 v169, v5
    v_mov_b32 v170, v5
    v_mov_b32 v171, v5
    v_mov_b32 v172, v5
    v_mov_b32 v173, v5
    v_mov_b32 v174, v5
    v_mov_b32 v175, v5
    s_branch L_ffy_mr
L_b0_s:
    s_call_b64 s[90:91], L_slow0
    s_branch L_b0_sr
L_b1_s:
    s_call_b64 s[90:91], L_slow2
    s_branch L_b1_sr
L_l0_s:
    s_call_b64 s[90:91], L_slow0
    s_branch L_l0_sr
L_ev:
    buffer_load_dword v31, v15, s[52:55], 0 offen sc1
    s_getpc_b64 s[90:91]
L_pc2:
    s_sub_u32 s90, s90, L_pc2 - L_end34
    s_subb_u32 s91, s91, 0
    s_lshr_b32 s70, s2, 3
    s_lshl_b32 s70, s70, 2
    s_add_u32 s70, s70, s60
    s_mul_i32 s70, s70, 384
    v_min_u32 v244, 2, v1
    v_lshlrev_b32 v244, 7, v244
    v_add_u32 v244, s70, v244
    v_min_u32 v244, L_codeend - L_end34, v244
    global_load_dword v30, v244, s[90:91]
    s_branch L_evr
L_l1_s:
    s_call_b64 s[90:91], L_slow2
    s_branch L_l1_sr
L_d0_s:
    s_call_b64 s[90:91], L_slow0
    s_branch L_d0_sr
L_evd:
    buffer_load_dword v31, v15, s[52:55], 0 offen sc1
    s_getpc_b64 s[90:91]
L_pc2d:
    s_sub_u32 s90, s90, L_pc2d - L_end34
    s_subb_u32 s91, s91, 0
    s_lshr_b32 s70, s2, 3
    s_lshl_b32 s70, s70, 2
    s_add_u32 s70, s70, s60
    s_mul_i32 s70, s70, 384
    v_min_u32 v244, 2, v1
    v_lshlrev_b32 v244, 7, v244
    v_add_u32 v244, s70, v244
    v_min_u32 v244, L_codeend - L_end34, v244
    global_load_dword v30, v244, s[90:91]
    s_branch L_evrd
L_d1_s:
    s_call_b64 s[90:91], L_slow2
    s_branch L_d1_sr
L_e1x_s:
    s_call_b64 s[90:91], L_slow0
    s_branch L_e1x_sr
L_e1y_s:
    v_mov_b32 v144, v5
    v_mov_b32 v145, v5
    v_mov_b32 v146, v5
    v_mov_b32 v147, v5
    v_mov_b32 v148, v5
    v_mov_b32 v149, v5
    v_mov_b32 v150, v5
    v_mov_b32 v151, v5
    v_mov_b32 v152, v5
    v_mov_b32 v153, v5
    v_mov_b32 v154, v5
    v_mov_b32 v155, v5
    v_mov_b32 v156, v5
    v_mov_b32 v157, v5
    v_mov_b32 v158, v5
    v_mov_b32 v159, v5
    s_call_b64 s[90:91], L_slow2
    s_branch L_e1y_sr
L_e2x_s:
    s_call_b64 s[90:91], L_slow0
    s_branch L_e2x_sr
L_e2y_s:
    v_mov_b32 v144, v5
    v_mov_b32 v145, v5
    v_mov_b32 v146, v5
    v_mov_b32 v147, v5
    v_mov_b32 v148, v5
    v_mov_b32 v149, v5
    v_mov_b32 v150, v5
    v_mov_b32 v151, v5
    v_mov_b32 v152, v5
    v_mov_b32 v153, v5
    v_mov_b32 v154, v5
    v_mov_b32 v155, v5
    v_mov_b32 v156, v5
    v_mov_b32 v157, v5
    v_mov_b32 v158, v5
    v_mov_b32 v159, v5
    s_call_b64 s[90:91], L_slow2
    s_branch L_e2y_sr
L_s2a:
    s_mov_b32 s88, 65536
L_s2aw_t:
    v_cmp_le_u32 vcc, 32, v31
    s_cmp_eq_u64 vcc, exec
    s_cbranch_scc1 L_s2aw_ok
    s_sub_u32 s88, s88, 1
    s_cmp_eq_u32 s88, 0
    s_cbranch_scc1 L_s2aw_ok
    s_sleep 1
    buffer_load_dword v31, v15, s[52:55], 0 offen sc1
    s_waitcnt vmcnt(0)
    s_branch L_s2aw_t
L_s2aw_ok:
    s_add_u32 s69, s92, 253952
    s_add_u32 m0, s66, 65536
    s_nop 0
    buffer_load_dwordx4 v2, s[48:51], s69 offen offset:0 sc1 lds
    buffer_load_dwordx4 v2, s[48:51], s69 offen offset:1024 sc1 lds
    buffer_load_dwordx4 v2, s[48:51], s69 offen offset:2048 sc1 lds
    buffer_load_dwordx4 v2, s[48:51], s69 offen offset:3072 sc1 lds
    s_add_u32 s69, s92, 262144
    s_add_u32 m0, s66, 81920
    s_nop 0
    buffer_load_dwordx4 v2, s[48:51], s69 offen offset:0 sc1 lds
    buffer_load_dwordx4 v2, s[48:51], s69 offen offset:1024 sc1 lds
    buffer_load_dwordx4 v2, s[48:51], s69 offen offset:2048 sc1 lds
    buffer_load_dwordx4 v2, s[48:51], s69 offen offset:3072 sc1 lds
    s_add_u32 s69, s92, 270336
    s_add_u32 m0, s66, 98304
    s_nop 0
    buffer_load_dwordx4 v2, s[48:51], s69 offen offset:0 sc1 lds
    buffer_load_dwordx4 v2, s[48:51], s69 offen offset:1024 sc1 lds
    buffer_load_dwordx4 v2, s[48:51], s69 offen offset:2048 sc1 lds
    buffer_load_dwordx4 v2, s[48:51], s69 offen offset:3072 sc1 lds
    s_waitcnt vmcnt(0)
    s_branch L_s2ar
L_short:
    s_cmp_eq_u32 s75, 2
    s_cbranch_scc1 L_exit
    v_accvgpr_write_b32 a0, 0
    v_accvgpr_write_b32 a1, 0
    v_accvgpr_write_b32 a2, 0
    v_accvgpr_write_b32 a3, 0
    v_accvgpr_write_b32 a4, 0
    v_accvgpr_write_b32 a5, 0
    v_accvgpr_write_b32 a6, 0
    v_accvgpr_write_b32 a7, 0
    v_accvgpr_write_b32 a8, 0
    v_accvgpr_write_b32 a9, 0
    v_accvgpr_write_b32 a10, 0
    v_accvgpr_write_b32 a11, 0
    v_accvgpr_write_b32 a12, 0
    v_accvgpr_write_b32 a13, 0
    v_accvgpr_write_b32 a14, 0
    v_accvgpr_write_b32 a15, 0
    v_accvgpr_write_b32 a16, 0
    v_accvgpr_write_b32 a17, 0
    v_accvgpr_write_b32 a18, 0
    v_accvgpr_write_b32 a19, 0
    v_accvgpr_write_b32 a20, 0
    v_accvgpr_write_b32 a21, 0
    v_accvgpr_write_b32 a22, 0
    v_accvgpr_write_b32 a23, 0
    v_accvgpr_write_b32 a24, 0
    v_accvgpr_write_b32 a25, 0
    v_accvgpr_write_b32 a26, 0
    v_accvgpr_write_b32 a27, 0
    v_accvgpr_write_b32 a28, 0
    v_accvgpr_write_b32 a29, 0
    v_accvgpr_write_b32 a30, 0
    v_accvgpr_write_b32 a31, 0
    v_accvgpr_write_b32 a32, 0
    v_accvgpr_write_b32 a33, 0
    v_accvgpr_write_b32 a34, 0
    v_accvgpr_write_b32 a35, 0
    v_accvgpr_write_b32 a36, 0
    v_accvgpr_write_b32 a37, 0
    v_accvgpr_write_b32 a38, 0
    v_accvgpr_write_b32 a39, 0
    v_accvgpr_write_b32 a40, 0
    v_accvgpr_write_b32 a41, 0
    v_accvgpr_write_b32 a42, 0
    v_accvgpr_write_b32 a43, 0
    v_accvgpr_write_b32 a44, 0
    v_accvgpr_write_b32 a45, 0
    v_accvgpr_write_b32 a46, 0
    v_accvgpr_write_b32 a47, 0
    v_accvgpr_write_b32 a48, 0
    v_accvgpr_write_b32 a49, 0
    v_accvgpr_write_b32 a50, 0
    v_accvgpr_write_b32 a51, 0
    v_accvgpr_write_b32 a52, 0
    v_accvgpr_write_b32 a53, 0
    v_accvgpr_write_b32 a54, 0
    v_accvgpr_write_b32 a55, 0
    v_accvgpr_write_b32 a56, 0
    v_accvgpr_write_b32 a57, 0
    v_accvgpr_write_b32 a58, 0
    v_accvgpr_write_b32 a59, 0
    v_accvgpr_write_b32 a60, 0
    v_accvgpr_write_b32 a61, 0
    v_accvgpr_write_b32 a62, 0
    v_accvgpr_write_b32 a63, 0
    s_branch L_exit
L_sc_s:
    s_call_b64 s[90:91], L_slow0
    s_branch L_sc_sr
L_s2b:
    s_mov_b32 s88, 65536
L_s2bw_t:
    v_cmp_le_u32 vcc, 32, v31
    s_cmp_eq_u64 vcc, exec
    s_cbranch_scc1 L_s2bw_ok
    s_sub_u32 s88, s88, 1
    s_cmp_eq_u32 s88, 0
    s_cbranch_scc1 L_s2bw_ok
    s_sleep 1
    buffer_load_dword v31, v15, s[52:55], 0 offen sc1
    s_waitcnt vmcnt(0)
    s_branch L_s2bw_t
L_s2bw_ok:
    s_add_u32 s69, s92, 253952
    s_add_u32 m0, s66, 65536
    s_nop 0
    buffer_load_dwordx4 v2, s[48:51], s69 offen offset:0 sc1 lds
    buffer_load_dwordx4 v2, s[48:51], s69 offen offset:1024 sc1 lds
    buffer_load_dwordx4 v2, s[48:51], s69 offen offset:2048 sc1 lds
    buffer_load_dwordx4 v2, s[48:51], s69 offen offset:3072 sc1 lds
    s_add_u32 s69, s92, 262144
    s_add_u32 m0, s66, 81920
    s_nop 0
    buffer_load_dwordx4 v2, s[48:51], s69 offen offset:0 sc1 lds
    buffer_load_dwordx4 v2, s[48:51], s69 offen offset:1024 sc1 lds
    buffer_load_dwordx4 v2, s[48:51], s69 offen offset:2048 sc1 lds
    buffer_load_dwordx4 v2, s[48:51], s69 offen offset:3072 sc1 lds
    s_add_u32 s69, s92, 270336
    s_add_u32 m0, s66, 98304
    s_nop 0
    buffer_load_dwordx4 v2, s[48:51], s69 offen offset:0 sc1 lds
    buffer_load_dwordx4 v2, s[48:51], s69 offen offset:1024 sc1 lds
    buffer_load_dwordx4 v2, s[48:51], s69 offen offset:2048 sc1 lds
    buffer_load_dwordx4 v2, s[48:51], s69 offen offset:3072 sc1 lds
    s_waitcnt vmcnt(0)
    s_branch L_s2br
L_codeend:
L_slow0:
    s_nop 7
    v_max3_f32 v224, v128, v129, v130
    v_max3_f32 v224, v224, v131, v132
    v_max3_f32 v224, v224, v133, v134
    v_max_f32 v224, v224, v135
    v_max3_f32 v226, v160, v161, v162
    v_max3_f32 v226, v226, v163, v164
    v_max3_f32 v226, v226, v165, v166
    v_max_f32 v226, v226, v167
    v_max3_f32 v224, v224, v226, 0
    v_max3_f32 v225, v136, v137, v138
    v_max3_f32 v225, v225, v139, v140
    v_max3_f32 v225, v225, v141, v142
    v_max_f32 v225, v225, v143
    v_max3_f32 v227, v168, v169, v170
    v_max3_f32 v227, v227, v171, v172
    v_max3_f32 v227, v227, v173, v174
    v_max_f32 v227, v227, v175
    v_max3_f32 v225, v225, v227, 0
    v_mov_b32 v226, v224
    v_mov_b32 v227, v225
    s_nop 1
    v_permlane16_swap_b32 v224, v226
    v_permlane16_swap_b32 v225, v227
    v_max_f32 v224, v224, v226
    v_max_f32 v225, v225, v227
    v_mov_b32 v226, v224
    v_mov_b32 v227, v225
    s_nop 1
    v_permlane32_swap_b32 v224, v226
    v_permlane32_swap_b32 v225, v227
    v_max_f32 v224, v224, v226
    v_max_f32 v225, v225, v227
    v_sub_f32 v128, v128, v224
    v_sub_f32 v129, v129, v224
    v_sub_f32 v130, v130, v224
    v_sub_f32 v131, v131, v224
    v_sub_f32 v132, v132, v224
    v_sub_f32 v133, v133, v224
    v_sub_f32 v134, v134, v224
    v_sub_f32 v135, v135, v224
    v_sub_f32 v160, v160, v224
    v_sub_f32 v161, v161, v224
    v_sub_f32 v162, v162, v224
    v_sub_f32 v163, v163, v224
    v_sub_f32 v164, v164, v224
    v_sub_f32 v165, v165, v224
    v_sub_f32 v166, v166, v224
    v_sub_f32 v167, v167, v224
    v_sub_f32 v48, v48, v224
    v_sub_f32 v49, v49, v224
    v_sub_f32 v50, v50, v224
    v_sub_f32 v51, v51, v224
    v_sub_f32 v136, v136, v225
    v_sub_f32 v137, v137, v225
    v_sub_f32 v138, v138, v225
    v_sub_f32 v139, v139, v225
    v_sub_f32 v140, v140, v225
    v_sub_f32 v141, v141, v225
    v_sub_f32 v142, v142, v225
    v_sub_f32 v143, v143, v225
    v_sub_f32 v168, v168, v225
    v_sub_f32 v169, v169, v225
    v_sub_f32 v170, v170, v225
    v_sub_f32 v171, v171, v225
    v_sub_f32 v172, v172, v225
    v_sub_f32 v173, v173, v225
    v_sub_f32 v174, v174, v225
    v_sub_f32 v175, v175, v225
    v_sub_f32 v52, v52, v225
    v_sub_f32 v53, v53, v225
    v_sub_f32 v54, v54, v225
    v_sub_f32 v55, v55, v225
    v_exp_f32 v228, -v224
    v_exp_f32 v229, -v225
    s_nop 0
    v_mul_f32 v44, v44, v228
    v_accvgpr_read_b32 v232, a0
    v_accvgpr_read_b32 v233, a1
    v_accvgpr_read_b32 v234, a2
    v_accvgpr_read_b32 v235, a3
    v_accvgpr_read_b32 v236, a4
    v_accvgpr_read_b32 v237, a5
    v_accvgpr_read_b32 v238, a6
    v_accvgpr_read_b32 v239, a7
    v_mul_f32 v232, v232, v228
    v_mul_f32 v233, v233, v228
    v_mul_f32 v234, v234, v228
    v_mul_f32 v235, v235, v228
    v_mul_f32 v236, v236, v228
    v_mul_f32 v237, v237, v228
    v_mul_f32 v238, v238, v228
    v_mul_f32 v239, v239, v228
    v_accvgpr_write_b32 a0, v232
    v_accvgpr_write_b32 a1, v233
    v_accvgpr_write_b32 a2, v234
    v_accvgpr_write_b32 a3, v235
    v_accvgpr_write_b32 a4, v236
    v_accvgpr_write_b32 a5, v237
    v_accvgpr_write_b32 a6, v238
    v_accvgpr_write_b32 a7, v239
    v_accvgpr_read_b32 v232, a8
    v_accvgpr_read_b32 v233, a9
    v_accvgpr_read_b32 v234, a10
    v_accvgpr_read_b32 v235, a11
    v_accvgpr_read_b32 v236, a12
    v_accvgpr_read_b32 v237, a13
    v_accvgpr_read_b32 v238, a14
    v_accvgpr_read_b32 v239, a15
    v_mul_f32 v232, v232, v228
    v_mul_f32 v233, v233, v228
    v_mul_f32 v234, v234, v228
    v_mul_f32 v235, v235, v228
    v_mul_f32 v236, v236, v228
    v_mul_f32 v237, v237, v228
    v_mul_f32 v238, v238, v228
    v_mul_f32 v239, v239, v228
    v_accvgpr_write_b32 a8, v232
    v_accvgpr_write_b32 a9, v233
    v_accvgpr_write_b32 a10, v234
    v_accvgpr_write_b32 a11, v235
    v_accvgpr_write_b32 a12, v236
    v_accvgpr_write_b32 a13, v237
    v_accvgpr_write_b32 a14, v238
    v_accvgpr_write_b32 a15, v239
    v_accvgpr_read_b32 v232, a16
    v_accvgpr_read_b32 v233, a17
    v_accvgpr_read_b32 v234, a18
    v_accvgpr_read_b32 v235, a19
    v_accvgpr_read_b32 v236, a20
    v_accvgpr_read_b32 v237, a21
    v_accvgpr_read_b32 v238, a22
    v_accvgpr_read_b32 v239, a23
    v_mul_f32 v232, v232, v228
    v_mul_f32 v233, v233, v228
    v_mul_f32 v234, v234, v228
    v_mul_f32 v235, v235, v228
    v_mul_f32 v236, v236, v228
    v_mul_f32 v237, v237, v228
    v_mul_f32 v238, v238, v228
    v_mul_f32 v239, v239, v228
    v_accvgpr_write_b32 a16, v232
    v_accvgpr_write_b32 a17, v233
    v_accvgpr_write_b32 a18, v234
    v_accvgpr_write_b32 a19, v235
    v_accvgpr_write_b32 a20, v236
    v_accvgpr_write_b32 a21, v237
    v_accvgpr_write_b32 a22, v238
    v_accvgpr_write_b32 a23, v239
    v_accvgpr_read_b32 v232, a24
    v_accvgpr_read_b32 v233, a25
    v_accvgpr_read_b32 v234, a26
    v_accvgpr_read_b32 v235, a27
    v_accvgpr_read_b32 v236, a28
    v_accvgpr_read_b32 v237, a29
    v_accvgpr_read_b32 v238, a30
    v_accvgpr_read_b32 v239, a31
    v_mul_f32 v232, v232, v228
    v_mul_f32 v233, v233, v228
    v_mul_f32 v234, v234, v228
    v_mul_f32 v235, v235, v228
    v_mul_f32 v236, v236, v228
    v_mul_f32 v237, v237, v228
    v_mul_f32 v238, v238, v228
    v_mul_f32 v239, v239, v228
    v_accvgpr_write_b32 a24, v232
    v_accvgpr_write_b32 a25, v233
    v_accvgpr_write_b32 a26, v234
    v_accvgpr_write_b32 a27, v235
    v_accvgpr_write_b32 a28, v236
    v_accvgpr_write_b32 a29, v237
    v_accvgpr_write_b32 a30, v238
    v_accvgpr_write_b32 a31, v239
    v_mul_f32 v45, v45, v229
    v_accvgpr_read_b32 v232, a32
    v_accvgpr_read_b32 v233, a33
    v_accvgpr_read_b32 v234, a34
    v_accvgpr_read_b32 v235, a35
    v_accvgpr_read_b32 v236, a36
    v_accvgpr_read_b32 v237, a37
    v_accvgpr_read_b32 v238, a38
    v_accvgpr_read_b32 v239, a39
    v_mul_f32 v232, v232, v229
    v_mul_f32 v233, v233, v229
    v_mul_f32 v234, v234, v229
    v_mul_f32 v235, v235, v229
    v_mul_f32 v236, v236, v229
    v_mul_f32 v237, v237, v229
    v_mul_f32 v238, v238, v229
    v_mul_f32 v239, v239, v229
    v_accvgpr_write_b32 a32, v232
    v_accvgpr_write_b32 a33, v233
    v_accvgpr_write_b32 a34, v234
    v_accvgpr_write_b32 a35, v235
    v_accvgpr_write_b32 a36, v236
    v_accvgpr_write_b32 a37, v237
    v_accvgpr_write_b32 a38, v238
    v_accvgpr_write_b32 a39, v239
    v_accvgpr_read_b32 v232, a40
    v_accvgpr_read_b32 v233, a41
    v_accvgpr_read_b32 v234, a42
    v_accvgpr_read_b32 v235, a43
    v_accvgpr_read_b32 v236, a44
    v_accvgpr_read_b32 v237, a45
    v_accvgpr_read_b32 v238, a46
    v_accvgpr_read_b32 v239, a47
    v_mul_f32 v232, v232, v229
    v_mul_f32 v233, v233, v229
    v_mul_f32 v234, v234, v229
    v_mul_f32 v235, v235, v229
    v_mul_f32 v236, v236, v229
    v_mul_f32 v237, v237, v229
    v_mul_f32 v238, v238, v229
    v_mul_f32 v239, v239, v229
    v_accvgpr_write_b32 a40, v232
    v_accvgpr_write_b32 a41, v233
    v_accvgpr_write_b32 a42, v234
    v_accvgpr_write_b32 a43, v235
    v_accvgpr_write_b32 a44, v236
    v_accvgpr_write_b32 a45, v237
    v_accvgpr_write_b32 a46, v238
    v_accvgpr_write_b32 a47, v239
    v_accvgpr_read_b32 v232, a48
    v_accvgpr_read_b32 v233, a49
    v_accvgpr_read_b32 v234, a50
    v_accvgpr_read_b32 v235, a51
    v_accvgpr_read_b32 v236, a52
    v_accvgpr_read_b32 v237, a53
    v_accvgpr_read_b32 v238, a54
    v_accvgpr_read_b32 v239, a55
    v_mul_f32 v232, v232, v229
    v_mul_f32 v233, v233, v229
    v_mul_f32 v234, v234, v229
    v_mul_f32 v235, v235, v229
    v_mul_f32 v236, v236, v229
    v_mul_f32 v237, v237, v229
    v_mul_f32 v238, v238, v229
    v_mul_f32 v239, v239, v229
    v_accvgpr_write_b32 a48, v232
    v_accvgpr_write_b32 a49, v233
    v_accvgpr_write_b32 a50, v234
    v_accvgpr_write_b32 a51, v235
    v_accvgpr_write_b32 a52, v236
    v_accvgpr_write_b32 a53, v237
    v_accvgpr_write_b32 a54, v238
    v_accvgpr_write_b32 a55, v239
    v_accvgpr_read_b32 v232, a56
    v_accvgpr_read_b32 v233, a57
    v_accvgpr_read_b32 v234, a58
    v_accvgpr_read_b32 v235, a59
    v_accvgpr_read_b32 v236, a60
    v_accvgpr_read_b32 v237, a61
    v_accvgpr_read_b32 v238, a62
    v_accvgpr_read_b32 v239, a63
    v_mul_f32 v232, v232, v229
    v_mul_f32 v233, v233, v229
    v_mul_f32 v234, v234, v229
    v_mul_f32 v235, v235, v229
    v_mul_f32 v236, v236, v229
    v_mul_f32 v237, v237, v229
    v_mul_f32 v238, v238, v229
    v_mul_f32 v239, v239, v229
    v_accvgpr_write_b32 a56, v232
    v_accvgpr_write_b32 a57, v233
    v_accvgpr_write_b32 a58, v234
    v_accvgpr_write_b32 a59, v235
    v_accvgpr_write_b32 a60, v236
    v_accvgpr_write_b32 a61, v237
    v_accvgpr_write_b32 a62, v238
    v_accvgpr_write_b32 a63, v239
    v_exp_f32 v232, v128
    v_exp_f32 v233, v129
    v_exp_f32 v234, v130
    v_exp_f32 v235, v131
    v_exp_f32 v236, v132
    v_exp_f32 v237, v133
    v_exp_f32 v238, v134
    v_exp_f32 v239, v135
    v_add_f32 v40, v232, v233
    v_add_f32 v40, v40, v234
    v_add_f32 v40, v40, v235
    v_add_f32 v40, v40, v236
    v_add_f32 v40, v40, v237
    v_add_f32 v40, v40, v238
    v_add_f32 v40, v40, v239
    v_cvt_pk_bf16_f32 v192, v232, v233
    v_cvt_pk_bf16_f32 v193, v234, v235
    v_cvt_pk_bf16_f32 v194, v236, v237
    v_cvt_pk_bf16_f32 v195, v238, v239
    v_exp_f32 v232, v160
    v_exp_f32 v233, v161
    v_exp_f32 v234, v162
    v_exp_f32 v235, v163
    v_exp_f32 v236, v164
    v_exp_f32 v237, v165
    v_exp_f32 v238, v166
    v_exp_f32 v239, v167
    v_add_f32 v40, v40, v232
    v_add_f32 v40, v40, v233
    v_add_f32 v40, v40, v234
    v_add_f32 v40, v40, v235
    v_add_f32 v40, v40, v236
    v_add_f32 v40, v40, v237
    v_add_f32 v40, v40, v238
    v_add_f32 v40, v40, v239
    v_cvt_pk_bf16_f32 v208, v232, v233
    v_cvt_pk_bf16_f32 v209, v234, v235
    v_cvt_pk_bf16_f32 v210, v236, v237
    v_cvt_pk_bf16_f32 v211, v238, v239
    v_exp_f32 v232, v136
    v_exp_f32 v233, v137
    v_exp_f32 v234, v138
    v_exp_f32 v235, v139
    v_exp_f32 v236, v140
    v_exp_f32 v237, v141
    v_exp_f32 v238, v142
    v_exp_f32 v239, v143
    v_add_f32 v252, v232, v233
    v_add_f32 v252, v252, v234
    v_add_f32 v252, v252, v235
    v_add_f32 v252, v252, v236
    v_add_f32 v252, v252, v237
    v_add_f32 v252, v252, v238
    v_add_f32 v252, v252, v239
    v_cvt_pk_bf16_f32 v196, v232, v233
    v_cvt_pk_bf16_f32 v197, v234, v235
    v_cvt_pk_bf16_f32 v198, v236, v237
    v_cvt_pk_bf16_f32 v199, v238, v239
    v_exp_f32 v232, v168
    v_exp_f32 v233, v169
    v_exp_f32 v234, v170
    v_exp_f32 v235, v171
    v_exp_f32 v236, v172
    v_exp_f32 v237, v173
    v_exp_f32 v238, v174
    v_exp_f32 v239, v175
    v_add_f32 v252, v252, v232
    v_add_f32 v252, v252, v233
    v_add_f32 v252, v252, v234
    v_add_f32 v252, v252, v235
    v_add_f32 v252, v252, v236
    v_add_f32 v252, v252, v237
    v_add_f32 v252, v252, v238
    v_add_f32 v252, v252, v239
    v_cvt_pk_bf16_f32 v212, v232, v233
    v_cvt_pk_bf16_f32 v213, v234, v235
    v_cvt_pk_bf16_f32 v214, v236, v237
    v_cvt_pk_bf16_f32 v215, v238, v239
    s_nop 1
    s_setpc_b64 s[90:91]
L_slow2:
    s_nop 7
    v_max3_f32 v224, v144, v145, v146
    v_max3_f32 v224, v224, v147, v148
    v_max3_f32 v224, v224, v149, v150
    v_max_f32 v224, v224, v151
    v_max3_f32 v226, v176, v177, v178
    v_max3_f32 v226, v226, v179, v180
    v_max3_f32 v226, v226, v181, v182
    v_max_f32 v226, v226, v183
    v_max3_f32 v224, v224, v226, 0
    v_max3_f32 v225, v152, v153, v154
    v_max3_f32 v225, v225, v155, v156
    v_max3_f32 v225, v225, v157, v158
    v_max_f32 v225, v225, v159
    v_max3_f32 v227, v184, v185, v186
    v_max3_f32 v227, v227, v187, v188
    v_max3_f32 v227, v227, v189, v190
    v_max_f32 v227, v227, v191
    v_max3_f32 v225, v225, v227, 0
    v_mov_b32 v226, v224
    v_mov_b32 v227, v225
    s_nop 1
    v_permlane16_swap_b32 v224, v226
    v_permlane16_swap_b32 v225, v227
    v_max_f32 v224, v224, v226
    v_max_f32 v225, v225, v227
    v_mov_b32 v226, v224
    v_mov_b32 v227, v225
    s_nop 1
    v_permlane32_swap_b32 v224, v226
    v_permlane32_swap_b32 v225, v227
    v_max_f32 v224, v224, v226
    v_max_f32 v225, v225, v227
    v_sub_f32 v144, v144, v224
    v_sub_f32 v145, v145, v224
    v_sub_f32 v146, v146, v224
    v_sub_f32 v147, v147, v224
    v_sub_f32 v148, v148, v224
    v_sub_f32 v149, v149, v224
    v_sub_f32 v150, v150, v224
    v_sub_f32 v151, v151, v224
    v_sub_f32 v176, v176, v224
    v_sub_f32 v177, v177, v224
    v_sub_f32 v178, v178, v224
    v_sub_f32 v179, v179, v224
    v_sub_f32 v180, v180, v224
    v_sub_f32 v181, v181, v224
    v_sub_f32 v182, v182, v224
    v_sub_f32 v183, v183, v224
    v_sub_f32 v56, v56, v224
    v_sub_f32 v57, v57, v224
    v_sub_f32 v58, v58, v224
    v_sub_f32 v59, v59, v224
    v_sub_f32 v152, v152, v225
    v_sub_f32 v153, v153, v225
    v_sub_f32 v154, v154, v225
    v_sub_f32 v155, v155, v225
    v_sub_f32 v156, v156, v225
    v_sub_f32 v157, v157, v225
    v_sub_f32 v158, v158, v225
    v_sub_f32 v159, v159, v225
    v_sub_f32 v184, v184, v225
    v_sub_f32 v185, v185, v225
    v_sub_f32 v186, v186, v225
    v_sub_f32 v187, v187, v225
    v_sub_f32 v188, v188, v225
    v_sub_f32 v189, v189, v225
    v_sub_f32 v190, v190, v225
    v_sub_f32 v191, v191, v225
    v_sub_f32 v60, v60, v225
    v_sub_f32 v61, v61, v225
    v_sub_f32 v62, v62, v225
    v_sub_f32 v63, v63, v225
    v_exp_f32 v228, -v224
    v_exp_f32 v229, -v225
    s_nop 0
    v_mul_f32 v46, v46, v228
    v_accvgpr_read_b32 v232, a64
    v_accvgpr_read_b32 v233, a65
    v_accvgpr_read_b32 v234, a66
    v_accvgpr_read_b32 v235, a67
    v_accvgpr_read_b32 v236, a68
    v_accvgpr_read_b32 v237, a69
    v_accvgpr_read_b32 v238, a70
    v_accvgpr_read_b32 v239, a71
    v_mul_f32 v232, v232, v228
    v_mul_f32 v233, v233, v228
    v_mul_f32 v234, v234, v228
    v_mul_f32 v235, v235, v228
    v_mul_f32 v236, v236, v228
    v_mul_f32 v237, v237, v228
    v_mul_f32 v238, v238, v228
    v_mul_f32 v239, v239, v228
    v_accvgpr_write_b32 a64, v232
    v_accvgpr_write_b32 a65, v233
    v_accvgpr_write_b32 a66, v234
    v_accvgpr_write_b32 a67, v235
    v_accvgpr_write_b32 a68, v236
    v_accvgpr_write_b32 a69, v237
    v_accvgpr_write_b32 a70, v238
    v_accvgpr_write_b32 a71, v239
    v_accvgpr_read_b32 v232, a72
    v_accvgpr_read_b32 v233, a73
    v_accvgpr_read_b32 v234, a74
    v_accvgpr_read_b32 v235, a75
    v_accvgpr_read_b32 v236, a76
    v_accvgpr_read_b32 v237, a77
    v_accvgpr_read_b32 v238, a78
    v_accvgpr_read_b32 v239, a79
    v_mul_f32 v232, v232, v228
    v_mul_f32 v233, v233, v228
    v_mul_f32 v234, v234, v228
    v_mul_f32 v235, v235, v228
    v_mul_f32 v236, v236, v228
    v_mul_f32 v237, v237, v228
    v_mul_f32 v238, v238, v228
    v_mul_f32 v239, v239, v228
    v_accvgpr_write_b32 a72, v232
    v_accvgpr_write_b32 a73, v233
    v_accvgpr_write_b32 a74, v234
    v_accvgpr_write_b32 a75, v235
    v_accvgpr_write_b32 a76, v236
    v_accvgpr_write_b32 a77, v237
    v_accvgpr_write_b32 a78, v238
    v_accvgpr_write_b32 a79, v239
    v_accvgpr_read_b32 v232, a80
    v_accvgpr_read_b32 v233, a81
    v_accvgpr_read_b32 v234, a82
    v_accvgpr_read_b32 v235, a83
    v_accvgpr_read_b32 v236, a84
    v_accvgpr_read_b32 v237, a85
    v_accvgpr_read_b32 v238, a86
    v_accvgpr_read_b32 v239, a87
    v_mul_f32 v232, v232, v228
    v_mul_f32 v233, v233, v228
    v_mul_f32 v234, v234, v228
    v_mul_f32 v235, v235, v228
    v_mul_f32 v236, v236, v228
    v_mul_f32 v237, v237, v228
    v_mul_f32 v238, v238, v228
    v_mul_f32 v239, v239, v228
    v_accvgpr_write_b32 a80, v232
    v_accvgpr_write_b32 a81, v233
    v_accvgpr_write_b32 a82, v234
    v_accvgpr_write_b32 a83, v235
    v_accvgpr_write_b32 a84, v236
    v_accvgpr_write_b32 a85, v237
    v_accvgpr_write_b32 a86, v238
    v_accvgpr_write_b32 a87, v239
    v_accvgpr_read_b32 v232, a88
    v_accvgpr_read_b32 v233, a89
    v_accvgpr_read_b32 v234, a90
    v_accvgpr_read_b32 v235, a91
    v_accvgpr_read_b32 v236, a92
    v_accvgpr_read_b32 v237, a93
    v_accvgpr_read_b32 v238, a94
    v_accvgpr_read_b32 v239, a95
    v_mul_f32 v232, v232, v228
    v_mul_f32 v233, v233, v228
    v_mul_f32 v234, v234, v228
    v_mul_f32 v235, v235, v228
    v_mul_f32 v236, v236, v228
    v_mul_f32 v237, v237, v228
    v_mul_f32 v238, v238, v228
    v_mul_f32 v239, v239, v228
    v_accvgpr_write_b32 a88, v232
    v_accvgpr_write_b32 a89, v233
    v_accvgpr_write_b32 a90, v234
    v_accvgpr_write_b32 a91, v235
    v_accvgpr_write_b32 a92, v236
    v_accvgpr_write_b32 a93, v237
    v_accvgpr_write_b32 a94, v238
    v_accvgpr_write_b32 a95, v239
    v_mul_f32 v47, v47, v229
    v_accvgpr_read_b32 v232, a96
    v_accvgpr_read_b32 v233, a97
    v_accvgpr_read_b32 v234, a98
    v_accvgpr_read_b32 v235, a99
    v_accvgpr_read_b32 v236, a100
    v_accvgpr_read_b32 v237, a101
    v_accvgpr_read_b32 v238, a102
    v_accvgpr_read_b32 v239, a103
    v_mul_f32 v232, v232, v229
    v_mul_f32 v233, v233, v229
    v_mul_f32 v234, v234, v229
    v_mul_f32 v235, v235, v229
    v_mul_f32 v236, v236, v229
    v_mul_f32 v237, v237, v229
    v_mul_f32 v238, v238, v229
    v_mul_f32 v239, v239, v229
    v_accvgpr_write_b32 a96, v232
    v_accvgpr_write_b32 a97, v233
    v_accvgpr_write_b32 a98, v234
    v_accvgpr_write_b32 a99, v235
    v_accvgpr_write_b32 a100, v236
    v_accvgpr_write_b32 a101, v237
    v_accvgpr_write_b32 a102, v238
    v_accvgpr_write_b32 a103, v239
    v_accvgpr_read_b32 v232, a104
    v_accvgpr_read_b32 v233, a105
    v_accvgpr_read_b32 v234, a106
    v_accvgpr_read_b32 v235, a107
    v_accvgpr_read_b32 v236, a108
    v_accvgpr_read_b32 v237, a109
    v_accvgpr_read_b32 v238, a110
    v_accvgpr_read_b32 v239, a111
    v_mul_f32 v232, v232, v229
    v_mul_f32 v233, v233, v229
    v_mul_f32 v234, v234, v229
    v_mul_f32 v235, v235, v229
    v_mul_f32 v236, v236, v229
    v_mul_f32 v237, v237, v229
    v_mul_f32 v238, v238, v229
    v_mul_f32 v239, v239, v229
    v_accvgpr_write_b32 a104, v232
    v_accvgpr_write_b32 a105, v233
    v_accvgpr_write_b32 a106, v234
    v_accvgpr_write_b32 a107, v235
    v_accvgpr_write_b32 a108, v236
    v_accvgpr_write_b32 a109, v237
    v_accvgpr_write_b32 a110, v238
    v_accvgpr_write_b32 a111, v239
    v_accvgpr_read_b32 v232, a112
    v_accvgpr_read_b32 v233, a113
    v_accvgpr_read_b32 v234, a114
    v_accvgpr_read_b32 v235, a115
    v_accvgpr_read_b32 v236, a116
    v_accvgpr_read_b32 v237, a117
    v_accvgpr_read_b32 v238, a118
    v_accvgpr_read_b32 v239, a119
    v_mul_f32 v232, v232, v229
    v_mul_f32 v233, v233, v229
    v_mul_f32 v234, v234, v229
    v_mul_f32 v235, v235, v229
    v_mul_f32 v236, v236, v229
    v_mul_f32 v237, v237, v229
    v_mul_f32 v238, v238, v229
    v_mul_f32 v239, v239, v229
    v_accvgpr_write_b32 a112, v232
    v_accvgpr_write_b32 a113, v233
    v_accvgpr_write_b32 a114, v234
    v_accvgpr_write_b32 a115, v235
    v_accvgpr_write_b32 a116, v236
    v_accvgpr_write_b32 a117, v237
    v_accvgpr_write_b32 a118, v238
    v_accvgpr_write_b32 a119, v239
    v_accvgpr_read_b32 v232, a120
    v_accvgpr_read_b32 v233, a121
    v_accvgpr_read_b32 v234, a122
    v_accvgpr_read_b32 v235, a123
    v_accvgpr_read_b32 v236, a124
    v_accvgpr_read_b32 v237, a125
    v_accvgpr_read_b32 v238, a126
    v_accvgpr_read_b32 v239, a127
    v_mul_f32 v232, v232, v229
    v_mul_f32 v233, v233, v229
    v_mul_f32 v234, v234, v229
    v_mul_f32 v235, v235, v229
    v_mul_f32 v236, v236, v229
    v_mul_f32 v237, v237, v229
    v_mul_f32 v238, v238, v229
    v_mul_f32 v239, v239, v229
    v_accvgpr_write_b32 a120, v232
    v_accvgpr_write_b32 a121, v233
    v_accvgpr_write_b32 a122, v234
    v_accvgpr_write_b32 a123, v235
    v_accvgpr_write_b32 a124, v236
    v_accvgpr_write_b32 a125, v237
    v_accvgpr_write_b32 a126, v238
    v_accvgpr_write_b32 a127, v239
    v_exp_f32 v232, v144
    v_exp_f32 v233, v145
    v_exp_f32 v234, v146
    v_exp_f32 v235, v147
    v_exp_f32 v236, v148
    v_exp_f32 v237, v149
    v_exp_f32 v238, v150
    v_exp_f32 v239, v151
    v_add_f32 v42, v232, v233
    v_add_f32 v42, v42, v234
    v_add_f32 v42, v42, v235
    v_add_f32 v42, v42, v236
    v_add_f32 v42, v42, v237
    v_add_f32 v42, v42, v238
    v_add_f32 v42, v42, v239
    v_cvt_pk_bf16_f32 v200, v232, v233
    v_cvt_pk_bf16_f32 v201, v234, v235
    v_cvt_pk_bf16_f32 v202, v236, v237
    v_cvt_pk_bf16_f32 v203, v238, v239
    v_exp_f32 v232, v176
    v_exp_f32 v233, v177
    v_exp_f32 v234, v178
    v_exp_f32 v235, v179
    v_exp_f32 v236, v180
    v_exp_f32 v237, v181
    v_exp_f32 v238, v182
    v_exp_f32 v239, v183
    v_add_f32 v42, v42, v232
    v_add_f32 v42, v42, v233
    v_add_f32 v42, v42, v234
    v_add_f32 v42, v42, v235
    v_add_f32 v42, v42, v236
    v_add_f32 v42, v42, v237
    v_add_f32 v42, v42, v238
    v_add_f32 v42, v42, v239
    v_cvt_pk_bf16_f32 v216, v232, v233
    v_cvt_pk_bf16_f32 v217, v234, v235
    v_cvt_pk_bf16_f32 v218, v236, v237
    v_cvt_pk_bf16_f32 v219, v238, v239
    v_exp_f32 v232, v152
    v_exp_f32 v233, v153
    v_exp_f32 v234, v154
    v_exp_f32 v235, v155
    v_exp_f32 v236, v156
    v_exp_f32 v237, v157
    v_exp_f32 v238, v158
    v_exp_f32 v239, v159
    v_add_f32 v252, v232, v233
    v_add_f32 v252, v252, v234
    v_add_f32 v252, v252, v235
    v_add_f32 v252, v252, v236
    v_add_f32 v252, v252, v237
    v_add_f32 v252, v252, v238
    v_add_f32 v252, v252, v239
    v_cvt_pk_bf16_f32 v204, v232, v233
    v_cvt_pk_bf16_f32 v205, v234, v235
    v_cvt_pk_bf16_f32 v206, v236, v237
    v_cvt_pk_bf16_f32 v207, v238, v239
    v_exp_f32 v232, v184
    v_exp_f32 v233, v185
    v_exp_f32 v234, v186
    v_exp_f32 v235, v187
    v_exp_f32 v236, v188
    v_exp_f32 v237, v189
    v_exp_f32 v238, v190
    v_exp_f32 v239, v191
    v_add_f32 v252, v252, v232
    v_add_f32 v252, v252, v233
    v_add_f32 v252, v252, v234
    v_add_f32 v252, v252, v235
    v_add_f32 v252, v252, v236
    v_add_f32 v252, v252, v237
    v_add_f32 v252, v252, v238
    v_add_f32 v252, v252, v239
    v_cvt_pk_bf16_f32 v220, v232, v233
    v_cvt_pk_bf16_f32 v221, v234, v235
    v_cvt_pk_bf16_f32 v222, v236, v237
    v_cvt_pk_bf16_f32 v223, v238, v239
    s_nop 1
    s_setpc_b64 s[90:91]
.section .rodata,"a"
.p2align 6
.amdhsa_kernel gated_mix__compressed_kv_cla__dense_activation_mish__prompt_kernel
  .amdhsa_next_free_vgpr 512
  .amdhsa_next_free_sgpr 102
  .amdhsa_accum_offset 256
  .amdhsa_group_segment_fixed_size 0
  .amdhsa_kernarg_size 112
  .amdhsa_user_sgpr_count 2
  .amdhsa_user_sgpr_kernarg_segment_ptr 1
  .amdhsa_system_sgpr_workgroup_id_x 1
.end_amdhsa_kernel
```
